```python
import torch

def _softmax(x, axis=-1):
    return torch.softmax(x, dim=axis)
def _gelu(x):
    return torch.nn.functional.gelu(x, approximate="tanh")
def _silu(x):
    return torch.nn.functional.silu(x)
def _sigmoid(x):
    return torch.sigmoid(x)
def _layernorm(x, axis=-1, eps=1e-5):
    m = x.mean(dim=axis, keepdim=True)
    v = x.var(dim=axis, keepdim=True, unbiased=False)
    return (x - m) / torch.sqrt(v + eps)
def _scatter_add(tgt, idx, src, axis=0):
    return tgt.clone().index_add_(axis, idx, src)
def _segment_sum(src, seg, n):
    out = torch.zeros((n,) + src.shape[1:], dtype=src.dtype)
    return out.index_add_(0, seg, src)
def _pad(x, pw):
    flat = tuple(v for pair in reversed(pw) for v in pair)
    return torch.nn.functional.pad(x, flat)

kernel_name = 'concat_heads__mha_block_cached__gqa_block_cached__near_ridge'

def setup_inputs():

    _w = (lambda a: (lambda t: t.to(torch.bfloat16) if t.is_floating_point() else t)(torch.as_tensor(a)))
    def _A_setup():
        B, Sq, D = 8, 144, 640
        H, Sk, Dh = 32, 1024, 128
        return {
            "x": _w((lambda *s: torch.randn(*s, dtype=torch.bfloat16) * 0.8)(B, Sq, D)),
            "k_cache": _w((lambda *s: torch.randn(*s, dtype=torch.bfloat16) * 0.8)(B, H, Sk, Dh)),
            "v_cache": _w((lambda *s: torch.randn(*s, dtype=torch.bfloat16) * 0.05)(B, H, Sk, Dh)),
            "wq": _w((lambda *s: torch.randn(*s, dtype=torch.bfloat16) * 0.8)(D, H * Dh) * (D ** -0.5)),
            "wo": _w((lambda *s: torch.randn(*s, dtype=torch.bfloat16) * 0.05)(H * Dh, D) * ((H * Dh) ** -0.5)),
        }
    _A_in = _A_setup()

    def _B_setup():
        B, Sq, D = 8, 144, 640
        Hq, Hkv, Sk, Dh = 32, 32, 1024, 128
        assert Hq % Hkv == 0, (Hq, Hkv)
        return {
            "x": _w((lambda *s: torch.randn(*s, dtype=torch.bfloat16) * 0.8)(B, Sq, D)),
            "k_cache": _w((lambda *s: torch.randn(*s, dtype=torch.bfloat16) * 0.8)(B, Hkv, Sk, Dh)),
            "v_cache": _w((lambda *s: torch.randn(*s, dtype=torch.bfloat16) * 0.05)(B, Hkv, Sk, Dh)),
            "wq": _w((lambda *s: torch.randn(*s, dtype=torch.bfloat16) * 0.8)(D, Hq * Dh) * (D ** -0.5)),
            "wo": _w((lambda *s: torch.randn(*s, dtype=torch.bfloat16) * 0.05)(Hq * Dh, D) * ((Hq * Dh) ** -0.5)),
        }
    _B_in = _B_setup()

    return {
        "A_x": _A_in["x"],
        "A_k_cache": _A_in["k_cache"],
        "A_v_cache": _A_in["v_cache"],
        "A_wq": _A_in["wq"],
        "A_wo": _A_in["wo"],
        "B_x": _B_in["x"],
        "B_k_cache": _B_in["k_cache"],
        "B_v_cache": _B_in["v_cache"],
        "B_wq": _B_in["wq"],
        "B_wo": _B_in["wo"],
    }

def reference(A_x, A_k_cache, A_v_cache, A_wq, A_wo, B_x, B_k_cache, B_v_cache, B_wq, B_wo):
    def _A_ref(x, k_cache, v_cache, wq, wo):
        B, Sq, D = x.shape
        H, Dh = 32, 128
        q = (lambda x, *d: x.permute(*d))((x @ wq).reshape(B, Sq, H, Dh), 0, 2, 1, 3)
        scores = torch.einsum("bhqd,bhkd->bhqk", q, k_cache) * (Dh ** -0.5)
        p = _softmax(scores, axis=-1)
        o = torch.einsum("bhqk,bhkd->bhqd", p, v_cache)
        return (lambda x, *d: x.permute(*d))(o, 0, 2, 1, 3).reshape(B, Sq, H * Dh) @ wo

    def _B_ref(x, k_cache, v_cache, wq, wo):
        B, Sq, D = x.shape
        Hq, Dh = 32, 128
        Hkv = k_cache.shape[1]
        rep = Hq // Hkv
        q = (lambda x, *d: x.permute(*d))((x @ wq).reshape(B, Sq, Hq, Dh), 0, 2, 1, 3)
        k = (lambda x, n, axis: torch.repeat_interleave(x, n, dim=axis))(k_cache, rep, axis=1)
        v = (lambda x, n, axis: torch.repeat_interleave(x, n, dim=axis))(v_cache, rep, axis=1)
        scores = torch.einsum("bhqd,bhkd->bhqk", q, k) * (Dh ** -0.5)
        p = _softmax(scores, axis=-1)
        o = torch.einsum("bhqk,bhkd->bhqd", p, v)
        return (lambda x, *d: x.permute(*d))(o, 0, 2, 1, 3).reshape(B, Sq, Hq * Dh) @ wo

    a = _A_ref(A_x, A_k_cache, A_v_cache, A_wq, A_wo)
    b = _B_ref(B_x, B_k_cache, B_v_cache, B_wq, B_wo)
    return torch.concatenate([a, b], axis=-1)
```

```asm
; @launch grid=(256,1,1) block=(512,1,1) lds=163840
.amdgcn_target "amdgcn-amd-amdhsa--gfx950"
.text
.globl concat_heads__mha_block_cached__gqa_block_cached__near_ridge_kernel
.p2align 8
.type concat_heads__mha_block_cached__gqa_block_cached__near_ridge_kernel,@function
concat_heads__mha_block_cached__gqa_block_cached__near_ridge_kernel:
    s_cmp_ge_u32 s2, 256
    s_cbranch_scc1 K1_END
    s_load_dwordx8 s[32:39], s[0:1], 0
    s_load_dwordx8 s[40:47], s[0:1], 40
    s_load_dwordx2 s[48:49], s[0:1], 96
    s_load_dwordx2 s[88:89], s[0:1], 88
    v_and_b32 v245, 63, v0
    v_lshrrev_b32 v243, 6, v0
    s_nop 0
    v_readfirstlane_b32 s61, v243
    s_and_b32 s62, s2, 7
    s_lshr_b32 s63, s2, 3
    s_lshr_b32 s64, s62, 2
    s_bfe_u32 s65, s62, 65537
    s_and_b32 s62, s62, 1
    s_lshr_b32 s69, s63, 3
    s_and_b32 s63, s63, 7
    s_mov_b32 s84, s63
    s_mov_b32 s85, s69
    s_lshl_b32 s65, s65, 2
    s_add_u32 s65, s65, s69
    s_lshl_b32 s62, s62, 4
    s_add_u32 s62, s62, s63
    s_and_b32 s24, s61, 3
    s_lshr_b32 s26, s61, 2
    s_mov_b32 s70, s2
    s_waitcnt lgkmcnt(0)
    s_mov_b32 s90, 256
    s_mov_b32 s91, 131072
    s_cmp_eq_u32 s64, 0
    s_cselect_b64 s[32:33], s[32:33], s[40:41]
    s_cselect_b64 s[34:35], s[34:35], s[42:43]
    s_cselect_b64 s[36:37], s[36:37], s[44:45]
    s_cselect_b64 s[38:39], s[38:39], s[46:47]
    s_lshl_b32 s63, s26, 3
    s_add_u32 s63, s63, s62
    s_lshl_b32 s69, s63, 8
    s_add_u32 s12, s38, s69
    s_addc_u32 s13, s39, 0
    s_sub_u32 s14, 5242880, s69
    s_mov_b32 s15, 131072
    s_lshl_b32 s69, s62, 8
    s_add_u32 s80, s38, s69
    s_addc_u32 s81, s39, 0
    s_sub_u32 s82, 5242880, s69
    s_mov_b32 s83, 131072
    s_mul_i32 s69, s65, 184320
    s_add_u32 s16, s32, s69
    s_addc_u32 s17, s33, 0
    s_mov_b32 s18, 184320
    s_mov_b32 s19, 131072
    v_lshrrev_b32 v220, 4, v245
    v_and_b32 v221, 15, v245
    v_lshlrev_b32 v248, 4, v245
    v_and_b32 v243, 1, v220
    v_and_b32 v244, 2, v220
    v_lshl_or_b32 v243, v244, 1, v243
    v_xor_b32 v243, v221, v243
    v_lshlrev_b32 v243, 4, v243
    v_lshl_or_b32 v206, v220, 13, v243
    v_xor_b32 v207, 128, v206
    v_lshrrev_b32 v243, 3, v245
    v_and_b32 v244, 7, v245
    v_lshrrev_b32 v209, 1, v243
    v_xor_b32 v244, v244, v209
    v_lshlrev_b32 v244, 4, v244
    v_mul_u32_u24 v243, 1280, v243
    v_add_u32 v208, v243, v244
    v_xor_b32 v209, 64, v208
    s_lshl_b32 s61, s65, 5
    s_add_u32 s69, s61, s62
    s_lshl_b32 s69, s69, 18
    s_add_u32 s4, s34, s69
    s_addc_u32 s5, s35, 0
    s_mov_b32 s6, 2359296
    s_mov_b32 s7, 131072
    s_add_u32 s8, s36, s69
    s_addc_u32 s9, s37, 0
    s_mov_b32 s10, 2359296
    s_mov_b32 s11, 131072
    s_lshl_b32 s69, s64, 8
    s_add_u32 s69, s69, s61
    s_add_u32 s69, s69, s63
    s_mul_i32 s69, s69, 36864
    s_add_u32 s20, s48, s69
    s_addc_u32 s21, s49, 0
    s_mov_b32 s22, 36864
    s_mov_b32 s23, 131072
    s_mov_b32 s50, 1149239296
    v_xor_b32 v243, v221, v220
    v_lshlrev_b32 v243, 4, v243
    v_lshl_or_b32 v241, v220, 8, v243
    v_lshlrev_b32 v243, 1, v220
    v_xor_b32 v243, v221, v243
    v_lshlrev_b32 v243, 4, v243
    v_lshl_or_b32 v242, v220, 8, v243
    v_bfe_u32 v243, v245, 2, 2
    v_and_b32 v244, 3, v245
    v_and_b32 v210, 1, v243
    v_and_b32 v211, 2, v243
    v_lshl_or_b32 v210, v211, 1, v210
    v_and_b32 v211, 1, v220
    v_lshl_or_b32 v210, v211, 3, v210
    v_xor_b32 v210, v244, v210
    v_lshlrev_b32 v210, 4, v210
    v_lshl_add_u32 v211, v220, 3, v243
    v_lshl_or_b32 v210, v211, 8, v210
    v_and_b32 v211, 1, v244
    v_lshl_or_b32 v210, v211, 3, v210
    s_mov_b32 s30, 67584
    v_xor_b32 v212, 0, v210
    v_add_u32 v196, s30, v212
    v_xor_b32 v212, 8, v210
    v_add_u32 v197, s30, v212
    v_xor_b32 v212, 64, v210
    v_add_u32 v198, s30, v212
    v_xor_b32 v212, 72, v210
    v_add_u32 v199, s30, v212
    v_xor_b32 v212, 128, v210
    v_add_u32 v200, s30, v212
    v_xor_b32 v212, 136, v210
    v_add_u32 v201, s30, v212
    v_xor_b32 v212, 192, v210
    v_add_u32 v202, s30, v212
    v_xor_b32 v212, 200, v210
    v_add_u32 v203, s30, v212
    v_lshrrev_b32 v210, 1, v221
    v_xor_b32 v210, v210, v220
    v_lshlrev_b32 v210, 4, v210
    v_lshl_or_b32 v210, v221, 7, v210
    v_add_u32 v204, 49152, v210
    v_xor_b32 v210, 64, v210
    v_add_u32 v205, 49152, v210
    v_xor_b32 v210, v220, v221
    v_lshlrev_b32 v210, 4, v210
    v_lshl_or_b32 v210, v221, 8, v210
    v_xor_b32 v234, 0, v210
    v_xor_b32 v235, 64, v210
    v_xor_b32 v236, 128, v210
    v_xor_b32 v237, 192, v210
    v_lshl_add_u32 v210, v220, 2, v243
    v_and_b32 v211, 7, v210
    v_lshlrev_b32 v211, 1, v211
    v_lshrrev_b32 v212, 1, v244
    v_xor_b32 v211, v211, v212
    v_lshlrev_b32 v211, 4, v211
    v_lshl_or_b32 v210, v210, 8, v211
    v_and_b32 v211, 1, v244
    v_lshl_or_b32 v210, v211, 3, v210
    v_or_b32 v238, 16384, v210
    v_and_b32 v210, 1, v220
    v_cmp_eq_u32 s[54:55], 1, v210
    s_cmp_eq_u32 s24, 1
    s_cbranch_scc1 K1W1_START
    s_cmp_eq_u32 s24, 2
    s_cbranch_scc1 K1W2_START
    s_cmp_eq_u32 s24, 3
    s_cbranch_scc1 K1W3_START
    s_lshl_b32 s58, s26, 14
    s_add_u32 s58, s58, 18432
    s_lshl_b32 s30, s26, 3
    s_add_u32 s30, s30, 0
    s_lshl_b32 s59, s30, 10
    s_mul_i32 s60, s30, 10240
    s_cmp_eq_u32 s26, 0
    s_cselect_b64 vcc, -1, 0
    v_cndmask_b32 v246, v209, v208, vcc
    s_lshl_b32 s30, s26, 14
    s_add_u32 s30, s30, 53248
    v_add_u32 v196, s30, v196
    v_add_u32 v197, s30, v197
    v_add_u32 v198, s30, v198
    v_add_u32 v199, s30, v199
    v_add_u32 v200, s30, v200
    v_add_u32 v201, s30, v201
    v_add_u32 v202, s30, v202
    v_add_u32 v203, s30, v203
    v_add_u32 v204, 53248, v204
    v_add_u32 v205, 53248, v205
    s_cmp_eq_u32 s26, 0
    s_cbranch_scc0 K1W0_NN
    s_memrealtime s[94:95]
    s_waitcnt lgkmcnt(0)
    s_or_b32 s92, s94, 1
    v_mov_b32 v252, s92
    v_mov_b32 v253, 0
    v_mov_b32 v243, 0
    s_mov_b64 exec, 1
    buffer_atomic_cmpswap v[252:253], v243, s[88:91], 0 offen sc0
    s_mov_b64 exec, -1
K1W0_NN:
    s_mov_b32 s52, 0
    s_mov_b32 s53, 0
    s_mov_b32 s56, 102400
    s_add_u32 m0, s56, s58
    s_add_u32 s30, s52, 0
    buffer_load_dwordx4 v206, s[12:15], s30 offen offset:0 lds
    s_add_u32 s30, s52, 31744
    buffer_load_dwordx4 v206, s[12:15], s30 offen offset:1024 lds
    s_add_u32 s30, s52, 63488
    buffer_load_dwordx4 v207, s[12:15], s30 offen offset:2048 lds
    s_add_u32 s30, s52, 95232
    buffer_load_dwordx4 v207, s[12:15], s30 offen offset:3072 lds
    s_add_u32 m0, s56, s59
    s_add_u32 s30, s53, s60
    buffer_load_dwordx4 v208, s[16:19], s30 offen lds
    s_add_u32 s30, s30, 9216
    buffer_load_dwordx4 v209, s[16:19], s30 offen offset:1024 lds
    s_lshl_b32 s31, s26, 10
    s_add_u32 s31, s31, 16384
    s_add_u32 m0, s56, s31
    s_mul_i32 s31, s26, 10240
    s_add_u32 s31, s31, 163840
    s_add_u32 s30, s53, s31
    buffer_load_dwordx4 v246, s[16:19], s30 offen lds
    s_add_u32 s52, s52, 524288
    s_add_u32 s53, s53, 128
    s_mov_b32 s56, 0
    s_add_u32 m0, s56, s58
    s_add_u32 s30, s52, 0
    buffer_load_dwordx4 v206, s[12:15], s30 offen offset:0 lds
    s_add_u32 s30, s52, 31744
    buffer_load_dwordx4 v206, s[12:15], s30 offen offset:1024 lds
    s_add_u32 s30, s52, 63488
    buffer_load_dwordx4 v207, s[12:15], s30 offen offset:2048 lds
    s_add_u32 s30, s52, 95232
    buffer_load_dwordx4 v207, s[12:15], s30 offen offset:3072 lds
    s_add_u32 m0, s56, s59
    s_add_u32 s30, s53, s60
    buffer_load_dwordx4 v208, s[16:19], s30 offen lds
    s_add_u32 s30, s30, 9216
    buffer_load_dwordx4 v209, s[16:19], s30 offen offset:1024 lds
    s_lshl_b32 s31, s26, 10
    s_add_u32 s31, s31, 16384
    s_add_u32 m0, s56, s31
    s_mul_i32 s31, s26, 10240
    s_add_u32 s31, s31, 163840
    s_add_u32 s30, s53, s31
    buffer_load_dwordx4 v246, s[16:19], s30 offen lds
    s_add_u32 s52, s52, 524288
    s_add_u32 s53, s53, 128
    v_mov_b32 v0, 0
    v_mov_b32 v1, 0
    v_mov_b32 v2, 0
    v_mov_b32 v3, 0
    v_mov_b32 v4, 0
    v_mov_b32 v5, 0
    v_mov_b32 v6, 0
    v_mov_b32 v7, 0
    v_mov_b32 v8, 0
    v_mov_b32 v9, 0
    v_mov_b32 v10, 0
    v_mov_b32 v11, 0
    v_mov_b32 v12, 0
    v_mov_b32 v13, 0
    v_mov_b32 v14, 0
    v_mov_b32 v15, 0
    v_mov_b32 v16, 0
    v_mov_b32 v17, 0
    v_mov_b32 v18, 0
    v_mov_b32 v19, 0
    v_mov_b32 v20, 0
    v_mov_b32 v21, 0
    v_mov_b32 v22, 0
    v_mov_b32 v23, 0
    v_mov_b32 v24, 0
    v_mov_b32 v25, 0
    v_mov_b32 v26, 0
    v_mov_b32 v27, 0
    v_mov_b32 v28, 0
    v_mov_b32 v29, 0
    v_mov_b32 v30, 0
    v_mov_b32 v31, 0
    v_mov_b32 v32, 0
    v_mov_b32 v33, 0
    v_mov_b32 v34, 0
    v_mov_b32 v35, 0
    v_mov_b32 v36, 0
    v_mov_b32 v37, 0
    v_mov_b32 v38, 0
    v_mov_b32 v39, 0
    v_mov_b32 v40, 0
    v_mov_b32 v41, 0
    v_mov_b32 v42, 0
    v_mov_b32 v43, 0
    v_mov_b32 v44, 0
    v_mov_b32 v45, 0
    v_mov_b32 v46, 0
    v_mov_b32 v47, 0
    v_mov_b32 v48, 0
    v_mov_b32 v49, 0
    v_mov_b32 v50, 0
    v_mov_b32 v51, 0
    v_mov_b32 v52, 0
    v_mov_b32 v53, 0
    v_mov_b32 v54, 0
    v_mov_b32 v55, 0
    v_mov_b32 v56, 0
    v_mov_b32 v57, 0
    v_mov_b32 v58, 0
    v_mov_b32 v59, 0
    v_mov_b32 v60, 0
    v_mov_b32 v61, 0
    v_mov_b32 v62, 0
    v_mov_b32 v63, 0
    v_mov_b32 v64, 0
    v_mov_b32 v65, 0
    v_mov_b32 v66, 0
    v_mov_b32 v67, 0
    v_mov_b32 v68, 0
    v_mov_b32 v69, 0
    v_mov_b32 v70, 0
    v_mov_b32 v71, 0
    s_waitcnt vmcnt(7)
    s_barrier
    s_mov_b32 s56, 51200
    ds_read_b128 v[160:163], v204 offset:0
    ds_read_b128 v[164:167], v204 offset:2048
    ds_read_b128 v[168:171], v204 offset:16384
    ds_read_b64_tr_b16 v[96:97], v196 offset:0
    ds_read_b64_tr_b16 v[98:99], v196 offset:1024
    ds_read_b64_tr_b16 v[100:101], v197 offset:0
    ds_read_b64_tr_b16 v[102:103], v197 offset:1024
    ds_read_b64_tr_b16 v[104:105], v198 offset:0
    ds_read_b64_tr_b16 v[106:107], v198 offset:1024
    ds_read_b64_tr_b16 v[108:109], v199 offset:0
    ds_read_b64_tr_b16 v[110:111], v199 offset:1024
    ds_read_b64_tr_b16 v[112:113], v200 offset:0
    ds_read_b64_tr_b16 v[114:115], v200 offset:1024
    ds_read_b64_tr_b16 v[116:117], v201 offset:0
    ds_read_b64_tr_b16 v[118:119], v201 offset:1024
    ds_read_b64_tr_b16 v[120:121], v202 offset:0
    ds_read_b64_tr_b16 v[122:123], v202 offset:1024
    ds_read_b64_tr_b16 v[124:125], v203 offset:0
    ds_read_b64_tr_b16 v[126:127], v203 offset:1024
    ds_read_b128 v[172:175], v205 offset:0
    ds_read_b128 v[176:179], v205 offset:2048
    ds_read_b128 v[180:183], v205 offset:16384
    ds_read_b64_tr_b16 v[128:129], v196 offset:8192
    ds_read_b64_tr_b16 v[130:131], v196 offset:9216
    ds_read_b64_tr_b16 v[132:133], v197 offset:8192
    ds_read_b64_tr_b16 v[134:135], v197 offset:9216
    ds_read_b64_tr_b16 v[136:137], v198 offset:8192
    ds_read_b64_tr_b16 v[138:139], v198 offset:9216
    ds_read_b64_tr_b16 v[140:141], v199 offset:8192
    ds_read_b64_tr_b16 v[142:143], v199 offset:9216
    ds_read_b64_tr_b16 v[144:145], v200 offset:8192
    ds_read_b64_tr_b16 v[146:147], v200 offset:9216
    ds_read_b64_tr_b16 v[148:149], v201 offset:8192
    ds_read_b64_tr_b16 v[150:151], v201 offset:9216
    ds_read_b64_tr_b16 v[152:153], v202 offset:8192
    ds_read_b64_tr_b16 v[154:155], v202 offset:9216
    ds_read_b64_tr_b16 v[156:157], v203 offset:8192
    ds_read_b64_tr_b16 v[158:159], v203 offset:9216
    s_waitcnt lgkmcnt(15)
    v_mfma_f32_16x16x32_bf16 v[0:3], v[96:99], v[160:163], v[0:3]
    s_add_u32 m0, s56, s58
    s_add_u32 s30, s52, 0
    v_mfma_f32_16x16x32_bf16 v[32:35], v[96:99], v[164:167], v[32:35]
    buffer_load_dwordx4 v206, s[12:15], s30 offen offset:0 lds
    v_mfma_f32_16x16x32_bf16 v[64:67], v[96:99], v[168:171], v[64:67]
    s_add_u32 s30, s52, 31744
    v_mfma_f32_16x16x32_bf16 v[4:7], v[100:103], v[160:163], v[4:7]
    buffer_load_dwordx4 v206, s[12:15], s30 offen offset:1024 lds
    s_add_u32 s30, s52, 63488
    v_mfma_f32_16x16x32_bf16 v[36:39], v[100:103], v[164:167], v[36:39]
    buffer_load_dwordx4 v207, s[12:15], s30 offen offset:2048 lds
    v_mfma_f32_16x16x32_bf16 v[68:71], v[100:103], v[168:171], v[68:71]
    s_add_u32 s30, s52, 95232
    v_mfma_f32_16x16x32_bf16 v[8:11], v[104:107], v[160:163], v[8:11]
    buffer_load_dwordx4 v207, s[12:15], s30 offen offset:3072 lds
    v_mfma_f32_16x16x32_bf16 v[40:43], v[104:107], v[164:167], v[40:43]
    s_add_u32 m0, s56, s59
    s_add_u32 s30, s53, s60
    v_mfma_f32_16x16x32_bf16 v[12:15], v[108:111], v[160:163], v[12:15]
    buffer_load_dwordx4 v208, s[16:19], s30 offen lds
    v_mfma_f32_16x16x32_bf16 v[44:47], v[108:111], v[164:167], v[44:47]
    s_add_u32 s30, s30, 9216
    v_mfma_f32_16x16x32_bf16 v[16:19], v[112:115], v[160:163], v[16:19]
    buffer_load_dwordx4 v209, s[16:19], s30 offen offset:1024 lds
    s_lshl_b32 s31, s26, 10
    v_mfma_f32_16x16x32_bf16 v[48:51], v[112:115], v[164:167], v[48:51]
    s_add_u32 s31, s31, 16384
    v_mfma_f32_16x16x32_bf16 v[20:23], v[116:119], v[160:163], v[20:23]
    s_add_u32 m0, s56, s31
    v_mfma_f32_16x16x32_bf16 v[52:55], v[116:119], v[164:167], v[52:55]
    s_mul_i32 s31, s26, 10240
    v_mfma_f32_16x16x32_bf16 v[24:27], v[120:123], v[160:163], v[24:27]
    s_add_u32 s31, s31, 163840
    s_add_u32 s30, s53, s31
    v_mfma_f32_16x16x32_bf16 v[56:59], v[120:123], v[164:167], v[56:59]
    buffer_load_dwordx4 v246, s[16:19], s30 offen lds
    v_mfma_f32_16x16x32_bf16 v[28:31], v[124:127], v[160:163], v[28:31]
    s_add_u32 s52, s52, 524288
    v_mfma_f32_16x16x32_bf16 v[60:63], v[124:127], v[164:167], v[60:63]
    s_add_u32 s53, s53, 128
    s_waitcnt lgkmcnt(0)
    s_mov_b32 s51, 1
    s_mov_b32 s57, 4294864896
    v_add_u32 v196, s57, v196
    v_add_u32 v197, s57, v197
    v_add_u32 v198, s57, v198
    v_add_u32 v199, s57, v199
    v_add_u32 v200, s57, v200
    v_add_u32 v201, s57, v201
    v_add_u32 v202, s57, v202
    v_add_u32 v203, s57, v203
    v_add_u32 v204, s57, v204
    v_add_u32 v205, s57, v205
    s_mov_b32 s56, 102400
K1W0_P1:
    s_cmp_eq_u32 s51, 9
    s_cbranch_scc1 K1W0_P1a
    s_waitcnt vmcnt(7)
    s_branch K1W0_P1b
K1W0_P1a:
    s_waitcnt vmcnt(4)
K1W0_P1b:
    s_barrier
    s_cmp_le_u32 s51, 7
    s_cbranch_scc1 K1W0_P1c
    v_mfma_f32_16x16x32_bf16 v[0:3], v[128:131], v[172:175], v[0:3]
    ds_read_b128 v[160:163], v204 offset:0
    ds_read_b128 v[164:167], v204 offset:2048
    v_mfma_f32_16x16x32_bf16 v[32:35], v[128:131], v[176:179], v[32:35]
    ds_read_b128 v[168:171], v204 offset:16384
    v_mfma_f32_16x16x32_bf16 v[64:67], v[128:131], v[180:183], v[64:67]
    ds_read_b64_tr_b16 v[96:97], v196 offset:0
    v_mfma_f32_16x16x32_bf16 v[4:7], v[132:135], v[172:175], v[4:7]
    ds_read_b64_tr_b16 v[98:99], v196 offset:1024
    v_mfma_f32_16x16x32_bf16 v[36:39], v[132:135], v[176:179], v[36:39]
    ds_read_b64_tr_b16 v[100:101], v197 offset:0
    v_mfma_f32_16x16x32_bf16 v[68:71], v[132:135], v[180:183], v[68:71]
    ds_read_b64_tr_b16 v[102:103], v197 offset:1024
    v_mfma_f32_16x16x32_bf16 v[8:11], v[136:139], v[172:175], v[8:11]
    ds_read_b64_tr_b16 v[104:105], v198 offset:0
    v_mfma_f32_16x16x32_bf16 v[40:43], v[136:139], v[176:179], v[40:43]
    ds_read_b64_tr_b16 v[106:107], v198 offset:1024
    v_mfma_f32_16x16x32_bf16 v[12:15], v[140:143], v[172:175], v[12:15]
    ds_read_b64_tr_b16 v[108:109], v199 offset:0
    v_mfma_f32_16x16x32_bf16 v[44:47], v[140:143], v[176:179], v[44:47]
    ds_read_b64_tr_b16 v[110:111], v199 offset:1024
    v_mfma_f32_16x16x32_bf16 v[16:19], v[144:147], v[172:175], v[16:19]
    ds_read_b64_tr_b16 v[112:113], v200 offset:0
    v_mfma_f32_16x16x32_bf16 v[48:51], v[144:147], v[176:179], v[48:51]
    ds_read_b64_tr_b16 v[114:115], v200 offset:1024
    v_mfma_f32_16x16x32_bf16 v[20:23], v[148:151], v[172:175], v[20:23]
    ds_read_b64_tr_b16 v[116:117], v201 offset:0
    v_mfma_f32_16x16x32_bf16 v[52:55], v[148:151], v[176:179], v[52:55]
    ds_read_b64_tr_b16 v[118:119], v201 offset:1024
    v_mfma_f32_16x16x32_bf16 v[24:27], v[152:155], v[172:175], v[24:27]
    ds_read_b64_tr_b16 v[120:121], v202 offset:0
    v_mfma_f32_16x16x32_bf16 v[56:59], v[152:155], v[176:179], v[56:59]
    ds_read_b64_tr_b16 v[122:123], v202 offset:1024
    v_mfma_f32_16x16x32_bf16 v[28:31], v[156:159], v[172:175], v[28:31]
    ds_read_b64_tr_b16 v[124:125], v203 offset:0
    v_mfma_f32_16x16x32_bf16 v[60:63], v[156:159], v[176:179], v[60:63]
    ds_read_b64_tr_b16 v[126:127], v203 offset:1024
    s_cmp_eq_u32 s51, 8
    s_cbranch_scc0 K1W0_P1d
    s_lshl_b32 s31, s26, 13
    s_add_u32 s31, s31, 0
    v_xor_b32 v243, 0, v241
    v_xor_b32 v244, 64, v241
    s_mov_b32 m0, s31
    s_nop 0
    buffer_load_dwordx4 v243, s[4:7], s31 offen nt lds
    buffer_load_dwordx4 v244, s[4:7], s31 offen offset:1024 nt lds
    s_add_u32 s30, s31, 32768
    s_mov_b32 m0, s30
    v_xor_b32 v243, 128, v242
    buffer_load_dwordx4 v242, s[8:11], s31 offen nt lds
    buffer_load_dwordx4 v243, s[8:11], s31 offen offset:1024 nt lds
K1W0_P1d:
    s_waitcnt lgkmcnt(0)
    s_cmp_eq_u32 s51, 9
    s_cbranch_scc0 K1W0_P1t
    s_and_b32 s47, s2, 1
    s_load_dwordx2 s[72:73], s[0:1], 32
    s_load_dwordx2 s[74:75], s[0:1], 72
    s_waitcnt lgkmcnt(0)
    s_cmp_eq_u32 s64, 0
    s_cselect_b64 s[76:77], s[72:73], s[74:75]
    s_mov_b32 s78, 5242880
    s_mov_b32 s79, 131072
    s_lshl_b32 s30, s47, 11
    s_lshl_b32 s31, s26, 10
    s_add_u32 s30, s30, s31
    s_lshl_b32 s31, s85, 3
    s_add_u32 s31, s31, s84
    s_lshl_b32 s31, s31, 5
    s_add_u32 s30, s30, s31
    s_mul_i32 s30, s30, 1280
    v_lshlrev_b32 v243, 7, v245
    s_add_u32 s30, s30, 0
    buffer_load_dword v249, v243, s[76:79], s30 offen
    v_add_u32 v243, 8192, v243
    v_mov_b32 v244, 2147418112
    v_cmp_gt_u32 vcc, 16, v245
    s_nop 1
    v_cndmask_b32 v243, v244, v243, vcc
    buffer_load_dword v250, v243, s[76:79], s30 offen
K1W0_P1t:
    v_mfma_f32_16x16x32_bf16 v[0:3], v[96:99], v[160:163], v[0:3]
    ds_read_b128 v[172:175], v205 offset:0
    ds_read_b128 v[176:179], v205 offset:2048
    v_mfma_f32_16x16x32_bf16 v[32:35], v[96:99], v[164:167], v[32:35]
    ds_read_b128 v[180:183], v205 offset:16384
    v_mfma_f32_16x16x32_bf16 v[64:67], v[96:99], v[168:171], v[64:67]
    ds_read_b64_tr_b16 v[128:129], v196 offset:8192
    v_mfma_f32_16x16x32_bf16 v[4:7], v[100:103], v[160:163], v[4:7]
    ds_read_b64_tr_b16 v[130:131], v196 offset:9216
    v_mfma_f32_16x16x32_bf16 v[36:39], v[100:103], v[164:167], v[36:39]
    ds_read_b64_tr_b16 v[132:133], v197 offset:8192
    v_mfma_f32_16x16x32_bf16 v[68:71], v[100:103], v[168:171], v[68:71]
    ds_read_b64_tr_b16 v[134:135], v197 offset:9216
    v_mfma_f32_16x16x32_bf16 v[8:11], v[104:107], v[160:163], v[8:11]
    ds_read_b64_tr_b16 v[136:137], v198 offset:8192
    v_mfma_f32_16x16x32_bf16 v[40:43], v[104:107], v[164:167], v[40:43]
    ds_read_b64_tr_b16 v[138:139], v198 offset:9216
    v_mfma_f32_16x16x32_bf16 v[12:15], v[108:111], v[160:163], v[12:15]
    ds_read_b64_tr_b16 v[140:141], v199 offset:8192
    v_mfma_f32_16x16x32_bf16 v[44:47], v[108:111], v[164:167], v[44:47]
    ds_read_b64_tr_b16 v[142:143], v199 offset:9216
    v_mfma_f32_16x16x32_bf16 v[16:19], v[112:115], v[160:163], v[16:19]
    ds_read_b64_tr_b16 v[144:145], v200 offset:8192
    v_mfma_f32_16x16x32_bf16 v[48:51], v[112:115], v[164:167], v[48:51]
    ds_read_b64_tr_b16 v[146:147], v200 offset:9216
    v_mfma_f32_16x16x32_bf16 v[20:23], v[116:119], v[160:163], v[20:23]
    ds_read_b64_tr_b16 v[148:149], v201 offset:8192
    v_mfma_f32_16x16x32_bf16 v[52:55], v[116:119], v[164:167], v[52:55]
    ds_read_b64_tr_b16 v[150:151], v201 offset:9216
    v_mfma_f32_16x16x32_bf16 v[24:27], v[120:123], v[160:163], v[24:27]
    ds_read_b64_tr_b16 v[152:153], v202 offset:8192
    v_mfma_f32_16x16x32_bf16 v[56:59], v[120:123], v[164:167], v[56:59]
    ds_read_b64_tr_b16 v[154:155], v202 offset:9216
    v_mfma_f32_16x16x32_bf16 v[28:31], v[124:127], v[160:163], v[28:31]
    ds_read_b64_tr_b16 v[156:157], v203 offset:8192
    v_mfma_f32_16x16x32_bf16 v[60:63], v[124:127], v[164:167], v[60:63]
    ds_read_b64_tr_b16 v[158:159], v203 offset:9216
    s_branch K1W0_P1e
K1W0_P1c:
    v_mfma_f32_16x16x32_bf16 v[0:3], v[128:131], v[172:175], v[0:3]
    ds_read_b128 v[160:163], v204 offset:0
    ds_read_b128 v[164:167], v204 offset:2048
    v_mfma_f32_16x16x32_bf16 v[32:35], v[128:131], v[176:179], v[32:35]
    ds_read_b128 v[168:171], v204 offset:16384
    ds_read_b64_tr_b16 v[96:97], v196 offset:0
    v_mfma_f32_16x16x32_bf16 v[64:67], v[128:131], v[180:183], v[64:67]
    ds_read_b64_tr_b16 v[98:99], v196 offset:1024
    v_mfma_f32_16x16x32_bf16 v[4:7], v[132:135], v[172:175], v[4:7]
    ds_read_b64_tr_b16 v[100:101], v197 offset:0
    ds_read_b64_tr_b16 v[102:103], v197 offset:1024
    v_mfma_f32_16x16x32_bf16 v[36:39], v[132:135], v[176:179], v[36:39]
    ds_read_b64_tr_b16 v[104:105], v198 offset:0
    ds_read_b64_tr_b16 v[106:107], v198 offset:1024
    v_mfma_f32_16x16x32_bf16 v[68:71], v[132:135], v[180:183], v[68:71]
    ds_read_b64_tr_b16 v[108:109], v199 offset:0
    v_mfma_f32_16x16x32_bf16 v[8:11], v[136:139], v[172:175], v[8:11]
    ds_read_b64_tr_b16 v[110:111], v199 offset:1024
    ds_read_b64_tr_b16 v[112:113], v200 offset:0
    v_mfma_f32_16x16x32_bf16 v[40:43], v[136:139], v[176:179], v[40:43]
    ds_read_b64_tr_b16 v[114:115], v200 offset:1024
    ds_read_b64_tr_b16 v[116:117], v201 offset:0
    v_mfma_f32_16x16x32_bf16 v[12:15], v[140:143], v[172:175], v[12:15]
    ds_read_b64_tr_b16 v[118:119], v201 offset:1024
    v_mfma_f32_16x16x32_bf16 v[44:47], v[140:143], v[176:179], v[44:47]
    ds_read_b64_tr_b16 v[120:121], v202 offset:0
    ds_read_b64_tr_b16 v[122:123], v202 offset:1024
    v_mfma_f32_16x16x32_bf16 v[16:19], v[144:147], v[172:175], v[16:19]
    ds_read_b64_tr_b16 v[124:125], v203 offset:0
    ds_read_b64_tr_b16 v[126:127], v203 offset:1024
    v_mfma_f32_16x16x32_bf16 v[48:51], v[144:147], v[176:179], v[48:51]
    s_add_u32 m0, s56, s58
    v_mfma_f32_16x16x32_bf16 v[20:23], v[148:151], v[172:175], v[20:23]
    s_add_u32 s30, s52, 0
    buffer_load_dwordx4 v206, s[12:15], s30 offen offset:0 lds
    v_mfma_f32_16x16x32_bf16 v[52:55], v[148:151], v[176:179], v[52:55]
    s_add_u32 s30, s52, 31744
    buffer_load_dwordx4 v206, s[12:15], s30 offen offset:1024 lds
    v_mfma_f32_16x16x32_bf16 v[24:27], v[152:155], v[172:175], v[24:27]
    s_add_u32 s30, s52, 63488
    v_mfma_f32_16x16x32_bf16 v[56:59], v[152:155], v[176:179], v[56:59]
    buffer_load_dwordx4 v207, s[12:15], s30 offen offset:2048 lds
    s_add_u32 s30, s52, 95232
    v_mfma_f32_16x16x32_bf16 v[28:31], v[156:159], v[172:175], v[28:31]
    buffer_load_dwordx4 v207, s[12:15], s30 offen offset:3072 lds
    s_add_u32 m0, s56, s59
    v_mfma_f32_16x16x32_bf16 v[60:63], v[156:159], v[176:179], v[60:63]
    s_add_u32 s30, s53, s60
    s_waitcnt lgkmcnt(14)
    v_mfma_f32_16x16x32_bf16 v[0:3], v[96:99], v[160:163], v[0:3]
    ds_read_b128 v[172:175], v205 offset:0
    ds_read_b128 v[176:179], v205 offset:2048
    v_mfma_f32_16x16x32_bf16 v[32:35], v[96:99], v[164:167], v[32:35]
    ds_read_b128 v[180:183], v205 offset:16384
    ds_read_b64_tr_b16 v[128:129], v196 offset:8192
    v_mfma_f32_16x16x32_bf16 v[64:67], v[96:99], v[168:171], v[64:67]
    ds_read_b64_tr_b16 v[130:131], v196 offset:9216
    ds_read_b64_tr_b16 v[132:133], v197 offset:8192
    s_waitcnt lgkmcnt(15)
    v_mfma_f32_16x16x32_bf16 v[4:7], v[100:103], v[160:163], v[4:7]
    ds_read_b64_tr_b16 v[134:135], v197 offset:9216
    v_mfma_f32_16x16x32_bf16 v[36:39], v[100:103], v[164:167], v[36:39]
    ds_read_b64_tr_b16 v[136:137], v198 offset:8192
    ds_read_b64_tr_b16 v[138:139], v198 offset:9216
    v_mfma_f32_16x16x32_bf16 v[68:71], v[100:103], v[168:171], v[68:71]
    ds_read_b64_tr_b16 v[140:141], v199 offset:8192
    ds_read_b64_tr_b16 v[142:143], v199 offset:9216
    v_mfma_f32_16x16x32_bf16 v[8:11], v[104:107], v[160:163], v[8:11]
    ds_read_b64_tr_b16 v[144:145], v200 offset:8192
    ds_read_b64_tr_b16 v[146:147], v200 offset:9216
    v_mfma_f32_16x16x32_bf16 v[40:43], v[104:107], v[164:167], v[40:43]
    ds_read_b64_tr_b16 v[148:149], v201 offset:8192
    s_waitcnt lgkmcnt(15)
    v_mfma_f32_16x16x32_bf16 v[12:15], v[108:111], v[160:163], v[12:15]
    ds_read_b64_tr_b16 v[150:151], v201 offset:9216
    ds_read_b64_tr_b16 v[152:153], v202 offset:8192
    v_mfma_f32_16x16x32_bf16 v[44:47], v[108:111], v[164:167], v[44:47]
    ds_read_b64_tr_b16 v[154:155], v202 offset:9216
    ds_read_b64_tr_b16 v[156:157], v203 offset:8192
    v_mfma_f32_16x16x32_bf16 v[16:19], v[112:115], v[160:163], v[16:19]
    ds_read_b64_tr_b16 v[158:159], v203 offset:9216
    v_mfma_f32_16x16x32_bf16 v[48:51], v[112:115], v[164:167], v[48:51]
    buffer_load_dwordx4 v208, s[16:19], s30 offen lds
    s_add_u32 s30, s30, 9216
    v_mfma_f32_16x16x32_bf16 v[20:23], v[116:119], v[160:163], v[20:23]
    buffer_load_dwordx4 v209, s[16:19], s30 offen offset:1024 lds
    s_lshl_b32 s31, s26, 10
    v_mfma_f32_16x16x32_bf16 v[52:55], v[116:119], v[164:167], v[52:55]
    s_add_u32 s31, s31, 16384
    s_add_u32 m0, s56, s31
    v_mfma_f32_16x16x32_bf16 v[24:27], v[120:123], v[160:163], v[24:27]
    s_mul_i32 s31, s26, 10240
    v_mfma_f32_16x16x32_bf16 v[56:59], v[120:123], v[164:167], v[56:59]
    s_add_u32 s31, s31, 163840
    s_add_u32 s30, s53, s31
    s_waitcnt lgkmcnt(15)
    v_mfma_f32_16x16x32_bf16 v[28:31], v[124:127], v[160:163], v[28:31]
    buffer_load_dwordx4 v246, s[16:19], s30 offen lds
    s_add_u32 s52, s52, 524288
    v_mfma_f32_16x16x32_bf16 v[60:63], v[124:127], v[164:167], v[60:63]
    s_add_u32 s53, s53, 128
K1W0_P1e:
    s_waitcnt lgkmcnt(0)
    s_mul_i32 s30, s51, 43691
    s_lshr_b32 s30, s30, 17
    s_mul_i32 s30, s30, 3
    s_cmp_eq_u32 s51, s30
    s_mov_b32 s57, 51200
    s_cselect_b32 s57, 4294864896, s57
    v_add_u32 v196, s57, v196
    v_add_u32 v197, s57, v197
    v_add_u32 v198, s57, v198
    v_add_u32 v199, s57, v199
    v_add_u32 v200, s57, v200
    v_add_u32 v201, s57, v201
    v_add_u32 v202, s57, v202
    v_add_u32 v203, s57, v203
    v_add_u32 v204, s57, v204
    v_add_u32 v205, s57, v205
    s_add_u32 s56, s56, 51200
    s_cmp_eq_u32 s56, 153600
    s_cselect_b32 s56, 0, s56
    s_add_u32 s51, s51, 1
    s_cmp_lt_u32 s51, 10
    s_cbranch_scc1 K1W0_P1
    v_mfma_f32_16x16x32_bf16 v[0:3], v[128:131], v[172:175], v[0:3]
    v_mfma_f32_16x16x32_bf16 v[32:35], v[128:131], v[176:179], v[32:35]
    v_mfma_f32_16x16x32_bf16 v[64:67], v[128:131], v[180:183], v[64:67]
    v_mfma_f32_16x16x32_bf16 v[4:7], v[132:135], v[172:175], v[4:7]
    v_mfma_f32_16x16x32_bf16 v[36:39], v[132:135], v[176:179], v[36:39]
    v_mfma_f32_16x16x32_bf16 v[68:71], v[132:135], v[180:183], v[68:71]
    v_mfma_f32_16x16x32_bf16 v[8:11], v[136:139], v[172:175], v[8:11]
    v_mfma_f32_16x16x32_bf16 v[40:43], v[136:139], v[176:179], v[40:43]
    v_mfma_f32_16x16x32_bf16 v[12:15], v[140:143], v[172:175], v[12:15]
    v_mfma_f32_16x16x32_bf16 v[44:47], v[140:143], v[176:179], v[44:47]
    v_mfma_f32_16x16x32_bf16 v[16:19], v[144:147], v[172:175], v[16:19]
    v_mfma_f32_16x16x32_bf16 v[48:51], v[144:147], v[176:179], v[48:51]
    v_mfma_f32_16x16x32_bf16 v[20:23], v[148:151], v[172:175], v[20:23]
    v_mfma_f32_16x16x32_bf16 v[52:55], v[148:151], v[176:179], v[52:55]
    v_mfma_f32_16x16x32_bf16 v[24:27], v[152:155], v[172:175], v[24:27]
    v_mfma_f32_16x16x32_bf16 v[56:59], v[152:155], v[176:179], v[56:59]
    v_mfma_f32_16x16x32_bf16 v[28:31], v[156:159], v[172:175], v[28:31]
    v_mfma_f32_16x16x32_bf16 v[60:63], v[156:159], v[176:179], v[60:63]
    s_mov_b32 s30, 1040356334
    v_mul_f32 v64, s30, v64
    v_mul_f32 v65, s30, v65
    v_mul_f32 v66, s30, v66
    v_mul_f32 v67, s30, v67
    v_mul_f32 v68, s30, v68
    v_mul_f32 v69, s30, v69
    v_mul_f32 v70, s30, v70
    v_mul_f32 v71, s30, v71
    v_cvt_pk_bf16_f32 v212, v64, v65
    v_cvt_pk_bf16_f32 v213, v66, v67
    v_cvt_pk_bf16_f32 v214, v68, v69
    v_cvt_pk_bf16_f32 v215, v70, v71
    v_cndmask_b32 v216, v212, v214, s[54:55]
    v_cndmask_b32 v217, v213, v215, s[54:55]
    v_cndmask_b32 v218, v214, v212, s[54:55]
    v_cndmask_b32 v219, v215, v213, s[54:55]
    s_lshl_b32 s31, s26, 12
    s_add_u32 s31, s31, 153600
    v_add_u32 v246, s31, v248
    ds_write_b128 v246, v[216:219] offset:0
    v_mul_f32 v0, s30, v0
    v_mul_f32 v1, s30, v1
    v_mul_f32 v2, s30, v2
    v_mul_f32 v3, s30, v3
    v_mul_f32 v4, s30, v4
    v_mul_f32 v5, s30, v5
    v_mul_f32 v6, s30, v6
    v_mul_f32 v7, s30, v7
    v_cvt_pk_bf16_f32 v212, v0, v1
    v_cvt_pk_bf16_f32 v213, v2, v3
    v_cvt_pk_bf16_f32 v214, v4, v5
    v_cvt_pk_bf16_f32 v215, v6, v7
    v_cndmask_b32 v96, v212, v214, s[54:55]
    v_cndmask_b32 v97, v213, v215, s[54:55]
    v_cndmask_b32 v98, v214, v212, s[54:55]
    v_cndmask_b32 v99, v215, v213, s[54:55]
    v_mul_f32 v32, s30, v32
    v_mul_f32 v33, s30, v33
    v_mul_f32 v34, s30, v34
    v_mul_f32 v35, s30, v35
    v_mul_f32 v36, s30, v36
    v_mul_f32 v37, s30, v37
    v_mul_f32 v38, s30, v38
    v_mul_f32 v39, s30, v39
    v_cvt_pk_bf16_f32 v212, v32, v33
    v_cvt_pk_bf16_f32 v213, v34, v35
    v_cvt_pk_bf16_f32 v214, v36, v37
    v_cvt_pk_bf16_f32 v215, v38, v39
    v_cndmask_b32 v112, v212, v214, s[54:55]
    v_cndmask_b32 v113, v213, v215, s[54:55]
    v_cndmask_b32 v114, v214, v212, s[54:55]
    v_cndmask_b32 v115, v215, v213, s[54:55]
    v_mul_f32 v8, s30, v8
    v_mul_f32 v9, s30, v9
    v_mul_f32 v10, s30, v10
    v_mul_f32 v11, s30, v11
    v_mul_f32 v12, s30, v12
    v_mul_f32 v13, s30, v13
    v_mul_f32 v14, s30, v14
    v_mul_f32 v15, s30, v15
    v_cvt_pk_bf16_f32 v212, v8, v9
    v_cvt_pk_bf16_f32 v213, v10, v11
    v_cvt_pk_bf16_f32 v214, v12, v13
    v_cvt_pk_bf16_f32 v215, v14, v15
    v_cndmask_b32 v100, v212, v214, s[54:55]
    v_cndmask_b32 v101, v213, v215, s[54:55]
    v_cndmask_b32 v102, v214, v212, s[54:55]
    v_cndmask_b32 v103, v215, v213, s[54:55]
    v_mul_f32 v40, s30, v40
    v_mul_f32 v41, s30, v41
    v_mul_f32 v42, s30, v42
    v_mul_f32 v43, s30, v43
    v_mul_f32 v44, s30, v44
    v_mul_f32 v45, s30, v45
    v_mul_f32 v46, s30, v46
    v_mul_f32 v47, s30, v47
    v_cvt_pk_bf16_f32 v212, v40, v41
    v_cvt_pk_bf16_f32 v213, v42, v43
    v_cvt_pk_bf16_f32 v214, v44, v45
    v_cvt_pk_bf16_f32 v215, v46, v47
    v_cndmask_b32 v116, v212, v214, s[54:55]
    v_cndmask_b32 v117, v213, v215, s[54:55]
    v_cndmask_b32 v118, v214, v212, s[54:55]
    v_cndmask_b32 v119, v215, v213, s[54:55]
    v_mul_f32 v16, s30, v16
    v_mul_f32 v17, s30, v17
    v_mul_f32 v18, s30, v18
    v_mul_f32 v19, s30, v19
    v_mul_f32 v20, s30, v20
    v_mul_f32 v21, s30, v21
    v_mul_f32 v22, s30, v22
    v_mul_f32 v23, s30, v23
    v_cvt_pk_bf16_f32 v212, v16, v17
    v_cvt_pk_bf16_f32 v213, v18, v19
    v_cvt_pk_bf16_f32 v214, v20, v21
    v_cvt_pk_bf16_f32 v215, v22, v23
    v_cndmask_b32 v104, v212, v214, s[54:55]
    v_cndmask_b32 v105, v213, v215, s[54:55]
    v_cndmask_b32 v106, v214, v212, s[54:55]
    v_cndmask_b32 v107, v215, v213, s[54:55]
    v_mul_f32 v48, s30, v48
    v_mul_f32 v49, s30, v49
    v_mul_f32 v50, s30, v50
    v_mul_f32 v51, s30, v51
    v_mul_f32 v52, s30, v52
    v_mul_f32 v53, s30, v53
    v_mul_f32 v54, s30, v54
    v_mul_f32 v55, s30, v55
    v_cvt_pk_bf16_f32 v212, v48, v49
    v_cvt_pk_bf16_f32 v213, v50, v51
    v_cvt_pk_bf16_f32 v214, v52, v53
    v_cvt_pk_bf16_f32 v215, v54, v55
    v_cndmask_b32 v120, v212, v214, s[54:55]
    v_cndmask_b32 v121, v213, v215, s[54:55]
    v_cndmask_b32 v122, v214, v212, s[54:55]
    v_cndmask_b32 v123, v215, v213, s[54:55]
    v_mul_f32 v24, s30, v24
    v_mul_f32 v25, s30, v25
    v_mul_f32 v26, s30, v26
    v_mul_f32 v27, s30, v27
    v_mul_f32 v28, s30, v28
    v_mul_f32 v29, s30, v29
    v_mul_f32 v30, s30, v30
    v_mul_f32 v31, s30, v31
    v_cvt_pk_bf16_f32 v212, v24, v25
    v_cvt_pk_bf16_f32 v213, v26, v27
    v_cvt_pk_bf16_f32 v214, v28, v29
    v_cvt_pk_bf16_f32 v215, v30, v31
    v_cndmask_b32 v108, v212, v214, s[54:55]
    v_cndmask_b32 v109, v213, v215, s[54:55]
    v_cndmask_b32 v110, v214, v212, s[54:55]
    v_cndmask_b32 v111, v215, v213, s[54:55]
    v_mul_f32 v56, s30, v56
    v_mul_f32 v57, s30, v57
    v_mul_f32 v58, s30, v58
    v_mul_f32 v59, s30, v59
    v_mul_f32 v60, s30, v60
    v_mul_f32 v61, s30, v61
    v_mul_f32 v62, s30, v62
    v_mul_f32 v63, s30, v63
    v_cvt_pk_bf16_f32 v212, v56, v57
    v_cvt_pk_bf16_f32 v213, v58, v59
    v_cvt_pk_bf16_f32 v214, v60, v61
    v_cvt_pk_bf16_f32 v215, v62, v63
    v_cndmask_b32 v124, v212, v214, s[54:55]
    v_cndmask_b32 v125, v213, v215, s[54:55]
    v_cndmask_b32 v126, v214, v212, s[54:55]
    v_cndmask_b32 v127, v215, v213, s[54:55]
    s_waitcnt lgkmcnt(0)
    s_waitcnt vmcnt(2)
    s_barrier
    ds_read_b128 v[128:131], v246 offset:0
    ds_read_b128 v[132:135], v246 offset:1024
    ds_read_b128 v[136:139], v246 offset:2048
    ds_read_b128 v[140:143], v246 offset:3072
    v_mov_b32 v0, 0
    v_mov_b32 v1, 0
    v_mov_b32 v2, 0
    v_mov_b32 v3, 0
    v_mov_b32 v4, 0
    v_mov_b32 v5, 0
    v_mov_b32 v6, 0
    v_mov_b32 v7, 0
    v_mov_b32 v8, 0
    v_mov_b32 v9, 0
    v_mov_b32 v10, 0
    v_mov_b32 v11, 0
    v_mov_b32 v12, 0
    v_mov_b32 v13, 0
    v_mov_b32 v14, 0
    v_mov_b32 v15, 0
    v_mov_b32 v16, 0
    v_mov_b32 v17, 0
    v_mov_b32 v18, 0
    v_mov_b32 v19, 0
    v_mov_b32 v20, 0
    v_mov_b32 v21, 0
    v_mov_b32 v22, 0
    v_mov_b32 v23, 0
    v_mov_b32 v24, 0
    v_mov_b32 v25, 0
    v_mov_b32 v26, 0
    v_mov_b32 v27, 0
    v_mov_b32 v28, 0
    v_mov_b32 v29, 0
    v_mov_b32 v30, 0
    v_mov_b32 v31, 0
    v_mov_b32 v32, 0
    v_mov_b32 v33, 0
    v_mov_b32 v34, 0
    v_mov_b32 v35, 0
    v_mov_b32 v36, 0
    v_mov_b32 v37, 0
    v_mov_b32 v38, 0
    v_mov_b32 v39, 0
    v_mov_b32 v40, 0
    v_mov_b32 v41, 0
    v_mov_b32 v42, 0
    v_mov_b32 v43, 0
    v_mov_b32 v44, 0
    v_mov_b32 v45, 0
    v_mov_b32 v46, 0
    v_mov_b32 v47, 0
    v_mov_b32 v48, 0
    v_mov_b32 v49, 0
    v_mov_b32 v50, 0
    v_mov_b32 v51, 0
    v_mov_b32 v52, 0
    v_mov_b32 v53, 0
    v_mov_b32 v54, 0
    v_mov_b32 v55, 0
    v_mov_b32 v56, 0
    v_mov_b32 v57, 0
    v_mov_b32 v58, 0
    v_mov_b32 v59, 0
    v_mov_b32 v60, 0
    v_mov_b32 v61, 0
    v_mov_b32 v62, 0
    v_mov_b32 v63, 0
    v_mov_b32 v64, 0
    v_mov_b32 v65, 0
    v_mov_b32 v66, 0
    v_mov_b32 v67, 0
    v_mov_b32 v68, 0
    v_mov_b32 v69, 0
    v_mov_b32 v70, 0
    v_mov_b32 v71, 0
    v_mov_b32 v72, 0
    v_mov_b32 v73, 0
    v_mov_b32 v74, 0
    v_mov_b32 v75, 0
    v_mov_b32 v76, 0
    v_mov_b32 v77, 0
    v_mov_b32 v78, 0
    v_mov_b32 v79, 0
    v_mov_b32 v80, 0
    v_mov_b32 v81, 0
    v_mov_b32 v82, 0
    v_mov_b32 v83, 0
    v_mov_b32 v84, 0
    v_mov_b32 v85, 0
    v_mov_b32 v86, 0
    v_mov_b32 v87, 0
    v_mov_b32 v88, 0
    v_mov_b32 v89, 0
    v_mov_b32 v90, 0
    v_mov_b32 v91, 0
    v_mov_b32 v92, 0
    v_mov_b32 v93, 0
    v_mov_b32 v94, 0
    v_mov_b32 v95, 0
    v_mov_b32 v228, 0
    v_mov_b32 v229, 0
    v_mov_b32 v230, 0
    v_mov_b32 v180, 0
    v_mov_b32 v181, 0
    v_mov_b32 v182, 0
    v_mov_b32 v183, 0
    s_waitcnt lgkmcnt(0)
    s_cmp_eq_u32 s26, 0
    s_cselect_b32 s30, 2113536, 0
    s_add_u32 s31, s30, 16384
    v_add_u32 v241, s31, v241
    s_cmp_eq_u32 s26, 0
    s_cselect_b32 s30, 2097152, 0
    s_add_u32 s31, s30, 16384
    v_add_u32 v242, s31, v242
    s_mov_b32 s27, 0
    s_cmp_eq_u32 s26, 0
    s_cbranch_scc1 K1W0_RND
    s_mov_b32 s28, 16384
    s_mov_b32 m0, s28
    v_xor_b32 v243, 64, v241
    buffer_load_dwordx4 v241, s[4:7], 0 offen nt lds
    v_xor_b32 v244, 128, v241
    buffer_load_dwordx4 v243, s[4:7], 0 offen offset:1024 nt lds
    v_xor_b32 v243, 192, v241
    buffer_load_dwordx4 v244, s[4:7], 0 offen offset:2048 nt lds
    buffer_load_dwordx4 v243, s[4:7], 0 offen offset:3072 nt lds
    v_add_u32 v241, 16384, v241
K1W0_RND:
    v_add_u32 v238, 16384, v238
    s_mov_b32 s29, 65536
K1W0_ROUND:
    s_mov_b32 s25, 0
    s_cmp_eq_u32 s26, s27
    s_cbranch_scc0 K1W0_LDR
    s_mov_b32 s57, s27
    s_mul_i32 s30, s27, 16384
    v_add_u32 v234, s30, v234
    v_add_u32 v235, s30, v235
    v_add_u32 v236, s30, v236
    v_add_u32 v237, s30, v237
    s_nop 1
K1W0_LOOP:
    s_cmp_eq_u32 s25, 0
    s_cbranch_scc1 K1W0_A1a
    s_waitcnt vmcnt(0) lgkmcnt(0)
    s_barrier
    s_branch K1W0_A1b
K1W0_A1a:
    s_waitcnt vmcnt(8) lgkmcnt(0)
    s_barrier
    ds_read_b128 v[196:199], v234
    ds_read_b128 v[200:203], v235
    ds_read_b128 v[204:207], v236
    ds_read_b128 v[208:211], v237
    s_waitcnt lgkmcnt(3)
    v_mfma_f32_16x16x32_bf16 v[144:147], v[196:199], v[96:99], 0
    v_mfma_f32_16x16x32_bf16 v[160:163], v[196:199], v[112:115], 0
    s_waitcnt lgkmcnt(2)
    v_mfma_f32_16x16x32_bf16 v[144:147], v[200:203], v[100:103], v[144:147]
    v_mfma_f32_16x16x32_bf16 v[160:163], v[200:203], v[116:119], v[160:163]
    s_waitcnt lgkmcnt(1)
    v_mfma_f32_16x16x32_bf16 v[144:147], v[204:207], v[104:107], v[144:147]
    v_mfma_f32_16x16x32_bf16 v[160:163], v[204:207], v[120:123], v[160:163]
    s_waitcnt lgkmcnt(0)
    v_mfma_f32_16x16x32_bf16 v[144:147], v[208:211], v[108:111], v[144:147]
    v_mfma_f32_16x16x32_bf16 v[160:163], v[208:211], v[124:127], v[160:163]
    s_nop 6
    v_max3_f32 v243, v144, v145, v146
    v_max_f32 v243, v243, v147
    v_mov_b32 v244, v243
    s_nop 1
    v_permlane16_swap_b32 v244, v243
    v_max_f32 v243, v243, v244
    v_mov_b32 v244, v243
    s_nop 1
    v_permlane32_swap_b32 v244, v243
    v_max_f32 v243, v243, v244
    v_sub_f32 v184, 0, v243
    v_sub_f32 v185, 0, v243
    v_sub_f32 v186, 0, v243
    v_sub_f32 v187, 0, v243
    v_max3_f32 v243, v160, v161, v162
    v_max_f32 v243, v243, v163
    v_mov_b32 v244, v243
    s_nop 1
    v_permlane16_swap_b32 v244, v243
    v_max_f32 v243, v243, v244
    v_mov_b32 v244, v243
    s_nop 1
    v_permlane32_swap_b32 v244, v243
    v_max_f32 v243, v243, v244
    v_sub_f32 v188, 0, v243
    v_sub_f32 v189, 0, v243
    v_sub_f32 v190, 0, v243
    v_sub_f32 v191, 0, v243
    s_nop 3
K1W0_A1b:
    ds_read_b128 v[196:199], v234 offset:0
    ds_read_b128 v[200:203], v235 offset:0
    ds_read_b128 v[204:207], v236 offset:0
    ds_read_b128 v[208:211], v237 offset:0
    ds_read_b128 v[212:215], v234 offset:4096
    ds_read_b128 v[216:219], v235 offset:4096
    ds_read_b128 v[220:223], v236 offset:4096
    ds_read_b128 v[224:227], v237 offset:4096
    s_waitcnt lgkmcnt(7)
    v_mfma_f32_16x16x32_bf16 v[144:147], v[196:199], v[96:99], v[184:187]
    v_mfma_f32_16x16x32_bf16 v[160:163], v[196:199], v[112:115], v[188:191]
    s_waitcnt lgkmcnt(6)
    v_mfma_f32_16x16x32_bf16 v[144:147], v[200:203], v[100:103], v[144:147]
    v_mfma_f32_16x16x32_bf16 v[160:163], v[200:203], v[116:119], v[160:163]
    s_waitcnt lgkmcnt(5)
    v_mfma_f32_16x16x32_bf16 v[144:147], v[204:207], v[104:107], v[144:147]
    v_mfma_f32_16x16x32_bf16 v[160:163], v[204:207], v[120:123], v[160:163]
    s_waitcnt lgkmcnt(4)
    v_mfma_f32_16x16x32_bf16 v[144:147], v[208:211], v[108:111], v[144:147]
    v_mfma_f32_16x16x32_bf16 v[160:163], v[208:211], v[124:127], v[160:163]
    s_waitcnt lgkmcnt(3)
    v_mfma_f32_16x16x32_bf16 v[148:151], v[212:215], v[96:99], v[184:187]
    v_mfma_f32_16x16x32_bf16 v[164:167], v[212:215], v[112:115], v[188:191]
    ds_read_b128 v[196:199], v234 offset:8192
    ds_read_b128 v[200:203], v235 offset:8192
    s_waitcnt lgkmcnt(4)
    v_mfma_f32_16x16x32_bf16 v[148:151], v[216:219], v[100:103], v[148:151]
    ds_read_b128 v[204:207], v236 offset:8192
    ds_read_b128 v[208:211], v237 offset:8192
    v_mfma_f32_16x16x32_bf16 v[164:167], v[216:219], v[116:119], v[164:167]
    v_exp_f32 v144, v144
    v_exp_f32 v145, v145
    s_waitcnt lgkmcnt(5)
    v_mfma_f32_16x16x32_bf16 v[148:151], v[220:223], v[104:107], v[148:151]
    v_exp_f32 v146, v146
    v_mfma_f32_16x16x32_bf16 v[164:167], v[220:223], v[120:123], v[164:167]
    v_exp_f32 v147, v147
    v_exp_f32 v160, v160
    s_waitcnt lgkmcnt(4)
    v_mfma_f32_16x16x32_bf16 v[148:151], v[224:227], v[108:111], v[148:151]
    v_exp_f32 v161, v161
    v_exp_f32 v162, v162
    v_mfma_f32_16x16x32_bf16 v[164:167], v[224:227], v[124:127], v[164:167]
    v_exp_f32 v163, v163
    s_waitcnt lgkmcnt(3)
    v_mfma_f32_16x16x32_bf16 v[152:155], v[196:199], v[96:99], v[184:187]
    v_mfma_f32_16x16x32_bf16 v[168:171], v[196:199], v[112:115], v[188:191]
    ds_read_b128 v[212:215], v234 offset:12288
    ds_read_b128 v[216:219], v235 offset:12288
    ds_read_b128 v[220:223], v236 offset:12288
    s_waitcnt lgkmcnt(5)
    v_mfma_f32_16x16x32_bf16 v[152:155], v[200:203], v[100:103], v[152:155]
    ds_read_b128 v[224:227], v237 offset:12288
    v_exp_f32 v148, v148
    v_exp_f32 v149, v149
    v_mfma_f32_16x16x32_bf16 v[168:171], v[200:203], v[116:119], v[168:171]
    v_exp_f32 v150, v150
    v_exp_f32 v151, v151
    s_waitcnt lgkmcnt(5)
    v_mfma_f32_16x16x32_bf16 v[152:155], v[204:207], v[104:107], v[152:155]
    v_exp_f32 v164, v164
    v_exp_f32 v165, v165
    v_exp_f32 v166, v166
    v_mfma_f32_16x16x32_bf16 v[168:171], v[204:207], v[120:123], v[168:171]
    v_exp_f32 v167, v167
    v_add_f32 v231, v144, v145
    s_waitcnt lgkmcnt(4)
    v_mfma_f32_16x16x32_bf16 v[152:155], v[208:211], v[108:111], v[152:155]
    v_add_f32 v231, v231, v146
    v_add_f32 v231, v231, v147
    v_add_f32 v232, v160, v161
    v_mfma_f32_16x16x32_bf16 v[168:171], v[208:211], v[124:127], v[168:171]
    v_add_f32 v232, v232, v162
    v_add_f32 v232, v232, v163
    s_waitcnt lgkmcnt(3)
    v_mfma_f32_16x16x32_bf16 v[156:159], v[212:215], v[96:99], v[184:187]
    v_add_f32 v231, v231, v148
    v_add_f32 v231, v231, v149
    v_mfma_f32_16x16x32_bf16 v[172:175], v[212:215], v[112:115], v[188:191]
    v_add_f32 v231, v231, v150
    v_add_f32 v231, v231, v151
    s_waitcnt lgkmcnt(2)
    v_mfma_f32_16x16x32_bf16 v[156:159], v[216:219], v[100:103], v[156:159]
    v_add_f32 v232, v232, v164
    v_add_f32 v232, v232, v165
    v_mfma_f32_16x16x32_bf16 v[172:175], v[216:219], v[116:119], v[172:175]
    v_add_f32 v232, v232, v166
    v_add_f32 v232, v232, v167
    s_waitcnt lgkmcnt(1)
    v_mfma_f32_16x16x32_bf16 v[156:159], v[220:223], v[104:107], v[156:159]
    v_cvt_pk_bf16_f32 v144, v144, v145
    v_cvt_pk_bf16_f32 v145, v146, v147
    v_mfma_f32_16x16x32_bf16 v[172:175], v[220:223], v[120:123], v[172:175]
    v_cvt_pk_bf16_f32 v146, v148, v149
    v_cvt_pk_bf16_f32 v147, v150, v151
    s_waitcnt lgkmcnt(0)
    v_mfma_f32_16x16x32_bf16 v[156:159], v[224:227], v[108:111], v[156:159]
    v_cvt_pk_bf16_f32 v160, v160, v161
    v_cvt_pk_bf16_f32 v161, v162, v163
    v_mfma_f32_16x16x32_bf16 v[172:175], v[224:227], v[124:127], v[172:175]
    v_cvt_pk_bf16_f32 v162, v164, v165
    v_cvt_pk_bf16_f32 v163, v166, v167
    v_add_f32 v243, v231, v232
    v_cmp_ngt_f32 vcc, s50, v243
    s_cbranch_vccnz K1W0_slow0
K1W0_back0:
    v_add_f32 v228, v228, v231
    v_add_f32 v229, v229, v232
    v_exp_f32 v152, v152
    v_exp_f32 v153, v153
    v_exp_f32 v154, v154
    v_exp_f32 v155, v155
    v_exp_f32 v168, v168
    v_exp_f32 v169, v169
    v_exp_f32 v170, v170
    v_exp_f32 v171, v171
    v_add_f32 v231, v152, v153
    v_add_f32 v231, v231, v154
    v_add_f32 v231, v231, v155
    v_add_f32 v232, v168, v169
    v_add_f32 v232, v232, v170
    v_add_f32 v232, v232, v171
    s_cmp_eq_u32 s25, 0
    s_cbranch_scc1 K1W0_A2a
    s_waitcnt vmcnt(0) lgkmcnt(0)
    s_branch K1W0_A2b
K1W0_A2a:
    s_waitcnt vmcnt(4) lgkmcnt(0)
K1W0_A2b:
    s_barrier
    ds_read_b64_tr_b16 v[196:197], v238 offset:0
    ds_read_b64_tr_b16 v[198:199], v238 offset:4096
    v_xor_b32 v240, 32, v238
    ds_read_b64_tr_b16 v[200:201], v240 offset:0
    ds_read_b64_tr_b16 v[202:203], v240 offset:4096
    v_xor_b32 v239, 64, v238
    ds_read_b64_tr_b16 v[204:205], v239 offset:0
    ds_read_b64_tr_b16 v[206:207], v239 offset:4096
    v_xor_b32 v240, 96, v238
    ds_read_b64_tr_b16 v[208:209], v240 offset:0
    ds_read_b64_tr_b16 v[210:211], v240 offset:4096
    v_xor_b32 v239, 128, v238
    ds_read_b64_tr_b16 v[212:213], v239 offset:0
    ds_read_b64_tr_b16 v[214:215], v239 offset:4096
    v_xor_b32 v240, 160, v238
    ds_read_b64_tr_b16 v[216:217], v240 offset:0
    ds_read_b64_tr_b16 v[218:219], v240 offset:4096
    v_xor_b32 v239, 192, v238
    ds_read_b64_tr_b16 v[220:221], v239 offset:0
    ds_read_b64_tr_b16 v[222:223], v239 offset:4096
    v_xor_b32 v240, 224, v238
    ds_read_b64_tr_b16 v[224:225], v240 offset:0
    ds_read_b64_tr_b16 v[226:227], v240 offset:4096
    s_waitcnt lgkmcnt(14)
    v_mfma_f32_16x16x32_bf16 v[0:3], v[196:199], v[144:147], v[0:3]
    v_exp_f32 v156, v156
    v_exp_f32 v157, v157
    v_mfma_f32_16x16x32_bf16 v[32:35], v[196:199], v[160:163], v[32:35]
    v_exp_f32 v158, v158
    ds_read_b64_tr_b16 v[196:197], v238 offset:8192
    ds_read_b64_tr_b16 v[198:199], v238 offset:12288
    s_waitcnt lgkmcnt(14)
    v_mfma_f32_16x16x32_bf16 v[4:7], v[200:203], v[144:147], v[4:7]
    v_exp_f32 v159, v159
    v_exp_f32 v172, v172
    v_mfma_f32_16x16x32_bf16 v[36:39], v[200:203], v[160:163], v[36:39]
    v_exp_f32 v173, v173
    v_xor_b32 v240, 32, v238
    ds_read_b64_tr_b16 v[200:201], v240 offset:8192
    ds_read_b64_tr_b16 v[202:203], v240 offset:12288
    s_waitcnt lgkmcnt(14)
    v_mfma_f32_16x16x32_bf16 v[8:11], v[204:207], v[144:147], v[8:11]
    v_exp_f32 v174, v174
    v_exp_f32 v175, v175
    v_mfma_f32_16x16x32_bf16 v[40:43], v[204:207], v[160:163], v[40:43]
    v_add_f32 v231, v231, v156
    v_xor_b32 v239, 64, v238
    ds_read_b64_tr_b16 v[204:205], v239 offset:8192
    ds_read_b64_tr_b16 v[206:207], v239 offset:12288
    s_waitcnt lgkmcnt(14)
    v_mfma_f32_16x16x32_bf16 v[12:15], v[208:211], v[144:147], v[12:15]
    v_add_f32 v231, v231, v157
    v_add_f32 v231, v231, v158
    v_mfma_f32_16x16x32_bf16 v[44:47], v[208:211], v[160:163], v[44:47]
    v_add_f32 v231, v231, v159
    v_xor_b32 v240, 96, v238
    ds_read_b64_tr_b16 v[208:209], v240 offset:8192
    ds_read_b64_tr_b16 v[210:211], v240 offset:12288
    s_waitcnt lgkmcnt(14)
    v_mfma_f32_16x16x32_bf16 v[16:19], v[212:215], v[144:147], v[16:19]
    v_add_f32 v232, v232, v172
    v_add_f32 v232, v232, v173
    v_mfma_f32_16x16x32_bf16 v[48:51], v[212:215], v[160:163], v[48:51]
    v_add_f32 v232, v232, v174
    v_xor_b32 v239, 128, v238
    ds_read_b64_tr_b16 v[212:213], v239 offset:8192
    ds_read_b64_tr_b16 v[214:215], v239 offset:12288
    s_waitcnt lgkmcnt(14)
    v_mfma_f32_16x16x32_bf16 v[20:23], v[216:219], v[144:147], v[20:23]
    v_add_f32 v232, v232, v175
    v_cvt_pk_bf16_f32 v148, v152, v153
    v_mfma_f32_16x16x32_bf16 v[52:55], v[216:219], v[160:163], v[52:55]
    v_cvt_pk_bf16_f32 v149, v154, v155
    v_xor_b32 v240, 160, v238
    ds_read_b64_tr_b16 v[216:217], v240 offset:8192
    ds_read_b64_tr_b16 v[218:219], v240 offset:12288
    s_waitcnt lgkmcnt(14)
    v_mfma_f32_16x16x32_bf16 v[24:27], v[220:223], v[144:147], v[24:27]
    v_cvt_pk_bf16_f32 v150, v156, v157
    v_cvt_pk_bf16_f32 v151, v158, v159
    v_mfma_f32_16x16x32_bf16 v[56:59], v[220:223], v[160:163], v[56:59]
    v_cvt_pk_bf16_f32 v164, v168, v169
    v_xor_b32 v239, 192, v238
    ds_read_b64_tr_b16 v[220:221], v239 offset:8192
    ds_read_b64_tr_b16 v[222:223], v239 offset:12288
    s_waitcnt lgkmcnt(14)
    v_mfma_f32_16x16x32_bf16 v[28:31], v[224:227], v[144:147], v[28:31]
    v_cvt_pk_bf16_f32 v165, v170, v171
    v_cvt_pk_bf16_f32 v166, v172, v173
    v_mfma_f32_16x16x32_bf16 v[60:63], v[224:227], v[160:163], v[60:63]
    v_cvt_pk_bf16_f32 v167, v174, v175
    v_xor_b32 v240, 224, v238
    ds_read_b64_tr_b16 v[224:225], v240 offset:8192
    ds_read_b64_tr_b16 v[226:227], v240 offset:12288
    v_add_f32 v243, v231, v232
    v_cmp_ngt_f32 vcc, s50, v243
    s_cbranch_vccnz K1W0_slow1
K1W0_back1:
    v_add_f32 v228, v228, v231
    v_add_f32 v229, v229, v232
    s_waitcnt lgkmcnt(14)
    v_mfma_f32_16x16x32_bf16 v[0:3], v[196:199], v[148:151], v[0:3]
    v_mfma_f32_16x16x32_bf16 v[32:35], v[196:199], v[164:167], v[32:35]
    s_waitcnt lgkmcnt(12)
    v_mfma_f32_16x16x32_bf16 v[4:7], v[200:203], v[148:151], v[4:7]
    v_mfma_f32_16x16x32_bf16 v[36:39], v[200:203], v[164:167], v[36:39]
    s_waitcnt lgkmcnt(10)
    v_mfma_f32_16x16x32_bf16 v[8:11], v[204:207], v[148:151], v[8:11]
    v_mfma_f32_16x16x32_bf16 v[40:43], v[204:207], v[164:167], v[40:43]
    s_waitcnt lgkmcnt(8)
    v_mfma_f32_16x16x32_bf16 v[12:15], v[208:211], v[148:151], v[12:15]
    v_mfma_f32_16x16x32_bf16 v[44:47], v[208:211], v[164:167], v[44:47]
    s_waitcnt lgkmcnt(6)
    v_mfma_f32_16x16x32_bf16 v[16:19], v[212:215], v[148:151], v[16:19]
    v_mfma_f32_16x16x32_bf16 v[48:51], v[212:215], v[164:167], v[48:51]
    s_waitcnt lgkmcnt(4)
    v_mfma_f32_16x16x32_bf16 v[20:23], v[216:219], v[148:151], v[20:23]
    v_mfma_f32_16x16x32_bf16 v[52:55], v[216:219], v[164:167], v[52:55]
    s_waitcnt lgkmcnt(2)
    v_mfma_f32_16x16x32_bf16 v[24:27], v[220:223], v[148:151], v[24:27]
    v_mfma_f32_16x16x32_bf16 v[56:59], v[220:223], v[164:167], v[56:59]
    s_waitcnt lgkmcnt(0)
    v_mfma_f32_16x16x32_bf16 v[28:31], v[224:227], v[148:151], v[28:31]
    v_mfma_f32_16x16x32_bf16 v[60:63], v[224:227], v[164:167], v[60:63]
    s_cmp_eq_u32 s57, 0
    s_cselect_b32 s60, 16384, 0
    s_cmp_eq_u32 s57, 1
    s_cselect_b32 s60, 32768, s60
    s_cmp_eq_u32 s57, 2
    s_cselect_b32 s60, 4294918144, s60
    s_cselect_b32 s57, -1, s57
    s_add_u32 s57, s57, 1
    v_add_u32 v234, s60, v234
    v_add_u32 v235, s60, v235
    v_add_u32 v236, s60, v236
    v_add_u32 v237, s60, v237
    v_xor_b32 v238, 98304, v238
    s_add_u32 s25, s25, 1
    s_cmp_lt_u32 s25, 16
    s_cbranch_scc1 K1W0_LOOP
    s_cmp_eq_u32 s27, 1
    s_cbranch_scc1 K1W0_FINAL1
    s_mov_b32 s27, 1
    s_branch K1W0_ROUND
K1W0_LDR:
    s_nop 1
    s_and_b32 s51, s2, 1
    s_cmp_eq_u32 s27, 0
    s_cbranch_scc1 K1W0_LR0
K1W0_LR0:
    s_cmp_eq_u32 s27, 0
    s_cselect_b32 s57, 2, 0
    s_mov_b32 s28, 0
    s_cselect_b32 s28, 49152, s28
    s_mov_b32 s45, 0
K1W0_LLOOP:
    s_mov_b32 s46, s45
    s_mov_b32 s45, 0
    s_cmp_eq_u32 s46, 0
    s_cbranch_scc0 K1W0_XW1_1
    s_waitcnt vmcnt(8) lgkmcnt(0)
    s_branch K1W0_XW1_z
K1W0_XW1_1:
    s_cmp_eq_u32 s46, 1
    s_cbranch_scc0 K1W0_XW1_2
    s_waitcnt vmcnt(9) lgkmcnt(0)
    s_branch K1W0_XW1_z
K1W0_XW1_2:
    s_cmp_eq_u32 s46, 2
    s_cbranch_scc0 K1W0_XW1_3
    s_waitcnt vmcnt(10) lgkmcnt(0)
    s_branch K1W0_XW1_z
K1W0_XW1_3:
    s_waitcnt vmcnt(11) lgkmcnt(0)
K1W0_XW1_z:
    s_barrier
    s_cmp_eq_u32 s27, 0
    s_cbranch_scc0 K1W0_L0
    s_cmp_eq_u32 s25, 15
    s_cbranch_scc0 K1W0_L0
    v_add_u32 v242, 1835008, v242
K1W0_L0:
    s_mov_b32 m0, s29
    v_xor_b32 v243, 128, v242
    buffer_load_dwordx4 v242, s[8:11], 0 offen nt lds
    buffer_load_dwordx4 v243, s[8:11], 0 offen offset:1024 nt lds
    buffer_load_dwordx4 v242, s[8:11], 0 offen offset:2048 nt lds
    buffer_load_dwordx4 v243, s[8:11], 0 offen offset:3072 nt lds
    v_add_u32 v242, 16384, v242
    s_xor_b32 s29, s29, 98304
    s_cmp_eq_u32 s27, 1
    s_cbranch_scc0 K1W0_L1
    s_cmp_eq_u32 s25, 0
    s_cbranch_scc0 K1W0_E0
    s_nop 7
    v_add_u32 v246, 81920, v248
    v_and_b32 v247, 15, v245
    v_lshlrev_b32 v247, 2, v247
    v_add_u32 v247, 114688, v247
    v_mov_b32 v244, v228
    s_nop 1
    v_permlane16_swap_b32 v244, v228
    v_add_f32 v228, v228, v244
    v_mov_b32 v244, v228
    s_nop 1
    v_permlane32_swap_b32 v244, v228
    v_add_f32 v228, v228, v244
    v_mov_b32 v244, v229
    s_nop 1
    v_permlane16_swap_b32 v244, v229
    v_add_f32 v229, v229, v244
    v_mov_b32 v244, v229
    s_nop 1
    v_permlane32_swap_b32 v244, v229
    v_add_f32 v229, v229, v244
    v_rcp_f32 v228, v228
    v_rcp_f32 v229, v229
    s_branch K1W0_L1
K1W0_E0:
    s_cmp_eq_u32 s25, 1
    s_cbranch_scc0 K1W0_E1
    s_nop 1
    v_mul_f32 v0, v0, v228
    v_mul_f32 v1, v1, v228
    v_mul_f32 v2, v2, v228
    v_mul_f32 v3, v3, v228
    v_mul_f32 v4, v4, v228
    v_mul_f32 v5, v5, v228
    v_mul_f32 v6, v6, v228
    v_mul_f32 v7, v7, v228
    v_cvt_pk_bf16_f32 v96, v0, v1
    v_cvt_pk_bf16_f32 v97, v2, v3
    v_cvt_pk_bf16_f32 v98, v4, v5
    v_cvt_pk_bf16_f32 v99, v6, v7
    v_mul_f32 v8, v8, v228
    v_mul_f32 v9, v9, v228
    v_mul_f32 v10, v10, v228
    v_mul_f32 v11, v11, v228
    v_mul_f32 v12, v12, v228
    v_mul_f32 v13, v13, v228
    v_mul_f32 v14, v14, v228
    v_mul_f32 v15, v15, v228
    v_cvt_pk_bf16_f32 v100, v8, v9
    v_cvt_pk_bf16_f32 v101, v10, v11
    v_cvt_pk_bf16_f32 v102, v12, v13
    v_cvt_pk_bf16_f32 v103, v14, v15
    v_mul_f32 v16, v16, v228
    v_mul_f32 v17, v17, v228
    v_mul_f32 v18, v18, v228
    v_mul_f32 v19, v19, v228
    v_mul_f32 v20, v20, v228
    v_mul_f32 v21, v21, v228
    v_mul_f32 v22, v22, v228
    v_mul_f32 v23, v23, v228
    v_cvt_pk_bf16_f32 v104, v16, v17
    v_cvt_pk_bf16_f32 v105, v18, v19
    v_cvt_pk_bf16_f32 v106, v20, v21
    v_cvt_pk_bf16_f32 v107, v22, v23
    v_mul_f32 v24, v24, v228
    v_mul_f32 v25, v25, v228
    v_mul_f32 v26, v26, v228
    v_mul_f32 v27, v27, v228
    v_mul_f32 v28, v28, v228
    v_mul_f32 v29, v29, v228
    v_mul_f32 v30, v30, v228
    v_mul_f32 v31, v31, v228
    v_cvt_pk_bf16_f32 v108, v24, v25
    v_cvt_pk_bf16_f32 v109, v26, v27
    v_cvt_pk_bf16_f32 v110, v28, v29
    v_cvt_pk_bf16_f32 v111, v30, v31
    s_branch K1W0_L1
K1W0_E1:
    s_cmp_eq_u32 s25, 2
    s_cbranch_scc0 K1W0_E2
    s_nop 1
    v_mul_f32 v32, v32, v229
    v_mul_f32 v33, v33, v229
    v_mul_f32 v34, v34, v229
    v_mul_f32 v35, v35, v229
    v_mul_f32 v36, v36, v229
    v_mul_f32 v37, v37, v229
    v_mul_f32 v38, v38, v229
    v_mul_f32 v39, v39, v229
    v_cvt_pk_bf16_f32 v112, v32, v33
    v_cvt_pk_bf16_f32 v113, v34, v35
    v_cvt_pk_bf16_f32 v114, v36, v37
    v_cvt_pk_bf16_f32 v115, v38, v39
    v_mul_f32 v40, v40, v229
    v_mul_f32 v41, v41, v229
    v_mul_f32 v42, v42, v229
    v_mul_f32 v43, v43, v229
    v_mul_f32 v44, v44, v229
    v_mul_f32 v45, v45, v229
    v_mul_f32 v46, v46, v229
    v_mul_f32 v47, v47, v229
    v_cvt_pk_bf16_f32 v116, v40, v41
    v_cvt_pk_bf16_f32 v117, v42, v43
    v_cvt_pk_bf16_f32 v118, v44, v45
    v_cvt_pk_bf16_f32 v119, v46, v47
    v_mul_f32 v48, v48, v229
    v_mul_f32 v49, v49, v229
    v_mul_f32 v50, v50, v229
    v_mul_f32 v51, v51, v229
    v_mul_f32 v52, v52, v229
    v_mul_f32 v53, v53, v229
    v_mul_f32 v54, v54, v229
    v_mul_f32 v55, v55, v229
    v_cvt_pk_bf16_f32 v120, v48, v49
    v_cvt_pk_bf16_f32 v121, v50, v51
    v_cvt_pk_bf16_f32 v122, v52, v53
    v_cvt_pk_bf16_f32 v123, v54, v55
    v_mul_f32 v56, v56, v229
    v_mul_f32 v57, v57, v229
    v_mul_f32 v58, v58, v229
    v_mul_f32 v59, v59, v229
    v_mul_f32 v60, v60, v229
    v_mul_f32 v61, v61, v229
    v_mul_f32 v62, v62, v229
    v_mul_f32 v63, v63, v229
    v_cvt_pk_bf16_f32 v124, v56, v57
    v_cvt_pk_bf16_f32 v125, v58, v59
    v_cvt_pk_bf16_f32 v126, v60, v61
    v_cvt_pk_bf16_f32 v127, v62, v63
    s_branch K1W0_L1
K1W0_E2:
    s_cmp_eq_u32 s25, 3
    s_cbranch_scc0 K1W0_E3
    s_nop 1
    ds_read_b32 v144, v247 offset:0
    ds_read_b32 v148, v247 offset:64
    ds_read_b32 v145, v247 offset:128
    ds_read_b32 v149, v247 offset:192
    ds_read_b128 v[196:199], v246 offset:0
    ds_read_b128 v[200:203], v246 offset:1024
    ds_read_b128 v[204:207], v246 offset:8192
    ds_read_b128 v[208:211], v246 offset:9216
    s_waitcnt lgkmcnt(5)
    v_max_f32 v244, v144, v145
    v_sub_f32 v152, v144, v244
    v_sub_f32 v153, v145, v244
    v_exp_f32 v152, v152
    v_exp_f32 v153, v153
    v_mul_f32 v244, v152, v148
    s_waitcnt lgkmcnt(4)
    v_fma_f32 v244, v153, v149, v244
    v_rcp_f32 v244, v244
    s_nop 0
    v_mul_f32 v152, v152, v244
    v_mul_f32 v153, v153, v244
    s_waitcnt lgkmcnt(3)
    v_mul_f32 v160, v196, v152
    s_waitcnt lgkmcnt(1)
    v_fma_f32 v160, v204, v153, v160
    v_mul_f32 v161, v197, v152
    v_fma_f32 v161, v205, v153, v161
    v_mul_f32 v162, v198, v152
    v_fma_f32 v162, v206, v153, v162
    v_mul_f32 v163, v199, v152
    v_fma_f32 v163, v207, v153, v163
    v_mul_f32 v164, v200, v152
    s_waitcnt lgkmcnt(0)
    v_fma_f32 v164, v208, v153, v164
    v_mul_f32 v165, v201, v152
    v_fma_f32 v165, v209, v153, v165
    v_mul_f32 v166, v202, v152
    v_fma_f32 v166, v210, v153, v166
    v_mul_f32 v167, v203, v152
    v_fma_f32 v167, v211, v153, v167
    v_cvt_pk_bf16_f32 v128, v160, v161
    v_cvt_pk_bf16_f32 v129, v162, v163
    v_cvt_pk_bf16_f32 v130, v164, v165
    v_cvt_pk_bf16_f32 v131, v166, v167
    s_branch K1W0_L1
K1W0_E3:
K1W0_L1c:
K1W0_L1:
    s_add_u32 s47, s46, s45
    s_cmp_eq_u32 s47, 0
    s_cbranch_scc0 K1W0_XW2_1
    s_waitcnt vmcnt(8) lgkmcnt(0)
    s_branch K1W0_XW2_z
K1W0_XW2_1:
    s_cmp_eq_u32 s47, 1
    s_cbranch_scc0 K1W0_XW2_2
    s_waitcnt vmcnt(9) lgkmcnt(0)
    s_branch K1W0_XW2_z
K1W0_XW2_2:
    s_cmp_eq_u32 s47, 2
    s_cbranch_scc0 K1W0_XW2_3
    s_waitcnt vmcnt(10) lgkmcnt(0)
    s_branch K1W0_XW2_z
K1W0_XW2_3:
    s_waitcnt vmcnt(11) lgkmcnt(0)
K1W0_XW2_z:
    s_barrier
    s_cmp_eq_u32 s27, 0
    s_cbranch_scc0 K1W0_L2
    s_cmp_eq_u32 s25, 14
    s_cbranch_scc0 K1W0_L2
    v_add_u32 v241, 1835008, v241
K1W0_L2:
    s_mov_b32 m0, s28
    v_xor_b32 v243, 64, v241
    buffer_load_dwordx4 v241, s[4:7], 0 offen nt lds
    v_xor_b32 v244, 128, v241
    buffer_load_dwordx4 v243, s[4:7], 0 offen offset:1024 nt lds
    v_xor_b32 v243, 192, v241
    buffer_load_dwordx4 v244, s[4:7], 0 offen offset:2048 nt lds
    buffer_load_dwordx4 v243, s[4:7], 0 offen offset:3072 nt lds
    v_add_u32 v241, 16384, v241
    s_add_u32 s57, s57, 1
    s_cmp_eq_u32 s57, 3
    s_cselect_b32 s57, 0, s57
    s_cmp_eq_u32 s57, 0
    s_mov_b32 s28, 0
    s_cmp_eq_u32 s57, 1
    s_cselect_b32 s28, 16384, s28
    s_cmp_eq_u32 s57, 2
    s_cselect_b32 s28, 49152, s28
    s_add_u32 s25, s25, 1
    s_cmp_lt_u32 s25, 16
    s_cbranch_scc1 K1W0_LLOOP
    s_cmp_eq_u32 s27, 1
    s_cbranch_scc1 K1W0_FIN0
    s_mov_b32 s27, 1
    s_branch K1W0_ROUND
K1W0_FIN0:
    s_nop 1
    s_mov_b32 s30, 0
    buffer_store_dwordx4 v[96:99], v248, s[20:23], s30 offen offset:0 sc1
    buffer_store_dwordx4 v[100:103], v248, s[20:23], s30 offen offset:1024 sc1
    buffer_store_dwordx4 v[104:107], v248, s[20:23], s30 offen offset:2048 sc1
    buffer_store_dwordx4 v[108:111], v248, s[20:23], s30 offen offset:3072 sc1
    s_mov_b32 s30, 4096
    buffer_store_dwordx4 v[112:115], v248, s[20:23], s30 offen offset:0 sc1
    buffer_store_dwordx4 v[116:119], v248, s[20:23], s30 offen offset:1024 sc1
    buffer_store_dwordx4 v[120:123], v248, s[20:23], s30 offen offset:2048 sc1
    buffer_store_dwordx4 v[124:127], v248, s[20:23], s30 offen offset:3072 sc1
    s_mov_b32 s30, 32768
    buffer_store_dwordx4 v[128:131], v248, s[20:23], s30 offen sc1
    s_barrier
    s_waitcnt vmcnt(0)
    s_lshl_b32 s30, s85, 3
    s_add_u32 s30, s30, s84
    s_mul_i32 s44, s30, 52
    s_lshr_b32 s44, s44, 8
    s_mul_i32 s31, s44, 5
    s_sub_u32 s45, s30, s31
    s_and_b32 s51, s2, 1
    s_load_dwordx2 s[72:73], s[0:1], 32
    s_load_dwordx2 s[74:75], s[0:1], 72
    s_load_dwordx2 s[46:47], s[0:1], 80
    s_waitcnt lgkmcnt(0)
    s_cmp_eq_u32 s64, 0
    s_cselect_b64 s[72:73], s[72:73], s[74:75]
    s_lshl_b32 s30, s45, 8
    s_add_u32 s12, s72, s30
    s_addc_u32 s13, s73, 0
    s_sub_u32 s14, 5242880, s30
    s_mov_b32 s15, 131072
    s_mov_b32 s16, s48
    s_mov_b32 s17, s49
    s_mov_b32 s18, 18874368
    s_mov_b32 s19, 131072
    s_add_u32 s80, s48, 50331648
    s_addc_u32 s81, s49, 0
    s_mov_b32 s82, 131072
    s_mov_b32 s83, 131072
    s_mov_b32 s4, s46
    s_mov_b32 s5, s47
    s_mov_b32 s6, 2949120
    s_mov_b32 s7, 131072
    s_add_u32 s8, s48, 33554432
    s_addc_u32 s9, s49, 0
    s_mov_b32 s10, 12582912
    s_mov_b32 s11, 131072
    s_sub_u32 s69, s65, s85
    s_mul_i32 s30, s44, 6
    s_add_u32 s30, s30, 0
    s_mul_i32 s31, s30, 57
    s_lshr_b32 s31, s31, 9
    s_mul_i32 s72, s31, 9
    s_sub_u32 s72, s30, s72
    s_add_u32 s31, s31, s69
    s_lshl_b32 s73, s64, 3
    s_add_u32 s73, s73, s31
    s_lshl_b32 s73, s73, 5
    s_lshl_b32 s74, s51, 4
    s_add_u32 s73, s73, s74
    s_mul_i32 s73, s73, 36864
    s_lshl_b32 s74, s72, 12
    s_add_u32 s32, s73, s74
    s_mul_i32 s73, s31, 144
    s_lshl_b32 s74, s72, 4
    s_add_u32 s73, s73, s74
    s_mul_i32 s73, s73, 2560
    s_mul_i32 s74, s64, 1280
    s_add_u32 s73, s73, s74
    s_lshl_b32 s74, s45, 8
    s_add_u32 s38, s73, s74
    s_mul_i32 s30, s44, 6
    s_add_u32 s30, s30, 1
    s_mul_i32 s31, s30, 57
    s_lshr_b32 s31, s31, 9
    s_mul_i32 s72, s31, 9
    s_sub_u32 s72, s30, s72
    s_add_u32 s31, s31, s69
    s_lshl_b32 s73, s64, 3
    s_add_u32 s73, s73, s31
    s_lshl_b32 s73, s73, 5
    s_lshl_b32 s74, s51, 4
    s_add_u32 s73, s73, s74
    s_mul_i32 s73, s73, 36864
    s_lshl_b32 s74, s72, 12
    s_add_u32 s33, s73, s74
    s_mul_i32 s73, s31, 144
    s_lshl_b32 s74, s72, 4
    s_add_u32 s73, s73, s74
    s_mul_i32 s73, s73, 2560
    s_mul_i32 s74, s64, 1280
    s_add_u32 s73, s73, s74
    s_lshl_b32 s74, s45, 8
    s_add_u32 s39, s73, s74
    s_mul_i32 s30, s44, 6
    s_add_u32 s30, s30, 2
    s_mul_i32 s31, s30, 57
    s_lshr_b32 s31, s31, 9
    s_mul_i32 s72, s31, 9
    s_sub_u32 s72, s30, s72
    s_add_u32 s31, s31, s69
    s_lshl_b32 s73, s64, 3
    s_add_u32 s73, s73, s31
    s_lshl_b32 s73, s73, 5
    s_lshl_b32 s74, s51, 4
    s_add_u32 s73, s73, s74
    s_mul_i32 s73, s73, 36864
    s_lshl_b32 s74, s72, 12
    s_add_u32 s34, s73, s74
    s_mul_i32 s73, s31, 144
    s_lshl_b32 s74, s72, 4
    s_add_u32 s73, s73, s74
    s_mul_i32 s73, s73, 2560
    s_mul_i32 s74, s64, 1280
    s_add_u32 s73, s73, s74
    s_lshl_b32 s74, s45, 8
    s_add_u32 s40, s73, s74
    s_mul_i32 s30, s44, 6
    s_add_u32 s30, s30, 3
    s_mul_i32 s31, s30, 57
    s_lshr_b32 s31, s31, 9
    s_mul_i32 s72, s31, 9
    s_sub_u32 s72, s30, s72
    s_add_u32 s31, s31, s69
    s_lshl_b32 s73, s64, 3
    s_add_u32 s73, s73, s31
    s_lshl_b32 s73, s73, 5
    s_lshl_b32 s74, s51, 4
    s_add_u32 s73, s73, s74
    s_mul_i32 s73, s73, 36864
    s_lshl_b32 s74, s72, 12
    s_add_u32 s35, s73, s74
    s_mul_i32 s73, s31, 144
    s_lshl_b32 s74, s72, 4
    s_add_u32 s73, s73, s74
    s_mul_i32 s73, s73, 2560
    s_mul_i32 s74, s64, 1280
    s_add_u32 s73, s73, s74
    s_lshl_b32 s74, s45, 8
    s_add_u32 s41, s73, s74
    s_mul_i32 s30, s44, 6
    s_add_u32 s30, s30, 4
    s_mul_i32 s31, s30, 57
    s_lshr_b32 s31, s31, 9
    s_mul_i32 s72, s31, 9
    s_sub_u32 s72, s30, s72
    s_add_u32 s31, s31, s69
    s_lshl_b32 s73, s64, 3
    s_add_u32 s73, s73, s31
    s_lshl_b32 s73, s73, 5
    s_lshl_b32 s74, s51, 4
    s_add_u32 s73, s73, s74
    s_mul_i32 s73, s73, 36864
    s_lshl_b32 s74, s72, 12
    s_add_u32 s36, s73, s74
    s_mul_i32 s73, s31, 144
    s_lshl_b32 s74, s72, 4
    s_add_u32 s73, s73, s74
    s_mul_i32 s73, s73, 2560
    s_mul_i32 s74, s64, 1280
    s_add_u32 s73, s73, s74
    s_lshl_b32 s74, s45, 8
    s_add_u32 s42, s73, s74
    s_mul_i32 s30, s44, 6
    s_add_u32 s30, s30, 5
    s_mul_i32 s31, s30, 57
    s_lshr_b32 s31, s31, 9
    s_mul_i32 s72, s31, 9
    s_sub_u32 s72, s30, s72
    s_add_u32 s31, s31, s69
    s_lshl_b32 s73, s64, 3
    s_add_u32 s73, s73, s31
    s_lshl_b32 s73, s73, 5
    s_lshl_b32 s74, s51, 4
    s_add_u32 s73, s73, s74
    s_mul_i32 s73, s73, 36864
    s_lshl_b32 s74, s72, 12
    s_add_u32 s37, s73, s74
    s_mul_i32 s73, s31, 144
    s_lshl_b32 s74, s72, 4
    s_add_u32 s73, s73, s74
    s_mul_i32 s73, s73, 2560
    s_mul_i32 s74, s64, 1280
    s_add_u32 s73, s73, s74
    s_lshl_b32 s74, s45, 8
    s_add_u32 s43, s73, s74
    s_mul_i32 s53, s51, 2621440
    v_mov_b32 v104, v248
    v_add_u32 v105, 57344, v248
    v_lshrrev_b32 v116, 4, v245
    v_bfe_u32 v117, v245, 2, 2
    v_lshl_add_u32 v116, v116, 2, v117
    v_and_b32 v117, 7, v116
    v_lshlrev_b32 v117, 1, v117
    v_bfe_u32 v118, v245, 1, 1
    v_xor_b32 v117, v117, v118
    v_lshlrev_b32 v117, 4, v117
    v_lshl_or_b32 v116, v116, 8, v117
    v_and_b32 v117, 1, v245
    v_lshl_or_b32 v116, v117, 3, v116
    v_xor_b32 v117, 0, v116
    v_add_u32 v106, 12288, v117
    v_add_u32 v110, 69632, v117
    v_xor_b32 v117, 32, v116
    v_add_u32 v107, 12288, v117
    v_add_u32 v111, 69632, v117
    v_xor_b32 v117, 64, v116
    v_add_u32 v108, 12288, v117
    v_add_u32 v112, 69632, v117
    v_xor_b32 v117, 96, v116
    v_add_u32 v109, 12288, v117
    v_add_u32 v113, 69632, v117
    v_mov_b32 v0, 0
    v_mov_b32 v1, 0
    v_mov_b32 v2, 0
    v_mov_b32 v3, 0
    v_mov_b32 v4, 0
    v_mov_b32 v5, 0
    v_mov_b32 v6, 0
    v_mov_b32 v7, 0
    v_mov_b32 v8, 0
    v_mov_b32 v9, 0
    v_mov_b32 v10, 0
    v_mov_b32 v11, 0
    v_mov_b32 v12, 0
    v_mov_b32 v13, 0
    v_mov_b32 v14, 0
    v_mov_b32 v15, 0
    v_mov_b32 v16, 0
    v_mov_b32 v17, 0
    v_mov_b32 v18, 0
    v_mov_b32 v19, 0
    v_mov_b32 v20, 0
    v_mov_b32 v21, 0
    v_mov_b32 v22, 0
    v_mov_b32 v23, 0
    v_mov_b32 v24, 0
    v_mov_b32 v25, 0
    v_mov_b32 v26, 0
    v_mov_b32 v27, 0
    v_mov_b32 v28, 0
    v_mov_b32 v29, 0
    v_mov_b32 v30, 0
    v_mov_b32 v31, 0
    v_mov_b32 v32, 0
    v_mov_b32 v33, 0
    v_mov_b32 v34, 0
    v_mov_b32 v35, 0
    v_mov_b32 v36, 0
    v_mov_b32 v37, 0
    v_mov_b32 v38, 0
    v_mov_b32 v39, 0
    v_mov_b32 v40, 0
    v_mov_b32 v41, 0
    v_mov_b32 v42, 0
    v_mov_b32 v43, 0
    v_mov_b32 v44, 0
    v_mov_b32 v45, 0
    v_mov_b32 v46, 0
    v_mov_b32 v47, 0
    v_readfirstlane_b32 s93, v252
    s_nop 0
    s_cmp_eq_u32 s93, 0
    s_cselect_b32 s93, s92, s93
    s_barrier
    v_mov_b32 v243, s93
    v_mov_b32 v244, 0
    s_lshl_b32 s30, s2, 7
    s_add_u32 s30, s30, 0
    s_mov_b64 exec, 1
    buffer_store_dword v243, v244, s[80:83], s30 offen sc1
    s_mov_b64 exec, -1
    s_cmp_ge_u32 s44, 6
    s_cbranch_scc1 K1_END
    s_barrier
    s_mov_b32 s58, 0
    s_nop 1
K1W0_TC:
    s_barrier
    s_cmp_eq_u32 s58, 0
    s_cbranch_scc1 K1W0_TCf
    v_mfma_f32_16x16x32_bf16 v[0:3], v[88:91], v[60:63], v[0:3]
    ds_read_b128 v[48:51], v104 offset:0
    v_mfma_f32_16x16x32_bf16 v[16:19], v[88:91], v[64:67], v[16:19]
    ds_read_b128 v[52:55], v104 offset:2048
    v_mfma_f32_16x16x32_bf16 v[32:35], v[88:91], v[68:71], v[32:35]
    ds_read_b128 v[56:59], v104 offset:4096
    v_mfma_f32_16x16x32_bf16 v[4:7], v[92:95], v[60:63], v[4:7]
    ds_read_b64_tr_b16 v[72:73], v106 offset:0
    v_mfma_f32_16x16x32_bf16 v[20:23], v[92:95], v[64:67], v[20:23]
    ds_read_b64_tr_b16 v[74:75], v106 offset:4096
    v_mfma_f32_16x16x32_bf16 v[36:39], v[92:95], v[68:71], v[36:39]
    ds_read_b64_tr_b16 v[76:77], v107 offset:0
    v_mfma_f32_16x16x32_bf16 v[8:11], v[96:99], v[60:63], v[8:11]
    ds_read_b64_tr_b16 v[78:79], v107 offset:4096
    v_mfma_f32_16x16x32_bf16 v[24:27], v[96:99], v[64:67], v[24:27]
    ds_read_b64_tr_b16 v[80:81], v108 offset:0
    v_mfma_f32_16x16x32_bf16 v[40:43], v[96:99], v[68:71], v[40:43]
    ds_read_b64_tr_b16 v[82:83], v108 offset:4096
    v_mfma_f32_16x16x32_bf16 v[12:15], v[100:103], v[60:63], v[12:15]
    ds_read_b64_tr_b16 v[84:85], v109 offset:0
    v_mfma_f32_16x16x32_bf16 v[28:31], v[100:103], v[64:67], v[28:31]
    ds_read_b64_tr_b16 v[86:87], v109 offset:4096
    v_mfma_f32_16x16x32_bf16 v[44:47], v[100:103], v[68:71], v[44:47]
    s_branch K1W0_TCg
K1W0_TCf:
    ds_read_b128 v[48:51], v104 offset:0
    ds_read_b128 v[52:55], v104 offset:2048
    ds_read_b128 v[56:59], v104 offset:4096
    ds_read_b64_tr_b16 v[72:73], v106 offset:0
    ds_read_b64_tr_b16 v[74:75], v106 offset:4096
    ds_read_b64_tr_b16 v[76:77], v107 offset:0
    ds_read_b64_tr_b16 v[78:79], v107 offset:4096
    ds_read_b64_tr_b16 v[80:81], v108 offset:0
    ds_read_b64_tr_b16 v[82:83], v108 offset:4096
    ds_read_b64_tr_b16 v[84:85], v109 offset:0
    ds_read_b64_tr_b16 v[86:87], v109 offset:4096
K1W0_TCg:
    s_waitcnt lgkmcnt(0)
    v_mfma_f32_16x16x32_bf16 v[0:3], v[72:75], v[48:51], v[0:3]
    ds_read_b128 v[60:63], v104 offset:1024
    v_mfma_f32_16x16x32_bf16 v[16:19], v[72:75], v[52:55], v[16:19]
    ds_read_b128 v[64:67], v104 offset:3072
    v_mfma_f32_16x16x32_bf16 v[32:35], v[72:75], v[56:59], v[32:35]
    ds_read_b128 v[68:71], v104 offset:5120
    v_mfma_f32_16x16x32_bf16 v[4:7], v[76:79], v[48:51], v[4:7]
    ds_read_b64_tr_b16 v[88:89], v106 offset:8192
    v_mfma_f32_16x16x32_bf16 v[20:23], v[76:79], v[52:55], v[20:23]
    ds_read_b64_tr_b16 v[90:91], v106 offset:12288
    v_mfma_f32_16x16x32_bf16 v[36:39], v[76:79], v[56:59], v[36:39]
    ds_read_b64_tr_b16 v[92:93], v107 offset:8192
    v_mfma_f32_16x16x32_bf16 v[8:11], v[80:83], v[48:51], v[8:11]
    ds_read_b64_tr_b16 v[94:95], v107 offset:12288
    v_mfma_f32_16x16x32_bf16 v[24:27], v[80:83], v[52:55], v[24:27]
    ds_read_b64_tr_b16 v[96:97], v108 offset:8192
    v_mfma_f32_16x16x32_bf16 v[40:43], v[80:83], v[56:59], v[40:43]
    ds_read_b64_tr_b16 v[98:99], v108 offset:12288
    v_mfma_f32_16x16x32_bf16 v[12:15], v[84:87], v[48:51], v[12:15]
    ds_read_b64_tr_b16 v[100:101], v109 offset:8192
    v_mfma_f32_16x16x32_bf16 v[28:31], v[84:87], v[52:55], v[28:31]
    ds_read_b64_tr_b16 v[102:103], v109 offset:12288
    v_mfma_f32_16x16x32_bf16 v[44:47], v[84:87], v[56:59], v[44:47]
    s_waitcnt lgkmcnt(0)
    s_barrier
    v_mfma_f32_16x16x32_bf16 v[0:3], v[88:91], v[60:63], v[0:3]
    ds_read_b128 v[48:51], v104 offset:28672
    v_mfma_f32_16x16x32_bf16 v[16:19], v[88:91], v[64:67], v[16:19]
    ds_read_b128 v[52:55], v104 offset:30720
    v_mfma_f32_16x16x32_bf16 v[32:35], v[88:91], v[68:71], v[32:35]
    ds_read_b128 v[56:59], v104 offset:32768
    v_mfma_f32_16x16x32_bf16 v[4:7], v[92:95], v[60:63], v[4:7]
    ds_read_b64_tr_b16 v[72:73], v106 offset:28672
    v_mfma_f32_16x16x32_bf16 v[20:23], v[92:95], v[64:67], v[20:23]
    ds_read_b64_tr_b16 v[74:75], v106 offset:32768
    v_mfma_f32_16x16x32_bf16 v[36:39], v[92:95], v[68:71], v[36:39]
    ds_read_b64_tr_b16 v[76:77], v107 offset:28672
    v_mfma_f32_16x16x32_bf16 v[8:11], v[96:99], v[60:63], v[8:11]
    ds_read_b64_tr_b16 v[78:79], v107 offset:32768
    v_mfma_f32_16x16x32_bf16 v[24:27], v[96:99], v[64:67], v[24:27]
    ds_read_b64_tr_b16 v[80:81], v108 offset:28672
    v_mfma_f32_16x16x32_bf16 v[40:43], v[96:99], v[68:71], v[40:43]
    ds_read_b64_tr_b16 v[82:83], v108 offset:32768
    v_mfma_f32_16x16x32_bf16 v[12:15], v[100:103], v[60:63], v[12:15]
    ds_read_b64_tr_b16 v[84:85], v109 offset:28672
    v_mfma_f32_16x16x32_bf16 v[28:31], v[100:103], v[64:67], v[28:31]
    ds_read_b64_tr_b16 v[86:87], v109 offset:32768
    v_mfma_f32_16x16x32_bf16 v[44:47], v[100:103], v[68:71], v[44:47]
    s_waitcnt lgkmcnt(6)
    v_mfma_f32_16x16x32_bf16 v[0:3], v[72:75], v[48:51], v[0:3]
    ds_read_b128 v[60:63], v104 offset:29696
    v_mfma_f32_16x16x32_bf16 v[16:19], v[72:75], v[52:55], v[16:19]
    ds_read_b128 v[64:67], v104 offset:31744
    v_mfma_f32_16x16x32_bf16 v[32:35], v[72:75], v[56:59], v[32:35]
    ds_read_b128 v[68:71], v104 offset:33792
    s_waitcnt lgkmcnt(7)
    v_mfma_f32_16x16x32_bf16 v[4:7], v[76:79], v[48:51], v[4:7]
    ds_read_b64_tr_b16 v[88:89], v106 offset:36864
    v_mfma_f32_16x16x32_bf16 v[20:23], v[76:79], v[52:55], v[20:23]
    ds_read_b64_tr_b16 v[90:91], v106 offset:40960
    v_mfma_f32_16x16x32_bf16 v[36:39], v[76:79], v[56:59], v[36:39]
    ds_read_b64_tr_b16 v[92:93], v107 offset:36864
    s_waitcnt lgkmcnt(8)
    v_mfma_f32_16x16x32_bf16 v[8:11], v[80:83], v[48:51], v[8:11]
    ds_read_b64_tr_b16 v[94:95], v107 offset:40960
    v_mfma_f32_16x16x32_bf16 v[24:27], v[80:83], v[52:55], v[24:27]
    ds_read_b64_tr_b16 v[96:97], v108 offset:36864
    v_mfma_f32_16x16x32_bf16 v[40:43], v[80:83], v[56:59], v[40:43]
    ds_read_b64_tr_b16 v[98:99], v108 offset:40960
    s_waitcnt lgkmcnt(9)
    v_mfma_f32_16x16x32_bf16 v[12:15], v[84:87], v[48:51], v[12:15]
    ds_read_b64_tr_b16 v[100:101], v109 offset:36864
    v_mfma_f32_16x16x32_bf16 v[28:31], v[84:87], v[52:55], v[28:31]
    ds_read_b64_tr_b16 v[102:103], v109 offset:40960
    v_mfma_f32_16x16x32_bf16 v[44:47], v[84:87], v[56:59], v[44:47]
    s_waitcnt lgkmcnt(0)
    s_barrier
    v_mfma_f32_16x16x32_bf16 v[0:3], v[88:91], v[60:63], v[0:3]
    ds_read_b128 v[48:51], v105 offset:0
    v_mfma_f32_16x16x32_bf16 v[16:19], v[88:91], v[64:67], v[16:19]
    ds_read_b128 v[52:55], v105 offset:2048
    v_mfma_f32_16x16x32_bf16 v[32:35], v[88:91], v[68:71], v[32:35]
    ds_read_b128 v[56:59], v105 offset:4096
    v_mfma_f32_16x16x32_bf16 v[4:7], v[92:95], v[60:63], v[4:7]
    ds_read_b64_tr_b16 v[72:73], v110 offset:0
    v_mfma_f32_16x16x32_bf16 v[20:23], v[92:95], v[64:67], v[20:23]
    ds_read_b64_tr_b16 v[74:75], v110 offset:4096
    v_mfma_f32_16x16x32_bf16 v[36:39], v[92:95], v[68:71], v[36:39]
    ds_read_b64_tr_b16 v[76:77], v111 offset:0
    v_mfma_f32_16x16x32_bf16 v[8:11], v[96:99], v[60:63], v[8:11]
    ds_read_b64_tr_b16 v[78:79], v111 offset:4096
    v_mfma_f32_16x16x32_bf16 v[24:27], v[96:99], v[64:67], v[24:27]
    ds_read_b64_tr_b16 v[80:81], v112 offset:0
    v_mfma_f32_16x16x32_bf16 v[40:43], v[96:99], v[68:71], v[40:43]
    ds_read_b64_tr_b16 v[82:83], v112 offset:4096
    v_mfma_f32_16x16x32_bf16 v[12:15], v[100:103], v[60:63], v[12:15]
    ds_read_b64_tr_b16 v[84:85], v113 offset:0
    v_mfma_f32_16x16x32_bf16 v[28:31], v[100:103], v[64:67], v[28:31]
    ds_read_b64_tr_b16 v[86:87], v113 offset:4096
    v_mfma_f32_16x16x32_bf16 v[44:47], v[100:103], v[68:71], v[44:47]
    s_waitcnt lgkmcnt(6)
    v_mfma_f32_16x16x32_bf16 v[0:3], v[72:75], v[48:51], v[0:3]
    ds_read_b128 v[60:63], v105 offset:1024
    v_mfma_f32_16x16x32_bf16 v[16:19], v[72:75], v[52:55], v[16:19]
    ds_read_b128 v[64:67], v105 offset:3072
    v_mfma_f32_16x16x32_bf16 v[32:35], v[72:75], v[56:59], v[32:35]
    ds_read_b128 v[68:71], v105 offset:5120
    s_waitcnt lgkmcnt(7)
    v_mfma_f32_16x16x32_bf16 v[4:7], v[76:79], v[48:51], v[4:7]
    ds_read_b64_tr_b16 v[88:89], v110 offset:8192
    v_mfma_f32_16x16x32_bf16 v[20:23], v[76:79], v[52:55], v[20:23]
    ds_read_b64_tr_b16 v[90:91], v110 offset:12288
    v_mfma_f32_16x16x32_bf16 v[36:39], v[76:79], v[56:59], v[36:39]
    ds_read_b64_tr_b16 v[92:93], v111 offset:8192
    s_waitcnt lgkmcnt(8)
    v_mfma_f32_16x16x32_bf16 v[8:11], v[80:83], v[48:51], v[8:11]
    ds_read_b64_tr_b16 v[94:95], v111 offset:12288
    v_mfma_f32_16x16x32_bf16 v[24:27], v[80:83], v[52:55], v[24:27]
    ds_read_b64_tr_b16 v[96:97], v112 offset:8192
    v_mfma_f32_16x16x32_bf16 v[40:43], v[80:83], v[56:59], v[40:43]
    ds_read_b64_tr_b16 v[98:99], v112 offset:12288
    s_waitcnt lgkmcnt(9)
    v_mfma_f32_16x16x32_bf16 v[12:15], v[84:87], v[48:51], v[12:15]
    ds_read_b64_tr_b16 v[100:101], v113 offset:8192
    v_mfma_f32_16x16x32_bf16 v[28:31], v[84:87], v[52:55], v[28:31]
    ds_read_b64_tr_b16 v[102:103], v113 offset:12288
    v_mfma_f32_16x16x32_bf16 v[44:47], v[84:87], v[56:59], v[44:47]
    s_waitcnt lgkmcnt(0)
    s_barrier
    v_mfma_f32_16x16x32_bf16 v[0:3], v[88:91], v[60:63], v[0:3]
    ds_read_b128 v[48:51], v105 offset:28672
    v_mfma_f32_16x16x32_bf16 v[16:19], v[88:91], v[64:67], v[16:19]
    ds_read_b128 v[52:55], v105 offset:30720
    v_mfma_f32_16x16x32_bf16 v[32:35], v[88:91], v[68:71], v[32:35]
    ds_read_b128 v[56:59], v105 offset:32768
    v_mfma_f32_16x16x32_bf16 v[4:7], v[92:95], v[60:63], v[4:7]
    ds_read_b64_tr_b16 v[72:73], v110 offset:28672
    v_mfma_f32_16x16x32_bf16 v[20:23], v[92:95], v[64:67], v[20:23]
    ds_read_b64_tr_b16 v[74:75], v110 offset:32768
    v_mfma_f32_16x16x32_bf16 v[36:39], v[92:95], v[68:71], v[36:39]
    ds_read_b64_tr_b16 v[76:77], v111 offset:28672
    v_mfma_f32_16x16x32_bf16 v[8:11], v[96:99], v[60:63], v[8:11]
    ds_read_b64_tr_b16 v[78:79], v111 offset:32768
    v_mfma_f32_16x16x32_bf16 v[24:27], v[96:99], v[64:67], v[24:27]
    ds_read_b64_tr_b16 v[80:81], v112 offset:28672
    v_mfma_f32_16x16x32_bf16 v[40:43], v[96:99], v[68:71], v[40:43]
    ds_read_b64_tr_b16 v[82:83], v112 offset:32768
    v_mfma_f32_16x16x32_bf16 v[12:15], v[100:103], v[60:63], v[12:15]
    ds_read_b64_tr_b16 v[84:85], v113 offset:28672
    v_mfma_f32_16x16x32_bf16 v[28:31], v[100:103], v[64:67], v[28:31]
    ds_read_b64_tr_b16 v[86:87], v113 offset:32768
    v_mfma_f32_16x16x32_bf16 v[44:47], v[100:103], v[68:71], v[44:47]
    s_waitcnt lgkmcnt(6)
    v_mfma_f32_16x16x32_bf16 v[0:3], v[72:75], v[48:51], v[0:3]
    ds_read_b128 v[60:63], v105 offset:29696
    v_mfma_f32_16x16x32_bf16 v[16:19], v[72:75], v[52:55], v[16:19]
    ds_read_b128 v[64:67], v105 offset:31744
    v_mfma_f32_16x16x32_bf16 v[32:35], v[72:75], v[56:59], v[32:35]
    ds_read_b128 v[68:71], v105 offset:33792
    s_waitcnt lgkmcnt(7)
    v_mfma_f32_16x16x32_bf16 v[4:7], v[76:79], v[48:51], v[4:7]
    ds_read_b64_tr_b16 v[88:89], v110 offset:36864
    v_mfma_f32_16x16x32_bf16 v[20:23], v[76:79], v[52:55], v[20:23]
    ds_read_b64_tr_b16 v[90:91], v110 offset:40960
    v_mfma_f32_16x16x32_bf16 v[36:39], v[76:79], v[56:59], v[36:39]
    ds_read_b64_tr_b16 v[92:93], v111 offset:36864
    s_waitcnt lgkmcnt(8)
    v_mfma_f32_16x16x32_bf16 v[8:11], v[80:83], v[48:51], v[8:11]
    ds_read_b64_tr_b16 v[94:95], v111 offset:40960
    v_mfma_f32_16x16x32_bf16 v[24:27], v[80:83], v[52:55], v[24:27]
    ds_read_b64_tr_b16 v[96:97], v112 offset:36864
    v_mfma_f32_16x16x32_bf16 v[40:43], v[80:83], v[56:59], v[40:43]
    ds_read_b64_tr_b16 v[98:99], v112 offset:40960
    s_waitcnt lgkmcnt(9)
    v_mfma_f32_16x16x32_bf16 v[12:15], v[84:87], v[48:51], v[12:15]
    ds_read_b64_tr_b16 v[100:101], v113 offset:36864
    v_mfma_f32_16x16x32_bf16 v[28:31], v[84:87], v[52:55], v[28:31]
    ds_read_b64_tr_b16 v[102:103], v113 offset:40960
    v_mfma_f32_16x16x32_bf16 v[44:47], v[84:87], v[56:59], v[44:47]
    s_waitcnt lgkmcnt(0)
    s_add_u32 s58, s58, 1
    s_cmp_lt_u32 s58, 8
    s_cbranch_scc1 K1W0_TC
    v_mfma_f32_16x16x32_bf16 v[0:3], v[88:91], v[60:63], v[0:3]
    v_mfma_f32_16x16x32_bf16 v[16:19], v[88:91], v[64:67], v[16:19]
    v_mfma_f32_16x16x32_bf16 v[32:35], v[88:91], v[68:71], v[32:35]
    v_mfma_f32_16x16x32_bf16 v[4:7], v[92:95], v[60:63], v[4:7]
    v_mfma_f32_16x16x32_bf16 v[20:23], v[92:95], v[64:67], v[20:23]
    v_mfma_f32_16x16x32_bf16 v[36:39], v[92:95], v[68:71], v[36:39]
    v_mfma_f32_16x16x32_bf16 v[8:11], v[96:99], v[60:63], v[8:11]
    v_mfma_f32_16x16x32_bf16 v[24:27], v[96:99], v[64:67], v[24:27]
    v_mfma_f32_16x16x32_bf16 v[40:43], v[96:99], v[68:71], v[40:43]
    v_mfma_f32_16x16x32_bf16 v[12:15], v[100:103], v[60:63], v[12:15]
    v_mfma_f32_16x16x32_bf16 v[28:31], v[100:103], v[64:67], v[28:31]
    v_mfma_f32_16x16x32_bf16 v[44:47], v[100:103], v[68:71], v[44:47]
    s_nop 7
    s_mul_i32 s30, s2, 49152
    s_add_u32 s30, s30, 0
    s_cmp_eq_u32 s51, 0
    s_cbranch_scc1 K1W0_TK
    buffer_store_dwordx4 v[0:3], v248, s[8:11], s30 offen offset:0 sc1
    buffer_store_dwordx4 v[4:7], v248, s[8:11], s30 offen offset:1024 sc1
    buffer_store_dwordx4 v[8:11], v248, s[8:11], s30 offen offset:2048 sc1
    buffer_store_dwordx4 v[12:15], v248, s[8:11], s30 offen offset:3072 sc1
    s_add_u32 s30, s30, 4096
    buffer_store_dwordx4 v[16:19], v248, s[8:11], s30 offen offset:0 sc1
    buffer_store_dwordx4 v[20:23], v248, s[8:11], s30 offen offset:1024 sc1
    buffer_store_dwordx4 v[24:27], v248, s[8:11], s30 offen offset:2048 sc1
    buffer_store_dwordx4 v[28:31], v248, s[8:11], s30 offen offset:3072 sc1
    s_add_u32 s30, s30, 4096
    buffer_store_dwordx4 v[32:35], v248, s[8:11], s30 offen offset:0 sc1
    buffer_store_dwordx4 v[36:39], v248, s[8:11], s30 offen offset:1024 sc1
    buffer_store_dwordx4 v[40:43], v248, s[8:11], s30 offen offset:2048 sc1
    buffer_store_dwordx4 v[44:47], v248, s[8:11], s30 offen offset:3072 sc1
K1W0_TK:
    s_waitcnt vmcnt(0)
    s_barrier
    v_mov_b32 v243, s93
    v_mov_b32 v244, 0
    s_lshl_b32 s30, s2, 7
    s_add_u32 s30, s30, 65536
    s_mov_b64 exec, 1
    buffer_store_dword v243, v244, s[80:83], s30 offen sc1
    s_mov_b64 exec, -1
    s_barrier
    s_cmp_eq_u32 s51, 0
    s_cbranch_scc0 K1W0_TF
    s_xor_b32 s30, s2, 1
    s_mul_i32 s30, s30, 49152
    s_add_u32 s30, s30, 0
    buffer_load_dwordx4 v[120:123], v248, s[8:11], s30 offen offset:0 sc1
    buffer_load_dwordx4 v[124:127], v248, s[8:11], s30 offen offset:1024 sc1
    buffer_load_dwordx4 v[128:131], v248, s[8:11], s30 offen offset:2048 sc1
    buffer_load_dwordx4 v[132:135], v248, s[8:11], s30 offen offset:3072 sc1
    s_add_u32 s30, s30, 4096
    buffer_load_dwordx4 v[136:139], v248, s[8:11], s30 offen offset:0 sc1
    buffer_load_dwordx4 v[140:143], v248, s[8:11], s30 offen offset:1024 sc1
    buffer_load_dwordx4 v[144:147], v248, s[8:11], s30 offen offset:2048 sc1
    buffer_load_dwordx4 v[148:151], v248, s[8:11], s30 offen offset:3072 sc1
    s_add_u32 s30, s30, 4096
    buffer_load_dwordx4 v[152:155], v248, s[8:11], s30 offen offset:0 sc1
    buffer_load_dwordx4 v[156:159], v248, s[8:11], s30 offen offset:1024 sc1
    buffer_load_dwordx4 v[160:163], v248, s[8:11], s30 offen offset:2048 sc1
    buffer_load_dwordx4 v[164:167], v248, s[8:11], s30 offen offset:3072 sc1
    v_and_b32 v116, 15, v245
    v_mul_u32_u24 v116, 2560, v116
    v_lshrrev_b32 v117, 4, v245
    v_lshl_add_u32 v116, v117, 3, v116
    s_waitcnt vmcnt(11)
    v_add_f32 v0, v0, v120
    v_add_f32 v1, v1, v121
    v_add_f32 v2, v2, v122
    v_add_f32 v3, v3, v123
    v_cvt_pk_bf16_f32 v48, v0, v1
    v_cvt_pk_bf16_f32 v49, v2, v3
    buffer_store_dwordx2 v[48:49], v116, s[4:7], s38 offen offset:0
    s_waitcnt vmcnt(11)
    v_add_f32 v4, v4, v124
    v_add_f32 v5, v5, v125
    v_add_f32 v6, v6, v126
    v_add_f32 v7, v7, v127
    v_cvt_pk_bf16_f32 v50, v4, v5
    v_cvt_pk_bf16_f32 v51, v6, v7
    buffer_store_dwordx2 v[50:51], v116, s[4:7], s38 offen offset:32
    s_waitcnt vmcnt(11)
    v_add_f32 v8, v8, v128
    v_add_f32 v9, v9, v129
    v_add_f32 v10, v10, v130
    v_add_f32 v11, v11, v131
    v_cvt_pk_bf16_f32 v52, v8, v9
    v_cvt_pk_bf16_f32 v53, v10, v11
    buffer_store_dwordx2 v[52:53], v116, s[4:7], s38 offen offset:64
    s_waitcnt vmcnt(11)
    v_add_f32 v12, v12, v132
    v_add_f32 v13, v13, v133
    v_add_f32 v14, v14, v134
    v_add_f32 v15, v15, v135
    v_cvt_pk_bf16_f32 v54, v12, v13
    v_cvt_pk_bf16_f32 v55, v14, v15
    buffer_store_dwordx2 v[54:55], v116, s[4:7], s38 offen offset:96
    s_waitcnt vmcnt(11)
    v_add_f32 v16, v16, v136
    v_add_f32 v17, v17, v137
    v_add_f32 v18, v18, v138
    v_add_f32 v19, v19, v139
    v_cvt_pk_bf16_f32 v56, v16, v17
    v_cvt_pk_bf16_f32 v57, v18, v19
    buffer_store_dwordx2 v[56:57], v116, s[4:7], s39 offen offset:0
    s_waitcnt vmcnt(11)
    v_add_f32 v20, v20, v140
    v_add_f32 v21, v21, v141
    v_add_f32 v22, v22, v142
    v_add_f32 v23, v23, v143
    v_cvt_pk_bf16_f32 v58, v20, v21
    v_cvt_pk_bf16_f32 v59, v22, v23
    buffer_store_dwordx2 v[58:59], v116, s[4:7], s39 offen offset:32
    s_waitcnt vmcnt(11)
    v_add_f32 v24, v24, v144
    v_add_f32 v25, v25, v145
    v_add_f32 v26, v26, v146
    v_add_f32 v27, v27, v147
    v_cvt_pk_bf16_f32 v60, v24, v25
    v_cvt_pk_bf16_f32 v61, v26, v27
    buffer_store_dwordx2 v[60:61], v116, s[4:7], s39 offen offset:64
    s_waitcnt vmcnt(11)
    v_add_f32 v28, v28, v148
    v_add_f32 v29, v29, v149
    v_add_f32 v30, v30, v150
    v_add_f32 v31, v31, v151
    v_cvt_pk_bf16_f32 v62, v28, v29
    v_cvt_pk_bf16_f32 v63, v30, v31
    buffer_store_dwordx2 v[62:63], v116, s[4:7], s39 offen offset:96
    s_waitcnt vmcnt(11)
    v_add_f32 v32, v32, v152
    v_add_f32 v33, v33, v153
    v_add_f32 v34, v34, v154
    v_add_f32 v35, v35, v155
    v_cvt_pk_bf16_f32 v64, v32, v33
    v_cvt_pk_bf16_f32 v65, v34, v35
    buffer_store_dwordx2 v[64:65], v116, s[4:7], s40 offen offset:0
    s_waitcnt vmcnt(11)
    v_add_f32 v36, v36, v156
    v_add_f32 v37, v37, v157
    v_add_f32 v38, v38, v158
    v_add_f32 v39, v39, v159
    v_cvt_pk_bf16_f32 v66, v36, v37
    v_cvt_pk_bf16_f32 v67, v38, v39
    buffer_store_dwordx2 v[66:67], v116, s[4:7], s40 offen offset:32
    s_waitcnt vmcnt(11)
    v_add_f32 v40, v40, v160
    v_add_f32 v41, v41, v161
    v_add_f32 v42, v42, v162
    v_add_f32 v43, v43, v163
    v_cvt_pk_bf16_f32 v68, v40, v41
    v_cvt_pk_bf16_f32 v69, v42, v43
    buffer_store_dwordx2 v[68:69], v116, s[4:7], s40 offen offset:64
    s_waitcnt vmcnt(11)
    v_add_f32 v44, v44, v164
    v_add_f32 v45, v45, v165
    v_add_f32 v46, v46, v166
    v_add_f32 v47, v47, v167
    v_cvt_pk_bf16_f32 v70, v44, v45
    v_cvt_pk_bf16_f32 v71, v46, v47
    buffer_store_dwordx2 v[70:71], v116, s[4:7], s40 offen offset:96
K1W0_TF:
    s_endpgm
K1W0_FINAL1:
    s_nop 7
    v_add_u32 v246, 81920, v248
    v_and_b32 v247, 15, v245
    v_lshlrev_b32 v247, 2, v247
    v_add_u32 v247, 114688, v247
    v_mov_b32 v244, v228
    s_nop 1
    v_permlane16_swap_b32 v244, v228
    v_add_f32 v228, v228, v244
    v_mov_b32 v244, v228
    s_nop 1
    v_permlane32_swap_b32 v244, v228
    v_add_f32 v228, v228, v244
    v_mov_b32 v244, v229
    s_nop 1
    v_permlane16_swap_b32 v244, v229
    v_add_f32 v229, v229, v244
    v_mov_b32 v244, v229
    s_nop 1
    v_permlane32_swap_b32 v244, v229
    v_add_f32 v229, v229, v244
    v_rcp_f32 v228, v228
    v_rcp_f32 v229, v229
    v_mul_f32 v0, v0, v228
    v_mul_f32 v1, v1, v228
    v_mul_f32 v2, v2, v228
    v_mul_f32 v3, v3, v228
    v_mul_f32 v4, v4, v228
    v_mul_f32 v5, v5, v228
    v_mul_f32 v6, v6, v228
    v_mul_f32 v7, v7, v228
    v_cvt_pk_bf16_f32 v96, v0, v1
    v_cvt_pk_bf16_f32 v97, v2, v3
    v_cvt_pk_bf16_f32 v98, v4, v5
    v_cvt_pk_bf16_f32 v99, v6, v7
    v_mul_f32 v8, v8, v228
    v_mul_f32 v9, v9, v228
    v_mul_f32 v10, v10, v228
    v_mul_f32 v11, v11, v228
    v_mul_f32 v12, v12, v228
    v_mul_f32 v13, v13, v228
    v_mul_f32 v14, v14, v228
    v_mul_f32 v15, v15, v228
    v_cvt_pk_bf16_f32 v100, v8, v9
    v_cvt_pk_bf16_f32 v101, v10, v11
    v_cvt_pk_bf16_f32 v102, v12, v13
    v_cvt_pk_bf16_f32 v103, v14, v15
    v_mul_f32 v16, v16, v228
    v_mul_f32 v17, v17, v228
    v_mul_f32 v18, v18, v228
    v_mul_f32 v19, v19, v228
    v_mul_f32 v20, v20, v228
    v_mul_f32 v21, v21, v228
    v_mul_f32 v22, v22, v228
    v_mul_f32 v23, v23, v228
    v_cvt_pk_bf16_f32 v104, v16, v17
    v_cvt_pk_bf16_f32 v105, v18, v19
    v_cvt_pk_bf16_f32 v106, v20, v21
    v_cvt_pk_bf16_f32 v107, v22, v23
    v_mul_f32 v24, v24, v228
    v_mul_f32 v25, v25, v228
    v_mul_f32 v26, v26, v228
    v_mul_f32 v27, v27, v228
    v_mul_f32 v28, v28, v228
    v_mul_f32 v29, v29, v228
    v_mul_f32 v30, v30, v228
    v_mul_f32 v31, v31, v228
    v_cvt_pk_bf16_f32 v108, v24, v25
    v_cvt_pk_bf16_f32 v109, v26, v27
    v_cvt_pk_bf16_f32 v110, v28, v29
    v_cvt_pk_bf16_f32 v111, v30, v31
    v_mul_f32 v32, v32, v229
    v_mul_f32 v33, v33, v229
    v_mul_f32 v34, v34, v229
    v_mul_f32 v35, v35, v229
    v_mul_f32 v36, v36, v229
    v_mul_f32 v37, v37, v229
    v_mul_f32 v38, v38, v229
    v_mul_f32 v39, v39, v229
    v_cvt_pk_bf16_f32 v112, v32, v33
    v_cvt_pk_bf16_f32 v113, v34, v35
    v_cvt_pk_bf16_f32 v114, v36, v37
    v_cvt_pk_bf16_f32 v115, v38, v39
    v_mul_f32 v40, v40, v229
    v_mul_f32 v41, v41, v229
    v_mul_f32 v42, v42, v229
    v_mul_f32 v43, v43, v229
    v_mul_f32 v44, v44, v229
    v_mul_f32 v45, v45, v229
    v_mul_f32 v46, v46, v229
    v_mul_f32 v47, v47, v229
    v_cvt_pk_bf16_f32 v116, v40, v41
    v_cvt_pk_bf16_f32 v117, v42, v43
    v_cvt_pk_bf16_f32 v118, v44, v45
    v_cvt_pk_bf16_f32 v119, v46, v47
    v_mul_f32 v48, v48, v229
    v_mul_f32 v49, v49, v229
    v_mul_f32 v50, v50, v229
    v_mul_f32 v51, v51, v229
    v_mul_f32 v52, v52, v229
    v_mul_f32 v53, v53, v229
    v_mul_f32 v54, v54, v229
    v_mul_f32 v55, v55, v229
    v_cvt_pk_bf16_f32 v120, v48, v49
    v_cvt_pk_bf16_f32 v121, v50, v51
    v_cvt_pk_bf16_f32 v122, v52, v53
    v_cvt_pk_bf16_f32 v123, v54, v55
    v_mul_f32 v56, v56, v229
    v_mul_f32 v57, v57, v229
    v_mul_f32 v58, v58, v229
    v_mul_f32 v59, v59, v229
    v_mul_f32 v60, v60, v229
    v_mul_f32 v61, v61, v229
    v_mul_f32 v62, v62, v229
    v_mul_f32 v63, v63, v229
    v_cvt_pk_bf16_f32 v124, v56, v57
    v_cvt_pk_bf16_f32 v125, v58, v59
    v_cvt_pk_bf16_f32 v126, v60, v61
    v_cvt_pk_bf16_f32 v127, v62, v63
    s_barrier
    ds_read_b32 v144, v247 offset:0
    ds_read_b32 v148, v247 offset:64
    ds_read_b32 v145, v247 offset:128
    ds_read_b32 v149, v247 offset:192
    ds_read_b128 v[32:35], v246 offset:0
    ds_read_b128 v[36:39], v246 offset:1024
    ds_read_b128 v[40:43], v246 offset:8192
    ds_read_b128 v[44:47], v246 offset:9216
    s_waitcnt lgkmcnt(5)
    v_max_f32 v244, v144, v145
    v_sub_f32 v152, v144, v244
    v_sub_f32 v153, v145, v244
    v_exp_f32 v152, v152
    v_exp_f32 v153, v153
    v_mul_f32 v244, v152, v148
    s_waitcnt lgkmcnt(4)
    v_fma_f32 v244, v153, v149, v244
    v_rcp_f32 v244, v244
    s_nop 0
    v_mul_f32 v152, v152, v244
    v_mul_f32 v153, v153, v244
    s_waitcnt lgkmcnt(3)
    v_mul_f32 v0, v32, v152
    s_waitcnt lgkmcnt(1)
    v_fma_f32 v0, v40, v153, v0
    v_mul_f32 v1, v33, v152
    v_fma_f32 v1, v41, v153, v1
    v_mul_f32 v2, v34, v152
    v_fma_f32 v2, v42, v153, v2
    v_mul_f32 v3, v35, v152
    v_fma_f32 v3, v43, v153, v3
    v_mul_f32 v4, v36, v152
    s_waitcnt lgkmcnt(0)
    v_fma_f32 v4, v44, v153, v4
    v_mul_f32 v5, v37, v152
    v_fma_f32 v5, v45, v153, v5
    v_mul_f32 v6, v38, v152
    v_fma_f32 v6, v46, v153, v6
    v_mul_f32 v7, v39, v152
    v_fma_f32 v7, v47, v153, v7
    v_cvt_pk_bf16_f32 v128, v0, v1
    v_cvt_pk_bf16_f32 v129, v2, v3
    v_cvt_pk_bf16_f32 v130, v4, v5
    v_cvt_pk_bf16_f32 v131, v6, v7
    s_mov_b32 s30, 0
    buffer_store_dwordx4 v[96:99], v248, s[20:23], s30 offen offset:0 sc1
    buffer_store_dwordx4 v[100:103], v248, s[20:23], s30 offen offset:1024 sc1
    buffer_store_dwordx4 v[104:107], v248, s[20:23], s30 offen offset:2048 sc1
    buffer_store_dwordx4 v[108:111], v248, s[20:23], s30 offen offset:3072 sc1
    s_mov_b32 s30, 4096
    buffer_store_dwordx4 v[112:115], v248, s[20:23], s30 offen offset:0 sc1
    buffer_store_dwordx4 v[116:119], v248, s[20:23], s30 offen offset:1024 sc1
    buffer_store_dwordx4 v[120:123], v248, s[20:23], s30 offen offset:2048 sc1
    buffer_store_dwordx4 v[124:127], v248, s[20:23], s30 offen offset:3072 sc1
    s_mov_b32 s30, 32768
    buffer_store_dwordx4 v[128:131], v248, s[20:23], s30 offen sc1
    s_lshl_b32 s30, s85, 3
    s_add_u32 s30, s30, s84
    s_mul_i32 s44, s30, 52
    s_lshr_b32 s44, s44, 8
    s_mul_i32 s31, s44, 5
    s_sub_u32 s45, s30, s31
    s_and_b32 s51, s2, 1
    s_load_dwordx2 s[72:73], s[0:1], 32
    s_load_dwordx2 s[74:75], s[0:1], 72
    s_load_dwordx2 s[46:47], s[0:1], 80
    s_waitcnt lgkmcnt(0)
    s_cmp_eq_u32 s64, 0
    s_cselect_b64 s[72:73], s[72:73], s[74:75]
    s_lshl_b32 s30, s45, 8
    s_add_u32 s12, s72, s30
    s_addc_u32 s13, s73, 0
    s_sub_u32 s14, 5242880, s30
    s_mov_b32 s15, 131072
    s_mov_b32 s16, s48
    s_mov_b32 s17, s49
    s_mov_b32 s18, 18874368
    s_mov_b32 s19, 131072
    s_add_u32 s80, s48, 50331648
    s_addc_u32 s81, s49, 0
    s_mov_b32 s82, 131072
    s_mov_b32 s83, 131072
    s_mov_b32 s4, s46
    s_mov_b32 s5, s47
    s_mov_b32 s6, 2949120
    s_mov_b32 s7, 131072
    s_add_u32 s8, s48, 33554432
    s_addc_u32 s9, s49, 0
    s_mov_b32 s10, 12582912
    s_mov_b32 s11, 131072
    s_sub_u32 s69, s65, s85
    s_mul_i32 s30, s44, 6
    s_add_u32 s30, s30, 0
    s_mul_i32 s31, s30, 57
    s_lshr_b32 s31, s31, 9
    s_mul_i32 s72, s31, 9
    s_sub_u32 s72, s30, s72
    s_add_u32 s31, s31, s69
    s_lshl_b32 s73, s64, 3
    s_add_u32 s73, s73, s31
    s_lshl_b32 s73, s73, 5
    s_lshl_b32 s74, s51, 4
    s_add_u32 s73, s73, s74
    s_mul_i32 s73, s73, 36864
    s_lshl_b32 s74, s72, 12
    s_add_u32 s32, s73, s74
    s_mul_i32 s73, s31, 144
    s_lshl_b32 s74, s72, 4
    s_add_u32 s73, s73, s74
    s_mul_i32 s73, s73, 2560
    s_mul_i32 s74, s64, 1280
    s_add_u32 s73, s73, s74
    s_lshl_b32 s74, s45, 8
    s_add_u32 s38, s73, s74
    s_mul_i32 s30, s44, 6
    s_add_u32 s30, s30, 1
    s_mul_i32 s31, s30, 57
    s_lshr_b32 s31, s31, 9
    s_mul_i32 s72, s31, 9
    s_sub_u32 s72, s30, s72
    s_add_u32 s31, s31, s69
    s_lshl_b32 s73, s64, 3
    s_add_u32 s73, s73, s31
    s_lshl_b32 s73, s73, 5
    s_lshl_b32 s74, s51, 4
    s_add_u32 s73, s73, s74
    s_mul_i32 s73, s73, 36864
    s_lshl_b32 s74, s72, 12
    s_add_u32 s33, s73, s74
    s_mul_i32 s73, s31, 144
    s_lshl_b32 s74, s72, 4
    s_add_u32 s73, s73, s74
    s_mul_i32 s73, s73, 2560
    s_mul_i32 s74, s64, 1280
    s_add_u32 s73, s73, s74
    s_lshl_b32 s74, s45, 8
    s_add_u32 s39, s73, s74
    s_mul_i32 s30, s44, 6
    s_add_u32 s30, s30, 2
    s_mul_i32 s31, s30, 57
    s_lshr_b32 s31, s31, 9
    s_mul_i32 s72, s31, 9
    s_sub_u32 s72, s30, s72
    s_add_u32 s31, s31, s69
    s_lshl_b32 s73, s64, 3
    s_add_u32 s73, s73, s31
    s_lshl_b32 s73, s73, 5
    s_lshl_b32 s74, s51, 4
    s_add_u32 s73, s73, s74
    s_mul_i32 s73, s73, 36864
    s_lshl_b32 s74, s72, 12
    s_add_u32 s34, s73, s74
    s_mul_i32 s73, s31, 144
    s_lshl_b32 s74, s72, 4
    s_add_u32 s73, s73, s74
    s_mul_i32 s73, s73, 2560
    s_mul_i32 s74, s64, 1280
    s_add_u32 s73, s73, s74
    s_lshl_b32 s74, s45, 8
    s_add_u32 s40, s73, s74
    s_mul_i32 s30, s44, 6
    s_add_u32 s30, s30, 3
    s_mul_i32 s31, s30, 57
    s_lshr_b32 s31, s31, 9
    s_mul_i32 s72, s31, 9
    s_sub_u32 s72, s30, s72
    s_add_u32 s31, s31, s69
    s_lshl_b32 s73, s64, 3
    s_add_u32 s73, s73, s31
    s_lshl_b32 s73, s73, 5
    s_lshl_b32 s74, s51, 4
    s_add_u32 s73, s73, s74
    s_mul_i32 s73, s73, 36864
    s_lshl_b32 s74, s72, 12
    s_add_u32 s35, s73, s74
    s_mul_i32 s73, s31, 144
    s_lshl_b32 s74, s72, 4
    s_add_u32 s73, s73, s74
    s_mul_i32 s73, s73, 2560
    s_mul_i32 s74, s64, 1280
    s_add_u32 s73, s73, s74
    s_lshl_b32 s74, s45, 8
    s_add_u32 s41, s73, s74
    s_mul_i32 s30, s44, 6
    s_add_u32 s30, s30, 4
    s_mul_i32 s31, s30, 57
    s_lshr_b32 s31, s31, 9
    s_mul_i32 s72, s31, 9
    s_sub_u32 s72, s30, s72
    s_add_u32 s31, s31, s69
    s_lshl_b32 s73, s64, 3
    s_add_u32 s73, s73, s31
    s_lshl_b32 s73, s73, 5
    s_lshl_b32 s74, s51, 4
    s_add_u32 s73, s73, s74
    s_mul_i32 s73, s73, 36864
    s_lshl_b32 s74, s72, 12
    s_add_u32 s36, s73, s74
    s_mul_i32 s73, s31, 144
    s_lshl_b32 s74, s72, 4
    s_add_u32 s73, s73, s74
    s_mul_i32 s73, s73, 2560
    s_mul_i32 s74, s64, 1280
    s_add_u32 s73, s73, s74
    s_lshl_b32 s74, s45, 8
    s_add_u32 s42, s73, s74
    s_mul_i32 s30, s44, 6
    s_add_u32 s30, s30, 5
    s_mul_i32 s31, s30, 57
    s_lshr_b32 s31, s31, 9
    s_mul_i32 s72, s31, 9
    s_sub_u32 s72, s30, s72
    s_add_u32 s31, s31, s69
    s_lshl_b32 s73, s64, 3
    s_add_u32 s73, s73, s31
    s_lshl_b32 s73, s73, 5
    s_lshl_b32 s74, s51, 4
    s_add_u32 s73, s73, s74
    s_mul_i32 s73, s73, 36864
    s_lshl_b32 s74, s72, 12
    s_add_u32 s37, s73, s74
    s_mul_i32 s73, s31, 144
    s_lshl_b32 s74, s72, 4
    s_add_u32 s73, s73, s74
    s_mul_i32 s73, s73, 2560
    s_mul_i32 s74, s64, 1280
    s_add_u32 s73, s73, s74
    s_lshl_b32 s74, s45, 8
    s_add_u32 s43, s73, s74
    s_mul_i32 s53, s51, 2621440
    v_lshrrev_b32 v116, 4, v245
    v_and_b32 v117, 15, v245
    v_lshlrev_b32 v118, 1, v116
    v_xor_b32 v117, v117, v118
    v_lshlrev_b32 v117, 4, v117
    v_mul_u32_u24 v116, 1280, v116
    v_add_u32 v114, v116, v117
    v_xor_b32 v117, 128, v117
    v_add_u32 v115, v116, v117
    s_waitcnt vmcnt(0) lgkmcnt(0)
    s_barrier
    s_cmp_ge_u32 s44, 6
    s_cbranch_scc1 K1_END
    s_mov_b32 m0, 12288
    s_add_u32 s30, s53, 0
    buffer_load_dwordx4 v114, s[12:15], s30 offen offset:0 lds
    s_add_u32 s30, s53, 4096
    buffer_load_dwordx4 v115, s[12:15], s30 offen offset:1024 lds
    s_add_u32 s30, s53, 8192
    buffer_load_dwordx4 v114, s[12:15], s30 offen offset:2048 lds
    s_add_u32 s30, s53, 12288
    buffer_load_dwordx4 v115, s[12:15], s30 offen offset:3072 lds
    s_mov_b32 m0, 40960
    s_add_u32 s30, s53, 81920
    buffer_load_dwordx4 v114, s[12:15], s30 offen offset:0 lds
    s_add_u32 s30, s53, 86016
    buffer_load_dwordx4 v115, s[12:15], s30 offen offset:1024 lds
    s_add_u32 s30, s53, 90112
    buffer_load_dwordx4 v114, s[12:15], s30 offen offset:2048 lds
    s_add_u32 s30, s53, 94208
    buffer_load_dwordx4 v115, s[12:15], s30 offen offset:3072 lds
    s_mov_b32 m0, 69632
    s_add_u32 s30, s53, 163840
    buffer_load_dwordx4 v114, s[12:15], s30 offen offset:0 lds
    s_add_u32 s30, s53, 167936
    buffer_load_dwordx4 v115, s[12:15], s30 offen offset:1024 lds
    s_add_u32 s30, s53, 172032
    buffer_load_dwordx4 v114, s[12:15], s30 offen offset:2048 lds
    s_add_u32 s30, s53, 176128
    buffer_load_dwordx4 v115, s[12:15], s30 offen offset:3072 lds
    s_barrier
    s_mov_b32 m0, 0
    s_add_u32 s30, s32, 0
    buffer_load_dwordx4 v248, s[16:19], s30 offen lds
    s_mov_b32 m0, 1024
    s_add_u32 s30, s32, 1024
    buffer_load_dwordx4 v248, s[16:19], s30 offen lds
    s_mov_b32 m0, 2048
    s_add_u32 s30, s33, 0
    buffer_load_dwordx4 v248, s[16:19], s30 offen lds
    s_mov_b32 m0, 28672
    s_add_u32 s30, s32, 2048
    buffer_load_dwordx4 v248, s[16:19], s30 offen lds
    s_mov_b32 m0, 29696
    s_add_u32 s30, s32, 3072
    buffer_load_dwordx4 v248, s[16:19], s30 offen lds
    s_mov_b32 m0, 30720
    s_add_u32 s30, s33, 2048
    buffer_load_dwordx4 v248, s[16:19], s30 offen lds
    s_mov_b32 m0, 57344
    s_add_u32 s30, s32, 36864
    buffer_load_dwordx4 v248, s[16:19], s30 offen lds
    s_mov_b32 m0, 58368
    s_add_u32 s30, s32, 37888
    buffer_load_dwordx4 v248, s[16:19], s30 offen lds
    s_mov_b32 m0, 59392
    s_add_u32 s30, s33, 36864
    buffer_load_dwordx4 v248, s[16:19], s30 offen lds
    s_mov_b32 s58, 0
K1W0_TL:
    s_cmp_eq_u32 s58, 0
    s_cbranch_scc0 K1W0_TLw0
    s_waitcnt vmcnt(6)
    s_branch K1W0_TLx0
K1W0_TLw0:
    s_waitcnt vmcnt(14)
K1W0_TLx0:
    s_barrier
    s_mov_b32 m0, 86016
    s_add_u32 s30, s32, 38912
    buffer_load_dwordx4 v248, s[16:19], s30 offen lds
    s_mov_b32 m0, 87040
    s_add_u32 s30, s32, 39936
    buffer_load_dwordx4 v248, s[16:19], s30 offen lds
    s_mov_b32 m0, 88064
    s_add_u32 s30, s33, 38912
    buffer_load_dwordx4 v248, s[16:19], s30 offen lds
    s_mov_b32 m0, 98304
    s_add_u32 s30, s53, 245760
    buffer_load_dwordx4 v114, s[12:15], s30 offen offset:0 lds
    s_add_u32 s30, s53, 249856
    buffer_load_dwordx4 v115, s[12:15], s30 offen offset:1024 lds
    s_add_u32 s30, s53, 253952
    buffer_load_dwordx4 v114, s[12:15], s30 offen offset:2048 lds
    s_add_u32 s30, s53, 258048
    buffer_load_dwordx4 v115, s[12:15], s30 offen offset:3072 lds
    s_cmp_eq_u32 s58, 0
    s_cbranch_scc0 K1W0_TLw1
    s_waitcnt vmcnt(10)
    s_branch K1W0_TLx1
K1W0_TLw1:
    s_waitcnt vmcnt(14)
K1W0_TLx1:
    s_barrier
    s_cmp_eq_u32 s58, 7
    s_cbranch_scc1 K1W0_TLs1
    s_mov_b32 m0, 0
    s_add_u32 s30, s32, 73728
    buffer_load_dwordx4 v248, s[16:19], s30 offen lds
    s_mov_b32 m0, 1024
    s_add_u32 s30, s32, 74752
    buffer_load_dwordx4 v248, s[16:19], s30 offen lds
    s_mov_b32 m0, 2048
    s_add_u32 s30, s33, 73728
    buffer_load_dwordx4 v248, s[16:19], s30 offen lds
    s_mov_b32 m0, 12288
    s_add_u32 s30, s53, 327680
    buffer_load_dwordx4 v114, s[12:15], s30 offen offset:0 lds
    s_add_u32 s30, s53, 331776
    buffer_load_dwordx4 v115, s[12:15], s30 offen offset:1024 lds
    s_add_u32 s30, s53, 335872
    buffer_load_dwordx4 v114, s[12:15], s30 offen offset:2048 lds
    s_add_u32 s30, s53, 339968
    buffer_load_dwordx4 v115, s[12:15], s30 offen offset:3072 lds
K1W0_TLs1:
    s_cmp_eq_u32 s58, 0
    s_cbranch_scc0 K1W0_TLw2
    s_waitcnt vmcnt(14)
    s_branch K1W0_TLx2
K1W0_TLw2:
    s_cmp_eq_u32 s58, 7
    s_cbranch_scc0 K1W0_TLu2
    s_waitcnt vmcnt(7)
    s_branch K1W0_TLx2
K1W0_TLu2:
    s_waitcnt vmcnt(14)
K1W0_TLx2:
    s_barrier
    s_cmp_eq_u32 s58, 7
    s_cbranch_scc1 K1W0_TLs2
    s_mov_b32 m0, 28672
    s_add_u32 s30, s32, 75776
    buffer_load_dwordx4 v248, s[16:19], s30 offen lds
    s_mov_b32 m0, 29696
    s_add_u32 s30, s32, 76800
    buffer_load_dwordx4 v248, s[16:19], s30 offen lds
    s_mov_b32 m0, 30720
    s_add_u32 s30, s33, 75776
    buffer_load_dwordx4 v248, s[16:19], s30 offen lds
    s_mov_b32 m0, 40960
    s_add_u32 s30, s53, 409600
    buffer_load_dwordx4 v114, s[12:15], s30 offen offset:0 lds
    s_add_u32 s30, s53, 413696
    buffer_load_dwordx4 v115, s[12:15], s30 offen offset:1024 lds
    s_add_u32 s30, s53, 417792
    buffer_load_dwordx4 v114, s[12:15], s30 offen offset:2048 lds
    s_add_u32 s30, s53, 421888
    buffer_load_dwordx4 v115, s[12:15], s30 offen offset:3072 lds
K1W0_TLs2:
    s_cmp_eq_u32 s58, 7
    s_cbranch_scc0 K1W0_TLu3
    s_waitcnt vmcnt(0)
    s_branch K1W0_TLx3
K1W0_TLu3:
    s_waitcnt vmcnt(14)
K1W0_TLx3:
    s_barrier
    s_cmp_eq_u32 s58, 7
    s_cbranch_scc1 K1W0_TLs3
    s_mov_b32 m0, 57344
    s_add_u32 s30, s32, 110592
    buffer_load_dwordx4 v248, s[16:19], s30 offen lds
    s_mov_b32 m0, 58368
    s_add_u32 s30, s32, 111616
    buffer_load_dwordx4 v248, s[16:19], s30 offen lds
    s_mov_b32 m0, 59392
    s_add_u32 s30, s33, 110592
    buffer_load_dwordx4 v248, s[16:19], s30 offen lds
    s_mov_b32 m0, 69632
    s_add_u32 s30, s53, 491520
    buffer_load_dwordx4 v114, s[12:15], s30 offen offset:0 lds
    s_add_u32 s30, s53, 495616
    buffer_load_dwordx4 v115, s[12:15], s30 offen offset:1024 lds
    s_add_u32 s30, s53, 499712
    buffer_load_dwordx4 v114, s[12:15], s30 offen offset:2048 lds
    s_add_u32 s30, s53, 503808
    buffer_load_dwordx4 v115, s[12:15], s30 offen offset:3072 lds
K1W0_TLs3:
    s_add_u32 s32, s32, 73728
    s_add_u32 s33, s33, 73728
    s_add_u32 s34, s34, 73728
    s_add_u32 s35, s35, 73728
    s_add_u32 s36, s36, 73728
    s_add_u32 s37, s37, 73728
    s_add_u32 s53, s53, 327680
    s_add_u32 s58, s58, 1
    s_cmp_lt_u32 s58, 8
    s_cbranch_scc1 K1W0_TL
    s_endpgm
K1W0_slow0:
    s_nop 7
    ds_read_b128 v[196:199], v234 offset:0
    ds_read_b128 v[200:203], v235 offset:0
    ds_read_b128 v[204:207], v236 offset:0
    ds_read_b128 v[208:211], v237 offset:0
    ds_read_b128 v[212:215], v234 offset:4096
    ds_read_b128 v[216:219], v235 offset:4096
    ds_read_b128 v[220:223], v236 offset:4096
    ds_read_b128 v[224:227], v237 offset:4096
    s_waitcnt lgkmcnt(7)
    v_mfma_f32_16x16x32_bf16 v[144:147], v[196:199], v[96:99], 0
    v_mfma_f32_16x16x32_bf16 v[160:163], v[196:199], v[112:115], 0
    s_waitcnt lgkmcnt(6)
    v_mfma_f32_16x16x32_bf16 v[144:147], v[200:203], v[100:103], v[144:147]
    v_mfma_f32_16x16x32_bf16 v[160:163], v[200:203], v[116:119], v[160:163]
    s_waitcnt lgkmcnt(5)
    v_mfma_f32_16x16x32_bf16 v[144:147], v[204:207], v[104:107], v[144:147]
    v_mfma_f32_16x16x32_bf16 v[160:163], v[204:207], v[120:123], v[160:163]
    s_waitcnt lgkmcnt(4)
    v_mfma_f32_16x16x32_bf16 v[144:147], v[208:211], v[108:111], v[144:147]
    v_mfma_f32_16x16x32_bf16 v[160:163], v[208:211], v[124:127], v[160:163]
    ds_read_b128 v[196:199], v234 offset:8192
    ds_read_b128 v[200:203], v235 offset:8192
    ds_read_b128 v[204:207], v236 offset:8192
    ds_read_b128 v[208:211], v237 offset:8192
    s_waitcnt lgkmcnt(7)
    v_mfma_f32_16x16x32_bf16 v[148:151], v[212:215], v[96:99], 0
    v_mfma_f32_16x16x32_bf16 v[164:167], v[212:215], v[112:115], 0
    s_waitcnt lgkmcnt(6)
    v_mfma_f32_16x16x32_bf16 v[148:151], v[216:219], v[100:103], v[148:151]
    v_mfma_f32_16x16x32_bf16 v[164:167], v[216:219], v[116:119], v[164:167]
    s_waitcnt lgkmcnt(5)
    v_mfma_f32_16x16x32_bf16 v[148:151], v[220:223], v[104:107], v[148:151]
    v_mfma_f32_16x16x32_bf16 v[164:167], v[220:223], v[120:123], v[164:167]
    s_waitcnt lgkmcnt(4)
    v_mfma_f32_16x16x32_bf16 v[148:151], v[224:227], v[108:111], v[148:151]
    v_mfma_f32_16x16x32_bf16 v[164:167], v[224:227], v[124:127], v[164:167]
    ds_read_b128 v[212:215], v234 offset:12288
    ds_read_b128 v[216:219], v235 offset:12288
    ds_read_b128 v[220:223], v236 offset:12288
    ds_read_b128 v[224:227], v237 offset:12288
    s_waitcnt lgkmcnt(7)
    v_mfma_f32_16x16x32_bf16 v[152:155], v[196:199], v[96:99], 0
    v_mfma_f32_16x16x32_bf16 v[168:171], v[196:199], v[112:115], 0
    s_waitcnt lgkmcnt(6)
    v_mfma_f32_16x16x32_bf16 v[152:155], v[200:203], v[100:103], v[152:155]
    v_mfma_f32_16x16x32_bf16 v[168:171], v[200:203], v[116:119], v[168:171]
    s_waitcnt lgkmcnt(5)
    v_mfma_f32_16x16x32_bf16 v[152:155], v[204:207], v[104:107], v[152:155]
    v_mfma_f32_16x16x32_bf16 v[168:171], v[204:207], v[120:123], v[168:171]
    s_waitcnt lgkmcnt(4)
    v_mfma_f32_16x16x32_bf16 v[152:155], v[208:211], v[108:111], v[152:155]
    v_mfma_f32_16x16x32_bf16 v[168:171], v[208:211], v[124:127], v[168:171]
    s_waitcnt lgkmcnt(3)
    v_mfma_f32_16x16x32_bf16 v[156:159], v[212:215], v[96:99], 0
    v_mfma_f32_16x16x32_bf16 v[172:175], v[212:215], v[112:115], 0
    s_waitcnt lgkmcnt(2)
    v_mfma_f32_16x16x32_bf16 v[156:159], v[216:219], v[100:103], v[156:159]
    v_mfma_f32_16x16x32_bf16 v[172:175], v[216:219], v[116:119], v[172:175]
    s_waitcnt lgkmcnt(1)
    v_mfma_f32_16x16x32_bf16 v[156:159], v[220:223], v[104:107], v[156:159]
    v_mfma_f32_16x16x32_bf16 v[172:175], v[220:223], v[120:123], v[172:175]
    s_waitcnt lgkmcnt(0)
    v_mfma_f32_16x16x32_bf16 v[156:159], v[224:227], v[108:111], v[156:159]
    v_mfma_f32_16x16x32_bf16 v[172:175], v[224:227], v[124:127], v[172:175]
    v_max3_f32 v243, v144, v145, v146
    v_max3_f32 v243, v243, v147, v148
    v_max3_f32 v243, v243, v149, v150
    v_max3_f32 v243, v243, v151, v152
    v_max3_f32 v243, v243, v153, v154
    s_nop 1
    v_max3_f32 v243, v243, v155, v156
    v_max3_f32 v243, v243, v157, v158
    v_max_f32 v243, v243, v159
    v_mov_b32 v244, v243
    s_nop 1
    v_permlane16_swap_b32 v244, v243
    v_max_f32 v243, v243, v244
    v_mov_b32 v244, v243
    s_nop 1
    v_permlane32_swap_b32 v244, v243
    v_max_f32 v243, v243, v244
    v_sub_f32 v244, 0, v184
    v_max_f32 v243, v243, v244
    v_sub_f32 v244, v244, v243
    v_exp_f32 v244, v244
    v_sub_f32 v184, 0, v243
    v_sub_f32 v185, 0, v243
    v_sub_f32 v186, 0, v243
    v_sub_f32 v187, 0, v243
    v_mul_f32 v0, v0, v244
    v_mul_f32 v1, v1, v244
    v_mul_f32 v2, v2, v244
    v_mul_f32 v3, v3, v244
    v_mul_f32 v4, v4, v244
    v_mul_f32 v5, v5, v244
    v_mul_f32 v6, v6, v244
    v_mul_f32 v7, v7, v244
    v_mul_f32 v8, v8, v244
    v_mul_f32 v9, v9, v244
    v_mul_f32 v10, v10, v244
    v_mul_f32 v11, v11, v244
    v_mul_f32 v12, v12, v244
    v_mul_f32 v13, v13, v244
    v_mul_f32 v14, v14, v244
    v_mul_f32 v15, v15, v244
    v_mul_f32 v16, v16, v244
    v_mul_f32 v17, v17, v244
    v_mul_f32 v18, v18, v244
    v_mul_f32 v19, v19, v244
    v_mul_f32 v20, v20, v244
    v_mul_f32 v21, v21, v244
    v_mul_f32 v22, v22, v244
    v_mul_f32 v23, v23, v244
    v_mul_f32 v24, v24, v244
    v_mul_f32 v25, v25, v244
    v_mul_f32 v26, v26, v244
    v_mul_f32 v27, v27, v244
    v_mul_f32 v28, v28, v244
    v_mul_f32 v29, v29, v244
    v_mul_f32 v30, v30, v244
    v_mul_f32 v31, v31, v244
    v_mul_f32 v228, v228, v244
    v_sub_f32 v144, v144, v243
    v_sub_f32 v145, v145, v243
    v_sub_f32 v146, v146, v243
    v_sub_f32 v147, v147, v243
    v_sub_f32 v148, v148, v243
    v_sub_f32 v149, v149, v243
    v_sub_f32 v150, v150, v243
    v_sub_f32 v151, v151, v243
    v_sub_f32 v152, v152, v243
    v_sub_f32 v153, v153, v243
    v_sub_f32 v154, v154, v243
    v_sub_f32 v155, v155, v243
    v_sub_f32 v156, v156, v243
    v_sub_f32 v157, v157, v243
    v_sub_f32 v158, v158, v243
    v_sub_f32 v159, v159, v243
    v_max3_f32 v243, v160, v161, v162
    v_max3_f32 v243, v243, v163, v164
    v_max3_f32 v243, v243, v165, v166
    v_max3_f32 v243, v243, v167, v168
    v_max3_f32 v243, v243, v169, v170
    v_max3_f32 v243, v243, v171, v172
    v_max3_f32 v243, v243, v173, v174
    v_max_f32 v243, v243, v175
    v_mov_b32 v244, v243
    s_nop 1
    v_permlane16_swap_b32 v244, v243
    v_max_f32 v243, v243, v244
    v_mov_b32 v244, v243
    s_nop 1
    v_permlane32_swap_b32 v244, v243
    v_max_f32 v243, v243, v244
    v_sub_f32 v244, 0, v188
    v_max_f32 v243, v243, v244
    v_sub_f32 v244, v244, v243
    v_exp_f32 v244, v244
    v_sub_f32 v188, 0, v243
    v_sub_f32 v189, 0, v243
    v_sub_f32 v190, 0, v243
    v_sub_f32 v191, 0, v243
    v_mul_f32 v32, v32, v244
    v_mul_f32 v33, v33, v244
    v_mul_f32 v34, v34, v244
    v_mul_f32 v35, v35, v244
    v_mul_f32 v36, v36, v244
    v_mul_f32 v37, v37, v244
    v_mul_f32 v38, v38, v244
    v_mul_f32 v39, v39, v244
    v_mul_f32 v40, v40, v244
    v_mul_f32 v41, v41, v244
    v_mul_f32 v42, v42, v244
    v_mul_f32 v43, v43, v244
    v_mul_f32 v44, v44, v244
    v_mul_f32 v45, v45, v244
    v_mul_f32 v46, v46, v244
    v_mul_f32 v47, v47, v244
    v_mul_f32 v48, v48, v244
    v_mul_f32 v49, v49, v244
    v_mul_f32 v50, v50, v244
    v_mul_f32 v51, v51, v244
    v_mul_f32 v52, v52, v244
    v_mul_f32 v53, v53, v244
    v_mul_f32 v54, v54, v244
    v_mul_f32 v55, v55, v244
    v_mul_f32 v56, v56, v244
    v_mul_f32 v57, v57, v244
    v_mul_f32 v58, v58, v244
    v_mul_f32 v59, v59, v244
    v_mul_f32 v60, v60, v244
    v_mul_f32 v61, v61, v244
    v_mul_f32 v62, v62, v244
    v_mul_f32 v63, v63, v244
    v_mul_f32 v229, v229, v244
    v_sub_f32 v160, v160, v243
    v_sub_f32 v161, v161, v243
    v_sub_f32 v162, v162, v243
    v_sub_f32 v163, v163, v243
    v_sub_f32 v164, v164, v243
    v_sub_f32 v165, v165, v243
    v_sub_f32 v166, v166, v243
    v_sub_f32 v167, v167, v243
    v_sub_f32 v168, v168, v243
    v_sub_f32 v169, v169, v243
    v_sub_f32 v170, v170, v243
    v_sub_f32 v171, v171, v243
    v_sub_f32 v172, v172, v243
    v_sub_f32 v173, v173, v243
    v_sub_f32 v174, v174, v243
    v_sub_f32 v175, v175, v243
    v_exp_f32 v144, v144
    v_exp_f32 v145, v145
    v_exp_f32 v146, v146
    v_exp_f32 v147, v147
    v_exp_f32 v160, v160
    v_exp_f32 v161, v161
    v_exp_f32 v162, v162
    v_exp_f32 v163, v163
    v_exp_f32 v148, v148
    v_exp_f32 v149, v149
    v_exp_f32 v150, v150
    v_exp_f32 v151, v151
    v_exp_f32 v164, v164
    v_exp_f32 v165, v165
    v_exp_f32 v166, v166
    v_exp_f32 v167, v167
    v_add_f32 v231, v144, v145
    v_add_f32 v231, v231, v146
    v_add_f32 v231, v231, v147
    v_add_f32 v232, v160, v161
    v_add_f32 v232, v232, v162
    v_add_f32 v232, v232, v163
    v_add_f32 v231, v231, v148
    v_add_f32 v231, v231, v149
    v_add_f32 v231, v231, v150
    v_add_f32 v231, v231, v151
    v_add_f32 v232, v232, v164
    v_add_f32 v232, v232, v165
    v_add_f32 v232, v232, v166
    v_add_f32 v232, v232, v167
    v_cvt_pk_bf16_f32 v144, v144, v145
    v_cvt_pk_bf16_f32 v145, v146, v147
    v_cvt_pk_bf16_f32 v146, v148, v149
    v_cvt_pk_bf16_f32 v147, v150, v151
    v_cvt_pk_bf16_f32 v160, v160, v161
    v_cvt_pk_bf16_f32 v161, v162, v163
    v_cvt_pk_bf16_f32 v162, v164, v165
    v_cvt_pk_bf16_f32 v163, v166, v167
    s_nop 1
    s_branch K1W0_back0
K1W0_slow1:
    s_nop 7
    ds_read_b128 v[196:199], v234 offset:8192
    ds_read_b128 v[200:203], v235 offset:8192
    ds_read_b128 v[204:207], v236 offset:8192
    ds_read_b128 v[208:211], v237 offset:8192
    ds_read_b128 v[212:215], v234 offset:12288
    ds_read_b128 v[216:219], v235 offset:12288
    ds_read_b128 v[220:223], v236 offset:12288
    ds_read_b128 v[224:227], v237 offset:12288
    s_waitcnt lgkmcnt(7)
    v_mfma_f32_16x16x32_bf16 v[152:155], v[196:199], v[96:99], 0
    v_mfma_f32_16x16x32_bf16 v[168:171], v[196:199], v[112:115], 0
    s_waitcnt lgkmcnt(6)
    v_mfma_f32_16x16x32_bf16 v[152:155], v[200:203], v[100:103], v[152:155]
    v_mfma_f32_16x16x32_bf16 v[168:171], v[200:203], v[116:119], v[168:171]
    s_waitcnt lgkmcnt(5)
    v_mfma_f32_16x16x32_bf16 v[152:155], v[204:207], v[104:107], v[152:155]
    v_mfma_f32_16x16x32_bf16 v[168:171], v[204:207], v[120:123], v[168:171]
    s_waitcnt lgkmcnt(4)
    v_mfma_f32_16x16x32_bf16 v[152:155], v[208:211], v[108:111], v[152:155]
    v_mfma_f32_16x16x32_bf16 v[168:171], v[208:211], v[124:127], v[168:171]
    s_waitcnt lgkmcnt(3)
    v_mfma_f32_16x16x32_bf16 v[156:159], v[212:215], v[96:99], 0
    v_mfma_f32_16x16x32_bf16 v[172:175], v[212:215], v[112:115], 0
    s_waitcnt lgkmcnt(2)
    v_mfma_f32_16x16x32_bf16 v[156:159], v[216:219], v[100:103], v[156:159]
    v_mfma_f32_16x16x32_bf16 v[172:175], v[216:219], v[116:119], v[172:175]
    s_waitcnt lgkmcnt(1)
    v_mfma_f32_16x16x32_bf16 v[156:159], v[220:223], v[104:107], v[156:159]
    v_mfma_f32_16x16x32_bf16 v[172:175], v[220:223], v[120:123], v[172:175]
    s_waitcnt lgkmcnt(0)
    v_mfma_f32_16x16x32_bf16 v[156:159], v[224:227], v[108:111], v[156:159]
    v_mfma_f32_16x16x32_bf16 v[172:175], v[224:227], v[124:127], v[172:175]
    v_max3_f32 v243, v152, v153, v154
    s_nop 5
    v_max3_f32 v243, v243, v155, v156
    v_max3_f32 v243, v243, v157, v158
    v_max_f32 v243, v243, v159
    v_mov_b32 v244, v243
    s_nop 1
    v_permlane16_swap_b32 v244, v243
    v_max_f32 v243, v243, v244
    v_mov_b32 v244, v243
    s_nop 1
    v_permlane32_swap_b32 v244, v243
    v_max_f32 v243, v243, v244
    v_sub_f32 v244, 0, v184
    v_max_f32 v243, v243, v244
    v_sub_f32 v244, v244, v243
    v_exp_f32 v244, v244
    v_sub_f32 v184, 0, v243
    v_sub_f32 v185, 0, v243
    v_sub_f32 v186, 0, v243
    v_sub_f32 v187, 0, v243
    v_mul_f32 v0, v0, v244
    v_mul_f32 v1, v1, v244
    v_mul_f32 v2, v2, v244
    v_mul_f32 v3, v3, v244
    v_mul_f32 v4, v4, v244
    v_mul_f32 v5, v5, v244
    v_mul_f32 v6, v6, v244
    v_mul_f32 v7, v7, v244
    v_mul_f32 v8, v8, v244
    v_mul_f32 v9, v9, v244
    v_mul_f32 v10, v10, v244
    v_mul_f32 v11, v11, v244
    v_mul_f32 v12, v12, v244
    v_mul_f32 v13, v13, v244
    v_mul_f32 v14, v14, v244
    v_mul_f32 v15, v15, v244
    v_mul_f32 v16, v16, v244
    v_mul_f32 v17, v17, v244
    v_mul_f32 v18, v18, v244
    v_mul_f32 v19, v19, v244
    v_mul_f32 v20, v20, v244
    v_mul_f32 v21, v21, v244
    v_mul_f32 v22, v22, v244
    v_mul_f32 v23, v23, v244
    v_mul_f32 v24, v24, v244
    v_mul_f32 v25, v25, v244
    v_mul_f32 v26, v26, v244
    v_mul_f32 v27, v27, v244
    v_mul_f32 v28, v28, v244
    v_mul_f32 v29, v29, v244
    v_mul_f32 v30, v30, v244
    v_mul_f32 v31, v31, v244
    v_mul_f32 v228, v228, v244
    v_sub_f32 v152, v152, v243
    v_sub_f32 v153, v153, v243
    v_sub_f32 v154, v154, v243
    v_sub_f32 v155, v155, v243
    v_sub_f32 v156, v156, v243
    v_sub_f32 v157, v157, v243
    v_sub_f32 v158, v158, v243
    v_sub_f32 v159, v159, v243
    v_max3_f32 v243, v168, v169, v170
    v_max3_f32 v243, v243, v171, v172
    v_max3_f32 v243, v243, v173, v174
    v_max_f32 v243, v243, v175
    v_mov_b32 v244, v243
    s_nop 1
    v_permlane16_swap_b32 v244, v243
    v_max_f32 v243, v243, v244
    v_mov_b32 v244, v243
    s_nop 1
    v_permlane32_swap_b32 v244, v243
    v_max_f32 v243, v243, v244
    v_sub_f32 v244, 0, v188
    v_max_f32 v243, v243, v244
    v_sub_f32 v244, v244, v243
    v_exp_f32 v244, v244
    v_sub_f32 v188, 0, v243
    v_sub_f32 v189, 0, v243
    v_sub_f32 v190, 0, v243
    v_sub_f32 v191, 0, v243
    v_mul_f32 v32, v32, v244
    v_mul_f32 v33, v33, v244
    v_mul_f32 v34, v34, v244
    v_mul_f32 v35, v35, v244
    v_mul_f32 v36, v36, v244
    v_mul_f32 v37, v37, v244
    v_mul_f32 v38, v38, v244
    v_mul_f32 v39, v39, v244
    v_mul_f32 v40, v40, v244
    v_mul_f32 v41, v41, v244
    v_mul_f32 v42, v42, v244
    v_mul_f32 v43, v43, v244
    v_mul_f32 v44, v44, v244
    v_mul_f32 v45, v45, v244
    v_mul_f32 v46, v46, v244
    v_mul_f32 v47, v47, v244
    v_mul_f32 v48, v48, v244
    v_mul_f32 v49, v49, v244
    v_mul_f32 v50, v50, v244
    v_mul_f32 v51, v51, v244
    v_mul_f32 v52, v52, v244
    v_mul_f32 v53, v53, v244
    v_mul_f32 v54, v54, v244
    v_mul_f32 v55, v55, v244
    v_mul_f32 v56, v56, v244
    v_mul_f32 v57, v57, v244
    v_mul_f32 v58, v58, v244
    v_mul_f32 v59, v59, v244
    v_mul_f32 v60, v60, v244
    v_mul_f32 v61, v61, v244
    v_mul_f32 v62, v62, v244
    v_mul_f32 v63, v63, v244
    v_mul_f32 v229, v229, v244
    v_sub_f32 v168, v168, v243
    v_sub_f32 v169, v169, v243
    v_sub_f32 v170, v170, v243
    v_sub_f32 v171, v171, v243
    v_sub_f32 v172, v172, v243
    v_sub_f32 v173, v173, v243
    v_sub_f32 v174, v174, v243
    v_sub_f32 v175, v175, v243
    v_exp_f32 v152, v152
    v_exp_f32 v153, v153
    v_exp_f32 v154, v154
    v_exp_f32 v155, v155
    v_exp_f32 v168, v168
    v_exp_f32 v169, v169
    v_exp_f32 v170, v170
    v_exp_f32 v171, v171
    v_exp_f32 v156, v156
    v_exp_f32 v157, v157
    v_exp_f32 v158, v158
    v_exp_f32 v159, v159
    v_exp_f32 v172, v172
    v_exp_f32 v173, v173
    v_exp_f32 v174, v174
    v_exp_f32 v175, v175
    v_add_f32 v231, v152, v153
    v_add_f32 v231, v231, v154
    v_add_f32 v231, v231, v155
    v_add_f32 v232, v168, v169
    v_add_f32 v232, v232, v170
    v_add_f32 v232, v232, v171
    v_add_f32 v231, v231, v156
    v_add_f32 v231, v231, v157
    v_add_f32 v231, v231, v158
    v_add_f32 v231, v231, v159
    v_add_f32 v232, v232, v172
    v_add_f32 v232, v232, v173
    v_add_f32 v232, v232, v174
    v_add_f32 v232, v232, v175
    v_cvt_pk_bf16_f32 v148, v152, v153
    v_cvt_pk_bf16_f32 v149, v154, v155
    v_cvt_pk_bf16_f32 v150, v156, v157
    v_cvt_pk_bf16_f32 v151, v158, v159
    v_cvt_pk_bf16_f32 v164, v168, v169
    v_cvt_pk_bf16_f32 v165, v170, v171
    v_cvt_pk_bf16_f32 v166, v172, v173
    v_cvt_pk_bf16_f32 v167, v174, v175
    ds_read_b64_tr_b16 v[196:197], v238 offset:8192
    ds_read_b64_tr_b16 v[198:199], v238 offset:12288
    v_xor_b32 v240, 32, v238
    ds_read_b64_tr_b16 v[200:201], v240 offset:8192
    ds_read_b64_tr_b16 v[202:203], v240 offset:12288
    v_xor_b32 v239, 64, v238
    ds_read_b64_tr_b16 v[204:205], v239 offset:8192
    ds_read_b64_tr_b16 v[206:207], v239 offset:12288
    v_xor_b32 v240, 96, v238
    ds_read_b64_tr_b16 v[208:209], v240 offset:8192
    ds_read_b64_tr_b16 v[210:211], v240 offset:12288
    v_xor_b32 v239, 128, v238
    ds_read_b64_tr_b16 v[212:213], v239 offset:8192
    ds_read_b64_tr_b16 v[214:215], v239 offset:12288
    v_xor_b32 v240, 160, v238
    ds_read_b64_tr_b16 v[216:217], v240 offset:8192
    ds_read_b64_tr_b16 v[218:219], v240 offset:12288
    v_xor_b32 v239, 192, v238
    ds_read_b64_tr_b16 v[220:221], v239 offset:8192
    ds_read_b64_tr_b16 v[222:223], v239 offset:12288
    v_xor_b32 v240, 224, v238
    ds_read_b64_tr_b16 v[224:225], v240 offset:8192
    ds_read_b64_tr_b16 v[226:227], v240 offset:12288
    s_waitcnt lgkmcnt(0)
    s_nop 1
    s_branch K1W0_back1
K1W1_START:
    s_lshl_b32 s58, s26, 14
    s_add_u32 s58, s58, 22528
    s_lshl_b32 s30, s26, 3
    s_add_u32 s30, s30, 2
    s_lshl_b32 s59, s30, 10
    s_mul_i32 s60, s30, 10240
    s_lshl_b32 s30, s26, 14
    s_add_u32 s30, s30, 53248
    v_add_u32 v196, s30, v196
    v_add_u32 v197, s30, v197
    v_add_u32 v198, s30, v198
    v_add_u32 v199, s30, v199
    v_add_u32 v200, s30, v200
    v_add_u32 v201, s30, v201
    v_add_u32 v202, s30, v202
    v_add_u32 v203, s30, v203
    v_add_u32 v204, 53248, v204
    v_add_u32 v205, 53248, v205
    s_mov_b32 s52, 0
    s_mov_b32 s53, 0
    s_mov_b32 s56, 102400
    s_add_u32 m0, s56, s58
    s_add_u32 s30, s52, 131072
    buffer_load_dwordx4 v206, s[12:15], s30 offen offset:0 lds
    s_add_u32 s30, s52, 162816
    buffer_load_dwordx4 v206, s[12:15], s30 offen offset:1024 lds
    s_add_u32 s30, s52, 194560
    buffer_load_dwordx4 v207, s[12:15], s30 offen offset:2048 lds
    s_add_u32 s30, s52, 226304
    buffer_load_dwordx4 v207, s[12:15], s30 offen offset:3072 lds
    s_add_u32 m0, s56, s59
    s_add_u32 s30, s53, s60
    buffer_load_dwordx4 v208, s[16:19], s30 offen lds
    s_add_u32 s30, s30, 9216
    buffer_load_dwordx4 v209, s[16:19], s30 offen offset:1024 lds
    s_add_u32 s52, s52, 524288
    s_add_u32 s53, s53, 128
    s_mov_b32 s56, 0
    s_add_u32 m0, s56, s58
    s_add_u32 s30, s52, 131072
    buffer_load_dwordx4 v206, s[12:15], s30 offen offset:0 lds
    s_add_u32 s30, s52, 162816
    buffer_load_dwordx4 v206, s[12:15], s30 offen offset:1024 lds
    s_add_u32 s30, s52, 194560
    buffer_load_dwordx4 v207, s[12:15], s30 offen offset:2048 lds
    s_add_u32 s30, s52, 226304
    buffer_load_dwordx4 v207, s[12:15], s30 offen offset:3072 lds
    s_add_u32 m0, s56, s59
    s_add_u32 s30, s53, s60
    buffer_load_dwordx4 v208, s[16:19], s30 offen lds
    s_add_u32 s30, s30, 9216
    buffer_load_dwordx4 v209, s[16:19], s30 offen offset:1024 lds
    s_add_u32 s52, s52, 524288
    s_add_u32 s53, s53, 128
    v_mov_b32 v0, 0
    v_mov_b32 v1, 0
    v_mov_b32 v2, 0
    v_mov_b32 v3, 0
    v_mov_b32 v4, 0
    v_mov_b32 v5, 0
    v_mov_b32 v6, 0
    v_mov_b32 v7, 0
    v_mov_b32 v8, 0
    v_mov_b32 v9, 0
    v_mov_b32 v10, 0
    v_mov_b32 v11, 0
    v_mov_b32 v12, 0
    v_mov_b32 v13, 0
    v_mov_b32 v14, 0
    v_mov_b32 v15, 0
    v_mov_b32 v16, 0
    v_mov_b32 v17, 0
    v_mov_b32 v18, 0
    v_mov_b32 v19, 0
    v_mov_b32 v20, 0
    v_mov_b32 v21, 0
    v_mov_b32 v22, 0
    v_mov_b32 v23, 0
    v_mov_b32 v24, 0
    v_mov_b32 v25, 0
    v_mov_b32 v26, 0
    v_mov_b32 v27, 0
    v_mov_b32 v28, 0
    v_mov_b32 v29, 0
    v_mov_b32 v30, 0
    v_mov_b32 v31, 0
    v_mov_b32 v32, 0
    v_mov_b32 v33, 0
    v_mov_b32 v34, 0
    v_mov_b32 v35, 0
    v_mov_b32 v36, 0
    v_mov_b32 v37, 0
    v_mov_b32 v38, 0
    v_mov_b32 v39, 0
    v_mov_b32 v40, 0
    v_mov_b32 v41, 0
    v_mov_b32 v42, 0
    v_mov_b32 v43, 0
    v_mov_b32 v44, 0
    v_mov_b32 v45, 0
    v_mov_b32 v46, 0
    v_mov_b32 v47, 0
    v_mov_b32 v48, 0
    v_mov_b32 v49, 0
    v_mov_b32 v50, 0
    v_mov_b32 v51, 0
    v_mov_b32 v52, 0
    v_mov_b32 v53, 0
    v_mov_b32 v54, 0
    v_mov_b32 v55, 0
    v_mov_b32 v56, 0
    v_mov_b32 v57, 0
    v_mov_b32 v58, 0
    v_mov_b32 v59, 0
    v_mov_b32 v60, 0
    v_mov_b32 v61, 0
    v_mov_b32 v62, 0
    v_mov_b32 v63, 0
    v_mov_b32 v64, 0
    v_mov_b32 v65, 0
    v_mov_b32 v66, 0
    v_mov_b32 v67, 0
    v_mov_b32 v68, 0
    v_mov_b32 v69, 0
    v_mov_b32 v70, 0
    v_mov_b32 v71, 0
    s_waitcnt vmcnt(6)
    s_barrier
    s_mov_b32 s56, 51200
    ds_read_b128 v[160:163], v204 offset:4096
    ds_read_b128 v[164:167], v204 offset:6144
    ds_read_b128 v[168:171], v204 offset:16384
    ds_read_b64_tr_b16 v[96:97], v196 offset:0
    ds_read_b64_tr_b16 v[98:99], v196 offset:1024
    ds_read_b64_tr_b16 v[100:101], v197 offset:0
    ds_read_b64_tr_b16 v[102:103], v197 offset:1024
    ds_read_b64_tr_b16 v[104:105], v198 offset:0
    ds_read_b64_tr_b16 v[106:107], v198 offset:1024
    ds_read_b64_tr_b16 v[108:109], v199 offset:0
    ds_read_b64_tr_b16 v[110:111], v199 offset:1024
    ds_read_b64_tr_b16 v[112:113], v200 offset:0
    ds_read_b64_tr_b16 v[114:115], v200 offset:1024
    ds_read_b64_tr_b16 v[116:117], v201 offset:0
    ds_read_b64_tr_b16 v[118:119], v201 offset:1024
    ds_read_b64_tr_b16 v[120:121], v202 offset:0
    ds_read_b64_tr_b16 v[122:123], v202 offset:1024
    ds_read_b64_tr_b16 v[124:125], v203 offset:0
    ds_read_b64_tr_b16 v[126:127], v203 offset:1024
    ds_read_b128 v[172:175], v205 offset:4096
    ds_read_b128 v[176:179], v205 offset:6144
    ds_read_b128 v[180:183], v205 offset:16384
    ds_read_b64_tr_b16 v[128:129], v196 offset:8192
    ds_read_b64_tr_b16 v[130:131], v196 offset:9216
    ds_read_b64_tr_b16 v[132:133], v197 offset:8192
    ds_read_b64_tr_b16 v[134:135], v197 offset:9216
    ds_read_b64_tr_b16 v[136:137], v198 offset:8192
    ds_read_b64_tr_b16 v[138:139], v198 offset:9216
    ds_read_b64_tr_b16 v[140:141], v199 offset:8192
    ds_read_b64_tr_b16 v[142:143], v199 offset:9216
    ds_read_b64_tr_b16 v[144:145], v200 offset:8192
    ds_read_b64_tr_b16 v[146:147], v200 offset:9216
    ds_read_b64_tr_b16 v[148:149], v201 offset:8192
    ds_read_b64_tr_b16 v[150:151], v201 offset:9216
    ds_read_b64_tr_b16 v[152:153], v202 offset:8192
    ds_read_b64_tr_b16 v[154:155], v202 offset:9216
    ds_read_b64_tr_b16 v[156:157], v203 offset:8192
    ds_read_b64_tr_b16 v[158:159], v203 offset:9216
    s_waitcnt lgkmcnt(15)
    v_mfma_f32_16x16x32_bf16 v[0:3], v[96:99], v[160:163], v[0:3]
    s_add_u32 m0, s56, s58
    v_mfma_f32_16x16x32_bf16 v[32:35], v[96:99], v[164:167], v[32:35]
    s_add_u32 s30, s52, 131072
    v_mfma_f32_16x16x32_bf16 v[4:7], v[100:103], v[160:163], v[4:7]
    buffer_load_dwordx4 v206, s[12:15], s30 offen offset:0 lds
    v_mfma_f32_16x16x32_bf16 v[36:39], v[100:103], v[164:167], v[36:39]
    s_add_u32 s30, s52, 162816
    v_mfma_f32_16x16x32_bf16 v[8:11], v[104:107], v[160:163], v[8:11]
    buffer_load_dwordx4 v206, s[12:15], s30 offen offset:1024 lds
    v_mfma_f32_16x16x32_bf16 v[40:43], v[104:107], v[164:167], v[40:43]
    s_add_u32 s30, s52, 194560
    v_mfma_f32_16x16x32_bf16 v[64:67], v[104:107], v[168:171], v[64:67]
    buffer_load_dwordx4 v207, s[12:15], s30 offen offset:2048 lds
    v_mfma_f32_16x16x32_bf16 v[12:15], v[108:111], v[160:163], v[12:15]
    s_add_u32 s30, s52, 226304
    v_mfma_f32_16x16x32_bf16 v[44:47], v[108:111], v[164:167], v[44:47]
    v_mfma_f32_16x16x32_bf16 v[68:71], v[108:111], v[168:171], v[68:71]
    buffer_load_dwordx4 v207, s[12:15], s30 offen offset:3072 lds
    v_mfma_f32_16x16x32_bf16 v[16:19], v[112:115], v[160:163], v[16:19]
    s_add_u32 m0, s56, s59
    v_mfma_f32_16x16x32_bf16 v[48:51], v[112:115], v[164:167], v[48:51]
    s_add_u32 s30, s53, s60
    v_mfma_f32_16x16x32_bf16 v[20:23], v[116:119], v[160:163], v[20:23]
    buffer_load_dwordx4 v208, s[16:19], s30 offen lds
    v_mfma_f32_16x16x32_bf16 v[52:55], v[116:119], v[164:167], v[52:55]
    s_add_u32 s30, s30, 9216
    v_mfma_f32_16x16x32_bf16 v[24:27], v[120:123], v[160:163], v[24:27]
    buffer_load_dwordx4 v209, s[16:19], s30 offen offset:1024 lds
    v_mfma_f32_16x16x32_bf16 v[56:59], v[120:123], v[164:167], v[56:59]
    s_add_u32 s52, s52, 524288
    v_mfma_f32_16x16x32_bf16 v[28:31], v[124:127], v[160:163], v[28:31]
    s_add_u32 s53, s53, 128
    v_mfma_f32_16x16x32_bf16 v[60:63], v[124:127], v[164:167], v[60:63]
    s_waitcnt lgkmcnt(0)
    s_mov_b32 s51, 1
    s_mov_b32 s57, 4294864896
    v_add_u32 v196, s57, v196
    v_add_u32 v197, s57, v197
    v_add_u32 v198, s57, v198
    v_add_u32 v199, s57, v199
    v_add_u32 v200, s57, v200
    v_add_u32 v201, s57, v201
    v_add_u32 v202, s57, v202
    v_add_u32 v203, s57, v203
    v_add_u32 v204, s57, v204
    v_add_u32 v205, s57, v205
    s_mov_b32 s56, 102400
K1W1_P1:
    s_cmp_eq_u32 s51, 9
    s_cbranch_scc1 K1W1_P1a
    s_waitcnt vmcnt(6)
    s_branch K1W1_P1b
K1W1_P1a:
    s_waitcnt vmcnt(4)
K1W1_P1b:
    s_barrier
    s_cmp_le_u32 s51, 7
    s_cbranch_scc1 K1W1_P1c
    v_mfma_f32_16x16x32_bf16 v[0:3], v[128:131], v[172:175], v[0:3]
    ds_read_b128 v[160:163], v204 offset:4096
    ds_read_b128 v[164:167], v204 offset:6144
    v_mfma_f32_16x16x32_bf16 v[32:35], v[128:131], v[176:179], v[32:35]
    ds_read_b128 v[168:171], v204 offset:16384
    v_mfma_f32_16x16x32_bf16 v[4:7], v[132:135], v[172:175], v[4:7]
    ds_read_b64_tr_b16 v[96:97], v196 offset:0
    v_mfma_f32_16x16x32_bf16 v[36:39], v[132:135], v[176:179], v[36:39]
    ds_read_b64_tr_b16 v[98:99], v196 offset:1024
    v_mfma_f32_16x16x32_bf16 v[8:11], v[136:139], v[172:175], v[8:11]
    ds_read_b64_tr_b16 v[100:101], v197 offset:0
    v_mfma_f32_16x16x32_bf16 v[40:43], v[136:139], v[176:179], v[40:43]
    ds_read_b64_tr_b16 v[102:103], v197 offset:1024
    v_mfma_f32_16x16x32_bf16 v[64:67], v[136:139], v[180:183], v[64:67]
    ds_read_b64_tr_b16 v[104:105], v198 offset:0
    v_mfma_f32_16x16x32_bf16 v[12:15], v[140:143], v[172:175], v[12:15]
    ds_read_b64_tr_b16 v[106:107], v198 offset:1024
    v_mfma_f32_16x16x32_bf16 v[44:47], v[140:143], v[176:179], v[44:47]
    ds_read_b64_tr_b16 v[108:109], v199 offset:0
    v_mfma_f32_16x16x32_bf16 v[68:71], v[140:143], v[180:183], v[68:71]
    ds_read_b64_tr_b16 v[110:111], v199 offset:1024
    v_mfma_f32_16x16x32_bf16 v[16:19], v[144:147], v[172:175], v[16:19]
    ds_read_b64_tr_b16 v[112:113], v200 offset:0
    v_mfma_f32_16x16x32_bf16 v[48:51], v[144:147], v[176:179], v[48:51]
    ds_read_b64_tr_b16 v[114:115], v200 offset:1024
    v_mfma_f32_16x16x32_bf16 v[20:23], v[148:151], v[172:175], v[20:23]
    ds_read_b64_tr_b16 v[116:117], v201 offset:0
    v_mfma_f32_16x16x32_bf16 v[52:55], v[148:151], v[176:179], v[52:55]
    ds_read_b64_tr_b16 v[118:119], v201 offset:1024
    v_mfma_f32_16x16x32_bf16 v[24:27], v[152:155], v[172:175], v[24:27]
    ds_read_b64_tr_b16 v[120:121], v202 offset:0
    v_mfma_f32_16x16x32_bf16 v[56:59], v[152:155], v[176:179], v[56:59]
    ds_read_b64_tr_b16 v[122:123], v202 offset:1024
    v_mfma_f32_16x16x32_bf16 v[28:31], v[156:159], v[172:175], v[28:31]
    ds_read_b64_tr_b16 v[124:125], v203 offset:0
    v_mfma_f32_16x16x32_bf16 v[60:63], v[156:159], v[176:179], v[60:63]
    ds_read_b64_tr_b16 v[126:127], v203 offset:1024
    s_cmp_eq_u32 s51, 8
    s_cbranch_scc0 K1W1_P1d
    s_lshl_b32 s31, s26, 13
    s_add_u32 s31, s31, 2048
    v_xor_b32 v243, 128, v241
    v_xor_b32 v244, 192, v241
    s_mov_b32 m0, s31
    s_nop 0
    buffer_load_dwordx4 v243, s[4:7], s31 offen nt lds
    buffer_load_dwordx4 v244, s[4:7], s31 offen offset:1024 nt lds
    s_add_u32 s30, s31, 32768
    s_mov_b32 m0, s30
    v_xor_b32 v243, 128, v242
    buffer_load_dwordx4 v242, s[8:11], s31 offen nt lds
    buffer_load_dwordx4 v243, s[8:11], s31 offen offset:1024 nt lds
K1W1_P1d:
    s_waitcnt lgkmcnt(0)
    s_cmp_eq_u32 s51, 9
    s_cbranch_scc0 K1W1_P1t
    s_and_b32 s47, s2, 1
    s_load_dwordx2 s[72:73], s[0:1], 32
    s_load_dwordx2 s[74:75], s[0:1], 72
    s_waitcnt lgkmcnt(0)
    s_cmp_eq_u32 s64, 0
    s_cselect_b64 s[76:77], s[72:73], s[74:75]
    s_mov_b32 s78, 5242880
    s_mov_b32 s79, 131072
    s_lshl_b32 s30, s47, 11
    s_lshl_b32 s31, s26, 10
    s_add_u32 s30, s30, s31
    s_lshl_b32 s31, s85, 3
    s_add_u32 s31, s31, s84
    s_lshl_b32 s31, s31, 5
    s_add_u32 s30, s30, s31
    s_mul_i32 s30, s30, 1280
    v_lshlrev_b32 v243, 7, v245
    s_add_u32 s30, s30, 10240
    buffer_load_dword v249, v243, s[76:79], s30 offen
    v_add_u32 v243, 8192, v243
    v_mov_b32 v244, 2147418112
    v_cmp_gt_u32 vcc, 16, v245
    s_nop 1
    v_cndmask_b32 v243, v244, v243, vcc
    buffer_load_dword v250, v243, s[76:79], s30 offen
K1W1_P1t:
    v_mfma_f32_16x16x32_bf16 v[0:3], v[96:99], v[160:163], v[0:3]
    ds_read_b128 v[172:175], v205 offset:4096
    ds_read_b128 v[176:179], v205 offset:6144
    v_mfma_f32_16x16x32_bf16 v[32:35], v[96:99], v[164:167], v[32:35]
    ds_read_b128 v[180:183], v205 offset:16384
    v_mfma_f32_16x16x32_bf16 v[4:7], v[100:103], v[160:163], v[4:7]
    ds_read_b64_tr_b16 v[128:129], v196 offset:8192
    v_mfma_f32_16x16x32_bf16 v[36:39], v[100:103], v[164:167], v[36:39]
    ds_read_b64_tr_b16 v[130:131], v196 offset:9216
    v_mfma_f32_16x16x32_bf16 v[8:11], v[104:107], v[160:163], v[8:11]
    ds_read_b64_tr_b16 v[132:133], v197 offset:8192
    v_mfma_f32_16x16x32_bf16 v[40:43], v[104:107], v[164:167], v[40:43]
    ds_read_b64_tr_b16 v[134:135], v197 offset:9216
    v_mfma_f32_16x16x32_bf16 v[64:67], v[104:107], v[168:171], v[64:67]
    ds_read_b64_tr_b16 v[136:137], v198 offset:8192
    v_mfma_f32_16x16x32_bf16 v[12:15], v[108:111], v[160:163], v[12:15]
    ds_read_b64_tr_b16 v[138:139], v198 offset:9216
    v_mfma_f32_16x16x32_bf16 v[44:47], v[108:111], v[164:167], v[44:47]
    ds_read_b64_tr_b16 v[140:141], v199 offset:8192
    v_mfma_f32_16x16x32_bf16 v[68:71], v[108:111], v[168:171], v[68:71]
    ds_read_b64_tr_b16 v[142:143], v199 offset:9216
    v_mfma_f32_16x16x32_bf16 v[16:19], v[112:115], v[160:163], v[16:19]
    ds_read_b64_tr_b16 v[144:145], v200 offset:8192
    v_mfma_f32_16x16x32_bf16 v[48:51], v[112:115], v[164:167], v[48:51]
    ds_read_b64_tr_b16 v[146:147], v200 offset:9216
    v_mfma_f32_16x16x32_bf16 v[20:23], v[116:119], v[160:163], v[20:23]
    ds_read_b64_tr_b16 v[148:149], v201 offset:8192
    v_mfma_f32_16x16x32_bf16 v[52:55], v[116:119], v[164:167], v[52:55]
    ds_read_b64_tr_b16 v[150:151], v201 offset:9216
    v_mfma_f32_16x16x32_bf16 v[24:27], v[120:123], v[160:163], v[24:27]
    ds_read_b64_tr_b16 v[152:153], v202 offset:8192
    v_mfma_f32_16x16x32_bf16 v[56:59], v[120:123], v[164:167], v[56:59]
    ds_read_b64_tr_b16 v[154:155], v202 offset:9216
    v_mfma_f32_16x16x32_bf16 v[28:31], v[124:127], v[160:163], v[28:31]
    ds_read_b64_tr_b16 v[156:157], v203 offset:8192
    v_mfma_f32_16x16x32_bf16 v[60:63], v[124:127], v[164:167], v[60:63]
    ds_read_b64_tr_b16 v[158:159], v203 offset:9216
    s_branch K1W1_P1e
K1W1_P1c:
    v_mfma_f32_16x16x32_bf16 v[0:3], v[128:131], v[172:175], v[0:3]
    ds_read_b128 v[160:163], v204 offset:4096
    ds_read_b128 v[164:167], v204 offset:6144
    v_mfma_f32_16x16x32_bf16 v[32:35], v[128:131], v[176:179], v[32:35]
    ds_read_b128 v[168:171], v204 offset:16384
    v_mfma_f32_16x16x32_bf16 v[4:7], v[132:135], v[172:175], v[4:7]
    ds_read_b64_tr_b16 v[96:97], v196 offset:0
    ds_read_b64_tr_b16 v[98:99], v196 offset:1024
    v_mfma_f32_16x16x32_bf16 v[36:39], v[132:135], v[176:179], v[36:39]
    ds_read_b64_tr_b16 v[100:101], v197 offset:0
    v_mfma_f32_16x16x32_bf16 v[8:11], v[136:139], v[172:175], v[8:11]
    ds_read_b64_tr_b16 v[102:103], v197 offset:1024
    ds_read_b64_tr_b16 v[104:105], v198 offset:0
    v_mfma_f32_16x16x32_bf16 v[40:43], v[136:139], v[176:179], v[40:43]
    ds_read_b64_tr_b16 v[106:107], v198 offset:1024
    v_mfma_f32_16x16x32_bf16 v[64:67], v[136:139], v[180:183], v[64:67]
    ds_read_b64_tr_b16 v[108:109], v199 offset:0
    ds_read_b64_tr_b16 v[110:111], v199 offset:1024
    v_mfma_f32_16x16x32_bf16 v[12:15], v[140:143], v[172:175], v[12:15]
    ds_read_b64_tr_b16 v[112:113], v200 offset:0
    v_mfma_f32_16x16x32_bf16 v[44:47], v[140:143], v[176:179], v[44:47]
    ds_read_b64_tr_b16 v[114:115], v200 offset:1024
    ds_read_b64_tr_b16 v[116:117], v201 offset:0
    v_mfma_f32_16x16x32_bf16 v[68:71], v[140:143], v[180:183], v[68:71]
    ds_read_b64_tr_b16 v[118:119], v201 offset:1024
    v_mfma_f32_16x16x32_bf16 v[16:19], v[144:147], v[172:175], v[16:19]
    ds_read_b64_tr_b16 v[120:121], v202 offset:0
    ds_read_b64_tr_b16 v[122:123], v202 offset:1024
    v_mfma_f32_16x16x32_bf16 v[48:51], v[144:147], v[176:179], v[48:51]
    ds_read_b64_tr_b16 v[124:125], v203 offset:0
    v_mfma_f32_16x16x32_bf16 v[20:23], v[148:151], v[172:175], v[20:23]
    ds_read_b64_tr_b16 v[126:127], v203 offset:1024
    s_add_u32 m0, s56, s58
    v_mfma_f32_16x16x32_bf16 v[52:55], v[148:151], v[176:179], v[52:55]
    s_add_u32 s30, s52, 131072
    v_mfma_f32_16x16x32_bf16 v[24:27], v[152:155], v[172:175], v[24:27]
    buffer_load_dwordx4 v206, s[12:15], s30 offen offset:0 lds
    s_add_u32 s30, s52, 162816
    v_mfma_f32_16x16x32_bf16 v[56:59], v[152:155], v[176:179], v[56:59]
    buffer_load_dwordx4 v206, s[12:15], s30 offen offset:1024 lds
    v_mfma_f32_16x16x32_bf16 v[28:31], v[156:159], v[172:175], v[28:31]
    s_add_u32 s30, s52, 194560
    buffer_load_dwordx4 v207, s[12:15], s30 offen offset:2048 lds
    v_mfma_f32_16x16x32_bf16 v[60:63], v[156:159], v[176:179], v[60:63]
    s_add_u32 s30, s52, 226304
    s_waitcnt lgkmcnt(14)
    v_mfma_f32_16x16x32_bf16 v[0:3], v[96:99], v[160:163], v[0:3]
    ds_read_b128 v[172:175], v205 offset:4096
    ds_read_b128 v[176:179], v205 offset:6144
    v_mfma_f32_16x16x32_bf16 v[32:35], v[96:99], v[164:167], v[32:35]
    ds_read_b128 v[180:183], v205 offset:16384
    s_waitcnt lgkmcnt(15)
    v_mfma_f32_16x16x32_bf16 v[4:7], v[100:103], v[160:163], v[4:7]
    ds_read_b64_tr_b16 v[128:129], v196 offset:8192
    ds_read_b64_tr_b16 v[130:131], v196 offset:9216
    v_mfma_f32_16x16x32_bf16 v[36:39], v[100:103], v[164:167], v[36:39]
    ds_read_b64_tr_b16 v[132:133], v197 offset:8192
    s_waitcnt lgkmcnt(15)
    v_mfma_f32_16x16x32_bf16 v[8:11], v[104:107], v[160:163], v[8:11]
    ds_read_b64_tr_b16 v[134:135], v197 offset:9216
    ds_read_b64_tr_b16 v[136:137], v198 offset:8192
    v_mfma_f32_16x16x32_bf16 v[40:43], v[104:107], v[164:167], v[40:43]
    ds_read_b64_tr_b16 v[138:139], v198 offset:9216
    v_mfma_f32_16x16x32_bf16 v[64:67], v[104:107], v[168:171], v[64:67]
    ds_read_b64_tr_b16 v[140:141], v199 offset:8192
    ds_read_b64_tr_b16 v[142:143], v199 offset:9216
    s_waitcnt lgkmcnt(15)
    v_mfma_f32_16x16x32_bf16 v[12:15], v[108:111], v[160:163], v[12:15]
    ds_read_b64_tr_b16 v[144:145], v200 offset:8192
    v_mfma_f32_16x16x32_bf16 v[44:47], v[108:111], v[164:167], v[44:47]
    ds_read_b64_tr_b16 v[146:147], v200 offset:9216
    ds_read_b64_tr_b16 v[148:149], v201 offset:8192
    v_mfma_f32_16x16x32_bf16 v[68:71], v[108:111], v[168:171], v[68:71]
    ds_read_b64_tr_b16 v[150:151], v201 offset:9216
    v_mfma_f32_16x16x32_bf16 v[16:19], v[112:115], v[160:163], v[16:19]
    ds_read_b64_tr_b16 v[152:153], v202 offset:8192
    ds_read_b64_tr_b16 v[154:155], v202 offset:9216
    v_mfma_f32_16x16x32_bf16 v[48:51], v[112:115], v[164:167], v[48:51]
    ds_read_b64_tr_b16 v[156:157], v203 offset:8192
    v_mfma_f32_16x16x32_bf16 v[20:23], v[116:119], v[160:163], v[20:23]
    ds_read_b64_tr_b16 v[158:159], v203 offset:9216
    buffer_load_dwordx4 v207, s[12:15], s30 offen offset:3072 lds
    v_mfma_f32_16x16x32_bf16 v[52:55], v[116:119], v[164:167], v[52:55]
    s_add_u32 m0, s56, s59
    s_waitcnt lgkmcnt(15)
    v_mfma_f32_16x16x32_bf16 v[24:27], v[120:123], v[160:163], v[24:27]
    s_add_u32 s30, s53, s60
    buffer_load_dwordx4 v208, s[16:19], s30 offen lds
    v_mfma_f32_16x16x32_bf16 v[56:59], v[120:123], v[164:167], v[56:59]
    s_add_u32 s30, s30, 9216
    v_mfma_f32_16x16x32_bf16 v[28:31], v[124:127], v[160:163], v[28:31]
    buffer_load_dwordx4 v209, s[16:19], s30 offen offset:1024 lds
    s_add_u32 s52, s52, 524288
    v_mfma_f32_16x16x32_bf16 v[60:63], v[124:127], v[164:167], v[60:63]
    s_add_u32 s53, s53, 128
K1W1_P1e:
    s_waitcnt lgkmcnt(0)
    s_mul_i32 s30, s51, 43691
    s_lshr_b32 s30, s30, 17
    s_mul_i32 s30, s30, 3
    s_cmp_eq_u32 s51, s30
    s_mov_b32 s57, 51200
    s_cselect_b32 s57, 4294864896, s57
    v_add_u32 v196, s57, v196
    v_add_u32 v197, s57, v197
    v_add_u32 v198, s57, v198
    v_add_u32 v199, s57, v199
    v_add_u32 v200, s57, v200
    v_add_u32 v201, s57, v201
    v_add_u32 v202, s57, v202
    v_add_u32 v203, s57, v203
    v_add_u32 v204, s57, v204
    v_add_u32 v205, s57, v205
    s_add_u32 s56, s56, 51200
    s_cmp_eq_u32 s56, 153600
    s_cselect_b32 s56, 0, s56
    s_add_u32 s51, s51, 1
    s_cmp_lt_u32 s51, 10
    s_cbranch_scc1 K1W1_P1
    v_mfma_f32_16x16x32_bf16 v[0:3], v[128:131], v[172:175], v[0:3]
    v_mfma_f32_16x16x32_bf16 v[32:35], v[128:131], v[176:179], v[32:35]
    v_mfma_f32_16x16x32_bf16 v[4:7], v[132:135], v[172:175], v[4:7]
    v_mfma_f32_16x16x32_bf16 v[36:39], v[132:135], v[176:179], v[36:39]
    v_mfma_f32_16x16x32_bf16 v[8:11], v[136:139], v[172:175], v[8:11]
    v_mfma_f32_16x16x32_bf16 v[40:43], v[136:139], v[176:179], v[40:43]
    v_mfma_f32_16x16x32_bf16 v[64:67], v[136:139], v[180:183], v[64:67]
    v_mfma_f32_16x16x32_bf16 v[12:15], v[140:143], v[172:175], v[12:15]
    v_mfma_f32_16x16x32_bf16 v[44:47], v[140:143], v[176:179], v[44:47]
    v_mfma_f32_16x16x32_bf16 v[68:71], v[140:143], v[180:183], v[68:71]
    v_mfma_f32_16x16x32_bf16 v[16:19], v[144:147], v[172:175], v[16:19]
    v_mfma_f32_16x16x32_bf16 v[48:51], v[144:147], v[176:179], v[48:51]
    v_mfma_f32_16x16x32_bf16 v[20:23], v[148:151], v[172:175], v[20:23]
    v_mfma_f32_16x16x32_bf16 v[52:55], v[148:151], v[176:179], v[52:55]
    v_mfma_f32_16x16x32_bf16 v[24:27], v[152:155], v[172:175], v[24:27]
    v_mfma_f32_16x16x32_bf16 v[56:59], v[152:155], v[176:179], v[56:59]
    v_mfma_f32_16x16x32_bf16 v[28:31], v[156:159], v[172:175], v[28:31]
    v_mfma_f32_16x16x32_bf16 v[60:63], v[156:159], v[176:179], v[60:63]
    s_mov_b32 s30, 1040356334
    v_mul_f32 v64, s30, v64
    v_mul_f32 v65, s30, v65
    v_mul_f32 v66, s30, v66
    v_mul_f32 v67, s30, v67
    v_mul_f32 v68, s30, v68
    v_mul_f32 v69, s30, v69
    v_mul_f32 v70, s30, v70
    v_mul_f32 v71, s30, v71
    v_cvt_pk_bf16_f32 v212, v64, v65
    v_cvt_pk_bf16_f32 v213, v66, v67
    v_cvt_pk_bf16_f32 v214, v68, v69
    v_cvt_pk_bf16_f32 v215, v70, v71
    v_cndmask_b32 v216, v212, v214, s[54:55]
    v_cndmask_b32 v217, v213, v215, s[54:55]
    v_cndmask_b32 v218, v214, v212, s[54:55]
    v_cndmask_b32 v219, v215, v213, s[54:55]
    s_lshl_b32 s31, s26, 12
    s_add_u32 s31, s31, 153600
    v_add_u32 v246, s31, v248
    ds_write_b128 v246, v[216:219] offset:1024
    v_mul_f32 v0, s30, v0
    v_mul_f32 v1, s30, v1
    v_mul_f32 v2, s30, v2
    v_mul_f32 v3, s30, v3
    v_mul_f32 v4, s30, v4
    v_mul_f32 v5, s30, v5
    v_mul_f32 v6, s30, v6
    v_mul_f32 v7, s30, v7
    v_cvt_pk_bf16_f32 v212, v0, v1
    v_cvt_pk_bf16_f32 v213, v2, v3
    v_cvt_pk_bf16_f32 v214, v4, v5
    v_cvt_pk_bf16_f32 v215, v6, v7
    v_cndmask_b32 v96, v212, v214, s[54:55]
    v_cndmask_b32 v97, v213, v215, s[54:55]
    v_cndmask_b32 v98, v214, v212, s[54:55]
    v_cndmask_b32 v99, v215, v213, s[54:55]
    v_mul_f32 v32, s30, v32
    v_mul_f32 v33, s30, v33
    v_mul_f32 v34, s30, v34
    v_mul_f32 v35, s30, v35
    v_mul_f32 v36, s30, v36
    v_mul_f32 v37, s30, v37
    v_mul_f32 v38, s30, v38
    v_mul_f32 v39, s30, v39
    v_cvt_pk_bf16_f32 v212, v32, v33
    v_cvt_pk_bf16_f32 v213, v34, v35
    v_cvt_pk_bf16_f32 v214, v36, v37
    v_cvt_pk_bf16_f32 v215, v38, v39
    v_cndmask_b32 v112, v212, v214, s[54:55]
    v_cndmask_b32 v113, v213, v215, s[54:55]
    v_cndmask_b32 v114, v214, v212, s[54:55]
    v_cndmask_b32 v115, v215, v213, s[54:55]
    v_mul_f32 v8, s30, v8
    v_mul_f32 v9, s30, v9
    v_mul_f32 v10, s30, v10
    v_mul_f32 v11, s30, v11
    v_mul_f32 v12, s30, v12
    v_mul_f32 v13, s30, v13
    v_mul_f32 v14, s30, v14
    v_mul_f32 v15, s30, v15
    v_cvt_pk_bf16_f32 v212, v8, v9
    v_cvt_pk_bf16_f32 v213, v10, v11
    v_cvt_pk_bf16_f32 v214, v12, v13
    v_cvt_pk_bf16_f32 v215, v14, v15
    v_cndmask_b32 v100, v212, v214, s[54:55]
    v_cndmask_b32 v101, v213, v215, s[54:55]
    v_cndmask_b32 v102, v214, v212, s[54:55]
    v_cndmask_b32 v103, v215, v213, s[54:55]
    v_mul_f32 v40, s30, v40
    v_mul_f32 v41, s30, v41
    v_mul_f32 v42, s30, v42
    v_mul_f32 v43, s30, v43
    v_mul_f32 v44, s30, v44
    v_mul_f32 v45, s30, v45
    v_mul_f32 v46, s30, v46
    v_mul_f32 v47, s30, v47
    v_cvt_pk_bf16_f32 v212, v40, v41
    v_cvt_pk_bf16_f32 v213, v42, v43
    v_cvt_pk_bf16_f32 v214, v44, v45
    v_cvt_pk_bf16_f32 v215, v46, v47
    v_cndmask_b32 v116, v212, v214, s[54:55]
    v_cndmask_b32 v117, v213, v215, s[54:55]
    v_cndmask_b32 v118, v214, v212, s[54:55]
    v_cndmask_b32 v119, v215, v213, s[54:55]
    v_mul_f32 v16, s30, v16
    v_mul_f32 v17, s30, v17
    v_mul_f32 v18, s30, v18
    v_mul_f32 v19, s30, v19
    v_mul_f32 v20, s30, v20
    v_mul_f32 v21, s30, v21
    v_mul_f32 v22, s30, v22
    v_mul_f32 v23, s30, v23
    v_cvt_pk_bf16_f32 v212, v16, v17
    v_cvt_pk_bf16_f32 v213, v18, v19
    v_cvt_pk_bf16_f32 v214, v20, v21
    v_cvt_pk_bf16_f32 v215, v22, v23
    v_cndmask_b32 v104, v212, v214, s[54:55]
    v_cndmask_b32 v105, v213, v215, s[54:55]
    v_cndmask_b32 v106, v214, v212, s[54:55]
    v_cndmask_b32 v107, v215, v213, s[54:55]
    v_mul_f32 v48, s30, v48
    v_mul_f32 v49, s30, v49
    v_mul_f32 v50, s30, v50
    v_mul_f32 v51, s30, v51
    v_mul_f32 v52, s30, v52
    v_mul_f32 v53, s30, v53
    v_mul_f32 v54, s30, v54
    v_mul_f32 v55, s30, v55
    v_cvt_pk_bf16_f32 v212, v48, v49
    v_cvt_pk_bf16_f32 v213, v50, v51
    v_cvt_pk_bf16_f32 v214, v52, v53
    v_cvt_pk_bf16_f32 v215, v54, v55
    v_cndmask_b32 v120, v212, v214, s[54:55]
    v_cndmask_b32 v121, v213, v215, s[54:55]
    v_cndmask_b32 v122, v214, v212, s[54:55]
    v_cndmask_b32 v123, v215, v213, s[54:55]
    v_mul_f32 v24, s30, v24
    v_mul_f32 v25, s30, v25
    v_mul_f32 v26, s30, v26
    v_mul_f32 v27, s30, v27
    v_mul_f32 v28, s30, v28
    v_mul_f32 v29, s30, v29
    v_mul_f32 v30, s30, v30
    v_mul_f32 v31, s30, v31
    v_cvt_pk_bf16_f32 v212, v24, v25
    v_cvt_pk_bf16_f32 v213, v26, v27
    v_cvt_pk_bf16_f32 v214, v28, v29
    v_cvt_pk_bf16_f32 v215, v30, v31
    v_cndmask_b32 v108, v212, v214, s[54:55]
    v_cndmask_b32 v109, v213, v215, s[54:55]
    v_cndmask_b32 v110, v214, v212, s[54:55]
    v_cndmask_b32 v111, v215, v213, s[54:55]
    v_mul_f32 v56, s30, v56
    v_mul_f32 v57, s30, v57
    v_mul_f32 v58, s30, v58
    v_mul_f32 v59, s30, v59
    v_mul_f32 v60, s30, v60
    v_mul_f32 v61, s30, v61
    v_mul_f32 v62, s30, v62
    v_mul_f32 v63, s30, v63
    v_cvt_pk_bf16_f32 v212, v56, v57
    v_cvt_pk_bf16_f32 v213, v58, v59
    v_cvt_pk_bf16_f32 v214, v60, v61
    v_cvt_pk_bf16_f32 v215, v62, v63
    v_cndmask_b32 v124, v212, v214, s[54:55]
    v_cndmask_b32 v125, v213, v215, s[54:55]
    v_cndmask_b32 v126, v214, v212, s[54:55]
    v_cndmask_b32 v127, v215, v213, s[54:55]
    s_waitcnt lgkmcnt(0)
    s_waitcnt vmcnt(2)
    s_barrier
    ds_read_b128 v[128:131], v246 offset:0
    ds_read_b128 v[132:135], v246 offset:1024
    ds_read_b128 v[136:139], v246 offset:2048
    ds_read_b128 v[140:143], v246 offset:3072
    v_mov_b32 v0, 0
    v_mov_b32 v1, 0
    v_mov_b32 v2, 0
    v_mov_b32 v3, 0
    v_mov_b32 v4, 0
    v_mov_b32 v5, 0
    v_mov_b32 v6, 0
    v_mov_b32 v7, 0
    v_mov_b32 v8, 0
    v_mov_b32 v9, 0
    v_mov_b32 v10, 0
    v_mov_b32 v11, 0
    v_mov_b32 v12, 0
    v_mov_b32 v13, 0
    v_mov_b32 v14, 0
    v_mov_b32 v15, 0
    v_mov_b32 v16, 0
    v_mov_b32 v17, 0
    v_mov_b32 v18, 0
    v_mov_b32 v19, 0
    v_mov_b32 v20, 0
    v_mov_b32 v21, 0
    v_mov_b32 v22, 0
    v_mov_b32 v23, 0
    v_mov_b32 v24, 0
    v_mov_b32 v25, 0
    v_mov_b32 v26, 0
    v_mov_b32 v27, 0
    v_mov_b32 v28, 0
    v_mov_b32 v29, 0
    v_mov_b32 v30, 0
    v_mov_b32 v31, 0
    v_mov_b32 v32, 0
    v_mov_b32 v33, 0
    v_mov_b32 v34, 0
    v_mov_b32 v35, 0
    v_mov_b32 v36, 0
    v_mov_b32 v37, 0
    v_mov_b32 v38, 0
    v_mov_b32 v39, 0
    v_mov_b32 v40, 0
    v_mov_b32 v41, 0
    v_mov_b32 v42, 0
    v_mov_b32 v43, 0
    v_mov_b32 v44, 0
    v_mov_b32 v45, 0
    v_mov_b32 v46, 0
    v_mov_b32 v47, 0
    v_mov_b32 v48, 0
    v_mov_b32 v49, 0
    v_mov_b32 v50, 0
    v_mov_b32 v51, 0
    v_mov_b32 v52, 0
    v_mov_b32 v53, 0
    v_mov_b32 v54, 0
    v_mov_b32 v55, 0
    v_mov_b32 v56, 0
    v_mov_b32 v57, 0
    v_mov_b32 v58, 0
    v_mov_b32 v59, 0
    v_mov_b32 v60, 0
    v_mov_b32 v61, 0
    v_mov_b32 v62, 0
    v_mov_b32 v63, 0
    v_mov_b32 v64, 0
    v_mov_b32 v65, 0
    v_mov_b32 v66, 0
    v_mov_b32 v67, 0
    v_mov_b32 v68, 0
    v_mov_b32 v69, 0
    v_mov_b32 v70, 0
    v_mov_b32 v71, 0
    v_mov_b32 v72, 0
    v_mov_b32 v73, 0
    v_mov_b32 v74, 0
    v_mov_b32 v75, 0
    v_mov_b32 v76, 0
    v_mov_b32 v77, 0
    v_mov_b32 v78, 0
    v_mov_b32 v79, 0
    v_mov_b32 v80, 0
    v_mov_b32 v81, 0
    v_mov_b32 v82, 0
    v_mov_b32 v83, 0
    v_mov_b32 v84, 0
    v_mov_b32 v85, 0
    v_mov_b32 v86, 0
    v_mov_b32 v87, 0
    v_mov_b32 v88, 0
    v_mov_b32 v89, 0
    v_mov_b32 v90, 0
    v_mov_b32 v91, 0
    v_mov_b32 v92, 0
    v_mov_b32 v93, 0
    v_mov_b32 v94, 0
    v_mov_b32 v95, 0
    v_mov_b32 v228, 0
    v_mov_b32 v229, 0
    v_mov_b32 v230, 0
    v_mov_b32 v180, 0
    v_mov_b32 v181, 0
    v_mov_b32 v182, 0
    v_mov_b32 v183, 0
    s_waitcnt lgkmcnt(0)
    s_cmp_eq_u32 s26, 0
    s_cselect_b32 s30, 2113536, 0
    s_add_u32 s31, s30, 20480
    v_add_u32 v241, s31, v241
    s_cmp_eq_u32 s26, 0
    s_cselect_b32 s30, 2097152, 0
    s_add_u32 s31, s30, 20480
    v_add_u32 v242, s31, v242
    s_mov_b32 s27, 0
    s_cmp_eq_u32 s26, 0
    s_cbranch_scc1 K1W1_RND
    s_mov_b32 s28, 20480
    s_mov_b32 m0, s28
    v_xor_b32 v243, 64, v241
    buffer_load_dwordx4 v241, s[4:7], 0 offen nt lds
    v_xor_b32 v244, 128, v241
    buffer_load_dwordx4 v243, s[4:7], 0 offen offset:1024 nt lds
    v_xor_b32 v243, 192, v241
    buffer_load_dwordx4 v244, s[4:7], 0 offen offset:2048 nt lds
    buffer_load_dwordx4 v243, s[4:7], 0 offen offset:3072 nt lds
    v_add_u32 v241, 16384, v241
K1W1_RND:
    v_add_u32 v238, 16384, v238
    s_mov_b32 s29, 69632
K1W1_ROUND:
    s_mov_b32 s25, 0
    s_cmp_eq_u32 s26, s27
    s_cbranch_scc0 K1W1_LDR
    s_mov_b32 s57, s27
    s_mul_i32 s30, s27, 16384
    v_add_u32 v234, s30, v234
    v_add_u32 v235, s30, v235
    v_add_u32 v236, s30, v236
    v_add_u32 v237, s30, v237
    s_nop 1
K1W1_LOOP:
    s_cmp_eq_u32 s25, 0
    s_cbranch_scc1 K1W1_A1a
    s_waitcnt vmcnt(0) lgkmcnt(0)
    s_barrier
    s_branch K1W1_A1b
K1W1_A1a:
    s_waitcnt vmcnt(8) lgkmcnt(0)
    s_barrier
    ds_read_b128 v[196:199], v234
    ds_read_b128 v[200:203], v235
    ds_read_b128 v[204:207], v236
    ds_read_b128 v[208:211], v237
    s_waitcnt lgkmcnt(3)
    v_mfma_f32_16x16x32_bf16 v[144:147], v[196:199], v[96:99], 0
    v_mfma_f32_16x16x32_bf16 v[160:163], v[196:199], v[112:115], 0
    s_waitcnt lgkmcnt(2)
    v_mfma_f32_16x16x32_bf16 v[144:147], v[200:203], v[100:103], v[144:147]
    v_mfma_f32_16x16x32_bf16 v[160:163], v[200:203], v[116:119], v[160:163]
    s_waitcnt lgkmcnt(1)
    v_mfma_f32_16x16x32_bf16 v[144:147], v[204:207], v[104:107], v[144:147]
    v_mfma_f32_16x16x32_bf16 v[160:163], v[204:207], v[120:123], v[160:163]
    s_waitcnt lgkmcnt(0)
    v_mfma_f32_16x16x32_bf16 v[144:147], v[208:211], v[108:111], v[144:147]
    v_mfma_f32_16x16x32_bf16 v[160:163], v[208:211], v[124:127], v[160:163]
    s_nop 6
    v_max3_f32 v243, v144, v145, v146
    v_max_f32 v243, v243, v147
    v_mov_b32 v244, v243
    s_nop 1
    v_permlane16_swap_b32 v244, v243
    v_max_f32 v243, v243, v244
    v_mov_b32 v244, v243
    s_nop 1
    v_permlane32_swap_b32 v244, v243
    v_max_f32 v243, v243, v244
    v_sub_f32 v184, 0, v243
    v_sub_f32 v185, 0, v243
    v_sub_f32 v186, 0, v243
    v_sub_f32 v187, 0, v243
    v_max3_f32 v243, v160, v161, v162
    v_max_f32 v243, v243, v163
    v_mov_b32 v244, v243
    s_nop 1
    v_permlane16_swap_b32 v244, v243
    v_max_f32 v243, v243, v244
    v_mov_b32 v244, v243
    s_nop 1
    v_permlane32_swap_b32 v244, v243
    v_max_f32 v243, v243, v244
    v_sub_f32 v188, 0, v243
    v_sub_f32 v189, 0, v243
    v_sub_f32 v190, 0, v243
    v_sub_f32 v191, 0, v243
    s_nop 3
K1W1_A1b:
    ds_read_b128 v[196:199], v234 offset:0
    ds_read_b128 v[200:203], v235 offset:0
    ds_read_b128 v[204:207], v236 offset:0
    ds_read_b128 v[208:211], v237 offset:0
    ds_read_b128 v[212:215], v234 offset:4096
    ds_read_b128 v[216:219], v235 offset:4096
    ds_read_b128 v[220:223], v236 offset:4096
    ds_read_b128 v[224:227], v237 offset:4096
    s_waitcnt lgkmcnt(7)
    v_mfma_f32_16x16x32_bf16 v[144:147], v[196:199], v[96:99], v[184:187]
    v_mfma_f32_16x16x32_bf16 v[160:163], v[196:199], v[112:115], v[188:191]
    s_waitcnt lgkmcnt(6)
    v_mfma_f32_16x16x32_bf16 v[144:147], v[200:203], v[100:103], v[144:147]
    v_mfma_f32_16x16x32_bf16 v[160:163], v[200:203], v[116:119], v[160:163]
    s_waitcnt lgkmcnt(5)
    v_mfma_f32_16x16x32_bf16 v[144:147], v[204:207], v[104:107], v[144:147]
    v_mfma_f32_16x16x32_bf16 v[160:163], v[204:207], v[120:123], v[160:163]
    s_waitcnt lgkmcnt(4)
    v_mfma_f32_16x16x32_bf16 v[144:147], v[208:211], v[108:111], v[144:147]
    v_mfma_f32_16x16x32_bf16 v[160:163], v[208:211], v[124:127], v[160:163]
    s_waitcnt lgkmcnt(3)
    v_mfma_f32_16x16x32_bf16 v[148:151], v[212:215], v[96:99], v[184:187]
    v_mfma_f32_16x16x32_bf16 v[164:167], v[212:215], v[112:115], v[188:191]
    ds_read_b128 v[196:199], v234 offset:8192
    ds_read_b128 v[200:203], v235 offset:8192
    s_waitcnt lgkmcnt(4)
    v_mfma_f32_16x16x32_bf16 v[148:151], v[216:219], v[100:103], v[148:151]
    ds_read_b128 v[204:207], v236 offset:8192
    ds_read_b128 v[208:211], v237 offset:8192
    v_mfma_f32_16x16x32_bf16 v[164:167], v[216:219], v[116:119], v[164:167]
    v_exp_f32 v144, v144
    v_exp_f32 v145, v145
    s_waitcnt lgkmcnt(5)
    v_mfma_f32_16x16x32_bf16 v[148:151], v[220:223], v[104:107], v[148:151]
    v_exp_f32 v146, v146
    v_mfma_f32_16x16x32_bf16 v[164:167], v[220:223], v[120:123], v[164:167]
    v_exp_f32 v147, v147
    v_exp_f32 v160, v160
    s_waitcnt lgkmcnt(4)
    v_mfma_f32_16x16x32_bf16 v[148:151], v[224:227], v[108:111], v[148:151]
    v_exp_f32 v161, v161
    v_exp_f32 v162, v162
    v_mfma_f32_16x16x32_bf16 v[164:167], v[224:227], v[124:127], v[164:167]
    v_exp_f32 v163, v163
    s_waitcnt lgkmcnt(3)
    v_mfma_f32_16x16x32_bf16 v[152:155], v[196:199], v[96:99], v[184:187]
    v_mfma_f32_16x16x32_bf16 v[168:171], v[196:199], v[112:115], v[188:191]
    ds_read_b128 v[212:215], v234 offset:12288
    ds_read_b128 v[216:219], v235 offset:12288
    ds_read_b128 v[220:223], v236 offset:12288
    s_waitcnt lgkmcnt(5)
    v_mfma_f32_16x16x32_bf16 v[152:155], v[200:203], v[100:103], v[152:155]
    ds_read_b128 v[224:227], v237 offset:12288
    v_exp_f32 v148, v148
    v_exp_f32 v149, v149
    v_mfma_f32_16x16x32_bf16 v[168:171], v[200:203], v[116:119], v[168:171]
    v_exp_f32 v150, v150
    v_exp_f32 v151, v151
    s_waitcnt lgkmcnt(5)
    v_mfma_f32_16x16x32_bf16 v[152:155], v[204:207], v[104:107], v[152:155]
    v_exp_f32 v164, v164
    v_exp_f32 v165, v165
    v_exp_f32 v166, v166
    v_mfma_f32_16x16x32_bf16 v[168:171], v[204:207], v[120:123], v[168:171]
    v_exp_f32 v167, v167
    v_add_f32 v231, v144, v145
    s_waitcnt lgkmcnt(4)
    v_mfma_f32_16x16x32_bf16 v[152:155], v[208:211], v[108:111], v[152:155]
    v_add_f32 v231, v231, v146
    v_add_f32 v231, v231, v147
    v_add_f32 v232, v160, v161
    v_mfma_f32_16x16x32_bf16 v[168:171], v[208:211], v[124:127], v[168:171]
    v_add_f32 v232, v232, v162
    v_add_f32 v232, v232, v163
    s_waitcnt lgkmcnt(3)
    v_mfma_f32_16x16x32_bf16 v[156:159], v[212:215], v[96:99], v[184:187]
    v_add_f32 v231, v231, v148
    v_add_f32 v231, v231, v149
    v_mfma_f32_16x16x32_bf16 v[172:175], v[212:215], v[112:115], v[188:191]
    v_add_f32 v231, v231, v150
    v_add_f32 v231, v231, v151
    s_waitcnt lgkmcnt(2)
    v_mfma_f32_16x16x32_bf16 v[156:159], v[216:219], v[100:103], v[156:159]
    v_add_f32 v232, v232, v164
    v_add_f32 v232, v232, v165
    v_mfma_f32_16x16x32_bf16 v[172:175], v[216:219], v[116:119], v[172:175]
    v_add_f32 v232, v232, v166
    v_add_f32 v232, v232, v167
    s_waitcnt lgkmcnt(1)
    v_mfma_f32_16x16x32_bf16 v[156:159], v[220:223], v[104:107], v[156:159]
    v_cvt_pk_bf16_f32 v144, v144, v145
    v_cvt_pk_bf16_f32 v145, v146, v147
    v_mfma_f32_16x16x32_bf16 v[172:175], v[220:223], v[120:123], v[172:175]
    v_cvt_pk_bf16_f32 v146, v148, v149
    v_cvt_pk_bf16_f32 v147, v150, v151
    s_waitcnt lgkmcnt(0)
    v_mfma_f32_16x16x32_bf16 v[156:159], v[224:227], v[108:111], v[156:159]
    v_cvt_pk_bf16_f32 v160, v160, v161
    v_cvt_pk_bf16_f32 v161, v162, v163
    v_mfma_f32_16x16x32_bf16 v[172:175], v[224:227], v[124:127], v[172:175]
    v_cvt_pk_bf16_f32 v162, v164, v165
    v_cvt_pk_bf16_f32 v163, v166, v167
    v_add_f32 v243, v231, v232
    v_cmp_ngt_f32 vcc, s50, v243
    s_cbranch_vccnz K1W1_slow0
K1W1_back0:
    v_add_f32 v228, v228, v231
    v_add_f32 v229, v229, v232
    v_exp_f32 v152, v152
    v_exp_f32 v153, v153
    v_exp_f32 v154, v154
    v_exp_f32 v155, v155
    v_exp_f32 v168, v168
    v_exp_f32 v169, v169
    v_exp_f32 v170, v170
    v_exp_f32 v171, v171
    v_add_f32 v231, v152, v153
    v_add_f32 v231, v231, v154
    v_add_f32 v231, v231, v155
    v_add_f32 v232, v168, v169
    v_add_f32 v232, v232, v170
    v_add_f32 v232, v232, v171
    s_cmp_eq_u32 s25, 0
    s_cbranch_scc1 K1W1_A2a
    s_waitcnt vmcnt(0) lgkmcnt(0)
    s_branch K1W1_A2b
K1W1_A2a:
    s_waitcnt vmcnt(4) lgkmcnt(0)
K1W1_A2b:
    s_barrier
    ds_read_b64_tr_b16 v[196:197], v238 offset:0
    ds_read_b64_tr_b16 v[198:199], v238 offset:4096
    v_xor_b32 v240, 32, v238
    ds_read_b64_tr_b16 v[200:201], v240 offset:0
    ds_read_b64_tr_b16 v[202:203], v240 offset:4096
    v_xor_b32 v239, 64, v238
    ds_read_b64_tr_b16 v[204:205], v239 offset:0
    ds_read_b64_tr_b16 v[206:207], v239 offset:4096
    v_xor_b32 v240, 96, v238
    ds_read_b64_tr_b16 v[208:209], v240 offset:0
    ds_read_b64_tr_b16 v[210:211], v240 offset:4096
    v_xor_b32 v239, 128, v238
    ds_read_b64_tr_b16 v[212:213], v239 offset:0
    ds_read_b64_tr_b16 v[214:215], v239 offset:4096
    v_xor_b32 v240, 160, v238
    ds_read_b64_tr_b16 v[216:217], v240 offset:0
    ds_read_b64_tr_b16 v[218:219], v240 offset:4096
    v_xor_b32 v239, 192, v238
    ds_read_b64_tr_b16 v[220:221], v239 offset:0
    ds_read_b64_tr_b16 v[222:223], v239 offset:4096
    v_xor_b32 v240, 224, v238
    ds_read_b64_tr_b16 v[224:225], v240 offset:0
    ds_read_b64_tr_b16 v[226:227], v240 offset:4096
    s_waitcnt lgkmcnt(14)
    v_mfma_f32_16x16x32_bf16 v[0:3], v[196:199], v[144:147], v[0:3]
    v_exp_f32 v156, v156
    v_exp_f32 v157, v157
    v_mfma_f32_16x16x32_bf16 v[32:35], v[196:199], v[160:163], v[32:35]
    v_exp_f32 v158, v158
    ds_read_b64_tr_b16 v[196:197], v238 offset:8192
    ds_read_b64_tr_b16 v[198:199], v238 offset:12288
    s_waitcnt lgkmcnt(14)
    v_mfma_f32_16x16x32_bf16 v[4:7], v[200:203], v[144:147], v[4:7]
    v_exp_f32 v159, v159
    v_exp_f32 v172, v172
    v_mfma_f32_16x16x32_bf16 v[36:39], v[200:203], v[160:163], v[36:39]
    v_exp_f32 v173, v173
    v_xor_b32 v240, 32, v238
    ds_read_b64_tr_b16 v[200:201], v240 offset:8192
    ds_read_b64_tr_b16 v[202:203], v240 offset:12288
    s_waitcnt lgkmcnt(14)
    v_mfma_f32_16x16x32_bf16 v[8:11], v[204:207], v[144:147], v[8:11]
    v_exp_f32 v174, v174
    v_exp_f32 v175, v175
    v_mfma_f32_16x16x32_bf16 v[40:43], v[204:207], v[160:163], v[40:43]
    v_add_f32 v231, v231, v156
    v_xor_b32 v239, 64, v238
    ds_read_b64_tr_b16 v[204:205], v239 offset:8192
    ds_read_b64_tr_b16 v[206:207], v239 offset:12288
    s_waitcnt lgkmcnt(14)
    v_mfma_f32_16x16x32_bf16 v[12:15], v[208:211], v[144:147], v[12:15]
    v_add_f32 v231, v231, v157
    v_add_f32 v231, v231, v158
    v_mfma_f32_16x16x32_bf16 v[44:47], v[208:211], v[160:163], v[44:47]
    v_add_f32 v231, v231, v159
    v_xor_b32 v240, 96, v238
    ds_read_b64_tr_b16 v[208:209], v240 offset:8192
    ds_read_b64_tr_b16 v[210:211], v240 offset:12288
    s_waitcnt lgkmcnt(14)
    v_mfma_f32_16x16x32_bf16 v[16:19], v[212:215], v[144:147], v[16:19]
    v_add_f32 v232, v232, v172
    v_add_f32 v232, v232, v173
    v_mfma_f32_16x16x32_bf16 v[48:51], v[212:215], v[160:163], v[48:51]
    v_add_f32 v232, v232, v174
    v_xor_b32 v239, 128, v238
    ds_read_b64_tr_b16 v[212:213], v239 offset:8192
    ds_read_b64_tr_b16 v[214:215], v239 offset:12288
    s_waitcnt lgkmcnt(14)
    v_mfma_f32_16x16x32_bf16 v[20:23], v[216:219], v[144:147], v[20:23]
    v_add_f32 v232, v232, v175
    v_cvt_pk_bf16_f32 v148, v152, v153
    v_mfma_f32_16x16x32_bf16 v[52:55], v[216:219], v[160:163], v[52:55]
    v_cvt_pk_bf16_f32 v149, v154, v155
    v_xor_b32 v240, 160, v238
    ds_read_b64_tr_b16 v[216:217], v240 offset:8192
    ds_read_b64_tr_b16 v[218:219], v240 offset:12288
    s_waitcnt lgkmcnt(14)
    v_mfma_f32_16x16x32_bf16 v[24:27], v[220:223], v[144:147], v[24:27]
    v_cvt_pk_bf16_f32 v150, v156, v157
    v_cvt_pk_bf16_f32 v151, v158, v159
    v_mfma_f32_16x16x32_bf16 v[56:59], v[220:223], v[160:163], v[56:59]
    v_cvt_pk_bf16_f32 v164, v168, v169
    v_xor_b32 v239, 192, v238
    ds_read_b64_tr_b16 v[220:221], v239 offset:8192
    ds_read_b64_tr_b16 v[222:223], v239 offset:12288
    s_waitcnt lgkmcnt(14)
    v_mfma_f32_16x16x32_bf16 v[28:31], v[224:227], v[144:147], v[28:31]
    v_cvt_pk_bf16_f32 v165, v170, v171
    v_cvt_pk_bf16_f32 v166, v172, v173
    v_mfma_f32_16x16x32_bf16 v[60:63], v[224:227], v[160:163], v[60:63]
    v_cvt_pk_bf16_f32 v167, v174, v175
    v_xor_b32 v240, 224, v238
    ds_read_b64_tr_b16 v[224:225], v240 offset:8192
    ds_read_b64_tr_b16 v[226:227], v240 offset:12288
    v_add_f32 v243, v231, v232
    v_cmp_ngt_f32 vcc, s50, v243
    s_cbranch_vccnz K1W1_slow1
K1W1_back1:
    v_add_f32 v228, v228, v231
    v_add_f32 v229, v229, v232
    s_waitcnt lgkmcnt(14)
    v_mfma_f32_16x16x32_bf16 v[0:3], v[196:199], v[148:151], v[0:3]
    v_mfma_f32_16x16x32_bf16 v[32:35], v[196:199], v[164:167], v[32:35]
    s_waitcnt lgkmcnt(12)
    v_mfma_f32_16x16x32_bf16 v[4:7], v[200:203], v[148:151], v[4:7]
    v_mfma_f32_16x16x32_bf16 v[36:39], v[200:203], v[164:167], v[36:39]
    s_waitcnt lgkmcnt(10)
    v_mfma_f32_16x16x32_bf16 v[8:11], v[204:207], v[148:151], v[8:11]
    v_mfma_f32_16x16x32_bf16 v[40:43], v[204:207], v[164:167], v[40:43]
    s_waitcnt lgkmcnt(8)
    v_mfma_f32_16x16x32_bf16 v[12:15], v[208:211], v[148:151], v[12:15]
    v_mfma_f32_16x16x32_bf16 v[44:47], v[208:211], v[164:167], v[44:47]
    s_waitcnt lgkmcnt(6)
    v_mfma_f32_16x16x32_bf16 v[16:19], v[212:215], v[148:151], v[16:19]
    v_mfma_f32_16x16x32_bf16 v[48:51], v[212:215], v[164:167], v[48:51]
    s_waitcnt lgkmcnt(4)
    v_mfma_f32_16x16x32_bf16 v[20:23], v[216:219], v[148:151], v[20:23]
    v_mfma_f32_16x16x32_bf16 v[52:55], v[216:219], v[164:167], v[52:55]
    s_waitcnt lgkmcnt(2)
    v_mfma_f32_16x16x32_bf16 v[24:27], v[220:223], v[148:151], v[24:27]
    v_mfma_f32_16x16x32_bf16 v[56:59], v[220:223], v[164:167], v[56:59]
    s_waitcnt lgkmcnt(0)
    v_mfma_f32_16x16x32_bf16 v[28:31], v[224:227], v[148:151], v[28:31]
    v_mfma_f32_16x16x32_bf16 v[60:63], v[224:227], v[164:167], v[60:63]
    s_cmp_eq_u32 s57, 0
    s_cselect_b32 s60, 16384, 0
    s_cmp_eq_u32 s57, 1
    s_cselect_b32 s60, 32768, s60
    s_cmp_eq_u32 s57, 2
    s_cselect_b32 s60, 4294918144, s60
    s_cselect_b32 s57, -1, s57
    s_add_u32 s57, s57, 1
    v_add_u32 v234, s60, v234
    v_add_u32 v235, s60, v235
    v_add_u32 v236, s60, v236
    v_add_u32 v237, s60, v237
    v_xor_b32 v238, 98304, v238
    s_add_u32 s25, s25, 1
    s_cmp_lt_u32 s25, 16
    s_cbranch_scc1 K1W1_LOOP
    s_cmp_eq_u32 s27, 1
    s_cbranch_scc1 K1W1_FINAL1
    s_mov_b32 s27, 1
    s_branch K1W1_ROUND
K1W1_LDR:
    s_nop 1
    s_and_b32 s51, s2, 1
    s_cmp_eq_u32 s27, 0
    s_cbranch_scc1 K1W1_LR0
K1W1_LR0:
    s_cmp_eq_u32 s27, 0
    s_cselect_b32 s57, 2, 0
    s_mov_b32 s28, 4096
    s_cselect_b32 s28, 53248, s28
    s_mov_b32 s45, 0
K1W1_LLOOP:
    s_mov_b32 s46, s45
    s_mov_b32 s45, 0
    s_cmp_eq_u32 s46, 0
    s_cbranch_scc0 K1W1_XW1_1
    s_waitcnt vmcnt(8) lgkmcnt(0)
    s_branch K1W1_XW1_z
K1W1_XW1_1:
    s_cmp_eq_u32 s46, 1
    s_cbranch_scc0 K1W1_XW1_2
    s_waitcnt vmcnt(9) lgkmcnt(0)
    s_branch K1W1_XW1_z
K1W1_XW1_2:
    s_cmp_eq_u32 s46, 2
    s_cbranch_scc0 K1W1_XW1_3
    s_waitcnt vmcnt(10) lgkmcnt(0)
    s_branch K1W1_XW1_z
K1W1_XW1_3:
    s_waitcnt vmcnt(11) lgkmcnt(0)
K1W1_XW1_z:
    s_barrier
    s_cmp_eq_u32 s27, 0
    s_cbranch_scc0 K1W1_L0
    s_cmp_eq_u32 s25, 15
    s_cbranch_scc0 K1W1_L0
    v_add_u32 v242, 1835008, v242
K1W1_L0:
    s_mov_b32 m0, s29
    v_xor_b32 v243, 128, v242
    buffer_load_dwordx4 v242, s[8:11], 0 offen nt lds
    buffer_load_dwordx4 v243, s[8:11], 0 offen offset:1024 nt lds
    buffer_load_dwordx4 v242, s[8:11], 0 offen offset:2048 nt lds
    buffer_load_dwordx4 v243, s[8:11], 0 offen offset:3072 nt lds
    v_add_u32 v242, 16384, v242
    s_xor_b32 s29, s29, 98304
    s_cmp_eq_u32 s27, 1
    s_cbranch_scc0 K1W1_L1
    s_cmp_eq_u32 s25, 0
    s_cbranch_scc0 K1W1_E0
    s_nop 7
    v_add_u32 v246, 81920, v248
    v_and_b32 v247, 15, v245
    v_lshlrev_b32 v247, 2, v247
    v_add_u32 v247, 114688, v247
    v_mov_b32 v244, v228
    s_nop 1
    v_permlane16_swap_b32 v244, v228
    v_add_f32 v228, v228, v244
    v_mov_b32 v244, v228
    s_nop 1
    v_permlane32_swap_b32 v244, v228
    v_add_f32 v228, v228, v244
    v_mov_b32 v244, v229
    s_nop 1
    v_permlane16_swap_b32 v244, v229
    v_add_f32 v229, v229, v244
    v_mov_b32 v244, v229
    s_nop 1
    v_permlane32_swap_b32 v244, v229
    v_add_f32 v229, v229, v244
    v_rcp_f32 v228, v228
    v_rcp_f32 v229, v229
    s_branch K1W1_L1
K1W1_E0:
    s_cmp_eq_u32 s25, 1
    s_cbranch_scc0 K1W1_E1
    s_nop 1
    v_mul_f32 v0, v0, v228
    v_mul_f32 v1, v1, v228
    v_mul_f32 v2, v2, v228
    v_mul_f32 v3, v3, v228
    v_mul_f32 v4, v4, v228
    v_mul_f32 v5, v5, v228
    v_mul_f32 v6, v6, v228
    v_mul_f32 v7, v7, v228
    v_cvt_pk_bf16_f32 v96, v0, v1
    v_cvt_pk_bf16_f32 v97, v2, v3
    v_cvt_pk_bf16_f32 v98, v4, v5
    v_cvt_pk_bf16_f32 v99, v6, v7
    v_mul_f32 v8, v8, v228
    v_mul_f32 v9, v9, v228
    v_mul_f32 v10, v10, v228
    v_mul_f32 v11, v11, v228
    v_mul_f32 v12, v12, v228
    v_mul_f32 v13, v13, v228
    v_mul_f32 v14, v14, v228
    v_mul_f32 v15, v15, v228
    v_cvt_pk_bf16_f32 v100, v8, v9
    v_cvt_pk_bf16_f32 v101, v10, v11
    v_cvt_pk_bf16_f32 v102, v12, v13
    v_cvt_pk_bf16_f32 v103, v14, v15
    v_mul_f32 v16, v16, v228
    v_mul_f32 v17, v17, v228
    v_mul_f32 v18, v18, v228
    v_mul_f32 v19, v19, v228
    v_mul_f32 v20, v20, v228
    v_mul_f32 v21, v21, v228
    v_mul_f32 v22, v22, v228
    v_mul_f32 v23, v23, v228
    v_cvt_pk_bf16_f32 v104, v16, v17
    v_cvt_pk_bf16_f32 v105, v18, v19
    v_cvt_pk_bf16_f32 v106, v20, v21
    v_cvt_pk_bf16_f32 v107, v22, v23
    v_mul_f32 v24, v24, v228
    v_mul_f32 v25, v25, v228
    v_mul_f32 v26, v26, v228
    v_mul_f32 v27, v27, v228
    v_mul_f32 v28, v28, v228
    v_mul_f32 v29, v29, v228
    v_mul_f32 v30, v30, v228
    v_mul_f32 v31, v31, v228
    v_cvt_pk_bf16_f32 v108, v24, v25
    v_cvt_pk_bf16_f32 v109, v26, v27
    v_cvt_pk_bf16_f32 v110, v28, v29
    v_cvt_pk_bf16_f32 v111, v30, v31
    s_branch K1W1_L1
K1W1_E1:
    s_cmp_eq_u32 s25, 2
    s_cbranch_scc0 K1W1_E2
    s_nop 1
    v_mul_f32 v32, v32, v229
    v_mul_f32 v33, v33, v229
    v_mul_f32 v34, v34, v229
    v_mul_f32 v35, v35, v229
    v_mul_f32 v36, v36, v229
    v_mul_f32 v37, v37, v229
    v_mul_f32 v38, v38, v229
    v_mul_f32 v39, v39, v229
    v_cvt_pk_bf16_f32 v112, v32, v33
    v_cvt_pk_bf16_f32 v113, v34, v35
    v_cvt_pk_bf16_f32 v114, v36, v37
    v_cvt_pk_bf16_f32 v115, v38, v39
    v_mul_f32 v40, v40, v229
    v_mul_f32 v41, v41, v229
    v_mul_f32 v42, v42, v229
    v_mul_f32 v43, v43, v229
    v_mul_f32 v44, v44, v229
    v_mul_f32 v45, v45, v229
    v_mul_f32 v46, v46, v229
    v_mul_f32 v47, v47, v229
    v_cvt_pk_bf16_f32 v116, v40, v41
    v_cvt_pk_bf16_f32 v117, v42, v43
    v_cvt_pk_bf16_f32 v118, v44, v45
    v_cvt_pk_bf16_f32 v119, v46, v47
    v_mul_f32 v48, v48, v229
    v_mul_f32 v49, v49, v229
    v_mul_f32 v50, v50, v229
    v_mul_f32 v51, v51, v229
    v_mul_f32 v52, v52, v229
    v_mul_f32 v53, v53, v229
    v_mul_f32 v54, v54, v229
    v_mul_f32 v55, v55, v229
    v_cvt_pk_bf16_f32 v120, v48, v49
    v_cvt_pk_bf16_f32 v121, v50, v51
    v_cvt_pk_bf16_f32 v122, v52, v53
    v_cvt_pk_bf16_f32 v123, v54, v55
    v_mul_f32 v56, v56, v229
    v_mul_f32 v57, v57, v229
    v_mul_f32 v58, v58, v229
    v_mul_f32 v59, v59, v229
    v_mul_f32 v60, v60, v229
    v_mul_f32 v61, v61, v229
    v_mul_f32 v62, v62, v229
    v_mul_f32 v63, v63, v229
    v_cvt_pk_bf16_f32 v124, v56, v57
    v_cvt_pk_bf16_f32 v125, v58, v59
    v_cvt_pk_bf16_f32 v126, v60, v61
    v_cvt_pk_bf16_f32 v127, v62, v63
    s_branch K1W1_L1
K1W1_E2:
    s_cmp_eq_u32 s25, 3
    s_cbranch_scc0 K1W1_E3
    s_nop 1
    ds_read_b32 v144, v247 offset:0
    ds_read_b32 v148, v247 offset:64
    ds_read_b32 v145, v247 offset:128
    ds_read_b32 v149, v247 offset:192
    ds_read_b128 v[196:199], v246 offset:2048
    ds_read_b128 v[200:203], v246 offset:3072
    ds_read_b128 v[204:207], v246 offset:10240
    ds_read_b128 v[208:211], v246 offset:11264
    s_waitcnt lgkmcnt(5)
    v_max_f32 v244, v144, v145
    v_sub_f32 v152, v144, v244
    v_sub_f32 v153, v145, v244
    v_exp_f32 v152, v152
    v_exp_f32 v153, v153
    v_mul_f32 v244, v152, v148
    s_waitcnt lgkmcnt(4)
    v_fma_f32 v244, v153, v149, v244
    v_rcp_f32 v244, v244
    s_nop 0
    v_mul_f32 v152, v152, v244
    v_mul_f32 v153, v153, v244
    s_waitcnt lgkmcnt(3)
    v_mul_f32 v160, v196, v152
    s_waitcnt lgkmcnt(1)
    v_fma_f32 v160, v204, v153, v160
    v_mul_f32 v161, v197, v152
    v_fma_f32 v161, v205, v153, v161
    v_mul_f32 v162, v198, v152
    v_fma_f32 v162, v206, v153, v162
    v_mul_f32 v163, v199, v152
    v_fma_f32 v163, v207, v153, v163
    v_mul_f32 v164, v200, v152
    s_waitcnt lgkmcnt(0)
    v_fma_f32 v164, v208, v153, v164
    v_mul_f32 v165, v201, v152
    v_fma_f32 v165, v209, v153, v165
    v_mul_f32 v166, v202, v152
    v_fma_f32 v166, v210, v153, v166
    v_mul_f32 v167, v203, v152
    v_fma_f32 v167, v211, v153, v167
    v_cvt_pk_bf16_f32 v128, v160, v161
    v_cvt_pk_bf16_f32 v129, v162, v163
    v_cvt_pk_bf16_f32 v130, v164, v165
    v_cvt_pk_bf16_f32 v131, v166, v167
    s_branch K1W1_L1
K1W1_E3:
K1W1_L1c:
K1W1_L1:
    s_add_u32 s47, s46, s45
    s_cmp_eq_u32 s47, 0
    s_cbranch_scc0 K1W1_XW2_1
    s_waitcnt vmcnt(8) lgkmcnt(0)
    s_branch K1W1_XW2_z
K1W1_XW2_1:
    s_cmp_eq_u32 s47, 1
    s_cbranch_scc0 K1W1_XW2_2
    s_waitcnt vmcnt(9) lgkmcnt(0)
    s_branch K1W1_XW2_z
K1W1_XW2_2:
    s_cmp_eq_u32 s47, 2
    s_cbranch_scc0 K1W1_XW2_3
    s_waitcnt vmcnt(10) lgkmcnt(0)
    s_branch K1W1_XW2_z
K1W1_XW2_3:
    s_waitcnt vmcnt(11) lgkmcnt(0)
K1W1_XW2_z:
    s_barrier
    s_cmp_eq_u32 s27, 0
    s_cbranch_scc0 K1W1_L2
    s_cmp_eq_u32 s25, 14
    s_cbranch_scc0 K1W1_L2
    v_add_u32 v241, 1835008, v241
K1W1_L2:
    s_mov_b32 m0, s28
    v_xor_b32 v243, 64, v241
    buffer_load_dwordx4 v241, s[4:7], 0 offen nt lds
    v_xor_b32 v244, 128, v241
    buffer_load_dwordx4 v243, s[4:7], 0 offen offset:1024 nt lds
    v_xor_b32 v243, 192, v241
    buffer_load_dwordx4 v244, s[4:7], 0 offen offset:2048 nt lds
    buffer_load_dwordx4 v243, s[4:7], 0 offen offset:3072 nt lds
    v_add_u32 v241, 16384, v241
    s_add_u32 s57, s57, 1
    s_cmp_eq_u32 s57, 3
    s_cselect_b32 s57, 0, s57
    s_cmp_eq_u32 s57, 0
    s_cselect_b32 s28, 4096, 0
    s_cmp_eq_u32 s57, 1
    s_cselect_b32 s28, 20480, s28
    s_cmp_eq_u32 s57, 2
    s_cselect_b32 s28, 53248, s28
    s_add_u32 s25, s25, 1
    s_cmp_lt_u32 s25, 16
    s_cbranch_scc1 K1W1_LLOOP
    s_cmp_eq_u32 s27, 1
    s_cbranch_scc1 K1W1_FIN0
    s_mov_b32 s27, 1
    s_branch K1W1_ROUND
K1W1_FIN0:
    s_nop 1
    s_mov_b32 s30, 8192
    buffer_store_dwordx4 v[96:99], v248, s[20:23], s30 offen offset:0 sc1
    buffer_store_dwordx4 v[100:103], v248, s[20:23], s30 offen offset:1024 sc1
    buffer_store_dwordx4 v[104:107], v248, s[20:23], s30 offen offset:2048 sc1
    buffer_store_dwordx4 v[108:111], v248, s[20:23], s30 offen offset:3072 sc1
    s_mov_b32 s30, 12288
    buffer_store_dwordx4 v[112:115], v248, s[20:23], s30 offen offset:0 sc1
    buffer_store_dwordx4 v[116:119], v248, s[20:23], s30 offen offset:1024 sc1
    buffer_store_dwordx4 v[120:123], v248, s[20:23], s30 offen offset:2048 sc1
    buffer_store_dwordx4 v[124:127], v248, s[20:23], s30 offen offset:3072 sc1
    s_mov_b32 s30, 33792
    buffer_store_dwordx4 v[128:131], v248, s[20:23], s30 offen sc1
    s_barrier
    s_waitcnt vmcnt(0)
    s_lshl_b32 s30, s85, 3
    s_add_u32 s30, s30, s84
    s_mul_i32 s44, s30, 52
    s_lshr_b32 s44, s44, 8
    s_mul_i32 s31, s44, 5
    s_sub_u32 s45, s30, s31
    s_and_b32 s51, s2, 1
    s_load_dwordx2 s[72:73], s[0:1], 32
    s_load_dwordx2 s[74:75], s[0:1], 72
    s_load_dwordx2 s[46:47], s[0:1], 80
    s_waitcnt lgkmcnt(0)
    s_cmp_eq_u32 s64, 0
    s_cselect_b64 s[72:73], s[72:73], s[74:75]
    s_lshl_b32 s30, s45, 8
    s_add_u32 s12, s72, s30
    s_addc_u32 s13, s73, 0
    s_sub_u32 s14, 5242880, s30
    s_mov_b32 s15, 131072
    s_mov_b32 s16, s48
    s_mov_b32 s17, s49
    s_mov_b32 s18, 18874368
    s_mov_b32 s19, 131072
    s_add_u32 s80, s48, 50331648
    s_addc_u32 s81, s49, 0
    s_mov_b32 s82, 131072
    s_mov_b32 s83, 131072
    s_mov_b32 s4, s46
    s_mov_b32 s5, s47
    s_mov_b32 s6, 2949120
    s_mov_b32 s7, 131072
    s_add_u32 s8, s48, 33554432
    s_addc_u32 s9, s49, 0
    s_mov_b32 s10, 12582912
    s_mov_b32 s11, 131072
    s_sub_u32 s69, s65, s85
    s_mul_i32 s30, s44, 6
    s_add_u32 s30, s30, 0
    s_mul_i32 s31, s30, 57
    s_lshr_b32 s31, s31, 9
    s_mul_i32 s72, s31, 9
    s_sub_u32 s72, s30, s72
    s_add_u32 s31, s31, s69
    s_lshl_b32 s73, s64, 3
    s_add_u32 s73, s73, s31
    s_lshl_b32 s73, s73, 5
    s_lshl_b32 s74, s51, 4
    s_add_u32 s73, s73, s74
    s_mul_i32 s73, s73, 36864
    s_lshl_b32 s74, s72, 12
    s_add_u32 s32, s73, s74
    s_mul_i32 s73, s31, 144
    s_lshl_b32 s74, s72, 4
    s_add_u32 s73, s73, s74
    s_mul_i32 s73, s73, 2560
    s_mul_i32 s74, s64, 1280
    s_add_u32 s73, s73, s74
    s_lshl_b32 s74, s45, 8
    s_add_u32 s38, s73, s74
    s_mul_i32 s30, s44, 6
    s_add_u32 s30, s30, 1
    s_mul_i32 s31, s30, 57
    s_lshr_b32 s31, s31, 9
    s_mul_i32 s72, s31, 9
    s_sub_u32 s72, s30, s72
    s_add_u32 s31, s31, s69
    s_lshl_b32 s73, s64, 3
    s_add_u32 s73, s73, s31
    s_lshl_b32 s73, s73, 5
    s_lshl_b32 s74, s51, 4
    s_add_u32 s73, s73, s74
    s_mul_i32 s73, s73, 36864
    s_lshl_b32 s74, s72, 12
    s_add_u32 s33, s73, s74
    s_mul_i32 s73, s31, 144
    s_lshl_b32 s74, s72, 4
    s_add_u32 s73, s73, s74
    s_mul_i32 s73, s73, 2560
    s_mul_i32 s74, s64, 1280
    s_add_u32 s73, s73, s74
    s_lshl_b32 s74, s45, 8
    s_add_u32 s39, s73, s74
    s_mul_i32 s30, s44, 6
    s_add_u32 s30, s30, 2
    s_mul_i32 s31, s30, 57
    s_lshr_b32 s31, s31, 9
    s_mul_i32 s72, s31, 9
    s_sub_u32 s72, s30, s72
    s_add_u32 s31, s31, s69
    s_lshl_b32 s73, s64, 3
    s_add_u32 s73, s73, s31
    s_lshl_b32 s73, s73, 5
    s_lshl_b32 s74, s51, 4
    s_add_u32 s73, s73, s74
    s_mul_i32 s73, s73, 36864
    s_lshl_b32 s74, s72, 12
    s_add_u32 s34, s73, s74
    s_mul_i32 s73, s31, 144
    s_lshl_b32 s74, s72, 4
    s_add_u32 s73, s73, s74
    s_mul_i32 s73, s73, 2560
    s_mul_i32 s74, s64, 1280
    s_add_u32 s73, s73, s74
    s_lshl_b32 s74, s45, 8
    s_add_u32 s40, s73, s74
    s_mul_i32 s30, s44, 6
    s_add_u32 s30, s30, 3
    s_mul_i32 s31, s30, 57
    s_lshr_b32 s31, s31, 9
    s_mul_i32 s72, s31, 9
    s_sub_u32 s72, s30, s72
    s_add_u32 s31, s31, s69
    s_lshl_b32 s73, s64, 3
    s_add_u32 s73, s73, s31
    s_lshl_b32 s73, s73, 5
    s_lshl_b32 s74, s51, 4
    s_add_u32 s73, s73, s74
    s_mul_i32 s73, s73, 36864
    s_lshl_b32 s74, s72, 12
    s_add_u32 s35, s73, s74
    s_mul_i32 s73, s31, 144
    s_lshl_b32 s74, s72, 4
    s_add_u32 s73, s73, s74
    s_mul_i32 s73, s73, 2560
    s_mul_i32 s74, s64, 1280
    s_add_u32 s73, s73, s74
    s_lshl_b32 s74, s45, 8
    s_add_u32 s41, s73, s74
    s_mul_i32 s30, s44, 6
    s_add_u32 s30, s30, 4
    s_mul_i32 s31, s30, 57
    s_lshr_b32 s31, s31, 9
    s_mul_i32 s72, s31, 9
    s_sub_u32 s72, s30, s72
    s_add_u32 s31, s31, s69
    s_lshl_b32 s73, s64, 3
    s_add_u32 s73, s73, s31
    s_lshl_b32 s73, s73, 5
    s_lshl_b32 s74, s51, 4
    s_add_u32 s73, s73, s74
    s_mul_i32 s73, s73, 36864
    s_lshl_b32 s74, s72, 12
    s_add_u32 s36, s73, s74
    s_mul_i32 s73, s31, 144
    s_lshl_b32 s74, s72, 4
    s_add_u32 s73, s73, s74
    s_mul_i32 s73, s73, 2560
    s_mul_i32 s74, s64, 1280
    s_add_u32 s73, s73, s74
    s_lshl_b32 s74, s45, 8
    s_add_u32 s42, s73, s74
    s_mul_i32 s30, s44, 6
    s_add_u32 s30, s30, 5
    s_mul_i32 s31, s30, 57
    s_lshr_b32 s31, s31, 9
    s_mul_i32 s72, s31, 9
    s_sub_u32 s72, s30, s72
    s_add_u32 s31, s31, s69
    s_lshl_b32 s73, s64, 3
    s_add_u32 s73, s73, s31
    s_lshl_b32 s73, s73, 5
    s_lshl_b32 s74, s51, 4
    s_add_u32 s73, s73, s74
    s_mul_i32 s73, s73, 36864
    s_lshl_b32 s74, s72, 12
    s_add_u32 s37, s73, s74
    s_mul_i32 s73, s31, 144
    s_lshl_b32 s74, s72, 4
    s_add_u32 s73, s73, s74
    s_mul_i32 s73, s73, 2560
    s_mul_i32 s74, s64, 1280
    s_add_u32 s73, s73, s74
    s_lshl_b32 s74, s45, 8
    s_add_u32 s43, s73, s74
    s_mul_i32 s53, s51, 2621440
    v_mov_b32 v104, v248
    v_add_u32 v105, 57344, v248
    v_lshrrev_b32 v116, 4, v245
    v_bfe_u32 v117, v245, 2, 2
    v_lshl_add_u32 v116, v116, 2, v117
    v_and_b32 v117, 7, v116
    v_lshlrev_b32 v117, 1, v117
    v_bfe_u32 v118, v245, 1, 1
    v_xor_b32 v117, v117, v118
    v_lshlrev_b32 v117, 4, v117
    v_lshl_or_b32 v116, v116, 8, v117
    v_and_b32 v117, 1, v245
    v_lshl_or_b32 v116, v117, 3, v116
    v_xor_b32 v117, 128, v116
    v_add_u32 v106, 12288, v117
    v_add_u32 v110, 69632, v117
    v_xor_b32 v117, 160, v116
    v_add_u32 v107, 12288, v117
    v_add_u32 v111, 69632, v117
    v_xor_b32 v117, 192, v116
    v_add_u32 v108, 12288, v117
    v_add_u32 v112, 69632, v117
    v_xor_b32 v117, 224, v116
    v_add_u32 v109, 12288, v117
    v_add_u32 v113, 69632, v117
    v_mov_b32 v0, 0
    v_mov_b32 v1, 0
    v_mov_b32 v2, 0
    v_mov_b32 v3, 0
    v_mov_b32 v4, 0
    v_mov_b32 v5, 0
    v_mov_b32 v6, 0
    v_mov_b32 v7, 0
    v_mov_b32 v8, 0
    v_mov_b32 v9, 0
    v_mov_b32 v10, 0
    v_mov_b32 v11, 0
    v_mov_b32 v12, 0
    v_mov_b32 v13, 0
    v_mov_b32 v14, 0
    v_mov_b32 v15, 0
    v_mov_b32 v16, 0
    v_mov_b32 v17, 0
    v_mov_b32 v18, 0
    v_mov_b32 v19, 0
    v_mov_b32 v20, 0
    v_mov_b32 v21, 0
    v_mov_b32 v22, 0
    v_mov_b32 v23, 0
    v_mov_b32 v24, 0
    v_mov_b32 v25, 0
    v_mov_b32 v26, 0
    v_mov_b32 v27, 0
    v_mov_b32 v28, 0
    v_mov_b32 v29, 0
    v_mov_b32 v30, 0
    v_mov_b32 v31, 0
    v_mov_b32 v32, 0
    v_mov_b32 v33, 0
    v_mov_b32 v34, 0
    v_mov_b32 v35, 0
    v_mov_b32 v36, 0
    v_mov_b32 v37, 0
    v_mov_b32 v38, 0
    v_mov_b32 v39, 0
    v_mov_b32 v40, 0
    v_mov_b32 v41, 0
    v_mov_b32 v42, 0
    v_mov_b32 v43, 0
    v_mov_b32 v44, 0
    v_mov_b32 v45, 0
    v_mov_b32 v46, 0
    v_mov_b32 v47, 0
    v_mov_b32 v244, 0
    buffer_load_dword v254, v244, s[88:91], 0 offen sc1
    s_waitcnt vmcnt(0)
    v_readfirstlane_b32 s93, v254
    s_barrier
    s_cmp_ge_u32 s44, 6
    s_cbranch_scc1 K1_END
    s_mul_i32 s30, s44, 6
    s_mul_i32 s31, s30, 57
    s_lshr_b32 s31, s31, 9
    s_add_u32 s30, s30, 5
    s_mul_i32 s30, s30, 57
    s_lshr_b32 s30, s30, 9
    v_and_b32 v244, 7, v245
    v_lshlrev_b32 v244, 10, v244
    s_lshl_b32 s31, s31, 13
    s_lshl_b32 s30, s30, 13
    v_mov_b32 v243, s31
    v_mov_b32 v246, s30
    v_cmp_gt_u32 vcc, 8, v245
    s_nop 1
    v_cndmask_b32 v243, v246, v243, vcc
    v_add_u32 v244, v244, v243
    s_and_b32 s30, s2, 7
    s_lshl_b32 s30, s30, 7
    s_mov_b32 s31, 0
    s_mov_b64 exec, 65535
K1W1_TP_P:
    buffer_load_dword v243, v244, s[80:83], s30 offen sc1
    s_waitcnt vmcnt(0)
    v_cmp_ne_u32 vcc, s93, v243
    s_add_u32 s31, s31, 1
    s_cbranch_vccz K1W1_TP_D
    s_sleep 1
    s_cmp_lt_u32 s31, 400000
    s_cbranch_scc1 K1W1_TP_P
K1W1_TP_D:
    s_mov_b64 exec, -1
    s_barrier
    s_mov_b32 s58, 0
    s_nop 1
K1W1_TC:
    s_barrier
    s_cmp_eq_u32 s58, 0
    s_cbranch_scc1 K1W1_TCf
    v_mfma_f32_16x16x32_bf16 v[0:3], v[88:91], v[60:63], v[0:3]
    ds_read_b128 v[48:51], v104 offset:0
    v_mfma_f32_16x16x32_bf16 v[16:19], v[88:91], v[64:67], v[16:19]
    ds_read_b128 v[52:55], v104 offset:2048
    v_mfma_f32_16x16x32_bf16 v[32:35], v[88:91], v[68:71], v[32:35]
    ds_read_b128 v[56:59], v104 offset:4096
    v_mfma_f32_16x16x32_bf16 v[4:7], v[92:95], v[60:63], v[4:7]
    ds_read_b64_tr_b16 v[72:73], v106 offset:0
    v_mfma_f32_16x16x32_bf16 v[20:23], v[92:95], v[64:67], v[20:23]
    ds_read_b64_tr_b16 v[74:75], v106 offset:4096
    v_mfma_f32_16x16x32_bf16 v[36:39], v[92:95], v[68:71], v[36:39]
    ds_read_b64_tr_b16 v[76:77], v107 offset:0
    v_mfma_f32_16x16x32_bf16 v[8:11], v[96:99], v[60:63], v[8:11]
    ds_read_b64_tr_b16 v[78:79], v107 offset:4096
    v_mfma_f32_16x16x32_bf16 v[24:27], v[96:99], v[64:67], v[24:27]
    ds_read_b64_tr_b16 v[80:81], v108 offset:0
    v_mfma_f32_16x16x32_bf16 v[40:43], v[96:99], v[68:71], v[40:43]
    ds_read_b64_tr_b16 v[82:83], v108 offset:4096
    v_mfma_f32_16x16x32_bf16 v[12:15], v[100:103], v[60:63], v[12:15]
    ds_read_b64_tr_b16 v[84:85], v109 offset:0
    v_mfma_f32_16x16x32_bf16 v[28:31], v[100:103], v[64:67], v[28:31]
    ds_read_b64_tr_b16 v[86:87], v109 offset:4096
    v_mfma_f32_16x16x32_bf16 v[44:47], v[100:103], v[68:71], v[44:47]
    s_branch K1W1_TCg
K1W1_TCf:
    ds_read_b128 v[48:51], v104 offset:0
    ds_read_b128 v[52:55], v104 offset:2048
    ds_read_b128 v[56:59], v104 offset:4096
    ds_read_b64_tr_b16 v[72:73], v106 offset:0
    ds_read_b64_tr_b16 v[74:75], v106 offset:4096
    ds_read_b64_tr_b16 v[76:77], v107 offset:0
    ds_read_b64_tr_b16 v[78:79], v107 offset:4096
    ds_read_b64_tr_b16 v[80:81], v108 offset:0
    ds_read_b64_tr_b16 v[82:83], v108 offset:4096
    ds_read_b64_tr_b16 v[84:85], v109 offset:0
    ds_read_b64_tr_b16 v[86:87], v109 offset:4096
K1W1_TCg:
    s_waitcnt lgkmcnt(0)
    v_mfma_f32_16x16x32_bf16 v[0:3], v[72:75], v[48:51], v[0:3]
    ds_read_b128 v[60:63], v104 offset:1024
    v_mfma_f32_16x16x32_bf16 v[16:19], v[72:75], v[52:55], v[16:19]
    ds_read_b128 v[64:67], v104 offset:3072
    v_mfma_f32_16x16x32_bf16 v[32:35], v[72:75], v[56:59], v[32:35]
    ds_read_b128 v[68:71], v104 offset:5120
    v_mfma_f32_16x16x32_bf16 v[4:7], v[76:79], v[48:51], v[4:7]
    ds_read_b64_tr_b16 v[88:89], v106 offset:8192
    v_mfma_f32_16x16x32_bf16 v[20:23], v[76:79], v[52:55], v[20:23]
    ds_read_b64_tr_b16 v[90:91], v106 offset:12288
    v_mfma_f32_16x16x32_bf16 v[36:39], v[76:79], v[56:59], v[36:39]
    ds_read_b64_tr_b16 v[92:93], v107 offset:8192
    v_mfma_f32_16x16x32_bf16 v[8:11], v[80:83], v[48:51], v[8:11]
    ds_read_b64_tr_b16 v[94:95], v107 offset:12288
    v_mfma_f32_16x16x32_bf16 v[24:27], v[80:83], v[52:55], v[24:27]
    ds_read_b64_tr_b16 v[96:97], v108 offset:8192
    v_mfma_f32_16x16x32_bf16 v[40:43], v[80:83], v[56:59], v[40:43]
    ds_read_b64_tr_b16 v[98:99], v108 offset:12288
    v_mfma_f32_16x16x32_bf16 v[12:15], v[84:87], v[48:51], v[12:15]
    ds_read_b64_tr_b16 v[100:101], v109 offset:8192
    v_mfma_f32_16x16x32_bf16 v[28:31], v[84:87], v[52:55], v[28:31]
    ds_read_b64_tr_b16 v[102:103], v109 offset:12288
    v_mfma_f32_16x16x32_bf16 v[44:47], v[84:87], v[56:59], v[44:47]
    s_waitcnt lgkmcnt(0)
    s_barrier
    v_mfma_f32_16x16x32_bf16 v[0:3], v[88:91], v[60:63], v[0:3]
    ds_read_b128 v[48:51], v104 offset:28672
    v_mfma_f32_16x16x32_bf16 v[16:19], v[88:91], v[64:67], v[16:19]
    ds_read_b128 v[52:55], v104 offset:30720
    v_mfma_f32_16x16x32_bf16 v[32:35], v[88:91], v[68:71], v[32:35]
    ds_read_b128 v[56:59], v104 offset:32768
    v_mfma_f32_16x16x32_bf16 v[4:7], v[92:95], v[60:63], v[4:7]
    ds_read_b64_tr_b16 v[72:73], v106 offset:28672
    v_mfma_f32_16x16x32_bf16 v[20:23], v[92:95], v[64:67], v[20:23]
    ds_read_b64_tr_b16 v[74:75], v106 offset:32768
    v_mfma_f32_16x16x32_bf16 v[36:39], v[92:95], v[68:71], v[36:39]
    ds_read_b64_tr_b16 v[76:77], v107 offset:28672
    v_mfma_f32_16x16x32_bf16 v[8:11], v[96:99], v[60:63], v[8:11]
    ds_read_b64_tr_b16 v[78:79], v107 offset:32768
    v_mfma_f32_16x16x32_bf16 v[24:27], v[96:99], v[64:67], v[24:27]
    ds_read_b64_tr_b16 v[80:81], v108 offset:28672
    v_mfma_f32_16x16x32_bf16 v[40:43], v[96:99], v[68:71], v[40:43]
    ds_read_b64_tr_b16 v[82:83], v108 offset:32768
    v_mfma_f32_16x16x32_bf16 v[12:15], v[100:103], v[60:63], v[12:15]
    ds_read_b64_tr_b16 v[84:85], v109 offset:28672
    v_mfma_f32_16x16x32_bf16 v[28:31], v[100:103], v[64:67], v[28:31]
    ds_read_b64_tr_b16 v[86:87], v109 offset:32768
    v_mfma_f32_16x16x32_bf16 v[44:47], v[100:103], v[68:71], v[44:47]
    s_waitcnt lgkmcnt(6)
    v_mfma_f32_16x16x32_bf16 v[0:3], v[72:75], v[48:51], v[0:3]
    ds_read_b128 v[60:63], v104 offset:29696
    v_mfma_f32_16x16x32_bf16 v[16:19], v[72:75], v[52:55], v[16:19]
    ds_read_b128 v[64:67], v104 offset:31744
    v_mfma_f32_16x16x32_bf16 v[32:35], v[72:75], v[56:59], v[32:35]
    ds_read_b128 v[68:71], v104 offset:33792
    s_waitcnt lgkmcnt(7)
    v_mfma_f32_16x16x32_bf16 v[4:7], v[76:79], v[48:51], v[4:7]
    ds_read_b64_tr_b16 v[88:89], v106 offset:36864
    v_mfma_f32_16x16x32_bf16 v[20:23], v[76:79], v[52:55], v[20:23]
    ds_read_b64_tr_b16 v[90:91], v106 offset:40960
    v_mfma_f32_16x16x32_bf16 v[36:39], v[76:79], v[56:59], v[36:39]
    ds_read_b64_tr_b16 v[92:93], v107 offset:36864
    s_waitcnt lgkmcnt(8)
    v_mfma_f32_16x16x32_bf16 v[8:11], v[80:83], v[48:51], v[8:11]
    ds_read_b64_tr_b16 v[94:95], v107 offset:40960
    v_mfma_f32_16x16x32_bf16 v[24:27], v[80:83], v[52:55], v[24:27]
    ds_read_b64_tr_b16 v[96:97], v108 offset:36864
    v_mfma_f32_16x16x32_bf16 v[40:43], v[80:83], v[56:59], v[40:43]
    ds_read_b64_tr_b16 v[98:99], v108 offset:40960
    s_waitcnt lgkmcnt(9)
    v_mfma_f32_16x16x32_bf16 v[12:15], v[84:87], v[48:51], v[12:15]
    ds_read_b64_tr_b16 v[100:101], v109 offset:36864
    v_mfma_f32_16x16x32_bf16 v[28:31], v[84:87], v[52:55], v[28:31]
    ds_read_b64_tr_b16 v[102:103], v109 offset:40960
    v_mfma_f32_16x16x32_bf16 v[44:47], v[84:87], v[56:59], v[44:47]
    s_waitcnt lgkmcnt(0)
    s_barrier
    v_mfma_f32_16x16x32_bf16 v[0:3], v[88:91], v[60:63], v[0:3]
    ds_read_b128 v[48:51], v105 offset:0
    v_mfma_f32_16x16x32_bf16 v[16:19], v[88:91], v[64:67], v[16:19]
    ds_read_b128 v[52:55], v105 offset:2048
    v_mfma_f32_16x16x32_bf16 v[32:35], v[88:91], v[68:71], v[32:35]
    ds_read_b128 v[56:59], v105 offset:4096
    v_mfma_f32_16x16x32_bf16 v[4:7], v[92:95], v[60:63], v[4:7]
    ds_read_b64_tr_b16 v[72:73], v110 offset:0
    v_mfma_f32_16x16x32_bf16 v[20:23], v[92:95], v[64:67], v[20:23]
    ds_read_b64_tr_b16 v[74:75], v110 offset:4096
    v_mfma_f32_16x16x32_bf16 v[36:39], v[92:95], v[68:71], v[36:39]
    ds_read_b64_tr_b16 v[76:77], v111 offset:0
    v_mfma_f32_16x16x32_bf16 v[8:11], v[96:99], v[60:63], v[8:11]
    ds_read_b64_tr_b16 v[78:79], v111 offset:4096
    v_mfma_f32_16x16x32_bf16 v[24:27], v[96:99], v[64:67], v[24:27]
    ds_read_b64_tr_b16 v[80:81], v112 offset:0
    v_mfma_f32_16x16x32_bf16 v[40:43], v[96:99], v[68:71], v[40:43]
    ds_read_b64_tr_b16 v[82:83], v112 offset:4096
    v_mfma_f32_16x16x32_bf16 v[12:15], v[100:103], v[60:63], v[12:15]
    ds_read_b64_tr_b16 v[84:85], v113 offset:0
    v_mfma_f32_16x16x32_bf16 v[28:31], v[100:103], v[64:67], v[28:31]
    ds_read_b64_tr_b16 v[86:87], v113 offset:4096
    v_mfma_f32_16x16x32_bf16 v[44:47], v[100:103], v[68:71], v[44:47]
    s_waitcnt lgkmcnt(6)
    v_mfma_f32_16x16x32_bf16 v[0:3], v[72:75], v[48:51], v[0:3]
    ds_read_b128 v[60:63], v105 offset:1024
    v_mfma_f32_16x16x32_bf16 v[16:19], v[72:75], v[52:55], v[16:19]
    ds_read_b128 v[64:67], v105 offset:3072
    v_mfma_f32_16x16x32_bf16 v[32:35], v[72:75], v[56:59], v[32:35]
    ds_read_b128 v[68:71], v105 offset:5120
    s_waitcnt lgkmcnt(7)
    v_mfma_f32_16x16x32_bf16 v[4:7], v[76:79], v[48:51], v[4:7]
    ds_read_b64_tr_b16 v[88:89], v110 offset:8192
    v_mfma_f32_16x16x32_bf16 v[20:23], v[76:79], v[52:55], v[20:23]
    ds_read_b64_tr_b16 v[90:91], v110 offset:12288
    v_mfma_f32_16x16x32_bf16 v[36:39], v[76:79], v[56:59], v[36:39]
    ds_read_b64_tr_b16 v[92:93], v111 offset:8192
    s_waitcnt lgkmcnt(8)
    v_mfma_f32_16x16x32_bf16 v[8:11], v[80:83], v[48:51], v[8:11]
    ds_read_b64_tr_b16 v[94:95], v111 offset:12288
    v_mfma_f32_16x16x32_bf16 v[24:27], v[80:83], v[52:55], v[24:27]
    ds_read_b64_tr_b16 v[96:97], v112 offset:8192
    v_mfma_f32_16x16x32_bf16 v[40:43], v[80:83], v[56:59], v[40:43]
    ds_read_b64_tr_b16 v[98:99], v112 offset:12288
    s_waitcnt lgkmcnt(9)
    v_mfma_f32_16x16x32_bf16 v[12:15], v[84:87], v[48:51], v[12:15]
    ds_read_b64_tr_b16 v[100:101], v113 offset:8192
    v_mfma_f32_16x16x32_bf16 v[28:31], v[84:87], v[52:55], v[28:31]
    ds_read_b64_tr_b16 v[102:103], v113 offset:12288
    v_mfma_f32_16x16x32_bf16 v[44:47], v[84:87], v[56:59], v[44:47]
    s_waitcnt lgkmcnt(0)
    s_barrier
    v_mfma_f32_16x16x32_bf16 v[0:3], v[88:91], v[60:63], v[0:3]
    ds_read_b128 v[48:51], v105 offset:28672
    v_mfma_f32_16x16x32_bf16 v[16:19], v[88:91], v[64:67], v[16:19]
    ds_read_b128 v[52:55], v105 offset:30720
    v_mfma_f32_16x16x32_bf16 v[32:35], v[88:91], v[68:71], v[32:35]
    ds_read_b128 v[56:59], v105 offset:32768
    v_mfma_f32_16x16x32_bf16 v[4:7], v[92:95], v[60:63], v[4:7]
    ds_read_b64_tr_b16 v[72:73], v110 offset:28672
    v_mfma_f32_16x16x32_bf16 v[20:23], v[92:95], v[64:67], v[20:23]
    ds_read_b64_tr_b16 v[74:75], v110 offset:32768
    v_mfma_f32_16x16x32_bf16 v[36:39], v[92:95], v[68:71], v[36:39]
    ds_read_b64_tr_b16 v[76:77], v111 offset:28672
    v_mfma_f32_16x16x32_bf16 v[8:11], v[96:99], v[60:63], v[8:11]
    ds_read_b64_tr_b16 v[78:79], v111 offset:32768
    v_mfma_f32_16x16x32_bf16 v[24:27], v[96:99], v[64:67], v[24:27]
    ds_read_b64_tr_b16 v[80:81], v112 offset:28672
    v_mfma_f32_16x16x32_bf16 v[40:43], v[96:99], v[68:71], v[40:43]
    ds_read_b64_tr_b16 v[82:83], v112 offset:32768
    v_mfma_f32_16x16x32_bf16 v[12:15], v[100:103], v[60:63], v[12:15]
    ds_read_b64_tr_b16 v[84:85], v113 offset:28672
    v_mfma_f32_16x16x32_bf16 v[28:31], v[100:103], v[64:67], v[28:31]
    ds_read_b64_tr_b16 v[86:87], v113 offset:32768
    v_mfma_f32_16x16x32_bf16 v[44:47], v[100:103], v[68:71], v[44:47]
    s_waitcnt lgkmcnt(6)
    v_mfma_f32_16x16x32_bf16 v[0:3], v[72:75], v[48:51], v[0:3]
    ds_read_b128 v[60:63], v105 offset:29696
    v_mfma_f32_16x16x32_bf16 v[16:19], v[72:75], v[52:55], v[16:19]
    ds_read_b128 v[64:67], v105 offset:31744
    v_mfma_f32_16x16x32_bf16 v[32:35], v[72:75], v[56:59], v[32:35]
    ds_read_b128 v[68:71], v105 offset:33792
    s_waitcnt lgkmcnt(7)
    v_mfma_f32_16x16x32_bf16 v[4:7], v[76:79], v[48:51], v[4:7]
    ds_read_b64_tr_b16 v[88:89], v110 offset:36864
    v_mfma_f32_16x16x32_bf16 v[20:23], v[76:79], v[52:55], v[20:23]
    ds_read_b64_tr_b16 v[90:91], v110 offset:40960
    v_mfma_f32_16x16x32_bf16 v[36:39], v[76:79], v[56:59], v[36:39]
    ds_read_b64_tr_b16 v[92:93], v111 offset:36864
    s_waitcnt lgkmcnt(8)
    v_mfma_f32_16x16x32_bf16 v[8:11], v[80:83], v[48:51], v[8:11]
    ds_read_b64_tr_b16 v[94:95], v111 offset:40960
    v_mfma_f32_16x16x32_bf16 v[24:27], v[80:83], v[52:55], v[24:27]
    ds_read_b64_tr_b16 v[96:97], v112 offset:36864
    v_mfma_f32_16x16x32_bf16 v[40:43], v[80:83], v[56:59], v[40:43]
    ds_read_b64_tr_b16 v[98:99], v112 offset:40960
    s_waitcnt lgkmcnt(9)
    v_mfma_f32_16x16x32_bf16 v[12:15], v[84:87], v[48:51], v[12:15]
    ds_read_b64_tr_b16 v[100:101], v113 offset:36864
    v_mfma_f32_16x16x32_bf16 v[28:31], v[84:87], v[52:55], v[28:31]
    ds_read_b64_tr_b16 v[102:103], v113 offset:40960
    v_mfma_f32_16x16x32_bf16 v[44:47], v[84:87], v[56:59], v[44:47]
    s_waitcnt lgkmcnt(0)
    s_add_u32 s58, s58, 1
    s_cmp_lt_u32 s58, 8
    s_cbranch_scc1 K1W1_TC
    v_mfma_f32_16x16x32_bf16 v[0:3], v[88:91], v[60:63], v[0:3]
    v_mfma_f32_16x16x32_bf16 v[16:19], v[88:91], v[64:67], v[16:19]
    v_mfma_f32_16x16x32_bf16 v[32:35], v[88:91], v[68:71], v[32:35]
    v_mfma_f32_16x16x32_bf16 v[4:7], v[92:95], v[60:63], v[4:7]
    v_mfma_f32_16x16x32_bf16 v[20:23], v[92:95], v[64:67], v[20:23]
    v_mfma_f32_16x16x32_bf16 v[36:39], v[92:95], v[68:71], v[36:39]
    v_mfma_f32_16x16x32_bf16 v[8:11], v[96:99], v[60:63], v[8:11]
    v_mfma_f32_16x16x32_bf16 v[24:27], v[96:99], v[64:67], v[24:27]
    v_mfma_f32_16x16x32_bf16 v[40:43], v[96:99], v[68:71], v[40:43]
    v_mfma_f32_16x16x32_bf16 v[12:15], v[100:103], v[60:63], v[12:15]
    v_mfma_f32_16x16x32_bf16 v[28:31], v[100:103], v[64:67], v[28:31]
    v_mfma_f32_16x16x32_bf16 v[44:47], v[100:103], v[68:71], v[44:47]
    s_nop 7
    s_mul_i32 s30, s2, 49152
    s_add_u32 s30, s30, 12288
    s_cmp_eq_u32 s51, 0
    s_cbranch_scc1 K1W1_TK
    buffer_store_dwordx4 v[0:3], v248, s[8:11], s30 offen offset:0 sc1
    buffer_store_dwordx4 v[4:7], v248, s[8:11], s30 offen offset:1024 sc1
    buffer_store_dwordx4 v[8:11], v248, s[8:11], s30 offen offset:2048 sc1
    buffer_store_dwordx4 v[12:15], v248, s[8:11], s30 offen offset:3072 sc1
    s_add_u32 s30, s30, 4096
    buffer_store_dwordx4 v[16:19], v248, s[8:11], s30 offen offset:0 sc1
    buffer_store_dwordx4 v[20:23], v248, s[8:11], s30 offen offset:1024 sc1
    buffer_store_dwordx4 v[24:27], v248, s[8:11], s30 offen offset:2048 sc1
    buffer_store_dwordx4 v[28:31], v248, s[8:11], s30 offen offset:3072 sc1
    s_add_u32 s30, s30, 4096
    buffer_store_dwordx4 v[32:35], v248, s[8:11], s30 offen offset:0 sc1
    buffer_store_dwordx4 v[36:39], v248, s[8:11], s30 offen offset:1024 sc1
    buffer_store_dwordx4 v[40:43], v248, s[8:11], s30 offen offset:2048 sc1
    buffer_store_dwordx4 v[44:47], v248, s[8:11], s30 offen offset:3072 sc1
K1W1_TK:
    s_waitcnt vmcnt(0)
    s_barrier
    s_xor_b32 s30, s2, 1
    s_lshl_b32 s30, s30, 7
    s_add_u32 s30, s30, 65536
    v_mov_b32 v117, 0
    s_mov_b32 s31, 0
    s_mov_b64 exec, 1
K1W1_XP_P:
    buffer_load_dword v118, v117, s[80:83], s30 offen sc1
    s_waitcnt vmcnt(0)
    v_cmp_ne_u32 vcc, s93, v118
    s_add_u32 s31, s31, 1
    s_cbranch_vccz K1W1_XP_D
    s_sleep 1
    s_cmp_lt_u32 s31, 400000
    s_cbranch_scc1 K1W1_XP_P
K1W1_XP_D:
    s_mov_b64 exec, -1
    s_barrier
    s_cmp_eq_u32 s51, 0
    s_cbranch_scc0 K1W1_TF
    s_xor_b32 s30, s2, 1
    s_mul_i32 s30, s30, 49152
    s_add_u32 s30, s30, 12288
    buffer_load_dwordx4 v[120:123], v248, s[8:11], s30 offen offset:0 sc1
    buffer_load_dwordx4 v[124:127], v248, s[8:11], s30 offen offset:1024 sc1
    buffer_load_dwordx4 v[128:131], v248, s[8:11], s30 offen offset:2048 sc1
    buffer_load_dwordx4 v[132:135], v248, s[8:11], s30 offen offset:3072 sc1
    s_add_u32 s30, s30, 4096
    buffer_load_dwordx4 v[136:139], v248, s[8:11], s30 offen offset:0 sc1
    buffer_load_dwordx4 v[140:143], v248, s[8:11], s30 offen offset:1024 sc1
    buffer_load_dwordx4 v[144:147], v248, s[8:11], s30 offen offset:2048 sc1
    buffer_load_dwordx4 v[148:151], v248, s[8:11], s30 offen offset:3072 sc1
    s_add_u32 s30, s30, 4096
    buffer_load_dwordx4 v[152:155], v248, s[8:11], s30 offen offset:0 sc1
    buffer_load_dwordx4 v[156:159], v248, s[8:11], s30 offen offset:1024 sc1
    buffer_load_dwordx4 v[160:163], v248, s[8:11], s30 offen offset:2048 sc1
    buffer_load_dwordx4 v[164:167], v248, s[8:11], s30 offen offset:3072 sc1
    v_and_b32 v116, 15, v245
    v_mul_u32_u24 v116, 2560, v116
    v_lshrrev_b32 v117, 4, v245
    v_lshl_add_u32 v116, v117, 3, v116
    s_waitcnt vmcnt(11)
    v_add_f32 v0, v0, v120
    v_add_f32 v1, v1, v121
    v_add_f32 v2, v2, v122
    v_add_f32 v3, v3, v123
    v_cvt_pk_bf16_f32 v48, v0, v1
    v_cvt_pk_bf16_f32 v49, v2, v3
    buffer_store_dwordx2 v[48:49], v116, s[4:7], s38 offen offset:128
    s_waitcnt vmcnt(11)
    v_add_f32 v4, v4, v124
    v_add_f32 v5, v5, v125
    v_add_f32 v6, v6, v126
    v_add_f32 v7, v7, v127
    v_cvt_pk_bf16_f32 v50, v4, v5
    v_cvt_pk_bf16_f32 v51, v6, v7
    buffer_store_dwordx2 v[50:51], v116, s[4:7], s38 offen offset:160
    s_waitcnt vmcnt(11)
    v_add_f32 v8, v8, v128
    v_add_f32 v9, v9, v129
    v_add_f32 v10, v10, v130
    v_add_f32 v11, v11, v131
    v_cvt_pk_bf16_f32 v52, v8, v9
    v_cvt_pk_bf16_f32 v53, v10, v11
    buffer_store_dwordx2 v[52:53], v116, s[4:7], s38 offen offset:192
    s_waitcnt vmcnt(11)
    v_add_f32 v12, v12, v132
    v_add_f32 v13, v13, v133
    v_add_f32 v14, v14, v134
    v_add_f32 v15, v15, v135
    v_cvt_pk_bf16_f32 v54, v12, v13
    v_cvt_pk_bf16_f32 v55, v14, v15
    buffer_store_dwordx2 v[54:55], v116, s[4:7], s38 offen offset:224
    s_waitcnt vmcnt(11)
    v_add_f32 v16, v16, v136
    v_add_f32 v17, v17, v137
    v_add_f32 v18, v18, v138
    v_add_f32 v19, v19, v139
    v_cvt_pk_bf16_f32 v56, v16, v17
    v_cvt_pk_bf16_f32 v57, v18, v19
    buffer_store_dwordx2 v[56:57], v116, s[4:7], s39 offen offset:128
    s_waitcnt vmcnt(11)
    v_add_f32 v20, v20, v140
    v_add_f32 v21, v21, v141
    v_add_f32 v22, v22, v142
    v_add_f32 v23, v23, v143
    v_cvt_pk_bf16_f32 v58, v20, v21
    v_cvt_pk_bf16_f32 v59, v22, v23
    buffer_store_dwordx2 v[58:59], v116, s[4:7], s39 offen offset:160
    s_waitcnt vmcnt(11)
    v_add_f32 v24, v24, v144
    v_add_f32 v25, v25, v145
    v_add_f32 v26, v26, v146
    v_add_f32 v27, v27, v147
    v_cvt_pk_bf16_f32 v60, v24, v25
    v_cvt_pk_bf16_f32 v61, v26, v27
    buffer_store_dwordx2 v[60:61], v116, s[4:7], s39 offen offset:192
    s_waitcnt vmcnt(11)
    v_add_f32 v28, v28, v148
    v_add_f32 v29, v29, v149
    v_add_f32 v30, v30, v150
    v_add_f32 v31, v31, v151
    v_cvt_pk_bf16_f32 v62, v28, v29
    v_cvt_pk_bf16_f32 v63, v30, v31
    buffer_store_dwordx2 v[62:63], v116, s[4:7], s39 offen offset:224
    s_waitcnt vmcnt(11)
    v_add_f32 v32, v32, v152
    v_add_f32 v33, v33, v153
    v_add_f32 v34, v34, v154
    v_add_f32 v35, v35, v155
    v_cvt_pk_bf16_f32 v64, v32, v33
    v_cvt_pk_bf16_f32 v65, v34, v35
    buffer_store_dwordx2 v[64:65], v116, s[4:7], s40 offen offset:128
    s_waitcnt vmcnt(11)
    v_add_f32 v36, v36, v156
    v_add_f32 v37, v37, v157
    v_add_f32 v38, v38, v158
    v_add_f32 v39, v39, v159
    v_cvt_pk_bf16_f32 v66, v36, v37
    v_cvt_pk_bf16_f32 v67, v38, v39
    buffer_store_dwordx2 v[66:67], v116, s[4:7], s40 offen offset:160
    s_waitcnt vmcnt(11)
    v_add_f32 v40, v40, v160
    v_add_f32 v41, v41, v161
    v_add_f32 v42, v42, v162
    v_add_f32 v43, v43, v163
    v_cvt_pk_bf16_f32 v68, v40, v41
    v_cvt_pk_bf16_f32 v69, v42, v43
    buffer_store_dwordx2 v[68:69], v116, s[4:7], s40 offen offset:192
    s_waitcnt vmcnt(11)
    v_add_f32 v44, v44, v164
    v_add_f32 v45, v45, v165
    v_add_f32 v46, v46, v166
    v_add_f32 v47, v47, v167
    v_cvt_pk_bf16_f32 v70, v44, v45
    v_cvt_pk_bf16_f32 v71, v46, v47
    buffer_store_dwordx2 v[70:71], v116, s[4:7], s40 offen offset:224
K1W1_TF:
    s_endpgm
K1W1_FINAL1:
    s_nop 7
    v_add_u32 v246, 81920, v248
    v_and_b32 v247, 15, v245
    v_lshlrev_b32 v247, 2, v247
    v_add_u32 v247, 114688, v247
    v_mov_b32 v244, v228
    s_nop 1
    v_permlane16_swap_b32 v244, v228
    v_add_f32 v228, v228, v244
    v_mov_b32 v244, v228
    s_nop 1
    v_permlane32_swap_b32 v244, v228
    v_add_f32 v228, v228, v244
    v_mov_b32 v244, v229
    s_nop 1
    v_permlane16_swap_b32 v244, v229
    v_add_f32 v229, v229, v244
    v_mov_b32 v244, v229
    s_nop 1
    v_permlane32_swap_b32 v244, v229
    v_add_f32 v229, v229, v244
    v_rcp_f32 v228, v228
    v_rcp_f32 v229, v229
    v_mul_f32 v0, v0, v228
    v_mul_f32 v1, v1, v228
    v_mul_f32 v2, v2, v228
    v_mul_f32 v3, v3, v228
    v_mul_f32 v4, v4, v228
    v_mul_f32 v5, v5, v228
    v_mul_f32 v6, v6, v228
    v_mul_f32 v7, v7, v228
    v_cvt_pk_bf16_f32 v96, v0, v1
    v_cvt_pk_bf16_f32 v97, v2, v3
    v_cvt_pk_bf16_f32 v98, v4, v5
    v_cvt_pk_bf16_f32 v99, v6, v7
    v_mul_f32 v8, v8, v228
    v_mul_f32 v9, v9, v228
    v_mul_f32 v10, v10, v228
    v_mul_f32 v11, v11, v228
    v_mul_f32 v12, v12, v228
    v_mul_f32 v13, v13, v228
    v_mul_f32 v14, v14, v228
    v_mul_f32 v15, v15, v228
    v_cvt_pk_bf16_f32 v100, v8, v9
    v_cvt_pk_bf16_f32 v101, v10, v11
    v_cvt_pk_bf16_f32 v102, v12, v13
    v_cvt_pk_bf16_f32 v103, v14, v15
    v_mul_f32 v16, v16, v228
    v_mul_f32 v17, v17, v228
    v_mul_f32 v18, v18, v228
    v_mul_f32 v19, v19, v228
    v_mul_f32 v20, v20, v228
    v_mul_f32 v21, v21, v228
    v_mul_f32 v22, v22, v228
    v_mul_f32 v23, v23, v228
    v_cvt_pk_bf16_f32 v104, v16, v17
    v_cvt_pk_bf16_f32 v105, v18, v19
    v_cvt_pk_bf16_f32 v106, v20, v21
    v_cvt_pk_bf16_f32 v107, v22, v23
    v_mul_f32 v24, v24, v228
    v_mul_f32 v25, v25, v228
    v_mul_f32 v26, v26, v228
    v_mul_f32 v27, v27, v228
    v_mul_f32 v28, v28, v228
    v_mul_f32 v29, v29, v228
    v_mul_f32 v30, v30, v228
    v_mul_f32 v31, v31, v228
    v_cvt_pk_bf16_f32 v108, v24, v25
    v_cvt_pk_bf16_f32 v109, v26, v27
    v_cvt_pk_bf16_f32 v110, v28, v29
    v_cvt_pk_bf16_f32 v111, v30, v31
    v_mul_f32 v32, v32, v229
    v_mul_f32 v33, v33, v229
    v_mul_f32 v34, v34, v229
    v_mul_f32 v35, v35, v229
    v_mul_f32 v36, v36, v229
    v_mul_f32 v37, v37, v229
    v_mul_f32 v38, v38, v229
    v_mul_f32 v39, v39, v229
    v_cvt_pk_bf16_f32 v112, v32, v33
    v_cvt_pk_bf16_f32 v113, v34, v35
    v_cvt_pk_bf16_f32 v114, v36, v37
    v_cvt_pk_bf16_f32 v115, v38, v39
    v_mul_f32 v40, v40, v229
    v_mul_f32 v41, v41, v229
    v_mul_f32 v42, v42, v229
    v_mul_f32 v43, v43, v229
    v_mul_f32 v44, v44, v229
    v_mul_f32 v45, v45, v229
    v_mul_f32 v46, v46, v229
    v_mul_f32 v47, v47, v229
    v_cvt_pk_bf16_f32 v116, v40, v41
    v_cvt_pk_bf16_f32 v117, v42, v43
    v_cvt_pk_bf16_f32 v118, v44, v45
    v_cvt_pk_bf16_f32 v119, v46, v47
    v_mul_f32 v48, v48, v229
    v_mul_f32 v49, v49, v229
    v_mul_f32 v50, v50, v229
    v_mul_f32 v51, v51, v229
    v_mul_f32 v52, v52, v229
    v_mul_f32 v53, v53, v229
    v_mul_f32 v54, v54, v229
    v_mul_f32 v55, v55, v229
    v_cvt_pk_bf16_f32 v120, v48, v49
    v_cvt_pk_bf16_f32 v121, v50, v51
    v_cvt_pk_bf16_f32 v122, v52, v53
    v_cvt_pk_bf16_f32 v123, v54, v55
    v_mul_f32 v56, v56, v229
    v_mul_f32 v57, v57, v229
    v_mul_f32 v58, v58, v229
    v_mul_f32 v59, v59, v229
    v_mul_f32 v60, v60, v229
    v_mul_f32 v61, v61, v229
    v_mul_f32 v62, v62, v229
    v_mul_f32 v63, v63, v229
    v_cvt_pk_bf16_f32 v124, v56, v57
    v_cvt_pk_bf16_f32 v125, v58, v59
    v_cvt_pk_bf16_f32 v126, v60, v61
    v_cvt_pk_bf16_f32 v127, v62, v63
    s_barrier
    ds_read_b32 v144, v247 offset:0
    ds_read_b32 v148, v247 offset:64
    ds_read_b32 v145, v247 offset:128
    ds_read_b32 v149, v247 offset:192
    ds_read_b128 v[32:35], v246 offset:2048
    ds_read_b128 v[36:39], v246 offset:3072
    ds_read_b128 v[40:43], v246 offset:10240
    ds_read_b128 v[44:47], v246 offset:11264
    s_waitcnt lgkmcnt(5)
    v_max_f32 v244, v144, v145
    v_sub_f32 v152, v144, v244
    v_sub_f32 v153, v145, v244
    v_exp_f32 v152, v152
    v_exp_f32 v153, v153
    v_mul_f32 v244, v152, v148
    s_waitcnt lgkmcnt(4)
    v_fma_f32 v244, v153, v149, v244
    v_rcp_f32 v244, v244
    s_nop 0
    v_mul_f32 v152, v152, v244
    v_mul_f32 v153, v153, v244
    s_waitcnt lgkmcnt(3)
    v_mul_f32 v0, v32, v152
    s_waitcnt lgkmcnt(1)
    v_fma_f32 v0, v40, v153, v0
    v_mul_f32 v1, v33, v152
    v_fma_f32 v1, v41, v153, v1
    v_mul_f32 v2, v34, v152
    v_fma_f32 v2, v42, v153, v2
    v_mul_f32 v3, v35, v152
    v_fma_f32 v3, v43, v153, v3
    v_mul_f32 v4, v36, v152
    s_waitcnt lgkmcnt(0)
    v_fma_f32 v4, v44, v153, v4
    v_mul_f32 v5, v37, v152
    v_fma_f32 v5, v45, v153, v5
    v_mul_f32 v6, v38, v152
    v_fma_f32 v6, v46, v153, v6
    v_mul_f32 v7, v39, v152
    v_fma_f32 v7, v47, v153, v7
    v_cvt_pk_bf16_f32 v128, v0, v1
    v_cvt_pk_bf16_f32 v129, v2, v3
    v_cvt_pk_bf16_f32 v130, v4, v5
    v_cvt_pk_bf16_f32 v131, v6, v7
    s_mov_b32 s30, 8192
    buffer_store_dwordx4 v[96:99], v248, s[20:23], s30 offen offset:0 sc1
    buffer_store_dwordx4 v[100:103], v248, s[20:23], s30 offen offset:1024 sc1
    buffer_store_dwordx4 v[104:107], v248, s[20:23], s30 offen offset:2048 sc1
    buffer_store_dwordx4 v[108:111], v248, s[20:23], s30 offen offset:3072 sc1
    s_mov_b32 s30, 12288
    buffer_store_dwordx4 v[112:115], v248, s[20:23], s30 offen offset:0 sc1
    buffer_store_dwordx4 v[116:119], v248, s[20:23], s30 offen offset:1024 sc1
    buffer_store_dwordx4 v[120:123], v248, s[20:23], s30 offen offset:2048 sc1
    buffer_store_dwordx4 v[124:127], v248, s[20:23], s30 offen offset:3072 sc1
    s_mov_b32 s30, 33792
    buffer_store_dwordx4 v[128:131], v248, s[20:23], s30 offen sc1
    s_lshl_b32 s30, s85, 3
    s_add_u32 s30, s30, s84
    s_mul_i32 s44, s30, 52
    s_lshr_b32 s44, s44, 8
    s_mul_i32 s31, s44, 5
    s_sub_u32 s45, s30, s31
    s_and_b32 s51, s2, 1
    s_load_dwordx2 s[72:73], s[0:1], 32
    s_load_dwordx2 s[74:75], s[0:1], 72
    s_load_dwordx2 s[46:47], s[0:1], 80
    s_waitcnt lgkmcnt(0)
    s_cmp_eq_u32 s64, 0
    s_cselect_b64 s[72:73], s[72:73], s[74:75]
    s_lshl_b32 s30, s45, 8
    s_add_u32 s12, s72, s30
    s_addc_u32 s13, s73, 0
    s_sub_u32 s14, 5242880, s30
    s_mov_b32 s15, 131072
    s_mov_b32 s16, s48
    s_mov_b32 s17, s49
    s_mov_b32 s18, 18874368
    s_mov_b32 s19, 131072
    s_add_u32 s80, s48, 50331648
    s_addc_u32 s81, s49, 0
    s_mov_b32 s82, 131072
    s_mov_b32 s83, 131072
    s_mov_b32 s4, s46
    s_mov_b32 s5, s47
    s_mov_b32 s6, 2949120
    s_mov_b32 s7, 131072
    s_add_u32 s8, s48, 33554432
    s_addc_u32 s9, s49, 0
    s_mov_b32 s10, 12582912
    s_mov_b32 s11, 131072
    s_sub_u32 s69, s65, s85
    s_mul_i32 s30, s44, 6
    s_add_u32 s30, s30, 0
    s_mul_i32 s31, s30, 57
    s_lshr_b32 s31, s31, 9
    s_mul_i32 s72, s31, 9
    s_sub_u32 s72, s30, s72
    s_add_u32 s31, s31, s69
    s_lshl_b32 s73, s64, 3
    s_add_u32 s73, s73, s31
    s_lshl_b32 s73, s73, 5
    s_lshl_b32 s74, s51, 4
    s_add_u32 s73, s73, s74
    s_mul_i32 s73, s73, 36864
    s_lshl_b32 s74, s72, 12
    s_add_u32 s32, s73, s74
    s_mul_i32 s73, s31, 144
    s_lshl_b32 s74, s72, 4
    s_add_u32 s73, s73, s74
    s_mul_i32 s73, s73, 2560
    s_mul_i32 s74, s64, 1280
    s_add_u32 s73, s73, s74
    s_lshl_b32 s74, s45, 8
    s_add_u32 s38, s73, s74
    s_mul_i32 s30, s44, 6
    s_add_u32 s30, s30, 1
    s_mul_i32 s31, s30, 57
    s_lshr_b32 s31, s31, 9
    s_mul_i32 s72, s31, 9
    s_sub_u32 s72, s30, s72
    s_add_u32 s31, s31, s69
    s_lshl_b32 s73, s64, 3
    s_add_u32 s73, s73, s31
    s_lshl_b32 s73, s73, 5
    s_lshl_b32 s74, s51, 4
    s_add_u32 s73, s73, s74
    s_mul_i32 s73, s73, 36864
    s_lshl_b32 s74, s72, 12
    s_add_u32 s33, s73, s74
    s_mul_i32 s73, s31, 144
    s_lshl_b32 s74, s72, 4
    s_add_u32 s73, s73, s74
    s_mul_i32 s73, s73, 2560
    s_mul_i32 s74, s64, 1280
    s_add_u32 s73, s73, s74
    s_lshl_b32 s74, s45, 8
    s_add_u32 s39, s73, s74
    s_mul_i32 s30, s44, 6
    s_add_u32 s30, s30, 2
    s_mul_i32 s31, s30, 57
    s_lshr_b32 s31, s31, 9
    s_mul_i32 s72, s31, 9
    s_sub_u32 s72, s30, s72
    s_add_u32 s31, s31, s69
    s_lshl_b32 s73, s64, 3
    s_add_u32 s73, s73, s31
    s_lshl_b32 s73, s73, 5
    s_lshl_b32 s74, s51, 4
    s_add_u32 s73, s73, s74
    s_mul_i32 s73, s73, 36864
    s_lshl_b32 s74, s72, 12
    s_add_u32 s34, s73, s74
    s_mul_i32 s73, s31, 144
    s_lshl_b32 s74, s72, 4
    s_add_u32 s73, s73, s74
    s_mul_i32 s73, s73, 2560
    s_mul_i32 s74, s64, 1280
    s_add_u32 s73, s73, s74
    s_lshl_b32 s74, s45, 8
    s_add_u32 s40, s73, s74
    s_mul_i32 s30, s44, 6
    s_add_u32 s30, s30, 3
    s_mul_i32 s31, s30, 57
    s_lshr_b32 s31, s31, 9
    s_mul_i32 s72, s31, 9
    s_sub_u32 s72, s30, s72
    s_add_u32 s31, s31, s69
    s_lshl_b32 s73, s64, 3
    s_add_u32 s73, s73, s31
    s_lshl_b32 s73, s73, 5
    s_lshl_b32 s74, s51, 4
    s_add_u32 s73, s73, s74
    s_mul_i32 s73, s73, 36864
    s_lshl_b32 s74, s72, 12
    s_add_u32 s35, s73, s74
    s_mul_i32 s73, s31, 144
    s_lshl_b32 s74, s72, 4
    s_add_u32 s73, s73, s74
    s_mul_i32 s73, s73, 2560
    s_mul_i32 s74, s64, 1280
    s_add_u32 s73, s73, s74
    s_lshl_b32 s74, s45, 8
    s_add_u32 s41, s73, s74
    s_mul_i32 s30, s44, 6
    s_add_u32 s30, s30, 4
    s_mul_i32 s31, s30, 57
    s_lshr_b32 s31, s31, 9
    s_mul_i32 s72, s31, 9
    s_sub_u32 s72, s30, s72
    s_add_u32 s31, s31, s69
    s_lshl_b32 s73, s64, 3
    s_add_u32 s73, s73, s31
    s_lshl_b32 s73, s73, 5
    s_lshl_b32 s74, s51, 4
    s_add_u32 s73, s73, s74
    s_mul_i32 s73, s73, 36864
    s_lshl_b32 s74, s72, 12
    s_add_u32 s36, s73, s74
    s_mul_i32 s73, s31, 144
    s_lshl_b32 s74, s72, 4
    s_add_u32 s73, s73, s74
    s_mul_i32 s73, s73, 2560
    s_mul_i32 s74, s64, 1280
    s_add_u32 s73, s73, s74
    s_lshl_b32 s74, s45, 8
    s_add_u32 s42, s73, s74
    s_mul_i32 s30, s44, 6
    s_add_u32 s30, s30, 5
    s_mul_i32 s31, s30, 57
    s_lshr_b32 s31, s31, 9
    s_mul_i32 s72, s31, 9
    s_sub_u32 s72, s30, s72
    s_add_u32 s31, s31, s69
    s_lshl_b32 s73, s64, 3
    s_add_u32 s73, s73, s31
    s_lshl_b32 s73, s73, 5
    s_lshl_b32 s74, s51, 4
    s_add_u32 s73, s73, s74
    s_mul_i32 s73, s73, 36864
    s_lshl_b32 s74, s72, 12
    s_add_u32 s37, s73, s74
    s_mul_i32 s73, s31, 144
    s_lshl_b32 s74, s72, 4
    s_add_u32 s73, s73, s74
    s_mul_i32 s73, s73, 2560
    s_mul_i32 s74, s64, 1280
    s_add_u32 s73, s73, s74
    s_lshl_b32 s74, s45, 8
    s_add_u32 s43, s73, s74
    s_mul_i32 s53, s51, 2621440
    v_lshrrev_b32 v116, 4, v245
    v_and_b32 v117, 15, v245
    v_lshlrev_b32 v118, 1, v116
    v_xor_b32 v117, v117, v118
    v_lshlrev_b32 v117, 4, v117
    v_mul_u32_u24 v116, 1280, v116
    v_add_u32 v114, v116, v117
    v_xor_b32 v117, 128, v117
    v_add_u32 v115, v116, v117
    s_waitcnt vmcnt(0) lgkmcnt(0)
    s_barrier
    s_cmp_ge_u32 s44, 6
    s_cbranch_scc1 K1_END
    s_mov_b32 m0, 16384
    s_add_u32 s30, s53, 20480
    buffer_load_dwordx4 v114, s[12:15], s30 offen offset:0 lds
    s_add_u32 s30, s53, 24576
    buffer_load_dwordx4 v115, s[12:15], s30 offen offset:1024 lds
    s_add_u32 s30, s53, 28672
    buffer_load_dwordx4 v114, s[12:15], s30 offen offset:2048 lds
    s_add_u32 s30, s53, 32768
    buffer_load_dwordx4 v115, s[12:15], s30 offen offset:3072 lds
    s_mov_b32 m0, 45056
    s_add_u32 s30, s53, 102400
    buffer_load_dwordx4 v114, s[12:15], s30 offen offset:0 lds
    s_add_u32 s30, s53, 106496
    buffer_load_dwordx4 v115, s[12:15], s30 offen offset:1024 lds
    s_add_u32 s30, s53, 110592
    buffer_load_dwordx4 v114, s[12:15], s30 offen offset:2048 lds
    s_add_u32 s30, s53, 114688
    buffer_load_dwordx4 v115, s[12:15], s30 offen offset:3072 lds
    s_mov_b32 m0, 73728
    s_add_u32 s30, s53, 184320
    buffer_load_dwordx4 v114, s[12:15], s30 offen offset:0 lds
    s_add_u32 s30, s53, 188416
    buffer_load_dwordx4 v115, s[12:15], s30 offen offset:1024 lds
    s_add_u32 s30, s53, 192512
    buffer_load_dwordx4 v114, s[12:15], s30 offen offset:2048 lds
    s_add_u32 s30, s53, 196608
    buffer_load_dwordx4 v115, s[12:15], s30 offen offset:3072 lds
    s_barrier
    s_mov_b32 m0, 3072
    s_add_u32 s30, s33, 1024
    buffer_load_dwordx4 v248, s[16:19], s30 offen lds
    s_mov_b32 m0, 4096
    s_add_u32 s30, s34, 0
    buffer_load_dwordx4 v248, s[16:19], s30 offen lds
    s_mov_b32 m0, 5120
    s_add_u32 s30, s34, 1024
    buffer_load_dwordx4 v248, s[16:19], s30 offen lds
    s_mov_b32 m0, 31744
    s_add_u32 s30, s33, 3072
    buffer_load_dwordx4 v248, s[16:19], s30 offen lds
    s_mov_b32 m0, 32768
    s_add_u32 s30, s34, 2048
    buffer_load_dwordx4 v248, s[16:19], s30 offen lds
    s_mov_b32 m0, 33792
    s_add_u32 s30, s34, 3072
    buffer_load_dwordx4 v248, s[16:19], s30 offen lds
    s_mov_b32 m0, 60416
    s_add_u32 s30, s33, 37888
    buffer_load_dwordx4 v248, s[16:19], s30 offen lds
    s_mov_b32 m0, 61440
    s_add_u32 s30, s34, 36864
    buffer_load_dwordx4 v248, s[16:19], s30 offen lds
    s_mov_b32 m0, 62464
    s_add_u32 s30, s34, 37888
    buffer_load_dwordx4 v248, s[16:19], s30 offen lds
    s_mov_b32 s58, 0
K1W1_TL:
    s_cmp_eq_u32 s58, 0
    s_cbranch_scc0 K1W1_TLw0
    s_waitcnt vmcnt(6)
    s_branch K1W1_TLx0
K1W1_TLw0:
    s_waitcnt vmcnt(14)
K1W1_TLx0:
    s_barrier
    s_mov_b32 m0, 89088
    s_add_u32 s30, s33, 39936
    buffer_load_dwordx4 v248, s[16:19], s30 offen lds
    s_mov_b32 m0, 90112
    s_add_u32 s30, s34, 38912
    buffer_load_dwordx4 v248, s[16:19], s30 offen lds
    s_mov_b32 m0, 91136
    s_add_u32 s30, s34, 39936
    buffer_load_dwordx4 v248, s[16:19], s30 offen lds
    s_mov_b32 m0, 102400
    s_add_u32 s30, s53, 266240
    buffer_load_dwordx4 v114, s[12:15], s30 offen offset:0 lds
    s_add_u32 s30, s53, 270336
    buffer_load_dwordx4 v115, s[12:15], s30 offen offset:1024 lds
    s_add_u32 s30, s53, 274432
    buffer_load_dwordx4 v114, s[12:15], s30 offen offset:2048 lds
    s_add_u32 s30, s53, 278528
    buffer_load_dwordx4 v115, s[12:15], s30 offen offset:3072 lds
    s_cmp_eq_u32 s58, 0
    s_cbranch_scc0 K1W1_TLw1
    s_waitcnt vmcnt(10)
    s_branch K1W1_TLx1
K1W1_TLw1:
    s_waitcnt vmcnt(14)
K1W1_TLx1:
    s_barrier
    s_cmp_eq_u32 s58, 7
    s_cbranch_scc1 K1W1_TLs1
    s_mov_b32 m0, 3072
    s_add_u32 s30, s33, 74752
    buffer_load_dwordx4 v248, s[16:19], s30 offen lds
    s_mov_b32 m0, 4096
    s_add_u32 s30, s34, 73728
    buffer_load_dwordx4 v248, s[16:19], s30 offen lds
    s_mov_b32 m0, 5120
    s_add_u32 s30, s34, 74752
    buffer_load_dwordx4 v248, s[16:19], s30 offen lds
    s_mov_b32 m0, 16384
    s_add_u32 s30, s53, 348160
    buffer_load_dwordx4 v114, s[12:15], s30 offen offset:0 lds
    s_add_u32 s30, s53, 352256
    buffer_load_dwordx4 v115, s[12:15], s30 offen offset:1024 lds
    s_add_u32 s30, s53, 356352
    buffer_load_dwordx4 v114, s[12:15], s30 offen offset:2048 lds
    s_add_u32 s30, s53, 360448
    buffer_load_dwordx4 v115, s[12:15], s30 offen offset:3072 lds
K1W1_TLs1:
    s_cmp_eq_u32 s58, 0
    s_cbranch_scc0 K1W1_TLw2
    s_waitcnt vmcnt(14)
    s_branch K1W1_TLx2
K1W1_TLw2:
    s_cmp_eq_u32 s58, 7
    s_cbranch_scc0 K1W1_TLu2
    s_waitcnt vmcnt(7)
    s_branch K1W1_TLx2
K1W1_TLu2:
    s_waitcnt vmcnt(14)
K1W1_TLx2:
    s_barrier
    s_cmp_eq_u32 s58, 7
    s_cbranch_scc1 K1W1_TLs2
    s_mov_b32 m0, 31744
    s_add_u32 s30, s33, 76800
    buffer_load_dwordx4 v248, s[16:19], s30 offen lds
    s_mov_b32 m0, 32768
    s_add_u32 s30, s34, 75776
    buffer_load_dwordx4 v248, s[16:19], s30 offen lds
    s_mov_b32 m0, 33792
    s_add_u32 s30, s34, 76800
    buffer_load_dwordx4 v248, s[16:19], s30 offen lds
    s_mov_b32 m0, 45056
    s_add_u32 s30, s53, 430080
    buffer_load_dwordx4 v114, s[12:15], s30 offen offset:0 lds
    s_add_u32 s30, s53, 434176
    buffer_load_dwordx4 v115, s[12:15], s30 offen offset:1024 lds
    s_add_u32 s30, s53, 438272
    buffer_load_dwordx4 v114, s[12:15], s30 offen offset:2048 lds
    s_add_u32 s30, s53, 442368
    buffer_load_dwordx4 v115, s[12:15], s30 offen offset:3072 lds
K1W1_TLs2:
    s_cmp_eq_u32 s58, 7
    s_cbranch_scc0 K1W1_TLu3
    s_waitcnt vmcnt(0)
    s_branch K1W1_TLx3
K1W1_TLu3:
    s_waitcnt vmcnt(14)
K1W1_TLx3:
    s_barrier
    s_cmp_eq_u32 s58, 7
    s_cbranch_scc1 K1W1_TLs3
    s_mov_b32 m0, 60416
    s_add_u32 s30, s33, 111616
    buffer_load_dwordx4 v248, s[16:19], s30 offen lds
    s_mov_b32 m0, 61440
    s_add_u32 s30, s34, 110592
    buffer_load_dwordx4 v248, s[16:19], s30 offen lds
    s_mov_b32 m0, 62464
    s_add_u32 s30, s34, 111616
    buffer_load_dwordx4 v248, s[16:19], s30 offen lds
    s_mov_b32 m0, 73728
    s_add_u32 s30, s53, 512000
    buffer_load_dwordx4 v114, s[12:15], s30 offen offset:0 lds
    s_add_u32 s30, s53, 516096
    buffer_load_dwordx4 v115, s[12:15], s30 offen offset:1024 lds
    s_add_u32 s30, s53, 520192
    buffer_load_dwordx4 v114, s[12:15], s30 offen offset:2048 lds
    s_add_u32 s30, s53, 524288
    buffer_load_dwordx4 v115, s[12:15], s30 offen offset:3072 lds
K1W1_TLs3:
    s_add_u32 s32, s32, 73728
    s_add_u32 s33, s33, 73728
    s_add_u32 s34, s34, 73728
    s_add_u32 s35, s35, 73728
    s_add_u32 s36, s36, 73728
    s_add_u32 s37, s37, 73728
    s_add_u32 s53, s53, 327680
    s_add_u32 s58, s58, 1
    s_cmp_lt_u32 s58, 8
    s_cbranch_scc1 K1W1_TL
    s_endpgm
K1W1_slow0:
    s_nop 7
    ds_read_b128 v[196:199], v234 offset:0
    ds_read_b128 v[200:203], v235 offset:0
    ds_read_b128 v[204:207], v236 offset:0
    ds_read_b128 v[208:211], v237 offset:0
    ds_read_b128 v[212:215], v234 offset:4096
    ds_read_b128 v[216:219], v235 offset:4096
    ds_read_b128 v[220:223], v236 offset:4096
    ds_read_b128 v[224:227], v237 offset:4096
    s_waitcnt lgkmcnt(7)
    v_mfma_f32_16x16x32_bf16 v[144:147], v[196:199], v[96:99], 0
    v_mfma_f32_16x16x32_bf16 v[160:163], v[196:199], v[112:115], 0
    s_waitcnt lgkmcnt(6)
    v_mfma_f32_16x16x32_bf16 v[144:147], v[200:203], v[100:103], v[144:147]
    v_mfma_f32_16x16x32_bf16 v[160:163], v[200:203], v[116:119], v[160:163]
    s_waitcnt lgkmcnt(5)
    v_mfma_f32_16x16x32_bf16 v[144:147], v[204:207], v[104:107], v[144:147]
    v_mfma_f32_16x16x32_bf16 v[160:163], v[204:207], v[120:123], v[160:163]
    s_waitcnt lgkmcnt(4)
    v_mfma_f32_16x16x32_bf16 v[144:147], v[208:211], v[108:111], v[144:147]
    v_mfma_f32_16x16x32_bf16 v[160:163], v[208:211], v[124:127], v[160:163]
    ds_read_b128 v[196:199], v234 offset:8192
    ds_read_b128 v[200:203], v235 offset:8192
    ds_read_b128 v[204:207], v236 offset:8192
    ds_read_b128 v[208:211], v237 offset:8192
    s_waitcnt lgkmcnt(7)
    v_mfma_f32_16x16x32_bf16 v[148:151], v[212:215], v[96:99], 0
    v_mfma_f32_16x16x32_bf16 v[164:167], v[212:215], v[112:115], 0
    s_waitcnt lgkmcnt(6)
    v_mfma_f32_16x16x32_bf16 v[148:151], v[216:219], v[100:103], v[148:151]
    v_mfma_f32_16x16x32_bf16 v[164:167], v[216:219], v[116:119], v[164:167]
    s_waitcnt lgkmcnt(5)
    v_mfma_f32_16x16x32_bf16 v[148:151], v[220:223], v[104:107], v[148:151]
    v_mfma_f32_16x16x32_bf16 v[164:167], v[220:223], v[120:123], v[164:167]
    s_waitcnt lgkmcnt(4)
    v_mfma_f32_16x16x32_bf16 v[148:151], v[224:227], v[108:111], v[148:151]
    v_mfma_f32_16x16x32_bf16 v[164:167], v[224:227], v[124:127], v[164:167]
    ds_read_b128 v[212:215], v234 offset:12288
    ds_read_b128 v[216:219], v235 offset:12288
    ds_read_b128 v[220:223], v236 offset:12288
    ds_read_b128 v[224:227], v237 offset:12288
    s_waitcnt lgkmcnt(7)
    v_mfma_f32_16x16x32_bf16 v[152:155], v[196:199], v[96:99], 0
    v_mfma_f32_16x16x32_bf16 v[168:171], v[196:199], v[112:115], 0
    s_waitcnt lgkmcnt(6)
    v_mfma_f32_16x16x32_bf16 v[152:155], v[200:203], v[100:103], v[152:155]
    v_mfma_f32_16x16x32_bf16 v[168:171], v[200:203], v[116:119], v[168:171]
    s_waitcnt lgkmcnt(5)
    v_mfma_f32_16x16x32_bf16 v[152:155], v[204:207], v[104:107], v[152:155]
    v_mfma_f32_16x16x32_bf16 v[168:171], v[204:207], v[120:123], v[168:171]
    s_waitcnt lgkmcnt(4)
    v_mfma_f32_16x16x32_bf16 v[152:155], v[208:211], v[108:111], v[152:155]
    v_mfma_f32_16x16x32_bf16 v[168:171], v[208:211], v[124:127], v[168:171]
    s_waitcnt lgkmcnt(3)
    v_mfma_f32_16x16x32_bf16 v[156:159], v[212:215], v[96:99], 0
    v_mfma_f32_16x16x32_bf16 v[172:175], v[212:215], v[112:115], 0
    s_waitcnt lgkmcnt(2)
    v_mfma_f32_16x16x32_bf16 v[156:159], v[216:219], v[100:103], v[156:159]
    v_mfma_f32_16x16x32_bf16 v[172:175], v[216:219], v[116:119], v[172:175]
    s_waitcnt lgkmcnt(1)
    v_mfma_f32_16x16x32_bf16 v[156:159], v[220:223], v[104:107], v[156:159]
    v_mfma_f32_16x16x32_bf16 v[172:175], v[220:223], v[120:123], v[172:175]
    s_waitcnt lgkmcnt(0)
    v_mfma_f32_16x16x32_bf16 v[156:159], v[224:227], v[108:111], v[156:159]
    v_mfma_f32_16x16x32_bf16 v[172:175], v[224:227], v[124:127], v[172:175]
    v_max3_f32 v243, v144, v145, v146
    v_max3_f32 v243, v243, v147, v148
    v_max3_f32 v243, v243, v149, v150
    v_max3_f32 v243, v243, v151, v152
    v_max3_f32 v243, v243, v153, v154
    s_nop 1
    v_max3_f32 v243, v243, v155, v156
    v_max3_f32 v243, v243, v157, v158
    v_max_f32 v243, v243, v159
    v_mov_b32 v244, v243
    s_nop 1
    v_permlane16_swap_b32 v244, v243
    v_max_f32 v243, v243, v244
    v_mov_b32 v244, v243
    s_nop 1
    v_permlane32_swap_b32 v244, v243
    v_max_f32 v243, v243, v244
    v_sub_f32 v244, 0, v184
    v_max_f32 v243, v243, v244
    v_sub_f32 v244, v244, v243
    v_exp_f32 v244, v244
    v_sub_f32 v184, 0, v243
    v_sub_f32 v185, 0, v243
    v_sub_f32 v186, 0, v243
    v_sub_f32 v187, 0, v243
    v_mul_f32 v0, v0, v244
    v_mul_f32 v1, v1, v244
    v_mul_f32 v2, v2, v244
    v_mul_f32 v3, v3, v244
    v_mul_f32 v4, v4, v244
    v_mul_f32 v5, v5, v244
    v_mul_f32 v6, v6, v244
    v_mul_f32 v7, v7, v244
    v_mul_f32 v8, v8, v244
    v_mul_f32 v9, v9, v244
    v_mul_f32 v10, v10, v244
    v_mul_f32 v11, v11, v244
    v_mul_f32 v12, v12, v244
    v_mul_f32 v13, v13, v244
    v_mul_f32 v14, v14, v244
    v_mul_f32 v15, v15, v244
    v_mul_f32 v16, v16, v244
    v_mul_f32 v17, v17, v244
    v_mul_f32 v18, v18, v244
    v_mul_f32 v19, v19, v244
    v_mul_f32 v20, v20, v244
    v_mul_f32 v21, v21, v244
    v_mul_f32 v22, v22, v244
    v_mul_f32 v23, v23, v244
    v_mul_f32 v24, v24, v244
    v_mul_f32 v25, v25, v244
    v_mul_f32 v26, v26, v244
    v_mul_f32 v27, v27, v244
    v_mul_f32 v28, v28, v244
    v_mul_f32 v29, v29, v244
    v_mul_f32 v30, v30, v244
    v_mul_f32 v31, v31, v244
    v_mul_f32 v228, v228, v244
    v_sub_f32 v144, v144, v243
    v_sub_f32 v145, v145, v243
    v_sub_f32 v146, v146, v243
    v_sub_f32 v147, v147, v243
    v_sub_f32 v148, v148, v243
    v_sub_f32 v149, v149, v243
    v_sub_f32 v150, v150, v243
    v_sub_f32 v151, v151, v243
    v_sub_f32 v152, v152, v243
    v_sub_f32 v153, v153, v243
    v_sub_f32 v154, v154, v243
    v_sub_f32 v155, v155, v243
    v_sub_f32 v156, v156, v243
    v_sub_f32 v157, v157, v243
    v_sub_f32 v158, v158, v243
    v_sub_f32 v159, v159, v243
    v_max3_f32 v243, v160, v161, v162
    v_max3_f32 v243, v243, v163, v164
    v_max3_f32 v243, v243, v165, v166
    v_max3_f32 v243, v243, v167, v168
    v_max3_f32 v243, v243, v169, v170
    v_max3_f32 v243, v243, v171, v172
    v_max3_f32 v243, v243, v173, v174
    v_max_f32 v243, v243, v175
    v_mov_b32 v244, v243
    s_nop 1
    v_permlane16_swap_b32 v244, v243
    v_max_f32 v243, v243, v244
    v_mov_b32 v244, v243
    s_nop 1
    v_permlane32_swap_b32 v244, v243
    v_max_f32 v243, v243, v244
    v_sub_f32 v244, 0, v188
    v_max_f32 v243, v243, v244
    v_sub_f32 v244, v244, v243
    v_exp_f32 v244, v244
    v_sub_f32 v188, 0, v243
    v_sub_f32 v189, 0, v243
    v_sub_f32 v190, 0, v243
    v_sub_f32 v191, 0, v243
    v_mul_f32 v32, v32, v244
    v_mul_f32 v33, v33, v244
    v_mul_f32 v34, v34, v244
    v_mul_f32 v35, v35, v244
    v_mul_f32 v36, v36, v244
    v_mul_f32 v37, v37, v244
    v_mul_f32 v38, v38, v244
    v_mul_f32 v39, v39, v244
    v_mul_f32 v40, v40, v244
    v_mul_f32 v41, v41, v244
    v_mul_f32 v42, v42, v244
    v_mul_f32 v43, v43, v244
    v_mul_f32 v44, v44, v244
    v_mul_f32 v45, v45, v244
    v_mul_f32 v46, v46, v244
    v_mul_f32 v47, v47, v244
    v_mul_f32 v48, v48, v244
    v_mul_f32 v49, v49, v244
    v_mul_f32 v50, v50, v244
    v_mul_f32 v51, v51, v244
    v_mul_f32 v52, v52, v244
    v_mul_f32 v53, v53, v244
    v_mul_f32 v54, v54, v244
    v_mul_f32 v55, v55, v244
    v_mul_f32 v56, v56, v244
    v_mul_f32 v57, v57, v244
    v_mul_f32 v58, v58, v244
    v_mul_f32 v59, v59, v244
    v_mul_f32 v60, v60, v244
    v_mul_f32 v61, v61, v244
    v_mul_f32 v62, v62, v244
    v_mul_f32 v63, v63, v244
    v_mul_f32 v229, v229, v244
    v_sub_f32 v160, v160, v243
    v_sub_f32 v161, v161, v243
    v_sub_f32 v162, v162, v243
    v_sub_f32 v163, v163, v243
    v_sub_f32 v164, v164, v243
    v_sub_f32 v165, v165, v243
    v_sub_f32 v166, v166, v243
    v_sub_f32 v167, v167, v243
    v_sub_f32 v168, v168, v243
    v_sub_f32 v169, v169, v243
    v_sub_f32 v170, v170, v243
    v_sub_f32 v171, v171, v243
    v_sub_f32 v172, v172, v243
    v_sub_f32 v173, v173, v243
    v_sub_f32 v174, v174, v243
    v_sub_f32 v175, v175, v243
    v_exp_f32 v144, v144
    v_exp_f32 v145, v145
    v_exp_f32 v146, v146
    v_exp_f32 v147, v147
    v_exp_f32 v160, v160
    v_exp_f32 v161, v161
    v_exp_f32 v162, v162
    v_exp_f32 v163, v163
    v_exp_f32 v148, v148
    v_exp_f32 v149, v149
    v_exp_f32 v150, v150
    v_exp_f32 v151, v151
    v_exp_f32 v164, v164
    v_exp_f32 v165, v165
    v_exp_f32 v166, v166
    v_exp_f32 v167, v167
    v_add_f32 v231, v144, v145
    v_add_f32 v231, v231, v146
    v_add_f32 v231, v231, v147
    v_add_f32 v232, v160, v161
    v_add_f32 v232, v232, v162
    v_add_f32 v232, v232, v163
    v_add_f32 v231, v231, v148
    v_add_f32 v231, v231, v149
    v_add_f32 v231, v231, v150
    v_add_f32 v231, v231, v151
    v_add_f32 v232, v232, v164
    v_add_f32 v232, v232, v165
    v_add_f32 v232, v232, v166
    v_add_f32 v232, v232, v167
    v_cvt_pk_bf16_f32 v144, v144, v145
    v_cvt_pk_bf16_f32 v145, v146, v147
    v_cvt_pk_bf16_f32 v146, v148, v149
    v_cvt_pk_bf16_f32 v147, v150, v151
    v_cvt_pk_bf16_f32 v160, v160, v161
    v_cvt_pk_bf16_f32 v161, v162, v163
    v_cvt_pk_bf16_f32 v162, v164, v165
    v_cvt_pk_bf16_f32 v163, v166, v167
    s_nop 1
    s_branch K1W1_back0
K1W1_slow1:
    s_nop 7
    ds_read_b128 v[196:199], v234 offset:8192
    ds_read_b128 v[200:203], v235 offset:8192
    ds_read_b128 v[204:207], v236 offset:8192
    ds_read_b128 v[208:211], v237 offset:8192
    ds_read_b128 v[212:215], v234 offset:12288
    ds_read_b128 v[216:219], v235 offset:12288
    ds_read_b128 v[220:223], v236 offset:12288
    ds_read_b128 v[224:227], v237 offset:12288
    s_waitcnt lgkmcnt(7)
    v_mfma_f32_16x16x32_bf16 v[152:155], v[196:199], v[96:99], 0
    v_mfma_f32_16x16x32_bf16 v[168:171], v[196:199], v[112:115], 0
    s_waitcnt lgkmcnt(6)
    v_mfma_f32_16x16x32_bf16 v[152:155], v[200:203], v[100:103], v[152:155]
    v_mfma_f32_16x16x32_bf16 v[168:171], v[200:203], v[116:119], v[168:171]
    s_waitcnt lgkmcnt(5)
    v_mfma_f32_16x16x32_bf16 v[152:155], v[204:207], v[104:107], v[152:155]
    v_mfma_f32_16x16x32_bf16 v[168:171], v[204:207], v[120:123], v[168:171]
    s_waitcnt lgkmcnt(4)
    v_mfma_f32_16x16x32_bf16 v[152:155], v[208:211], v[108:111], v[152:155]
    v_mfma_f32_16x16x32_bf16 v[168:171], v[208:211], v[124:127], v[168:171]
    s_waitcnt lgkmcnt(3)
    v_mfma_f32_16x16x32_bf16 v[156:159], v[212:215], v[96:99], 0
    v_mfma_f32_16x16x32_bf16 v[172:175], v[212:215], v[112:115], 0
    s_waitcnt lgkmcnt(2)
    v_mfma_f32_16x16x32_bf16 v[156:159], v[216:219], v[100:103], v[156:159]
    v_mfma_f32_16x16x32_bf16 v[172:175], v[216:219], v[116:119], v[172:175]
    s_waitcnt lgkmcnt(1)
    v_mfma_f32_16x16x32_bf16 v[156:159], v[220:223], v[104:107], v[156:159]
    v_mfma_f32_16x16x32_bf16 v[172:175], v[220:223], v[120:123], v[172:175]
    s_waitcnt lgkmcnt(0)
    v_mfma_f32_16x16x32_bf16 v[156:159], v[224:227], v[108:111], v[156:159]
    v_mfma_f32_16x16x32_bf16 v[172:175], v[224:227], v[124:127], v[172:175]
    v_max3_f32 v243, v152, v153, v154
    s_nop 5
    v_max3_f32 v243, v243, v155, v156
    v_max3_f32 v243, v243, v157, v158
    v_max_f32 v243, v243, v159
    v_mov_b32 v244, v243
    s_nop 1
    v_permlane16_swap_b32 v244, v243
    v_max_f32 v243, v243, v244
    v_mov_b32 v244, v243
    s_nop 1
    v_permlane32_swap_b32 v244, v243
    v_max_f32 v243, v243, v244
    v_sub_f32 v244, 0, v184
    v_max_f32 v243, v243, v244
    v_sub_f32 v244, v244, v243
    v_exp_f32 v244, v244
    v_sub_f32 v184, 0, v243
    v_sub_f32 v185, 0, v243
    v_sub_f32 v186, 0, v243
    v_sub_f32 v187, 0, v243
    v_mul_f32 v0, v0, v244
    v_mul_f32 v1, v1, v244
    v_mul_f32 v2, v2, v244
    v_mul_f32 v3, v3, v244
    v_mul_f32 v4, v4, v244
    v_mul_f32 v5, v5, v244
    v_mul_f32 v6, v6, v244
    v_mul_f32 v7, v7, v244
    v_mul_f32 v8, v8, v244
    v_mul_f32 v9, v9, v244
    v_mul_f32 v10, v10, v244
    v_mul_f32 v11, v11, v244
    v_mul_f32 v12, v12, v244
    v_mul_f32 v13, v13, v244
    v_mul_f32 v14, v14, v244
    v_mul_f32 v15, v15, v244
    v_mul_f32 v16, v16, v244
    v_mul_f32 v17, v17, v244
    v_mul_f32 v18, v18, v244
    v_mul_f32 v19, v19, v244
    v_mul_f32 v20, v20, v244
    v_mul_f32 v21, v21, v244
    v_mul_f32 v22, v22, v244
    v_mul_f32 v23, v23, v244
    v_mul_f32 v24, v24, v244
    v_mul_f32 v25, v25, v244
    v_mul_f32 v26, v26, v244
    v_mul_f32 v27, v27, v244
    v_mul_f32 v28, v28, v244
    v_mul_f32 v29, v29, v244
    v_mul_f32 v30, v30, v244
    v_mul_f32 v31, v31, v244
    v_mul_f32 v228, v228, v244
    v_sub_f32 v152, v152, v243
    v_sub_f32 v153, v153, v243
    v_sub_f32 v154, v154, v243
    v_sub_f32 v155, v155, v243
    v_sub_f32 v156, v156, v243
    v_sub_f32 v157, v157, v243
    v_sub_f32 v158, v158, v243
    v_sub_f32 v159, v159, v243
    v_max3_f32 v243, v168, v169, v170
    v_max3_f32 v243, v243, v171, v172
    v_max3_f32 v243, v243, v173, v174
    v_max_f32 v243, v243, v175
    v_mov_b32 v244, v243
    s_nop 1
    v_permlane16_swap_b32 v244, v243
    v_max_f32 v243, v243, v244
    v_mov_b32 v244, v243
    s_nop 1
    v_permlane32_swap_b32 v244, v243
    v_max_f32 v243, v243, v244
    v_sub_f32 v244, 0, v188
    v_max_f32 v243, v243, v244
    v_sub_f32 v244, v244, v243
    v_exp_f32 v244, v244
    v_sub_f32 v188, 0, v243
    v_sub_f32 v189, 0, v243
    v_sub_f32 v190, 0, v243
    v_sub_f32 v191, 0, v243
    v_mul_f32 v32, v32, v244
    v_mul_f32 v33, v33, v244
    v_mul_f32 v34, v34, v244
    v_mul_f32 v35, v35, v244
    v_mul_f32 v36, v36, v244
    v_mul_f32 v37, v37, v244
    v_mul_f32 v38, v38, v244
    v_mul_f32 v39, v39, v244
    v_mul_f32 v40, v40, v244
    v_mul_f32 v41, v41, v244
    v_mul_f32 v42, v42, v244
    v_mul_f32 v43, v43, v244
    v_mul_f32 v44, v44, v244
    v_mul_f32 v45, v45, v244
    v_mul_f32 v46, v46, v244
    v_mul_f32 v47, v47, v244
    v_mul_f32 v48, v48, v244
    v_mul_f32 v49, v49, v244
    v_mul_f32 v50, v50, v244
    v_mul_f32 v51, v51, v244
    v_mul_f32 v52, v52, v244
    v_mul_f32 v53, v53, v244
    v_mul_f32 v54, v54, v244
    v_mul_f32 v55, v55, v244
    v_mul_f32 v56, v56, v244
    v_mul_f32 v57, v57, v244
    v_mul_f32 v58, v58, v244
    v_mul_f32 v59, v59, v244
    v_mul_f32 v60, v60, v244
    v_mul_f32 v61, v61, v244
    v_mul_f32 v62, v62, v244
    v_mul_f32 v63, v63, v244
    v_mul_f32 v229, v229, v244
    v_sub_f32 v168, v168, v243
    v_sub_f32 v169, v169, v243
    v_sub_f32 v170, v170, v243
    v_sub_f32 v171, v171, v243
    v_sub_f32 v172, v172, v243
    v_sub_f32 v173, v173, v243
    v_sub_f32 v174, v174, v243
    v_sub_f32 v175, v175, v243
    v_exp_f32 v152, v152
    v_exp_f32 v153, v153
    v_exp_f32 v154, v154
    v_exp_f32 v155, v155
    v_exp_f32 v168, v168
    v_exp_f32 v169, v169
    v_exp_f32 v170, v170
    v_exp_f32 v171, v171
    v_exp_f32 v156, v156
    v_exp_f32 v157, v157
    v_exp_f32 v158, v158
    v_exp_f32 v159, v159
    v_exp_f32 v172, v172
    v_exp_f32 v173, v173
    v_exp_f32 v174, v174
    v_exp_f32 v175, v175
    v_add_f32 v231, v152, v153
    v_add_f32 v231, v231, v154
    v_add_f32 v231, v231, v155
    v_add_f32 v232, v168, v169
    v_add_f32 v232, v232, v170
    v_add_f32 v232, v232, v171
    v_add_f32 v231, v231, v156
    v_add_f32 v231, v231, v157
    v_add_f32 v231, v231, v158
    v_add_f32 v231, v231, v159
    v_add_f32 v232, v232, v172
    v_add_f32 v232, v232, v173
    v_add_f32 v232, v232, v174
    v_add_f32 v232, v232, v175
    v_cvt_pk_bf16_f32 v148, v152, v153
    v_cvt_pk_bf16_f32 v149, v154, v155
    v_cvt_pk_bf16_f32 v150, v156, v157
    v_cvt_pk_bf16_f32 v151, v158, v159
    v_cvt_pk_bf16_f32 v164, v168, v169
    v_cvt_pk_bf16_f32 v165, v170, v171
    v_cvt_pk_bf16_f32 v166, v172, v173
    v_cvt_pk_bf16_f32 v167, v174, v175
    ds_read_b64_tr_b16 v[196:197], v238 offset:8192
    ds_read_b64_tr_b16 v[198:199], v238 offset:12288
    v_xor_b32 v240, 32, v238
    ds_read_b64_tr_b16 v[200:201], v240 offset:8192
    ds_read_b64_tr_b16 v[202:203], v240 offset:12288
    v_xor_b32 v239, 64, v238
    ds_read_b64_tr_b16 v[204:205], v239 offset:8192
    ds_read_b64_tr_b16 v[206:207], v239 offset:12288
    v_xor_b32 v240, 96, v238
    ds_read_b64_tr_b16 v[208:209], v240 offset:8192
    ds_read_b64_tr_b16 v[210:211], v240 offset:12288
    v_xor_b32 v239, 128, v238
    ds_read_b64_tr_b16 v[212:213], v239 offset:8192
    ds_read_b64_tr_b16 v[214:215], v239 offset:12288
    v_xor_b32 v240, 160, v238
    ds_read_b64_tr_b16 v[216:217], v240 offset:8192
    ds_read_b64_tr_b16 v[218:219], v240 offset:12288
    v_xor_b32 v239, 192, v238
    ds_read_b64_tr_b16 v[220:221], v239 offset:8192
    ds_read_b64_tr_b16 v[222:223], v239 offset:12288
    v_xor_b32 v240, 224, v238
    ds_read_b64_tr_b16 v[224:225], v240 offset:8192
    ds_read_b64_tr_b16 v[226:227], v240 offset:12288
    s_waitcnt lgkmcnt(0)
    s_nop 1
    s_branch K1W1_back1
K1W2_START:
    s_lshl_b32 s58, s26, 14
    s_add_u32 s58, s58, 26624
    s_lshl_b32 s30, s26, 3
    s_add_u32 s30, s30, 4
    s_lshl_b32 s59, s30, 10
    s_mul_i32 s60, s30, 10240
    s_lshl_b32 s30, s26, 14
    s_add_u32 s30, s30, 53248
    v_add_u32 v196, s30, v196
    v_add_u32 v197, s30, v197
    v_add_u32 v198, s30, v198
    v_add_u32 v199, s30, v199
    v_add_u32 v200, s30, v200
    v_add_u32 v201, s30, v201
    v_add_u32 v202, s30, v202
    v_add_u32 v203, s30, v203
    v_add_u32 v204, 53248, v204
    v_add_u32 v205, 53248, v205
    s_mov_b32 s52, 0
    s_mov_b32 s53, 0
    s_mov_b32 s56, 102400
    s_add_u32 m0, s56, s58
    s_add_u32 s30, s52, 262144
    buffer_load_dwordx4 v206, s[12:15], s30 offen offset:0 lds
    s_add_u32 s30, s52, 293888
    buffer_load_dwordx4 v206, s[12:15], s30 offen offset:1024 lds
    s_add_u32 s30, s52, 325632
    buffer_load_dwordx4 v207, s[12:15], s30 offen offset:2048 lds
    s_add_u32 s30, s52, 357376
    buffer_load_dwordx4 v207, s[12:15], s30 offen offset:3072 lds
    s_add_u32 m0, s56, s59
    s_add_u32 s30, s53, s60
    buffer_load_dwordx4 v208, s[16:19], s30 offen lds
    s_add_u32 s30, s30, 9216
    buffer_load_dwordx4 v209, s[16:19], s30 offen offset:1024 lds
    s_add_u32 s52, s52, 524288
    s_add_u32 s53, s53, 128
    s_mov_b32 s56, 0
    s_add_u32 m0, s56, s58
    s_add_u32 s30, s52, 262144
    buffer_load_dwordx4 v206, s[12:15], s30 offen offset:0 lds
    s_add_u32 s30, s52, 293888
    buffer_load_dwordx4 v206, s[12:15], s30 offen offset:1024 lds
    s_add_u32 s30, s52, 325632
    buffer_load_dwordx4 v207, s[12:15], s30 offen offset:2048 lds
    s_add_u32 s30, s52, 357376
    buffer_load_dwordx4 v207, s[12:15], s30 offen offset:3072 lds
    s_add_u32 m0, s56, s59
    s_add_u32 s30, s53, s60
    buffer_load_dwordx4 v208, s[16:19], s30 offen lds
    s_add_u32 s30, s30, 9216
    buffer_load_dwordx4 v209, s[16:19], s30 offen offset:1024 lds
    s_add_u32 s52, s52, 524288
    s_add_u32 s53, s53, 128
    v_mov_b32 v0, 0
    v_mov_b32 v1, 0
    v_mov_b32 v2, 0
    v_mov_b32 v3, 0
    v_mov_b32 v4, 0
    v_mov_b32 v5, 0
    v_mov_b32 v6, 0
    v_mov_b32 v7, 0
    v_mov_b32 v8, 0
    v_mov_b32 v9, 0
    v_mov_b32 v10, 0
    v_mov_b32 v11, 0
    v_mov_b32 v12, 0
    v_mov_b32 v13, 0
    v_mov_b32 v14, 0
    v_mov_b32 v15, 0
    v_mov_b32 v16, 0
    v_mov_b32 v17, 0
    v_mov_b32 v18, 0
    v_mov_b32 v19, 0
    v_mov_b32 v20, 0
    v_mov_b32 v21, 0
    v_mov_b32 v22, 0
    v_mov_b32 v23, 0
    v_mov_b32 v24, 0
    v_mov_b32 v25, 0
    v_mov_b32 v26, 0
    v_mov_b32 v27, 0
    v_mov_b32 v28, 0
    v_mov_b32 v29, 0
    v_mov_b32 v30, 0
    v_mov_b32 v31, 0
    v_mov_b32 v32, 0
    v_mov_b32 v33, 0
    v_mov_b32 v34, 0
    v_mov_b32 v35, 0
    v_mov_b32 v36, 0
    v_mov_b32 v37, 0
    v_mov_b32 v38, 0
    v_mov_b32 v39, 0
    v_mov_b32 v40, 0
    v_mov_b32 v41, 0
    v_mov_b32 v42, 0
    v_mov_b32 v43, 0
    v_mov_b32 v44, 0
    v_mov_b32 v45, 0
    v_mov_b32 v46, 0
    v_mov_b32 v47, 0
    v_mov_b32 v48, 0
    v_mov_b32 v49, 0
    v_mov_b32 v50, 0
    v_mov_b32 v51, 0
    v_mov_b32 v52, 0
    v_mov_b32 v53, 0
    v_mov_b32 v54, 0
    v_mov_b32 v55, 0
    v_mov_b32 v56, 0
    v_mov_b32 v57, 0
    v_mov_b32 v58, 0
    v_mov_b32 v59, 0
    v_mov_b32 v60, 0
    v_mov_b32 v61, 0
    v_mov_b32 v62, 0
    v_mov_b32 v63, 0
    v_mov_b32 v64, 0
    v_mov_b32 v65, 0
    v_mov_b32 v66, 0
    v_mov_b32 v67, 0
    v_mov_b32 v68, 0
    v_mov_b32 v69, 0
    v_mov_b32 v70, 0
    v_mov_b32 v71, 0
    s_waitcnt vmcnt(6)
    s_barrier
    s_mov_b32 s56, 51200
    ds_read_b128 v[160:163], v204 offset:8192
    ds_read_b128 v[164:167], v204 offset:10240
    ds_read_b128 v[168:171], v204 offset:16384
    ds_read_b64_tr_b16 v[96:97], v196 offset:0
    ds_read_b64_tr_b16 v[98:99], v196 offset:1024
    ds_read_b64_tr_b16 v[100:101], v197 offset:0
    ds_read_b64_tr_b16 v[102:103], v197 offset:1024
    ds_read_b64_tr_b16 v[104:105], v198 offset:0
    ds_read_b64_tr_b16 v[106:107], v198 offset:1024
    ds_read_b64_tr_b16 v[108:109], v199 offset:0
    ds_read_b64_tr_b16 v[110:111], v199 offset:1024
    ds_read_b64_tr_b16 v[112:113], v200 offset:0
    ds_read_b64_tr_b16 v[114:115], v200 offset:1024
    ds_read_b64_tr_b16 v[116:117], v201 offset:0
    ds_read_b64_tr_b16 v[118:119], v201 offset:1024
    ds_read_b64_tr_b16 v[120:121], v202 offset:0
    ds_read_b64_tr_b16 v[122:123], v202 offset:1024
    ds_read_b64_tr_b16 v[124:125], v203 offset:0
    ds_read_b64_tr_b16 v[126:127], v203 offset:1024
    ds_read_b128 v[172:175], v205 offset:8192
    ds_read_b128 v[176:179], v205 offset:10240
    ds_read_b128 v[180:183], v205 offset:16384
    ds_read_b64_tr_b16 v[128:129], v196 offset:8192
    ds_read_b64_tr_b16 v[130:131], v196 offset:9216
    ds_read_b64_tr_b16 v[132:133], v197 offset:8192
    ds_read_b64_tr_b16 v[134:135], v197 offset:9216
    ds_read_b64_tr_b16 v[136:137], v198 offset:8192
    ds_read_b64_tr_b16 v[138:139], v198 offset:9216
    ds_read_b64_tr_b16 v[140:141], v199 offset:8192
    ds_read_b64_tr_b16 v[142:143], v199 offset:9216
    ds_read_b64_tr_b16 v[144:145], v200 offset:8192
    ds_read_b64_tr_b16 v[146:147], v200 offset:9216
    ds_read_b64_tr_b16 v[148:149], v201 offset:8192
    ds_read_b64_tr_b16 v[150:151], v201 offset:9216
    ds_read_b64_tr_b16 v[152:153], v202 offset:8192
    ds_read_b64_tr_b16 v[154:155], v202 offset:9216
    ds_read_b64_tr_b16 v[156:157], v203 offset:8192
    ds_read_b64_tr_b16 v[158:159], v203 offset:9216
    s_waitcnt lgkmcnt(15)
    v_mfma_f32_16x16x32_bf16 v[0:3], v[96:99], v[160:163], v[0:3]
    s_add_u32 m0, s56, s58
    v_mfma_f32_16x16x32_bf16 v[32:35], v[96:99], v[164:167], v[32:35]
    s_add_u32 s30, s52, 262144
    v_mfma_f32_16x16x32_bf16 v[4:7], v[100:103], v[160:163], v[4:7]
    buffer_load_dwordx4 v206, s[12:15], s30 offen offset:0 lds
    v_mfma_f32_16x16x32_bf16 v[36:39], v[100:103], v[164:167], v[36:39]
    s_add_u32 s30, s52, 293888
    v_mfma_f32_16x16x32_bf16 v[8:11], v[104:107], v[160:163], v[8:11]
    buffer_load_dwordx4 v206, s[12:15], s30 offen offset:1024 lds
    v_mfma_f32_16x16x32_bf16 v[40:43], v[104:107], v[164:167], v[40:43]
    s_add_u32 s30, s52, 325632
    v_mfma_f32_16x16x32_bf16 v[12:15], v[108:111], v[160:163], v[12:15]
    buffer_load_dwordx4 v207, s[12:15], s30 offen offset:2048 lds
    v_mfma_f32_16x16x32_bf16 v[44:47], v[108:111], v[164:167], v[44:47]
    s_add_u32 s30, s52, 357376
    v_mfma_f32_16x16x32_bf16 v[16:19], v[112:115], v[160:163], v[16:19]
    v_mfma_f32_16x16x32_bf16 v[48:51], v[112:115], v[164:167], v[48:51]
    buffer_load_dwordx4 v207, s[12:15], s30 offen offset:3072 lds
    v_mfma_f32_16x16x32_bf16 v[64:67], v[112:115], v[168:171], v[64:67]
    s_add_u32 m0, s56, s59
    v_mfma_f32_16x16x32_bf16 v[20:23], v[116:119], v[160:163], v[20:23]
    s_add_u32 s30, s53, s60
    v_mfma_f32_16x16x32_bf16 v[52:55], v[116:119], v[164:167], v[52:55]
    buffer_load_dwordx4 v208, s[16:19], s30 offen lds
    v_mfma_f32_16x16x32_bf16 v[68:71], v[116:119], v[168:171], v[68:71]
    s_add_u32 s30, s30, 9216
    v_mfma_f32_16x16x32_bf16 v[24:27], v[120:123], v[160:163], v[24:27]
    buffer_load_dwordx4 v209, s[16:19], s30 offen offset:1024 lds
    v_mfma_f32_16x16x32_bf16 v[56:59], v[120:123], v[164:167], v[56:59]
    s_add_u32 s52, s52, 524288
    v_mfma_f32_16x16x32_bf16 v[28:31], v[124:127], v[160:163], v[28:31]
    s_add_u32 s53, s53, 128
    v_mfma_f32_16x16x32_bf16 v[60:63], v[124:127], v[164:167], v[60:63]
    s_waitcnt lgkmcnt(0)
    s_mov_b32 s51, 1
    s_mov_b32 s57, 4294864896
    v_add_u32 v196, s57, v196
    v_add_u32 v197, s57, v197
    v_add_u32 v198, s57, v198
    v_add_u32 v199, s57, v199
    v_add_u32 v200, s57, v200
    v_add_u32 v201, s57, v201
    v_add_u32 v202, s57, v202
    v_add_u32 v203, s57, v203
    v_add_u32 v204, s57, v204
    v_add_u32 v205, s57, v205
    s_mov_b32 s56, 102400
K1W2_P1:
    s_cmp_eq_u32 s51, 9
    s_cbranch_scc1 K1W2_P1a
    s_waitcnt vmcnt(6)
    s_branch K1W2_P1b
K1W2_P1a:
    s_waitcnt vmcnt(4)
K1W2_P1b:
    s_barrier
    s_cmp_le_u32 s51, 7
    s_cbranch_scc1 K1W2_P1c
    v_mfma_f32_16x16x32_bf16 v[0:3], v[128:131], v[172:175], v[0:3]
    ds_read_b128 v[160:163], v204 offset:8192
    ds_read_b128 v[164:167], v204 offset:10240
    v_mfma_f32_16x16x32_bf16 v[32:35], v[128:131], v[176:179], v[32:35]
    ds_read_b128 v[168:171], v204 offset:16384
    v_mfma_f32_16x16x32_bf16 v[4:7], v[132:135], v[172:175], v[4:7]
    ds_read_b64_tr_b16 v[96:97], v196 offset:0
    v_mfma_f32_16x16x32_bf16 v[36:39], v[132:135], v[176:179], v[36:39]
    ds_read_b64_tr_b16 v[98:99], v196 offset:1024
    v_mfma_f32_16x16x32_bf16 v[8:11], v[136:139], v[172:175], v[8:11]
    ds_read_b64_tr_b16 v[100:101], v197 offset:0
    v_mfma_f32_16x16x32_bf16 v[40:43], v[136:139], v[176:179], v[40:43]
    ds_read_b64_tr_b16 v[102:103], v197 offset:1024
    v_mfma_f32_16x16x32_bf16 v[12:15], v[140:143], v[172:175], v[12:15]
    ds_read_b64_tr_b16 v[104:105], v198 offset:0
    v_mfma_f32_16x16x32_bf16 v[44:47], v[140:143], v[176:179], v[44:47]
    ds_read_b64_tr_b16 v[106:107], v198 offset:1024
    v_mfma_f32_16x16x32_bf16 v[16:19], v[144:147], v[172:175], v[16:19]
    ds_read_b64_tr_b16 v[108:109], v199 offset:0
    v_mfma_f32_16x16x32_bf16 v[48:51], v[144:147], v[176:179], v[48:51]
    ds_read_b64_tr_b16 v[110:111], v199 offset:1024
    v_mfma_f32_16x16x32_bf16 v[64:67], v[144:147], v[180:183], v[64:67]
    ds_read_b64_tr_b16 v[112:113], v200 offset:0
    v_mfma_f32_16x16x32_bf16 v[20:23], v[148:151], v[172:175], v[20:23]
    ds_read_b64_tr_b16 v[114:115], v200 offset:1024
    v_mfma_f32_16x16x32_bf16 v[52:55], v[148:151], v[176:179], v[52:55]
    ds_read_b64_tr_b16 v[116:117], v201 offset:0
    v_mfma_f32_16x16x32_bf16 v[68:71], v[148:151], v[180:183], v[68:71]
    ds_read_b64_tr_b16 v[118:119], v201 offset:1024
    v_mfma_f32_16x16x32_bf16 v[24:27], v[152:155], v[172:175], v[24:27]
    ds_read_b64_tr_b16 v[120:121], v202 offset:0
    v_mfma_f32_16x16x32_bf16 v[56:59], v[152:155], v[176:179], v[56:59]
    ds_read_b64_tr_b16 v[122:123], v202 offset:1024
    v_mfma_f32_16x16x32_bf16 v[28:31], v[156:159], v[172:175], v[28:31]
    ds_read_b64_tr_b16 v[124:125], v203 offset:0
    v_mfma_f32_16x16x32_bf16 v[60:63], v[156:159], v[176:179], v[60:63]
    ds_read_b64_tr_b16 v[126:127], v203 offset:1024
    s_cmp_eq_u32 s51, 8
    s_cbranch_scc0 K1W2_P1d
    s_lshl_b32 s31, s26, 13
    s_add_u32 s31, s31, 4096
    v_xor_b32 v243, 0, v241
    v_xor_b32 v244, 64, v241
    s_mov_b32 m0, s31
    s_nop 0
    buffer_load_dwordx4 v243, s[4:7], s31 offen nt lds
    buffer_load_dwordx4 v244, s[4:7], s31 offen offset:1024 nt lds
    s_add_u32 s30, s31, 32768
    s_mov_b32 m0, s30
    v_xor_b32 v243, 128, v242
    buffer_load_dwordx4 v242, s[8:11], s31 offen nt lds
    buffer_load_dwordx4 v243, s[8:11], s31 offen offset:1024 nt lds
K1W2_P1d:
    s_waitcnt lgkmcnt(0)
    s_cmp_eq_u32 s51, 9
    s_cbranch_scc0 K1W2_P1t
    s_and_b32 s47, s2, 1
    s_load_dwordx2 s[72:73], s[0:1], 32
    s_load_dwordx2 s[74:75], s[0:1], 72
    s_waitcnt lgkmcnt(0)
    s_cmp_eq_u32 s64, 0
    s_cselect_b64 s[76:77], s[72:73], s[74:75]
    s_mov_b32 s78, 5242880
    s_mov_b32 s79, 131072
    s_lshl_b32 s30, s47, 11
    s_lshl_b32 s31, s26, 10
    s_add_u32 s30, s30, s31
    s_lshl_b32 s31, s85, 3
    s_add_u32 s31, s31, s84
    s_lshl_b32 s31, s31, 5
    s_add_u32 s30, s30, s31
    s_mul_i32 s30, s30, 1280
    v_lshlrev_b32 v243, 7, v245
    s_add_u32 s30, s30, 20480
    buffer_load_dword v249, v243, s[76:79], s30 offen
    v_add_u32 v243, 8192, v243
    v_mov_b32 v244, 2147418112
    v_cmp_gt_u32 vcc, 16, v245
    s_nop 1
    v_cndmask_b32 v243, v244, v243, vcc
    buffer_load_dword v250, v243, s[76:79], s30 offen
K1W2_P1t:
    v_mfma_f32_16x16x32_bf16 v[0:3], v[96:99], v[160:163], v[0:3]
    ds_read_b128 v[172:175], v205 offset:8192
    ds_read_b128 v[176:179], v205 offset:10240
    v_mfma_f32_16x16x32_bf16 v[32:35], v[96:99], v[164:167], v[32:35]
    ds_read_b128 v[180:183], v205 offset:16384
    v_mfma_f32_16x16x32_bf16 v[4:7], v[100:103], v[160:163], v[4:7]
    ds_read_b64_tr_b16 v[128:129], v196 offset:8192
    v_mfma_f32_16x16x32_bf16 v[36:39], v[100:103], v[164:167], v[36:39]
    ds_read_b64_tr_b16 v[130:131], v196 offset:9216
    v_mfma_f32_16x16x32_bf16 v[8:11], v[104:107], v[160:163], v[8:11]
    ds_read_b64_tr_b16 v[132:133], v197 offset:8192
    v_mfma_f32_16x16x32_bf16 v[40:43], v[104:107], v[164:167], v[40:43]
    ds_read_b64_tr_b16 v[134:135], v197 offset:9216
    v_mfma_f32_16x16x32_bf16 v[12:15], v[108:111], v[160:163], v[12:15]
    ds_read_b64_tr_b16 v[136:137], v198 offset:8192
    v_mfma_f32_16x16x32_bf16 v[44:47], v[108:111], v[164:167], v[44:47]
    ds_read_b64_tr_b16 v[138:139], v198 offset:9216
    v_mfma_f32_16x16x32_bf16 v[16:19], v[112:115], v[160:163], v[16:19]
    ds_read_b64_tr_b16 v[140:141], v199 offset:8192
    v_mfma_f32_16x16x32_bf16 v[48:51], v[112:115], v[164:167], v[48:51]
    ds_read_b64_tr_b16 v[142:143], v199 offset:9216
    v_mfma_f32_16x16x32_bf16 v[64:67], v[112:115], v[168:171], v[64:67]
    ds_read_b64_tr_b16 v[144:145], v200 offset:8192
    v_mfma_f32_16x16x32_bf16 v[20:23], v[116:119], v[160:163], v[20:23]
    ds_read_b64_tr_b16 v[146:147], v200 offset:9216
    v_mfma_f32_16x16x32_bf16 v[52:55], v[116:119], v[164:167], v[52:55]
    ds_read_b64_tr_b16 v[148:149], v201 offset:8192
    v_mfma_f32_16x16x32_bf16 v[68:71], v[116:119], v[168:171], v[68:71]
    ds_read_b64_tr_b16 v[150:151], v201 offset:9216
    v_mfma_f32_16x16x32_bf16 v[24:27], v[120:123], v[160:163], v[24:27]
    ds_read_b64_tr_b16 v[152:153], v202 offset:8192
    v_mfma_f32_16x16x32_bf16 v[56:59], v[120:123], v[164:167], v[56:59]
    ds_read_b64_tr_b16 v[154:155], v202 offset:9216
    v_mfma_f32_16x16x32_bf16 v[28:31], v[124:127], v[160:163], v[28:31]
    ds_read_b64_tr_b16 v[156:157], v203 offset:8192
    v_mfma_f32_16x16x32_bf16 v[60:63], v[124:127], v[164:167], v[60:63]
    ds_read_b64_tr_b16 v[158:159], v203 offset:9216
    s_branch K1W2_P1e
K1W2_P1c:
    v_mfma_f32_16x16x32_bf16 v[0:3], v[128:131], v[172:175], v[0:3]
    ds_read_b128 v[160:163], v204 offset:8192
    ds_read_b128 v[164:167], v204 offset:10240
    v_mfma_f32_16x16x32_bf16 v[32:35], v[128:131], v[176:179], v[32:35]
    ds_read_b128 v[168:171], v204 offset:16384
    v_mfma_f32_16x16x32_bf16 v[4:7], v[132:135], v[172:175], v[4:7]
    ds_read_b64_tr_b16 v[96:97], v196 offset:0
    ds_read_b64_tr_b16 v[98:99], v196 offset:1024
    v_mfma_f32_16x16x32_bf16 v[36:39], v[132:135], v[176:179], v[36:39]
    ds_read_b64_tr_b16 v[100:101], v197 offset:0
    v_mfma_f32_16x16x32_bf16 v[8:11], v[136:139], v[172:175], v[8:11]
    ds_read_b64_tr_b16 v[102:103], v197 offset:1024
    ds_read_b64_tr_b16 v[104:105], v198 offset:0
    v_mfma_f32_16x16x32_bf16 v[40:43], v[136:139], v[176:179], v[40:43]
    ds_read_b64_tr_b16 v[106:107], v198 offset:1024
    v_mfma_f32_16x16x32_bf16 v[12:15], v[140:143], v[172:175], v[12:15]
    ds_read_b64_tr_b16 v[108:109], v199 offset:0
    ds_read_b64_tr_b16 v[110:111], v199 offset:1024
    v_mfma_f32_16x16x32_bf16 v[44:47], v[140:143], v[176:179], v[44:47]
    ds_read_b64_tr_b16 v[112:113], v200 offset:0
    v_mfma_f32_16x16x32_bf16 v[16:19], v[144:147], v[172:175], v[16:19]
    ds_read_b64_tr_b16 v[114:115], v200 offset:1024
    ds_read_b64_tr_b16 v[116:117], v201 offset:0
    v_mfma_f32_16x16x32_bf16 v[48:51], v[144:147], v[176:179], v[48:51]
    ds_read_b64_tr_b16 v[118:119], v201 offset:1024
    v_mfma_f32_16x16x32_bf16 v[64:67], v[144:147], v[180:183], v[64:67]
    ds_read_b64_tr_b16 v[120:121], v202 offset:0
    ds_read_b64_tr_b16 v[122:123], v202 offset:1024
    v_mfma_f32_16x16x32_bf16 v[20:23], v[148:151], v[172:175], v[20:23]
    ds_read_b64_tr_b16 v[124:125], v203 offset:0
    v_mfma_f32_16x16x32_bf16 v[52:55], v[148:151], v[176:179], v[52:55]
    ds_read_b64_tr_b16 v[126:127], v203 offset:1024
    s_add_u32 m0, s56, s58
    v_mfma_f32_16x16x32_bf16 v[68:71], v[148:151], v[180:183], v[68:71]
    s_add_u32 s30, s52, 262144
    v_mfma_f32_16x16x32_bf16 v[24:27], v[152:155], v[172:175], v[24:27]
    buffer_load_dwordx4 v206, s[12:15], s30 offen offset:0 lds
    s_add_u32 s30, s52, 293888
    v_mfma_f32_16x16x32_bf16 v[56:59], v[152:155], v[176:179], v[56:59]
    buffer_load_dwordx4 v206, s[12:15], s30 offen offset:1024 lds
    v_mfma_f32_16x16x32_bf16 v[28:31], v[156:159], v[172:175], v[28:31]
    s_add_u32 s30, s52, 325632
    buffer_load_dwordx4 v207, s[12:15], s30 offen offset:2048 lds
    v_mfma_f32_16x16x32_bf16 v[60:63], v[156:159], v[176:179], v[60:63]
    s_add_u32 s30, s52, 357376
    s_waitcnt lgkmcnt(14)
    v_mfma_f32_16x16x32_bf16 v[0:3], v[96:99], v[160:163], v[0:3]
    ds_read_b128 v[172:175], v205 offset:8192
    ds_read_b128 v[176:179], v205 offset:10240
    v_mfma_f32_16x16x32_bf16 v[32:35], v[96:99], v[164:167], v[32:35]
    ds_read_b128 v[180:183], v205 offset:16384
    s_waitcnt lgkmcnt(15)
    v_mfma_f32_16x16x32_bf16 v[4:7], v[100:103], v[160:163], v[4:7]
    ds_read_b64_tr_b16 v[128:129], v196 offset:8192
    ds_read_b64_tr_b16 v[130:131], v196 offset:9216
    v_mfma_f32_16x16x32_bf16 v[36:39], v[100:103], v[164:167], v[36:39]
    ds_read_b64_tr_b16 v[132:133], v197 offset:8192
    s_waitcnt lgkmcnt(15)
    v_mfma_f32_16x16x32_bf16 v[8:11], v[104:107], v[160:163], v[8:11]
    ds_read_b64_tr_b16 v[134:135], v197 offset:9216
    ds_read_b64_tr_b16 v[136:137], v198 offset:8192
    v_mfma_f32_16x16x32_bf16 v[40:43], v[104:107], v[164:167], v[40:43]
    ds_read_b64_tr_b16 v[138:139], v198 offset:9216
    s_waitcnt lgkmcnt(15)
    v_mfma_f32_16x16x32_bf16 v[12:15], v[108:111], v[160:163], v[12:15]
    ds_read_b64_tr_b16 v[140:141], v199 offset:8192
    ds_read_b64_tr_b16 v[142:143], v199 offset:9216
    v_mfma_f32_16x16x32_bf16 v[44:47], v[108:111], v[164:167], v[44:47]
    ds_read_b64_tr_b16 v[144:145], v200 offset:8192
    v_mfma_f32_16x16x32_bf16 v[16:19], v[112:115], v[160:163], v[16:19]
    ds_read_b64_tr_b16 v[146:147], v200 offset:9216
    ds_read_b64_tr_b16 v[148:149], v201 offset:8192
    v_mfma_f32_16x16x32_bf16 v[48:51], v[112:115], v[164:167], v[48:51]
    ds_read_b64_tr_b16 v[150:151], v201 offset:9216
    v_mfma_f32_16x16x32_bf16 v[64:67], v[112:115], v[168:171], v[64:67]
    ds_read_b64_tr_b16 v[152:153], v202 offset:8192
    ds_read_b64_tr_b16 v[154:155], v202 offset:9216
    s_waitcnt lgkmcnt(15)
    v_mfma_f32_16x16x32_bf16 v[20:23], v[116:119], v[160:163], v[20:23]
    ds_read_b64_tr_b16 v[156:157], v203 offset:8192
    v_mfma_f32_16x16x32_bf16 v[52:55], v[116:119], v[164:167], v[52:55]
    ds_read_b64_tr_b16 v[158:159], v203 offset:9216
    buffer_load_dwordx4 v207, s[12:15], s30 offen offset:3072 lds
    v_mfma_f32_16x16x32_bf16 v[68:71], v[116:119], v[168:171], v[68:71]
    s_add_u32 m0, s56, s59
    v_mfma_f32_16x16x32_bf16 v[24:27], v[120:123], v[160:163], v[24:27]
    s_add_u32 s30, s53, s60
    buffer_load_dwordx4 v208, s[16:19], s30 offen lds
    v_mfma_f32_16x16x32_bf16 v[56:59], v[120:123], v[164:167], v[56:59]
    s_add_u32 s30, s30, 9216
    v_mfma_f32_16x16x32_bf16 v[28:31], v[124:127], v[160:163], v[28:31]
    buffer_load_dwordx4 v209, s[16:19], s30 offen offset:1024 lds
    s_add_u32 s52, s52, 524288
    v_mfma_f32_16x16x32_bf16 v[60:63], v[124:127], v[164:167], v[60:63]
    s_add_u32 s53, s53, 128
K1W2_P1e:
    s_waitcnt lgkmcnt(0)
    s_mul_i32 s30, s51, 43691
    s_lshr_b32 s30, s30, 17
    s_mul_i32 s30, s30, 3
    s_cmp_eq_u32 s51, s30
    s_mov_b32 s57, 51200
    s_cselect_b32 s57, 4294864896, s57
    v_add_u32 v196, s57, v196
    v_add_u32 v197, s57, v197
    v_add_u32 v198, s57, v198
    v_add_u32 v199, s57, v199
    v_add_u32 v200, s57, v200
    v_add_u32 v201, s57, v201
    v_add_u32 v202, s57, v202
    v_add_u32 v203, s57, v203
    v_add_u32 v204, s57, v204
    v_add_u32 v205, s57, v205
    s_add_u32 s56, s56, 51200
    s_cmp_eq_u32 s56, 153600
    s_cselect_b32 s56, 0, s56
    s_add_u32 s51, s51, 1
    s_cmp_lt_u32 s51, 10
    s_cbranch_scc1 K1W2_P1
    v_mfma_f32_16x16x32_bf16 v[0:3], v[128:131], v[172:175], v[0:3]
    v_mfma_f32_16x16x32_bf16 v[32:35], v[128:131], v[176:179], v[32:35]
    v_mfma_f32_16x16x32_bf16 v[4:7], v[132:135], v[172:175], v[4:7]
    v_mfma_f32_16x16x32_bf16 v[36:39], v[132:135], v[176:179], v[36:39]
    v_mfma_f32_16x16x32_bf16 v[8:11], v[136:139], v[172:175], v[8:11]
    v_mfma_f32_16x16x32_bf16 v[40:43], v[136:139], v[176:179], v[40:43]
    v_mfma_f32_16x16x32_bf16 v[12:15], v[140:143], v[172:175], v[12:15]
    v_mfma_f32_16x16x32_bf16 v[44:47], v[140:143], v[176:179], v[44:47]
    v_mfma_f32_16x16x32_bf16 v[16:19], v[144:147], v[172:175], v[16:19]
    v_mfma_f32_16x16x32_bf16 v[48:51], v[144:147], v[176:179], v[48:51]
    v_mfma_f32_16x16x32_bf16 v[64:67], v[144:147], v[180:183], v[64:67]
    v_mfma_f32_16x16x32_bf16 v[20:23], v[148:151], v[172:175], v[20:23]
    v_mfma_f32_16x16x32_bf16 v[52:55], v[148:151], v[176:179], v[52:55]
    v_mfma_f32_16x16x32_bf16 v[68:71], v[148:151], v[180:183], v[68:71]
    v_mfma_f32_16x16x32_bf16 v[24:27], v[152:155], v[172:175], v[24:27]
    v_mfma_f32_16x16x32_bf16 v[56:59], v[152:155], v[176:179], v[56:59]
    v_mfma_f32_16x16x32_bf16 v[28:31], v[156:159], v[172:175], v[28:31]
    v_mfma_f32_16x16x32_bf16 v[60:63], v[156:159], v[176:179], v[60:63]
    s_mov_b32 s30, 1040356334
    v_mul_f32 v64, s30, v64
    v_mul_f32 v65, s30, v65
    v_mul_f32 v66, s30, v66
    v_mul_f32 v67, s30, v67
    v_mul_f32 v68, s30, v68
    v_mul_f32 v69, s30, v69
    v_mul_f32 v70, s30, v70
    v_mul_f32 v71, s30, v71
    v_cvt_pk_bf16_f32 v212, v64, v65
    v_cvt_pk_bf16_f32 v213, v66, v67
    v_cvt_pk_bf16_f32 v214, v68, v69
    v_cvt_pk_bf16_f32 v215, v70, v71
    v_cndmask_b32 v216, v212, v214, s[54:55]
    v_cndmask_b32 v217, v213, v215, s[54:55]
    v_cndmask_b32 v218, v214, v212, s[54:55]
    v_cndmask_b32 v219, v215, v213, s[54:55]
    s_lshl_b32 s31, s26, 12
    s_add_u32 s31, s31, 153600
    v_add_u32 v246, s31, v248
    ds_write_b128 v246, v[216:219] offset:2048
    v_mul_f32 v0, s30, v0
    v_mul_f32 v1, s30, v1
    v_mul_f32 v2, s30, v2
    v_mul_f32 v3, s30, v3
    v_mul_f32 v4, s30, v4
    v_mul_f32 v5, s30, v5
    v_mul_f32 v6, s30, v6
    v_mul_f32 v7, s30, v7
    v_cvt_pk_bf16_f32 v212, v0, v1
    v_cvt_pk_bf16_f32 v213, v2, v3
    v_cvt_pk_bf16_f32 v214, v4, v5
    v_cvt_pk_bf16_f32 v215, v6, v7
    v_cndmask_b32 v96, v212, v214, s[54:55]
    v_cndmask_b32 v97, v213, v215, s[54:55]
    v_cndmask_b32 v98, v214, v212, s[54:55]
    v_cndmask_b32 v99, v215, v213, s[54:55]
    v_mul_f32 v32, s30, v32
    v_mul_f32 v33, s30, v33
    v_mul_f32 v34, s30, v34
    v_mul_f32 v35, s30, v35
    v_mul_f32 v36, s30, v36
    v_mul_f32 v37, s30, v37
    v_mul_f32 v38, s30, v38
    v_mul_f32 v39, s30, v39
    v_cvt_pk_bf16_f32 v212, v32, v33
    v_cvt_pk_bf16_f32 v213, v34, v35
    v_cvt_pk_bf16_f32 v214, v36, v37
    v_cvt_pk_bf16_f32 v215, v38, v39
    v_cndmask_b32 v112, v212, v214, s[54:55]
    v_cndmask_b32 v113, v213, v215, s[54:55]
    v_cndmask_b32 v114, v214, v212, s[54:55]
    v_cndmask_b32 v115, v215, v213, s[54:55]
    v_mul_f32 v8, s30, v8
    v_mul_f32 v9, s30, v9
    v_mul_f32 v10, s30, v10
    v_mul_f32 v11, s30, v11
    v_mul_f32 v12, s30, v12
    v_mul_f32 v13, s30, v13
    v_mul_f32 v14, s30, v14
    v_mul_f32 v15, s30, v15
    v_cvt_pk_bf16_f32 v212, v8, v9
    v_cvt_pk_bf16_f32 v213, v10, v11
    v_cvt_pk_bf16_f32 v214, v12, v13
    v_cvt_pk_bf16_f32 v215, v14, v15
    v_cndmask_b32 v100, v212, v214, s[54:55]
    v_cndmask_b32 v101, v213, v215, s[54:55]
    v_cndmask_b32 v102, v214, v212, s[54:55]
    v_cndmask_b32 v103, v215, v213, s[54:55]
    v_mul_f32 v40, s30, v40
    v_mul_f32 v41, s30, v41
    v_mul_f32 v42, s30, v42
    v_mul_f32 v43, s30, v43
    v_mul_f32 v44, s30, v44
    v_mul_f32 v45, s30, v45
    v_mul_f32 v46, s30, v46
    v_mul_f32 v47, s30, v47
    v_cvt_pk_bf16_f32 v212, v40, v41
    v_cvt_pk_bf16_f32 v213, v42, v43
    v_cvt_pk_bf16_f32 v214, v44, v45
    v_cvt_pk_bf16_f32 v215, v46, v47
    v_cndmask_b32 v116, v212, v214, s[54:55]
    v_cndmask_b32 v117, v213, v215, s[54:55]
    v_cndmask_b32 v118, v214, v212, s[54:55]
    v_cndmask_b32 v119, v215, v213, s[54:55]
    v_mul_f32 v16, s30, v16
    v_mul_f32 v17, s30, v17
    v_mul_f32 v18, s30, v18
    v_mul_f32 v19, s30, v19
    v_mul_f32 v20, s30, v20
    v_mul_f32 v21, s30, v21
    v_mul_f32 v22, s30, v22
    v_mul_f32 v23, s30, v23
    v_cvt_pk_bf16_f32 v212, v16, v17
    v_cvt_pk_bf16_f32 v213, v18, v19
    v_cvt_pk_bf16_f32 v214, v20, v21
    v_cvt_pk_bf16_f32 v215, v22, v23
    v_cndmask_b32 v104, v212, v214, s[54:55]
    v_cndmask_b32 v105, v213, v215, s[54:55]
    v_cndmask_b32 v106, v214, v212, s[54:55]
    v_cndmask_b32 v107, v215, v213, s[54:55]
    v_mul_f32 v48, s30, v48
    v_mul_f32 v49, s30, v49
    v_mul_f32 v50, s30, v50
    v_mul_f32 v51, s30, v51
    v_mul_f32 v52, s30, v52
    v_mul_f32 v53, s30, v53
    v_mul_f32 v54, s30, v54
    v_mul_f32 v55, s30, v55
    v_cvt_pk_bf16_f32 v212, v48, v49
    v_cvt_pk_bf16_f32 v213, v50, v51
    v_cvt_pk_bf16_f32 v214, v52, v53
    v_cvt_pk_bf16_f32 v215, v54, v55
    v_cndmask_b32 v120, v212, v214, s[54:55]
    v_cndmask_b32 v121, v213, v215, s[54:55]
    v_cndmask_b32 v122, v214, v212, s[54:55]
    v_cndmask_b32 v123, v215, v213, s[54:55]
    v_mul_f32 v24, s30, v24
    v_mul_f32 v25, s30, v25
    v_mul_f32 v26, s30, v26
    v_mul_f32 v27, s30, v27
    v_mul_f32 v28, s30, v28
    v_mul_f32 v29, s30, v29
    v_mul_f32 v30, s30, v30
    v_mul_f32 v31, s30, v31
    v_cvt_pk_bf16_f32 v212, v24, v25
    v_cvt_pk_bf16_f32 v213, v26, v27
    v_cvt_pk_bf16_f32 v214, v28, v29
    v_cvt_pk_bf16_f32 v215, v30, v31
    v_cndmask_b32 v108, v212, v214, s[54:55]
    v_cndmask_b32 v109, v213, v215, s[54:55]
    v_cndmask_b32 v110, v214, v212, s[54:55]
    v_cndmask_b32 v111, v215, v213, s[54:55]
    v_mul_f32 v56, s30, v56
    v_mul_f32 v57, s30, v57
    v_mul_f32 v58, s30, v58
    v_mul_f32 v59, s30, v59
    v_mul_f32 v60, s30, v60
    v_mul_f32 v61, s30, v61
    v_mul_f32 v62, s30, v62
    v_mul_f32 v63, s30, v63
    v_cvt_pk_bf16_f32 v212, v56, v57
    v_cvt_pk_bf16_f32 v213, v58, v59
    v_cvt_pk_bf16_f32 v214, v60, v61
    v_cvt_pk_bf16_f32 v215, v62, v63
    v_cndmask_b32 v124, v212, v214, s[54:55]
    v_cndmask_b32 v125, v213, v215, s[54:55]
    v_cndmask_b32 v126, v214, v212, s[54:55]
    v_cndmask_b32 v127, v215, v213, s[54:55]
    s_waitcnt lgkmcnt(0)
    s_waitcnt vmcnt(2)
    s_barrier
    ds_read_b128 v[128:131], v246 offset:0
    ds_read_b128 v[132:135], v246 offset:1024
    ds_read_b128 v[136:139], v246 offset:2048
    ds_read_b128 v[140:143], v246 offset:3072
    v_mov_b32 v0, 0
    v_mov_b32 v1, 0
    v_mov_b32 v2, 0
    v_mov_b32 v3, 0
    v_mov_b32 v4, 0
    v_mov_b32 v5, 0
    v_mov_b32 v6, 0
    v_mov_b32 v7, 0
    v_mov_b32 v8, 0
    v_mov_b32 v9, 0
    v_mov_b32 v10, 0
    v_mov_b32 v11, 0
    v_mov_b32 v12, 0
    v_mov_b32 v13, 0
    v_mov_b32 v14, 0
    v_mov_b32 v15, 0
    v_mov_b32 v16, 0
    v_mov_b32 v17, 0
    v_mov_b32 v18, 0
    v_mov_b32 v19, 0
    v_mov_b32 v20, 0
    v_mov_b32 v21, 0
    v_mov_b32 v22, 0
    v_mov_b32 v23, 0
    v_mov_b32 v24, 0
    v_mov_b32 v25, 0
    v_mov_b32 v26, 0
    v_mov_b32 v27, 0
    v_mov_b32 v28, 0
    v_mov_b32 v29, 0
    v_mov_b32 v30, 0
    v_mov_b32 v31, 0
    v_mov_b32 v32, 0
    v_mov_b32 v33, 0
    v_mov_b32 v34, 0
    v_mov_b32 v35, 0
    v_mov_b32 v36, 0
    v_mov_b32 v37, 0
    v_mov_b32 v38, 0
    v_mov_b32 v39, 0
    v_mov_b32 v40, 0
    v_mov_b32 v41, 0
    v_mov_b32 v42, 0
    v_mov_b32 v43, 0
    v_mov_b32 v44, 0
    v_mov_b32 v45, 0
    v_mov_b32 v46, 0
    v_mov_b32 v47, 0
    v_mov_b32 v48, 0
    v_mov_b32 v49, 0
    v_mov_b32 v50, 0
    v_mov_b32 v51, 0
    v_mov_b32 v52, 0
    v_mov_b32 v53, 0
    v_mov_b32 v54, 0
    v_mov_b32 v55, 0
    v_mov_b32 v56, 0
    v_mov_b32 v57, 0
    v_mov_b32 v58, 0
    v_mov_b32 v59, 0
    v_mov_b32 v60, 0
    v_mov_b32 v61, 0
    v_mov_b32 v62, 0
    v_mov_b32 v63, 0
    v_mov_b32 v64, 0
    v_mov_b32 v65, 0
    v_mov_b32 v66, 0
    v_mov_b32 v67, 0
    v_mov_b32 v68, 0
    v_mov_b32 v69, 0
    v_mov_b32 v70, 0
    v_mov_b32 v71, 0
    v_mov_b32 v72, 0
    v_mov_b32 v73, 0
    v_mov_b32 v74, 0
    v_mov_b32 v75, 0
    v_mov_b32 v76, 0
    v_mov_b32 v77, 0
    v_mov_b32 v78, 0
    v_mov_b32 v79, 0
    v_mov_b32 v80, 0
    v_mov_b32 v81, 0
    v_mov_b32 v82, 0
    v_mov_b32 v83, 0
    v_mov_b32 v84, 0
    v_mov_b32 v85, 0
    v_mov_b32 v86, 0
    v_mov_b32 v87, 0
    v_mov_b32 v88, 0
    v_mov_b32 v89, 0
    v_mov_b32 v90, 0
    v_mov_b32 v91, 0
    v_mov_b32 v92, 0
    v_mov_b32 v93, 0
    v_mov_b32 v94, 0
    v_mov_b32 v95, 0
    v_mov_b32 v228, 0
    v_mov_b32 v229, 0
    v_mov_b32 v230, 0
    v_mov_b32 v180, 0
    v_mov_b32 v181, 0
    v_mov_b32 v182, 0
    v_mov_b32 v183, 0
    s_waitcnt lgkmcnt(0)
    s_cmp_eq_u32 s26, 0
    s_cselect_b32 s30, 2113536, 0
    s_add_u32 s31, s30, 24576
    v_add_u32 v241, s31, v241
    s_cmp_eq_u32 s26, 0
    s_cselect_b32 s30, 2097152, 0
    s_add_u32 s31, s30, 24576
    v_add_u32 v242, s31, v242
    s_mov_b32 s27, 0
    s_cmp_eq_u32 s26, 0
    s_cbranch_scc1 K1W2_RND
    s_mov_b32 s28, 24576
    s_mov_b32 m0, s28
    v_xor_b32 v243, 64, v241
    buffer_load_dwordx4 v241, s[4:7], 0 offen nt lds
    v_xor_b32 v244, 128, v241
    buffer_load_dwordx4 v243, s[4:7], 0 offen offset:1024 nt lds
    v_xor_b32 v243, 192, v241
    buffer_load_dwordx4 v244, s[4:7], 0 offen offset:2048 nt lds
    buffer_load_dwordx4 v243, s[4:7], 0 offen offset:3072 nt lds
    v_add_u32 v241, 16384, v241
K1W2_RND:
    v_add_u32 v238, 16384, v238
    s_mov_b32 s29, 73728
K1W2_ROUND:
    s_mov_b32 s25, 0
    s_cmp_eq_u32 s26, s27
    s_cbranch_scc0 K1W2_LDR
    s_mov_b32 s57, s27
    s_mul_i32 s30, s27, 16384
    v_add_u32 v234, s30, v234
    v_add_u32 v235, s30, v235
    v_add_u32 v236, s30, v236
    v_add_u32 v237, s30, v237
    s_nop 1
K1W2_LOOP:
    s_cmp_eq_u32 s25, 0
    s_cbranch_scc1 K1W2_A1a
    s_waitcnt vmcnt(0) lgkmcnt(0)
    s_barrier
    s_branch K1W2_A1b
K1W2_A1a:
    s_waitcnt vmcnt(8) lgkmcnt(0)
    s_barrier
    ds_read_b128 v[196:199], v234
    ds_read_b128 v[200:203], v235
    ds_read_b128 v[204:207], v236
    ds_read_b128 v[208:211], v237
    s_waitcnt lgkmcnt(3)
    v_mfma_f32_16x16x32_bf16 v[144:147], v[196:199], v[96:99], 0
    v_mfma_f32_16x16x32_bf16 v[160:163], v[196:199], v[112:115], 0
    v_mfma_f32_16x16x32_bf16 v[176:179], v[196:199], v[128:131], 0
    s_waitcnt lgkmcnt(2)
    v_mfma_f32_16x16x32_bf16 v[144:147], v[200:203], v[100:103], v[144:147]
    v_mfma_f32_16x16x32_bf16 v[160:163], v[200:203], v[116:119], v[160:163]
    v_mfma_f32_16x16x32_bf16 v[176:179], v[200:203], v[132:135], v[176:179]
    s_waitcnt lgkmcnt(1)
    v_mfma_f32_16x16x32_bf16 v[144:147], v[204:207], v[104:107], v[144:147]
    v_mfma_f32_16x16x32_bf16 v[160:163], v[204:207], v[120:123], v[160:163]
    v_mfma_f32_16x16x32_bf16 v[176:179], v[204:207], v[136:139], v[176:179]
    s_waitcnt lgkmcnt(0)
    v_mfma_f32_16x16x32_bf16 v[144:147], v[208:211], v[108:111], v[144:147]
    v_mfma_f32_16x16x32_bf16 v[160:163], v[208:211], v[124:127], v[160:163]
    v_mfma_f32_16x16x32_bf16 v[176:179], v[208:211], v[140:143], v[176:179]
    s_nop 5
    v_max3_f32 v243, v144, v145, v146
    v_max_f32 v243, v243, v147
    v_mov_b32 v244, v243
    s_nop 1
    v_permlane16_swap_b32 v244, v243
    v_max_f32 v243, v243, v244
    v_mov_b32 v244, v243
    s_nop 1
    v_permlane32_swap_b32 v244, v243
    v_max_f32 v243, v243, v244
    v_sub_f32 v184, 0, v243
    v_sub_f32 v185, 0, v243
    v_sub_f32 v186, 0, v243
    v_sub_f32 v187, 0, v243
    v_max3_f32 v243, v160, v161, v162
    v_max_f32 v243, v243, v163
    v_mov_b32 v244, v243
    s_nop 1
    v_permlane16_swap_b32 v244, v243
    v_max_f32 v243, v243, v244
    v_mov_b32 v244, v243
    s_nop 1
    v_permlane32_swap_b32 v244, v243
    v_max_f32 v243, v243, v244
    v_sub_f32 v188, 0, v243
    v_sub_f32 v189, 0, v243
    v_sub_f32 v190, 0, v243
    v_sub_f32 v191, 0, v243
    v_max3_f32 v243, v176, v177, v178
    v_max_f32 v243, v243, v179
    v_mov_b32 v244, v243
    s_nop 1
    v_permlane16_swap_b32 v244, v243
    v_max_f32 v243, v243, v244
    v_mov_b32 v244, v243
    s_nop 1
    v_permlane32_swap_b32 v244, v243
    v_max_f32 v243, v243, v244
    v_sub_f32 v192, 0, v243
    v_sub_f32 v193, 0, v243
    v_sub_f32 v194, 0, v243
    v_sub_f32 v195, 0, v243
    s_nop 3
K1W2_A1b:
    ds_read_b128 v[196:199], v234 offset:0
    ds_read_b128 v[200:203], v235 offset:0
    ds_read_b128 v[204:207], v236 offset:0
    ds_read_b128 v[208:211], v237 offset:0
    ds_read_b128 v[212:215], v234 offset:4096
    ds_read_b128 v[216:219], v235 offset:4096
    ds_read_b128 v[220:223], v236 offset:4096
    ds_read_b128 v[224:227], v237 offset:4096
    s_waitcnt lgkmcnt(7)
    v_mfma_f32_16x16x32_bf16 v[144:147], v[196:199], v[96:99], v[184:187]
    v_mfma_f32_16x16x32_bf16 v[160:163], v[196:199], v[112:115], v[188:191]
    v_mfma_f32_16x16x32_bf16 v[176:179], v[196:199], v[128:131], v[192:195]
    s_waitcnt lgkmcnt(6)
    v_mfma_f32_16x16x32_bf16 v[144:147], v[200:203], v[100:103], v[144:147]
    v_mfma_f32_16x16x32_bf16 v[160:163], v[200:203], v[116:119], v[160:163]
    v_mfma_f32_16x16x32_bf16 v[176:179], v[200:203], v[132:135], v[176:179]
    s_waitcnt lgkmcnt(5)
    v_mfma_f32_16x16x32_bf16 v[144:147], v[204:207], v[104:107], v[144:147]
    v_mfma_f32_16x16x32_bf16 v[160:163], v[204:207], v[120:123], v[160:163]
    v_mfma_f32_16x16x32_bf16 v[176:179], v[204:207], v[136:139], v[176:179]
    s_waitcnt lgkmcnt(4)
    v_mfma_f32_16x16x32_bf16 v[144:147], v[208:211], v[108:111], v[144:147]
    v_mfma_f32_16x16x32_bf16 v[160:163], v[208:211], v[124:127], v[160:163]
    v_mfma_f32_16x16x32_bf16 v[176:179], v[208:211], v[140:143], v[176:179]
    s_waitcnt lgkmcnt(3)
    v_mfma_f32_16x16x32_bf16 v[148:151], v[212:215], v[96:99], v[184:187]
    v_mfma_f32_16x16x32_bf16 v[164:167], v[212:215], v[112:115], v[188:191]
    ds_read_b128 v[196:199], v234 offset:8192
    ds_read_b128 v[200:203], v235 offset:8192
    v_mfma_f32_16x16x32_bf16 v[180:183], v[212:215], v[128:131], v[192:195]
    ds_read_b128 v[204:207], v236 offset:8192
    s_waitcnt lgkmcnt(5)
    v_mfma_f32_16x16x32_bf16 v[148:151], v[216:219], v[100:103], v[148:151]
    ds_read_b128 v[208:211], v237 offset:8192
    v_exp_f32 v144, v144
    v_mfma_f32_16x16x32_bf16 v[164:167], v[216:219], v[116:119], v[164:167]
    v_exp_f32 v145, v145
    v_mfma_f32_16x16x32_bf16 v[180:183], v[216:219], v[132:135], v[180:183]
    v_exp_f32 v146, v146
    v_exp_f32 v147, v147
    s_waitcnt lgkmcnt(5)
    v_mfma_f32_16x16x32_bf16 v[148:151], v[220:223], v[104:107], v[148:151]
    v_exp_f32 v160, v160
    v_mfma_f32_16x16x32_bf16 v[164:167], v[220:223], v[120:123], v[164:167]
    v_exp_f32 v161, v161
    v_exp_f32 v162, v162
    v_mfma_f32_16x16x32_bf16 v[180:183], v[220:223], v[136:139], v[180:183]
    v_exp_f32 v163, v163
    s_waitcnt lgkmcnt(4)
    v_mfma_f32_16x16x32_bf16 v[148:151], v[224:227], v[108:111], v[148:151]
    v_exp_f32 v176, v176
    v_exp_f32 v177, v177
    v_mfma_f32_16x16x32_bf16 v[164:167], v[224:227], v[124:127], v[164:167]
    v_exp_f32 v178, v178
    v_mfma_f32_16x16x32_bf16 v[180:183], v[224:227], v[140:143], v[180:183]
    v_exp_f32 v179, v179
    s_waitcnt lgkmcnt(3)
    v_mfma_f32_16x16x32_bf16 v[152:155], v[196:199], v[96:99], v[184:187]
    v_mfma_f32_16x16x32_bf16 v[168:171], v[196:199], v[112:115], v[188:191]
    ds_read_b128 v[212:215], v234 offset:12288
    ds_read_b128 v[216:219], v235 offset:12288
    ds_read_b128 v[220:223], v236 offset:12288
    ds_read_b128 v[224:227], v237 offset:12288
    s_waitcnt lgkmcnt(6)
    v_mfma_f32_16x16x32_bf16 v[152:155], v[200:203], v[100:103], v[152:155]
    v_exp_f32 v148, v148
    v_exp_f32 v149, v149
    v_exp_f32 v150, v150
    v_exp_f32 v151, v151
    v_mfma_f32_16x16x32_bf16 v[168:171], v[200:203], v[116:119], v[168:171]
    v_exp_f32 v164, v164
    v_exp_f32 v165, v165
    v_exp_f32 v166, v166
    s_waitcnt lgkmcnt(5)
    v_mfma_f32_16x16x32_bf16 v[152:155], v[204:207], v[104:107], v[152:155]
    v_exp_f32 v167, v167
    v_exp_f32 v180, v180
    v_exp_f32 v181, v181
    v_exp_f32 v182, v182
    v_mfma_f32_16x16x32_bf16 v[168:171], v[204:207], v[120:123], v[168:171]
    v_exp_f32 v183, v183
    v_add_f32 v231, v144, v145
    v_add_f32 v231, v231, v146
    s_waitcnt lgkmcnt(4)
    v_mfma_f32_16x16x32_bf16 v[152:155], v[208:211], v[108:111], v[152:155]
    v_add_f32 v231, v231, v147
    v_add_f32 v232, v160, v161
    v_add_f32 v232, v232, v162
    v_add_f32 v232, v232, v163
    v_mfma_f32_16x16x32_bf16 v[168:171], v[208:211], v[124:127], v[168:171]
    v_add_f32 v233, v176, v177
    v_add_f32 v233, v233, v178
    v_add_f32 v233, v233, v179
    s_waitcnt lgkmcnt(3)
    v_mfma_f32_16x16x32_bf16 v[156:159], v[212:215], v[96:99], v[184:187]
    v_add_f32 v231, v231, v148
    v_add_f32 v231, v231, v149
    v_add_f32 v231, v231, v150
    v_mfma_f32_16x16x32_bf16 v[172:175], v[212:215], v[112:115], v[188:191]
    v_add_f32 v231, v231, v151
    v_add_f32 v232, v232, v164
    v_add_f32 v232, v232, v165
    s_waitcnt lgkmcnt(2)
    v_mfma_f32_16x16x32_bf16 v[156:159], v[216:219], v[100:103], v[156:159]
    v_add_f32 v232, v232, v166
    v_add_f32 v232, v232, v167
    v_add_f32 v233, v233, v180
    v_mfma_f32_16x16x32_bf16 v[172:175], v[216:219], v[116:119], v[172:175]
    v_add_f32 v233, v233, v181
    v_add_f32 v233, v233, v182
    v_add_f32 v233, v233, v183
    s_waitcnt lgkmcnt(1)
    v_mfma_f32_16x16x32_bf16 v[156:159], v[220:223], v[104:107], v[156:159]
    v_cvt_pk_bf16_f32 v144, v144, v145
    v_cvt_pk_bf16_f32 v145, v146, v147
    v_cvt_pk_bf16_f32 v146, v148, v149
    v_mfma_f32_16x16x32_bf16 v[172:175], v[220:223], v[120:123], v[172:175]
    v_cvt_pk_bf16_f32 v147, v150, v151
    v_cvt_pk_bf16_f32 v160, v160, v161
    v_cvt_pk_bf16_f32 v161, v162, v163
    s_waitcnt lgkmcnt(0)
    v_mfma_f32_16x16x32_bf16 v[156:159], v[224:227], v[108:111], v[156:159]
    v_cvt_pk_bf16_f32 v162, v164, v165
    v_cvt_pk_bf16_f32 v163, v166, v167
    v_cvt_pk_bf16_f32 v176, v176, v177
    v_mfma_f32_16x16x32_bf16 v[172:175], v[224:227], v[124:127], v[172:175]
    v_cvt_pk_bf16_f32 v177, v178, v179
    v_cvt_pk_bf16_f32 v178, v180, v181
    v_cvt_pk_bf16_f32 v179, v182, v183
    v_add_f32 v243, v231, v232
    v_add_f32 v243, v243, v233
    v_cmp_ngt_f32 vcc, s50, v243
    s_cbranch_vccnz K1W2_slow0
K1W2_back0:
    v_add_f32 v228, v228, v231
    v_add_f32 v229, v229, v232
    v_add_f32 v230, v230, v233
    s_cmp_eq_u32 s25, 0
    s_cbranch_scc1 K1W2_A2a
    s_waitcnt vmcnt(0) lgkmcnt(0)
    s_branch K1W2_A2b
K1W2_A2a:
    s_waitcnt vmcnt(4) lgkmcnt(0)
K1W2_A2b:
    s_barrier
    ds_read_b64_tr_b16 v[196:197], v238 offset:0
    ds_read_b64_tr_b16 v[198:199], v238 offset:4096
    v_xor_b32 v240, 32, v238
    ds_read_b64_tr_b16 v[200:201], v240 offset:0
    ds_read_b64_tr_b16 v[202:203], v240 offset:4096
    v_xor_b32 v239, 64, v238
    ds_read_b64_tr_b16 v[204:205], v239 offset:0
    ds_read_b64_tr_b16 v[206:207], v239 offset:4096
    v_xor_b32 v240, 96, v238
    ds_read_b64_tr_b16 v[208:209], v240 offset:0
    ds_read_b64_tr_b16 v[210:211], v240 offset:4096
    v_xor_b32 v239, 128, v238
    ds_read_b64_tr_b16 v[212:213], v239 offset:0
    ds_read_b64_tr_b16 v[214:215], v239 offset:4096
    v_xor_b32 v240, 160, v238
    ds_read_b64_tr_b16 v[216:217], v240 offset:0
    ds_read_b64_tr_b16 v[218:219], v240 offset:4096
    v_xor_b32 v239, 192, v238
    ds_read_b64_tr_b16 v[220:221], v239 offset:0
    ds_read_b64_tr_b16 v[222:223], v239 offset:4096
    v_xor_b32 v240, 224, v238
    ds_read_b64_tr_b16 v[224:225], v240 offset:0
    ds_read_b64_tr_b16 v[226:227], v240 offset:4096
    v_exp_f32 v152, v152
    v_exp_f32 v153, v153
    v_exp_f32 v154, v154
    v_exp_f32 v155, v155
    v_exp_f32 v168, v168
    v_exp_f32 v169, v169
    v_exp_f32 v170, v170
    v_exp_f32 v171, v171
    s_waitcnt lgkmcnt(14)
    v_mfma_f32_16x16x32_bf16 v[0:3], v[196:199], v[144:147], v[0:3]
    v_exp_f32 v156, v156
    v_mfma_f32_16x16x32_bf16 v[32:35], v[196:199], v[160:163], v[32:35]
    v_exp_f32 v157, v157
    v_mfma_f32_16x16x32_bf16 v[64:67], v[196:199], v[176:179], v[64:67]
    v_exp_f32 v158, v158
    ds_read_b64_tr_b16 v[196:197], v238 offset:8192
    ds_read_b64_tr_b16 v[198:199], v238 offset:12288
    s_waitcnt lgkmcnt(14)
    v_mfma_f32_16x16x32_bf16 v[4:7], v[200:203], v[144:147], v[4:7]
    v_exp_f32 v159, v159
    v_exp_f32 v172, v172
    v_mfma_f32_16x16x32_bf16 v[36:39], v[200:203], v[160:163], v[36:39]
    v_exp_f32 v173, v173
    v_mfma_f32_16x16x32_bf16 v[68:71], v[200:203], v[176:179], v[68:71]
    v_exp_f32 v174, v174
    v_xor_b32 v240, 32, v238
    ds_read_b64_tr_b16 v[200:201], v240 offset:8192
    ds_read_b64_tr_b16 v[202:203], v240 offset:12288
    s_waitcnt lgkmcnt(14)
    v_mfma_f32_16x16x32_bf16 v[8:11], v[204:207], v[144:147], v[8:11]
    v_exp_f32 v175, v175
    v_add_f32 v231, v152, v153
    v_mfma_f32_16x16x32_bf16 v[40:43], v[204:207], v[160:163], v[40:43]
    v_add_f32 v231, v231, v154
    v_mfma_f32_16x16x32_bf16 v[72:75], v[204:207], v[176:179], v[72:75]
    v_add_f32 v231, v231, v155
    v_xor_b32 v239, 64, v238
    ds_read_b64_tr_b16 v[204:205], v239 offset:8192
    ds_read_b64_tr_b16 v[206:207], v239 offset:12288
    s_waitcnt lgkmcnt(14)
    v_mfma_f32_16x16x32_bf16 v[12:15], v[208:211], v[144:147], v[12:15]
    v_add_f32 v232, v168, v169
    v_add_f32 v232, v232, v170
    v_mfma_f32_16x16x32_bf16 v[44:47], v[208:211], v[160:163], v[44:47]
    v_add_f32 v232, v232, v171
    v_mfma_f32_16x16x32_bf16 v[76:79], v[208:211], v[176:179], v[76:79]
    v_add_f32 v231, v231, v156
    v_xor_b32 v240, 96, v238
    ds_read_b64_tr_b16 v[208:209], v240 offset:8192
    ds_read_b64_tr_b16 v[210:211], v240 offset:12288
    s_waitcnt lgkmcnt(14)
    v_mfma_f32_16x16x32_bf16 v[16:19], v[212:215], v[144:147], v[16:19]
    v_add_f32 v231, v231, v157
    v_mfma_f32_16x16x32_bf16 v[48:51], v[212:215], v[160:163], v[48:51]
    v_add_f32 v231, v231, v158
    v_mfma_f32_16x16x32_bf16 v[80:83], v[212:215], v[176:179], v[80:83]
    v_add_f32 v231, v231, v159
    v_xor_b32 v239, 128, v238
    ds_read_b64_tr_b16 v[212:213], v239 offset:8192
    ds_read_b64_tr_b16 v[214:215], v239 offset:12288
    s_waitcnt lgkmcnt(14)
    v_mfma_f32_16x16x32_bf16 v[20:23], v[216:219], v[144:147], v[20:23]
    v_add_f32 v232, v232, v172
    v_add_f32 v232, v232, v173
    v_mfma_f32_16x16x32_bf16 v[52:55], v[216:219], v[160:163], v[52:55]
    v_add_f32 v232, v232, v174
    v_mfma_f32_16x16x32_bf16 v[84:87], v[216:219], v[176:179], v[84:87]
    v_add_f32 v232, v232, v175
    v_xor_b32 v240, 160, v238
    ds_read_b64_tr_b16 v[216:217], v240 offset:8192
    ds_read_b64_tr_b16 v[218:219], v240 offset:12288
    s_waitcnt lgkmcnt(14)
    v_mfma_f32_16x16x32_bf16 v[24:27], v[220:223], v[144:147], v[24:27]
    v_cvt_pk_bf16_f32 v148, v152, v153
    v_cvt_pk_bf16_f32 v149, v154, v155
    v_mfma_f32_16x16x32_bf16 v[56:59], v[220:223], v[160:163], v[56:59]
    v_cvt_pk_bf16_f32 v150, v156, v157
    v_mfma_f32_16x16x32_bf16 v[88:91], v[220:223], v[176:179], v[88:91]
    v_cvt_pk_bf16_f32 v151, v158, v159
    v_xor_b32 v239, 192, v238
    ds_read_b64_tr_b16 v[220:221], v239 offset:8192
    ds_read_b64_tr_b16 v[222:223], v239 offset:12288
    s_waitcnt lgkmcnt(14)
    v_mfma_f32_16x16x32_bf16 v[28:31], v[224:227], v[144:147], v[28:31]
    v_cvt_pk_bf16_f32 v164, v168, v169
    v_cvt_pk_bf16_f32 v165, v170, v171
    v_mfma_f32_16x16x32_bf16 v[60:63], v[224:227], v[160:163], v[60:63]
    v_cvt_pk_bf16_f32 v166, v172, v173
    v_mfma_f32_16x16x32_bf16 v[92:95], v[224:227], v[176:179], v[92:95]
    v_cvt_pk_bf16_f32 v167, v174, v175
    v_xor_b32 v240, 224, v238
    ds_read_b64_tr_b16 v[224:225], v240 offset:8192
    ds_read_b64_tr_b16 v[226:227], v240 offset:12288
    v_add_f32 v243, v231, v232
    v_cmp_ngt_f32 vcc, s50, v243
    s_cbranch_vccnz K1W2_slow1
K1W2_back1:
    v_add_f32 v228, v228, v231
    v_add_f32 v229, v229, v232
    s_waitcnt lgkmcnt(14)
    v_mfma_f32_16x16x32_bf16 v[0:3], v[196:199], v[148:151], v[0:3]
    v_mfma_f32_16x16x32_bf16 v[32:35], v[196:199], v[164:167], v[32:35]
    s_waitcnt lgkmcnt(12)
    v_mfma_f32_16x16x32_bf16 v[4:7], v[200:203], v[148:151], v[4:7]
    v_mfma_f32_16x16x32_bf16 v[36:39], v[200:203], v[164:167], v[36:39]
    s_waitcnt lgkmcnt(10)
    v_mfma_f32_16x16x32_bf16 v[8:11], v[204:207], v[148:151], v[8:11]
    v_mfma_f32_16x16x32_bf16 v[40:43], v[204:207], v[164:167], v[40:43]
    s_waitcnt lgkmcnt(8)
    v_mfma_f32_16x16x32_bf16 v[12:15], v[208:211], v[148:151], v[12:15]
    v_mfma_f32_16x16x32_bf16 v[44:47], v[208:211], v[164:167], v[44:47]
    s_waitcnt lgkmcnt(6)
    v_mfma_f32_16x16x32_bf16 v[16:19], v[212:215], v[148:151], v[16:19]
    v_mfma_f32_16x16x32_bf16 v[48:51], v[212:215], v[164:167], v[48:51]
    s_waitcnt lgkmcnt(4)
    v_mfma_f32_16x16x32_bf16 v[20:23], v[216:219], v[148:151], v[20:23]
    v_mfma_f32_16x16x32_bf16 v[52:55], v[216:219], v[164:167], v[52:55]
    s_waitcnt lgkmcnt(2)
    v_mfma_f32_16x16x32_bf16 v[24:27], v[220:223], v[148:151], v[24:27]
    v_mfma_f32_16x16x32_bf16 v[56:59], v[220:223], v[164:167], v[56:59]
    s_waitcnt lgkmcnt(0)
    v_mfma_f32_16x16x32_bf16 v[28:31], v[224:227], v[148:151], v[28:31]
    v_mfma_f32_16x16x32_bf16 v[60:63], v[224:227], v[164:167], v[60:63]
    s_cmp_eq_u32 s57, 0
    s_cselect_b32 s60, 16384, 0
    s_cmp_eq_u32 s57, 1
    s_cselect_b32 s60, 32768, s60
    s_cmp_eq_u32 s57, 2
    s_cselect_b32 s60, 4294918144, s60
    s_cselect_b32 s57, -1, s57
    s_add_u32 s57, s57, 1
    v_add_u32 v234, s60, v234
    v_add_u32 v235, s60, v235
    v_add_u32 v236, s60, v236
    v_add_u32 v237, s60, v237
    v_xor_b32 v238, 98304, v238
    s_add_u32 s25, s25, 1
    s_cmp_lt_u32 s25, 16
    s_cbranch_scc1 K1W2_LOOP
    s_cmp_eq_u32 s27, 1
    s_cbranch_scc1 K1W2_FINAL1
    s_mov_b32 s27, 1
    s_branch K1W2_ROUND
K1W2_LDR:
    s_nop 1
    s_and_b32 s51, s2, 1
    s_cmp_eq_u32 s27, 0
    s_cbranch_scc1 K1W2_LR0
K1W2_LR0:
    s_cmp_eq_u32 s27, 0
    s_cselect_b32 s57, 2, 0
    s_mov_b32 s28, 8192
    s_cselect_b32 s28, 57344, s28
    s_mov_b32 s45, 0
K1W2_LLOOP:
    s_mov_b32 s46, s45
    s_mov_b32 s45, 0
    s_cmp_eq_u32 s46, 0
    s_cbranch_scc0 K1W2_XW1_1
    s_waitcnt vmcnt(8) lgkmcnt(0)
    s_branch K1W2_XW1_z
K1W2_XW1_1:
    s_cmp_eq_u32 s46, 1
    s_cbranch_scc0 K1W2_XW1_2
    s_waitcnt vmcnt(9) lgkmcnt(0)
    s_branch K1W2_XW1_z
K1W2_XW1_2:
    s_cmp_eq_u32 s46, 2
    s_cbranch_scc0 K1W2_XW1_3
    s_waitcnt vmcnt(10) lgkmcnt(0)
    s_branch K1W2_XW1_z
K1W2_XW1_3:
    s_waitcnt vmcnt(11) lgkmcnt(0)
K1W2_XW1_z:
    s_barrier
    s_cmp_eq_u32 s27, 0
    s_cbranch_scc0 K1W2_L0
    s_cmp_eq_u32 s25, 15
    s_cbranch_scc0 K1W2_L0
    v_add_u32 v242, 1835008, v242
K1W2_L0:
    s_mov_b32 m0, s29
    v_xor_b32 v243, 128, v242
    buffer_load_dwordx4 v242, s[8:11], 0 offen nt lds
    buffer_load_dwordx4 v243, s[8:11], 0 offen offset:1024 nt lds
    buffer_load_dwordx4 v242, s[8:11], 0 offen offset:2048 nt lds
    buffer_load_dwordx4 v243, s[8:11], 0 offen offset:3072 nt lds
    v_add_u32 v242, 16384, v242
    s_xor_b32 s29, s29, 98304
    s_cmp_eq_u32 s27, 1
    s_cbranch_scc0 K1W2_L1
    s_cmp_eq_u32 s25, 0
    s_cbranch_scc0 K1W2_E0
    s_nop 7
    v_add_u32 v246, 81920, v248
    v_and_b32 v247, 15, v245
    v_lshlrev_b32 v247, 2, v247
    v_add_u32 v247, 114688, v247
    ds_write_b128 v246, v[64:67] offset:0
    ds_write_b128 v246, v[68:71] offset:1024
    ds_write_b128 v246, v[72:75] offset:2048
    ds_write_b128 v246, v[76:79] offset:3072
    ds_write_b128 v246, v[80:83] offset:4096
    ds_write_b128 v246, v[84:87] offset:5120
    ds_write_b128 v246, v[88:91] offset:6144
    ds_write_b128 v246, v[92:95] offset:7168
    v_mov_b32 v244, v230
    s_nop 1
    v_permlane16_swap_b32 v244, v230
    v_add_f32 v230, v230, v244
    v_mov_b32 v244, v230
    s_nop 1
    v_permlane32_swap_b32 v244, v230
    v_add_f32 v230, v230, v244
    v_sub_f32 v244, 0, v192
    ds_write_b32 v247, v244 offset:0
    ds_write_b32 v247, v230 offset:64
    v_mov_b32 v244, v228
    s_nop 1
    v_permlane16_swap_b32 v244, v228
    v_add_f32 v228, v228, v244
    v_mov_b32 v244, v228
    s_nop 1
    v_permlane32_swap_b32 v244, v228
    v_add_f32 v228, v228, v244
    v_mov_b32 v244, v229
    s_nop 1
    v_permlane16_swap_b32 v244, v229
    v_add_f32 v229, v229, v244
    v_mov_b32 v244, v229
    s_nop 1
    v_permlane32_swap_b32 v244, v229
    v_add_f32 v229, v229, v244
    v_rcp_f32 v228, v228
    v_rcp_f32 v229, v229
    s_waitcnt lgkmcnt(0)
    s_branch K1W2_L1
K1W2_E0:
    s_cmp_eq_u32 s25, 1
    s_cbranch_scc0 K1W2_E1
    s_nop 1
    v_mul_f32 v0, v0, v228
    v_mul_f32 v1, v1, v228
    v_mul_f32 v2, v2, v228
    v_mul_f32 v3, v3, v228
    v_mul_f32 v4, v4, v228
    v_mul_f32 v5, v5, v228
    v_mul_f32 v6, v6, v228
    v_mul_f32 v7, v7, v228
    v_cvt_pk_bf16_f32 v96, v0, v1
    v_cvt_pk_bf16_f32 v97, v2, v3
    v_cvt_pk_bf16_f32 v98, v4, v5
    v_cvt_pk_bf16_f32 v99, v6, v7
    v_mul_f32 v8, v8, v228
    v_mul_f32 v9, v9, v228
    v_mul_f32 v10, v10, v228
    v_mul_f32 v11, v11, v228
    v_mul_f32 v12, v12, v228
    v_mul_f32 v13, v13, v228
    v_mul_f32 v14, v14, v228
    v_mul_f32 v15, v15, v228
    v_cvt_pk_bf16_f32 v100, v8, v9
    v_cvt_pk_bf16_f32 v101, v10, v11
    v_cvt_pk_bf16_f32 v102, v12, v13
    v_cvt_pk_bf16_f32 v103, v14, v15
    v_mul_f32 v16, v16, v228
    v_mul_f32 v17, v17, v228
    v_mul_f32 v18, v18, v228
    v_mul_f32 v19, v19, v228
    v_mul_f32 v20, v20, v228
    v_mul_f32 v21, v21, v228
    v_mul_f32 v22, v22, v228
    v_mul_f32 v23, v23, v228
    v_cvt_pk_bf16_f32 v104, v16, v17
    v_cvt_pk_bf16_f32 v105, v18, v19
    v_cvt_pk_bf16_f32 v106, v20, v21
    v_cvt_pk_bf16_f32 v107, v22, v23
    v_mul_f32 v24, v24, v228
    v_mul_f32 v25, v25, v228
    v_mul_f32 v26, v26, v228
    v_mul_f32 v27, v27, v228
    v_mul_f32 v28, v28, v228
    v_mul_f32 v29, v29, v228
    v_mul_f32 v30, v30, v228
    v_mul_f32 v31, v31, v228
    v_cvt_pk_bf16_f32 v108, v24, v25
    v_cvt_pk_bf16_f32 v109, v26, v27
    v_cvt_pk_bf16_f32 v110, v28, v29
    v_cvt_pk_bf16_f32 v111, v30, v31
    s_branch K1W2_L1
K1W2_E1:
    s_cmp_eq_u32 s25, 2
    s_cbranch_scc0 K1W2_E2
    s_nop 1
    v_mul_f32 v32, v32, v229
    v_mul_f32 v33, v33, v229
    v_mul_f32 v34, v34, v229
    v_mul_f32 v35, v35, v229
    v_mul_f32 v36, v36, v229
    v_mul_f32 v37, v37, v229
    v_mul_f32 v38, v38, v229
    v_mul_f32 v39, v39, v229
    v_cvt_pk_bf16_f32 v112, v32, v33
    v_cvt_pk_bf16_f32 v113, v34, v35
    v_cvt_pk_bf16_f32 v114, v36, v37
    v_cvt_pk_bf16_f32 v115, v38, v39
    v_mul_f32 v40, v40, v229
    v_mul_f32 v41, v41, v229
    v_mul_f32 v42, v42, v229
    v_mul_f32 v43, v43, v229
    v_mul_f32 v44, v44, v229
    v_mul_f32 v45, v45, v229
    v_mul_f32 v46, v46, v229
    v_mul_f32 v47, v47, v229
    v_cvt_pk_bf16_f32 v116, v40, v41
    v_cvt_pk_bf16_f32 v117, v42, v43
    v_cvt_pk_bf16_f32 v118, v44, v45
    v_cvt_pk_bf16_f32 v119, v46, v47
    v_mul_f32 v48, v48, v229
    v_mul_f32 v49, v49, v229
    v_mul_f32 v50, v50, v229
    v_mul_f32 v51, v51, v229
    v_mul_f32 v52, v52, v229
    v_mul_f32 v53, v53, v229
    v_mul_f32 v54, v54, v229
    v_mul_f32 v55, v55, v229
    v_cvt_pk_bf16_f32 v120, v48, v49
    v_cvt_pk_bf16_f32 v121, v50, v51
    v_cvt_pk_bf16_f32 v122, v52, v53
    v_cvt_pk_bf16_f32 v123, v54, v55
    v_mul_f32 v56, v56, v229
    v_mul_f32 v57, v57, v229
    v_mul_f32 v58, v58, v229
    v_mul_f32 v59, v59, v229
    v_mul_f32 v60, v60, v229
    v_mul_f32 v61, v61, v229
    v_mul_f32 v62, v62, v229
    v_mul_f32 v63, v63, v229
    v_cvt_pk_bf16_f32 v124, v56, v57
    v_cvt_pk_bf16_f32 v125, v58, v59
    v_cvt_pk_bf16_f32 v126, v60, v61
    v_cvt_pk_bf16_f32 v127, v62, v63
    s_branch K1W2_L1
K1W2_E2:
    s_cmp_eq_u32 s25, 3
    s_cbranch_scc0 K1W2_E3
    s_nop 1
    ds_read_b32 v144, v247 offset:0
    ds_read_b32 v148, v247 offset:64
    ds_read_b32 v145, v247 offset:128
    ds_read_b32 v149, v247 offset:192
    ds_read_b128 v[196:199], v246 offset:4096
    ds_read_b128 v[200:203], v246 offset:5120
    ds_read_b128 v[204:207], v246 offset:12288
    ds_read_b128 v[208:211], v246 offset:13312
    s_waitcnt lgkmcnt(5)
    v_max_f32 v244, v144, v145
    v_sub_f32 v152, v144, v244
    v_sub_f32 v153, v145, v244
    v_exp_f32 v152, v152
    v_exp_f32 v153, v153
    v_mul_f32 v244, v152, v148
    s_waitcnt lgkmcnt(4)
    v_fma_f32 v244, v153, v149, v244
    v_rcp_f32 v244, v244
    s_nop 0
    v_mul_f32 v152, v152, v244
    v_mul_f32 v153, v153, v244
    s_waitcnt lgkmcnt(3)
    v_mul_f32 v160, v196, v152
    s_waitcnt lgkmcnt(1)
    v_fma_f32 v160, v204, v153, v160
    v_mul_f32 v161, v197, v152
    v_fma_f32 v161, v205, v153, v161
    v_mul_f32 v162, v198, v152
    v_fma_f32 v162, v206, v153, v162
    v_mul_f32 v163, v199, v152
    v_fma_f32 v163, v207, v153, v163
    v_mul_f32 v164, v200, v152
    s_waitcnt lgkmcnt(0)
    v_fma_f32 v164, v208, v153, v164
    v_mul_f32 v165, v201, v152
    v_fma_f32 v165, v209, v153, v165
    v_mul_f32 v166, v202, v152
    v_fma_f32 v166, v210, v153, v166
    v_mul_f32 v167, v203, v152
    v_fma_f32 v167, v211, v153, v167
    v_cvt_pk_bf16_f32 v128, v160, v161
    v_cvt_pk_bf16_f32 v129, v162, v163
    v_cvt_pk_bf16_f32 v130, v164, v165
    v_cvt_pk_bf16_f32 v131, v166, v167
    s_branch K1W2_L1
K1W2_E3:
K1W2_L1c:
K1W2_L1:
    s_add_u32 s47, s46, s45
    s_cmp_eq_u32 s47, 0
    s_cbranch_scc0 K1W2_XW2_1
    s_waitcnt vmcnt(8) lgkmcnt(0)
    s_branch K1W2_XW2_z
K1W2_XW2_1:
    s_cmp_eq_u32 s47, 1
    s_cbranch_scc0 K1W2_XW2_2
    s_waitcnt vmcnt(9) lgkmcnt(0)
    s_branch K1W2_XW2_z
K1W2_XW2_2:
    s_cmp_eq_u32 s47, 2
    s_cbranch_scc0 K1W2_XW2_3
    s_waitcnt vmcnt(10) lgkmcnt(0)
    s_branch K1W2_XW2_z
K1W2_XW2_3:
    s_waitcnt vmcnt(11) lgkmcnt(0)
K1W2_XW2_z:
    s_barrier
    s_cmp_eq_u32 s27, 0
    s_cbranch_scc0 K1W2_L2
    s_cmp_eq_u32 s25, 14
    s_cbranch_scc0 K1W2_L2
    v_add_u32 v241, 1835008, v241
K1W2_L2:
    s_mov_b32 m0, s28
    v_xor_b32 v243, 64, v241
    buffer_load_dwordx4 v241, s[4:7], 0 offen nt lds
    v_xor_b32 v244, 128, v241
    buffer_load_dwordx4 v243, s[4:7], 0 offen offset:1024 nt lds
    v_xor_b32 v243, 192, v241
    buffer_load_dwordx4 v244, s[4:7], 0 offen offset:2048 nt lds
    buffer_load_dwordx4 v243, s[4:7], 0 offen offset:3072 nt lds
    v_add_u32 v241, 16384, v241
    s_add_u32 s57, s57, 1
    s_cmp_eq_u32 s57, 3
    s_cselect_b32 s57, 0, s57
    s_cmp_eq_u32 s57, 0
    s_cselect_b32 s28, 8192, 0
    s_cmp_eq_u32 s57, 1
    s_cselect_b32 s28, 24576, s28
    s_cmp_eq_u32 s57, 2
    s_cselect_b32 s28, 57344, s28
    s_add_u32 s25, s25, 1
    s_cmp_lt_u32 s25, 16
    s_cbranch_scc1 K1W2_LLOOP
    s_cmp_eq_u32 s27, 1
    s_cbranch_scc1 K1W2_FIN0
    s_mov_b32 s27, 1
    s_branch K1W2_ROUND
K1W2_FIN0:
    s_nop 1
    s_mov_b32 s30, 16384
    buffer_store_dwordx4 v[96:99], v248, s[20:23], s30 offen offset:0 sc1
    buffer_store_dwordx4 v[100:103], v248, s[20:23], s30 offen offset:1024 sc1
    buffer_store_dwordx4 v[104:107], v248, s[20:23], s30 offen offset:2048 sc1
    buffer_store_dwordx4 v[108:111], v248, s[20:23], s30 offen offset:3072 sc1
    s_mov_b32 s30, 20480
    buffer_store_dwordx4 v[112:115], v248, s[20:23], s30 offen offset:0 sc1
    buffer_store_dwordx4 v[116:119], v248, s[20:23], s30 offen offset:1024 sc1
    buffer_store_dwordx4 v[120:123], v248, s[20:23], s30 offen offset:2048 sc1
    buffer_store_dwordx4 v[124:127], v248, s[20:23], s30 offen offset:3072 sc1
    s_mov_b32 s30, 34816
    buffer_store_dwordx4 v[128:131], v248, s[20:23], s30 offen sc1
    s_barrier
    s_waitcnt vmcnt(0)
    s_lshl_b32 s30, s85, 3
    s_add_u32 s30, s30, s84
    s_mul_i32 s44, s30, 52
    s_lshr_b32 s44, s44, 8
    s_mul_i32 s31, s44, 5
    s_sub_u32 s45, s30, s31
    s_and_b32 s51, s2, 1
    s_load_dwordx2 s[72:73], s[0:1], 32
    s_load_dwordx2 s[74:75], s[0:1], 72
    s_load_dwordx2 s[46:47], s[0:1], 80
    s_waitcnt lgkmcnt(0)
    s_cmp_eq_u32 s64, 0
    s_cselect_b64 s[72:73], s[72:73], s[74:75]
    s_lshl_b32 s30, s45, 8
    s_add_u32 s12, s72, s30
    s_addc_u32 s13, s73, 0
    s_sub_u32 s14, 5242880, s30
    s_mov_b32 s15, 131072
    s_mov_b32 s16, s48
    s_mov_b32 s17, s49
    s_mov_b32 s18, 18874368
    s_mov_b32 s19, 131072
    s_add_u32 s80, s48, 50331648
    s_addc_u32 s81, s49, 0
    s_mov_b32 s82, 131072
    s_mov_b32 s83, 131072
    s_mov_b32 s4, s46
    s_mov_b32 s5, s47
    s_mov_b32 s6, 2949120
    s_mov_b32 s7, 131072
    s_add_u32 s8, s48, 33554432
    s_addc_u32 s9, s49, 0
    s_mov_b32 s10, 12582912
    s_mov_b32 s11, 131072
    s_sub_u32 s69, s65, s85
    s_mul_i32 s30, s44, 6
    s_add_u32 s30, s30, 0
    s_mul_i32 s31, s30, 57
    s_lshr_b32 s31, s31, 9
    s_mul_i32 s72, s31, 9
    s_sub_u32 s72, s30, s72
    s_add_u32 s31, s31, s69
    s_lshl_b32 s73, s64, 3
    s_add_u32 s73, s73, s31
    s_lshl_b32 s73, s73, 5
    s_lshl_b32 s74, s51, 4
    s_add_u32 s73, s73, s74
    s_mul_i32 s73, s73, 36864
    s_lshl_b32 s74, s72, 12
    s_add_u32 s32, s73, s74
    s_mul_i32 s73, s31, 144
    s_lshl_b32 s74, s72, 4
    s_add_u32 s73, s73, s74
    s_mul_i32 s73, s73, 2560
    s_mul_i32 s74, s64, 1280
    s_add_u32 s73, s73, s74
    s_lshl_b32 s74, s45, 8
    s_add_u32 s38, s73, s74
    s_mul_i32 s30, s44, 6
    s_add_u32 s30, s30, 1
    s_mul_i32 s31, s30, 57
    s_lshr_b32 s31, s31, 9
    s_mul_i32 s72, s31, 9
    s_sub_u32 s72, s30, s72
    s_add_u32 s31, s31, s69
    s_lshl_b32 s73, s64, 3
    s_add_u32 s73, s73, s31
    s_lshl_b32 s73, s73, 5
    s_lshl_b32 s74, s51, 4
    s_add_u32 s73, s73, s74
    s_mul_i32 s73, s73, 36864
    s_lshl_b32 s74, s72, 12
    s_add_u32 s33, s73, s74
    s_mul_i32 s73, s31, 144
    s_lshl_b32 s74, s72, 4
    s_add_u32 s73, s73, s74
    s_mul_i32 s73, s73, 2560
    s_mul_i32 s74, s64, 1280
    s_add_u32 s73, s73, s74
    s_lshl_b32 s74, s45, 8
    s_add_u32 s39, s73, s74
    s_mul_i32 s30, s44, 6
    s_add_u32 s30, s30, 2
    s_mul_i32 s31, s30, 57
    s_lshr_b32 s31, s31, 9
    s_mul_i32 s72, s31, 9
    s_sub_u32 s72, s30, s72
    s_add_u32 s31, s31, s69
    s_lshl_b32 s73, s64, 3
    s_add_u32 s73, s73, s31
    s_lshl_b32 s73, s73, 5
    s_lshl_b32 s74, s51, 4
    s_add_u32 s73, s73, s74
    s_mul_i32 s73, s73, 36864
    s_lshl_b32 s74, s72, 12
    s_add_u32 s34, s73, s74
    s_mul_i32 s73, s31, 144
    s_lshl_b32 s74, s72, 4
    s_add_u32 s73, s73, s74
    s_mul_i32 s73, s73, 2560
    s_mul_i32 s74, s64, 1280
    s_add_u32 s73, s73, s74
    s_lshl_b32 s74, s45, 8
    s_add_u32 s40, s73, s74
    s_mul_i32 s30, s44, 6
    s_add_u32 s30, s30, 3
    s_mul_i32 s31, s30, 57
    s_lshr_b32 s31, s31, 9
    s_mul_i32 s72, s31, 9
    s_sub_u32 s72, s30, s72
    s_add_u32 s31, s31, s69
    s_lshl_b32 s73, s64, 3
    s_add_u32 s73, s73, s31
    s_lshl_b32 s73, s73, 5
    s_lshl_b32 s74, s51, 4
    s_add_u32 s73, s73, s74
    s_mul_i32 s73, s73, 36864
    s_lshl_b32 s74, s72, 12
    s_add_u32 s35, s73, s74
    s_mul_i32 s73, s31, 144
    s_lshl_b32 s74, s72, 4
    s_add_u32 s73, s73, s74
    s_mul_i32 s73, s73, 2560
    s_mul_i32 s74, s64, 1280
    s_add_u32 s73, s73, s74
    s_lshl_b32 s74, s45, 8
    s_add_u32 s41, s73, s74
    s_mul_i32 s30, s44, 6
    s_add_u32 s30, s30, 4
    s_mul_i32 s31, s30, 57
    s_lshr_b32 s31, s31, 9
    s_mul_i32 s72, s31, 9
    s_sub_u32 s72, s30, s72
    s_add_u32 s31, s31, s69
    s_lshl_b32 s73, s64, 3
    s_add_u32 s73, s73, s31
    s_lshl_b32 s73, s73, 5
    s_lshl_b32 s74, s51, 4
    s_add_u32 s73, s73, s74
    s_mul_i32 s73, s73, 36864
    s_lshl_b32 s74, s72, 12
    s_add_u32 s36, s73, s74
    s_mul_i32 s73, s31, 144
    s_lshl_b32 s74, s72, 4
    s_add_u32 s73, s73, s74
    s_mul_i32 s73, s73, 2560
    s_mul_i32 s74, s64, 1280
    s_add_u32 s73, s73, s74
    s_lshl_b32 s74, s45, 8
    s_add_u32 s42, s73, s74
    s_mul_i32 s30, s44, 6
    s_add_u32 s30, s30, 5
    s_mul_i32 s31, s30, 57
    s_lshr_b32 s31, s31, 9
    s_mul_i32 s72, s31, 9
    s_sub_u32 s72, s30, s72
    s_add_u32 s31, s31, s69
    s_lshl_b32 s73, s64, 3
    s_add_u32 s73, s73, s31
    s_lshl_b32 s73, s73, 5
    s_lshl_b32 s74, s51, 4
    s_add_u32 s73, s73, s74
    s_mul_i32 s73, s73, 36864
    s_lshl_b32 s74, s72, 12
    s_add_u32 s37, s73, s74
    s_mul_i32 s73, s31, 144
    s_lshl_b32 s74, s72, 4
    s_add_u32 s73, s73, s74
    s_mul_i32 s73, s73, 2560
    s_mul_i32 s74, s64, 1280
    s_add_u32 s73, s73, s74
    s_lshl_b32 s74, s45, 8
    s_add_u32 s43, s73, s74
    s_mul_i32 s53, s51, 2621440
    v_mov_b32 v104, v248
    v_add_u32 v105, 57344, v248
    v_lshrrev_b32 v116, 4, v245
    v_bfe_u32 v117, v245, 2, 2
    v_lshl_add_u32 v116, v116, 2, v117
    v_and_b32 v117, 7, v116
    v_lshlrev_b32 v117, 1, v117
    v_bfe_u32 v118, v245, 1, 1
    v_xor_b32 v117, v117, v118
    v_lshlrev_b32 v117, 4, v117
    v_lshl_or_b32 v116, v116, 8, v117
    v_and_b32 v117, 1, v245
    v_lshl_or_b32 v116, v117, 3, v116
    v_xor_b32 v117, 0, v116
    v_add_u32 v106, 12288, v117
    v_add_u32 v110, 69632, v117
    v_xor_b32 v117, 32, v116
    v_add_u32 v107, 12288, v117
    v_add_u32 v111, 69632, v117
    v_xor_b32 v117, 64, v116
    v_add_u32 v108, 12288, v117
    v_add_u32 v112, 69632, v117
    v_xor_b32 v117, 96, v116
    v_add_u32 v109, 12288, v117
    v_add_u32 v113, 69632, v117
    v_mov_b32 v0, 0
    v_mov_b32 v1, 0
    v_mov_b32 v2, 0
    v_mov_b32 v3, 0
    v_mov_b32 v4, 0
    v_mov_b32 v5, 0
    v_mov_b32 v6, 0
    v_mov_b32 v7, 0
    v_mov_b32 v8, 0
    v_mov_b32 v9, 0
    v_mov_b32 v10, 0
    v_mov_b32 v11, 0
    v_mov_b32 v12, 0
    v_mov_b32 v13, 0
    v_mov_b32 v14, 0
    v_mov_b32 v15, 0
    v_mov_b32 v16, 0
    v_mov_b32 v17, 0
    v_mov_b32 v18, 0
    v_mov_b32 v19, 0
    v_mov_b32 v20, 0
    v_mov_b32 v21, 0
    v_mov_b32 v22, 0
    v_mov_b32 v23, 0
    v_mov_b32 v24, 0
    v_mov_b32 v25, 0
    v_mov_b32 v26, 0
    v_mov_b32 v27, 0
    v_mov_b32 v28, 0
    v_mov_b32 v29, 0
    v_mov_b32 v30, 0
    v_mov_b32 v31, 0
    v_mov_b32 v32, 0
    v_mov_b32 v33, 0
    v_mov_b32 v34, 0
    v_mov_b32 v35, 0
    v_mov_b32 v36, 0
    v_mov_b32 v37, 0
    v_mov_b32 v38, 0
    v_mov_b32 v39, 0
    v_mov_b32 v40, 0
    v_mov_b32 v41, 0
    v_mov_b32 v42, 0
    v_mov_b32 v43, 0
    v_mov_b32 v44, 0
    v_mov_b32 v45, 0
    v_mov_b32 v46, 0
    v_mov_b32 v47, 0
    s_barrier
    s_cmp_ge_u32 s44, 6
    s_cbranch_scc1 K1_END
    s_barrier
    s_mov_b32 s58, 0
    s_nop 1
K1W2_TC:
    s_barrier
    s_cmp_eq_u32 s58, 0
    s_cbranch_scc1 K1W2_TCf
    v_mfma_f32_16x16x32_bf16 v[0:3], v[88:91], v[60:63], v[0:3]
    ds_read_b128 v[48:51], v104 offset:6144
    v_mfma_f32_16x16x32_bf16 v[16:19], v[88:91], v[64:67], v[16:19]
    ds_read_b128 v[52:55], v104 offset:8192
    v_mfma_f32_16x16x32_bf16 v[32:35], v[88:91], v[68:71], v[32:35]
    ds_read_b128 v[56:59], v104 offset:10240
    v_mfma_f32_16x16x32_bf16 v[4:7], v[92:95], v[60:63], v[4:7]
    ds_read_b64_tr_b16 v[72:73], v106 offset:0
    v_mfma_f32_16x16x32_bf16 v[20:23], v[92:95], v[64:67], v[20:23]
    ds_read_b64_tr_b16 v[74:75], v106 offset:4096
    v_mfma_f32_16x16x32_bf16 v[36:39], v[92:95], v[68:71], v[36:39]
    ds_read_b64_tr_b16 v[76:77], v107 offset:0
    v_mfma_f32_16x16x32_bf16 v[8:11], v[96:99], v[60:63], v[8:11]
    ds_read_b64_tr_b16 v[78:79], v107 offset:4096
    v_mfma_f32_16x16x32_bf16 v[24:27], v[96:99], v[64:67], v[24:27]
    ds_read_b64_tr_b16 v[80:81], v108 offset:0
    v_mfma_f32_16x16x32_bf16 v[40:43], v[96:99], v[68:71], v[40:43]
    ds_read_b64_tr_b16 v[82:83], v108 offset:4096
    v_mfma_f32_16x16x32_bf16 v[12:15], v[100:103], v[60:63], v[12:15]
    ds_read_b64_tr_b16 v[84:85], v109 offset:0
    v_mfma_f32_16x16x32_bf16 v[28:31], v[100:103], v[64:67], v[28:31]
    ds_read_b64_tr_b16 v[86:87], v109 offset:4096
    v_mfma_f32_16x16x32_bf16 v[44:47], v[100:103], v[68:71], v[44:47]
    s_branch K1W2_TCg
K1W2_TCf:
    ds_read_b128 v[48:51], v104 offset:6144
    ds_read_b128 v[52:55], v104 offset:8192
    ds_read_b128 v[56:59], v104 offset:10240
    ds_read_b64_tr_b16 v[72:73], v106 offset:0
    ds_read_b64_tr_b16 v[74:75], v106 offset:4096
    ds_read_b64_tr_b16 v[76:77], v107 offset:0
    ds_read_b64_tr_b16 v[78:79], v107 offset:4096
    ds_read_b64_tr_b16 v[80:81], v108 offset:0
    ds_read_b64_tr_b16 v[82:83], v108 offset:4096
    ds_read_b64_tr_b16 v[84:85], v109 offset:0
    ds_read_b64_tr_b16 v[86:87], v109 offset:4096
K1W2_TCg:
    s_waitcnt lgkmcnt(0)
    v_mfma_f32_16x16x32_bf16 v[0:3], v[72:75], v[48:51], v[0:3]
    ds_read_b128 v[60:63], v104 offset:7168
    v_mfma_f32_16x16x32_bf16 v[16:19], v[72:75], v[52:55], v[16:19]
    ds_read_b128 v[64:67], v104 offset:9216
    v_mfma_f32_16x16x32_bf16 v[32:35], v[72:75], v[56:59], v[32:35]
    ds_read_b128 v[68:71], v104 offset:11264
    v_mfma_f32_16x16x32_bf16 v[4:7], v[76:79], v[48:51], v[4:7]
    ds_read_b64_tr_b16 v[88:89], v106 offset:8192
    v_mfma_f32_16x16x32_bf16 v[20:23], v[76:79], v[52:55], v[20:23]
    ds_read_b64_tr_b16 v[90:91], v106 offset:12288
    v_mfma_f32_16x16x32_bf16 v[36:39], v[76:79], v[56:59], v[36:39]
    ds_read_b64_tr_b16 v[92:93], v107 offset:8192
    v_mfma_f32_16x16x32_bf16 v[8:11], v[80:83], v[48:51], v[8:11]
    ds_read_b64_tr_b16 v[94:95], v107 offset:12288
    v_mfma_f32_16x16x32_bf16 v[24:27], v[80:83], v[52:55], v[24:27]
    ds_read_b64_tr_b16 v[96:97], v108 offset:8192
    v_mfma_f32_16x16x32_bf16 v[40:43], v[80:83], v[56:59], v[40:43]
    ds_read_b64_tr_b16 v[98:99], v108 offset:12288
    v_mfma_f32_16x16x32_bf16 v[12:15], v[84:87], v[48:51], v[12:15]
    ds_read_b64_tr_b16 v[100:101], v109 offset:8192
    v_mfma_f32_16x16x32_bf16 v[28:31], v[84:87], v[52:55], v[28:31]
    ds_read_b64_tr_b16 v[102:103], v109 offset:12288
    v_mfma_f32_16x16x32_bf16 v[44:47], v[84:87], v[56:59], v[44:47]
    s_waitcnt lgkmcnt(0)
    s_barrier
    v_mfma_f32_16x16x32_bf16 v[0:3], v[88:91], v[60:63], v[0:3]
    ds_read_b128 v[48:51], v104 offset:34816
    v_mfma_f32_16x16x32_bf16 v[16:19], v[88:91], v[64:67], v[16:19]
    ds_read_b128 v[52:55], v104 offset:36864
    v_mfma_f32_16x16x32_bf16 v[32:35], v[88:91], v[68:71], v[32:35]
    ds_read_b128 v[56:59], v104 offset:38912
    v_mfma_f32_16x16x32_bf16 v[4:7], v[92:95], v[60:63], v[4:7]
    ds_read_b64_tr_b16 v[72:73], v106 offset:28672
    v_mfma_f32_16x16x32_bf16 v[20:23], v[92:95], v[64:67], v[20:23]
    ds_read_b64_tr_b16 v[74:75], v106 offset:32768
    v_mfma_f32_16x16x32_bf16 v[36:39], v[92:95], v[68:71], v[36:39]
    ds_read_b64_tr_b16 v[76:77], v107 offset:28672
    v_mfma_f32_16x16x32_bf16 v[8:11], v[96:99], v[60:63], v[8:11]
    ds_read_b64_tr_b16 v[78:79], v107 offset:32768
    v_mfma_f32_16x16x32_bf16 v[24:27], v[96:99], v[64:67], v[24:27]
    ds_read_b64_tr_b16 v[80:81], v108 offset:28672
    v_mfma_f32_16x16x32_bf16 v[40:43], v[96:99], v[68:71], v[40:43]
    ds_read_b64_tr_b16 v[82:83], v108 offset:32768
    v_mfma_f32_16x16x32_bf16 v[12:15], v[100:103], v[60:63], v[12:15]
    ds_read_b64_tr_b16 v[84:85], v109 offset:28672
    v_mfma_f32_16x16x32_bf16 v[28:31], v[100:103], v[64:67], v[28:31]
    ds_read_b64_tr_b16 v[86:87], v109 offset:32768
    v_mfma_f32_16x16x32_bf16 v[44:47], v[100:103], v[68:71], v[44:47]
    s_waitcnt lgkmcnt(6)
    v_mfma_f32_16x16x32_bf16 v[0:3], v[72:75], v[48:51], v[0:3]
    ds_read_b128 v[60:63], v104 offset:35840
    v_mfma_f32_16x16x32_bf16 v[16:19], v[72:75], v[52:55], v[16:19]
    ds_read_b128 v[64:67], v104 offset:37888
    v_mfma_f32_16x16x32_bf16 v[32:35], v[72:75], v[56:59], v[32:35]
    ds_read_b128 v[68:71], v104 offset:39936
    s_waitcnt lgkmcnt(7)
    v_mfma_f32_16x16x32_bf16 v[4:7], v[76:79], v[48:51], v[4:7]
    ds_read_b64_tr_b16 v[88:89], v106 offset:36864
    v_mfma_f32_16x16x32_bf16 v[20:23], v[76:79], v[52:55], v[20:23]
    ds_read_b64_tr_b16 v[90:91], v106 offset:40960
    v_mfma_f32_16x16x32_bf16 v[36:39], v[76:79], v[56:59], v[36:39]
    ds_read_b64_tr_b16 v[92:93], v107 offset:36864
    s_waitcnt lgkmcnt(8)
    v_mfma_f32_16x16x32_bf16 v[8:11], v[80:83], v[48:51], v[8:11]
    ds_read_b64_tr_b16 v[94:95], v107 offset:40960
    v_mfma_f32_16x16x32_bf16 v[24:27], v[80:83], v[52:55], v[24:27]
    ds_read_b64_tr_b16 v[96:97], v108 offset:36864
    v_mfma_f32_16x16x32_bf16 v[40:43], v[80:83], v[56:59], v[40:43]
    ds_read_b64_tr_b16 v[98:99], v108 offset:40960
    s_waitcnt lgkmcnt(9)
    v_mfma_f32_16x16x32_bf16 v[12:15], v[84:87], v[48:51], v[12:15]
    ds_read_b64_tr_b16 v[100:101], v109 offset:36864
    v_mfma_f32_16x16x32_bf16 v[28:31], v[84:87], v[52:55], v[28:31]
    ds_read_b64_tr_b16 v[102:103], v109 offset:40960
    v_mfma_f32_16x16x32_bf16 v[44:47], v[84:87], v[56:59], v[44:47]
    s_waitcnt lgkmcnt(0)
    s_barrier
    v_mfma_f32_16x16x32_bf16 v[0:3], v[88:91], v[60:63], v[0:3]
    ds_read_b128 v[48:51], v105 offset:6144
    v_mfma_f32_16x16x32_bf16 v[16:19], v[88:91], v[64:67], v[16:19]
    ds_read_b128 v[52:55], v105 offset:8192
    v_mfma_f32_16x16x32_bf16 v[32:35], v[88:91], v[68:71], v[32:35]
    ds_read_b128 v[56:59], v105 offset:10240
    v_mfma_f32_16x16x32_bf16 v[4:7], v[92:95], v[60:63], v[4:7]
    ds_read_b64_tr_b16 v[72:73], v110 offset:0
    v_mfma_f32_16x16x32_bf16 v[20:23], v[92:95], v[64:67], v[20:23]
    ds_read_b64_tr_b16 v[74:75], v110 offset:4096
    v_mfma_f32_16x16x32_bf16 v[36:39], v[92:95], v[68:71], v[36:39]
    ds_read_b64_tr_b16 v[76:77], v111 offset:0
    v_mfma_f32_16x16x32_bf16 v[8:11], v[96:99], v[60:63], v[8:11]
    ds_read_b64_tr_b16 v[78:79], v111 offset:4096
    v_mfma_f32_16x16x32_bf16 v[24:27], v[96:99], v[64:67], v[24:27]
    ds_read_b64_tr_b16 v[80:81], v112 offset:0
    v_mfma_f32_16x16x32_bf16 v[40:43], v[96:99], v[68:71], v[40:43]
    ds_read_b64_tr_b16 v[82:83], v112 offset:4096
    v_mfma_f32_16x16x32_bf16 v[12:15], v[100:103], v[60:63], v[12:15]
    ds_read_b64_tr_b16 v[84:85], v113 offset:0
    v_mfma_f32_16x16x32_bf16 v[28:31], v[100:103], v[64:67], v[28:31]
    ds_read_b64_tr_b16 v[86:87], v113 offset:4096
    v_mfma_f32_16x16x32_bf16 v[44:47], v[100:103], v[68:71], v[44:47]
    s_waitcnt lgkmcnt(6)
    v_mfma_f32_16x16x32_bf16 v[0:3], v[72:75], v[48:51], v[0:3]
    ds_read_b128 v[60:63], v105 offset:7168
    v_mfma_f32_16x16x32_bf16 v[16:19], v[72:75], v[52:55], v[16:19]
    ds_read_b128 v[64:67], v105 offset:9216
    v_mfma_f32_16x16x32_bf16 v[32:35], v[72:75], v[56:59], v[32:35]
    ds_read_b128 v[68:71], v105 offset:11264
    s_waitcnt lgkmcnt(7)
    v_mfma_f32_16x16x32_bf16 v[4:7], v[76:79], v[48:51], v[4:7]
    ds_read_b64_tr_b16 v[88:89], v110 offset:8192
    v_mfma_f32_16x16x32_bf16 v[20:23], v[76:79], v[52:55], v[20:23]
    ds_read_b64_tr_b16 v[90:91], v110 offset:12288
    v_mfma_f32_16x16x32_bf16 v[36:39], v[76:79], v[56:59], v[36:39]
    ds_read_b64_tr_b16 v[92:93], v111 offset:8192
    s_waitcnt lgkmcnt(8)
    v_mfma_f32_16x16x32_bf16 v[8:11], v[80:83], v[48:51], v[8:11]
    ds_read_b64_tr_b16 v[94:95], v111 offset:12288
    v_mfma_f32_16x16x32_bf16 v[24:27], v[80:83], v[52:55], v[24:27]
    ds_read_b64_tr_b16 v[96:97], v112 offset:8192
    v_mfma_f32_16x16x32_bf16 v[40:43], v[80:83], v[56:59], v[40:43]
    ds_read_b64_tr_b16 v[98:99], v112 offset:12288
    s_waitcnt lgkmcnt(9)
    v_mfma_f32_16x16x32_bf16 v[12:15], v[84:87], v[48:51], v[12:15]
    ds_read_b64_tr_b16 v[100:101], v113 offset:8192
    v_mfma_f32_16x16x32_bf16 v[28:31], v[84:87], v[52:55], v[28:31]
    ds_read_b64_tr_b16 v[102:103], v113 offset:12288
    v_mfma_f32_16x16x32_bf16 v[44:47], v[84:87], v[56:59], v[44:47]
    s_waitcnt lgkmcnt(0)
    s_barrier
    v_mfma_f32_16x16x32_bf16 v[0:3], v[88:91], v[60:63], v[0:3]
    ds_read_b128 v[48:51], v105 offset:34816
    v_mfma_f32_16x16x32_bf16 v[16:19], v[88:91], v[64:67], v[16:19]
    ds_read_b128 v[52:55], v105 offset:36864
    v_mfma_f32_16x16x32_bf16 v[32:35], v[88:91], v[68:71], v[32:35]
    ds_read_b128 v[56:59], v105 offset:38912
    v_mfma_f32_16x16x32_bf16 v[4:7], v[92:95], v[60:63], v[4:7]
    ds_read_b64_tr_b16 v[72:73], v110 offset:28672
    v_mfma_f32_16x16x32_bf16 v[20:23], v[92:95], v[64:67], v[20:23]
    ds_read_b64_tr_b16 v[74:75], v110 offset:32768
    v_mfma_f32_16x16x32_bf16 v[36:39], v[92:95], v[68:71], v[36:39]
    ds_read_b64_tr_b16 v[76:77], v111 offset:28672
    v_mfma_f32_16x16x32_bf16 v[8:11], v[96:99], v[60:63], v[8:11]
    ds_read_b64_tr_b16 v[78:79], v111 offset:32768
    v_mfma_f32_16x16x32_bf16 v[24:27], v[96:99], v[64:67], v[24:27]
    ds_read_b64_tr_b16 v[80:81], v112 offset:28672
    v_mfma_f32_16x16x32_bf16 v[40:43], v[96:99], v[68:71], v[40:43]
    ds_read_b64_tr_b16 v[82:83], v112 offset:32768
    v_mfma_f32_16x16x32_bf16 v[12:15], v[100:103], v[60:63], v[12:15]
    ds_read_b64_tr_b16 v[84:85], v113 offset:28672
    v_mfma_f32_16x16x32_bf16 v[28:31], v[100:103], v[64:67], v[28:31]
    ds_read_b64_tr_b16 v[86:87], v113 offset:32768
    v_mfma_f32_16x16x32_bf16 v[44:47], v[100:103], v[68:71], v[44:47]
    s_waitcnt lgkmcnt(6)
    v_mfma_f32_16x16x32_bf16 v[0:3], v[72:75], v[48:51], v[0:3]
    ds_read_b128 v[60:63], v105 offset:35840
    v_mfma_f32_16x16x32_bf16 v[16:19], v[72:75], v[52:55], v[16:19]
    ds_read_b128 v[64:67], v105 offset:37888
    v_mfma_f32_16x16x32_bf16 v[32:35], v[72:75], v[56:59], v[32:35]
    ds_read_b128 v[68:71], v105 offset:39936
    s_waitcnt lgkmcnt(7)
    v_mfma_f32_16x16x32_bf16 v[4:7], v[76:79], v[48:51], v[4:7]
    ds_read_b64_tr_b16 v[88:89], v110 offset:36864
    v_mfma_f32_16x16x32_bf16 v[20:23], v[76:79], v[52:55], v[20:23]
    ds_read_b64_tr_b16 v[90:91], v110 offset:40960
    v_mfma_f32_16x16x32_bf16 v[36:39], v[76:79], v[56:59], v[36:39]
    ds_read_b64_tr_b16 v[92:93], v111 offset:36864
    s_waitcnt lgkmcnt(8)
    v_mfma_f32_16x16x32_bf16 v[8:11], v[80:83], v[48:51], v[8:11]
    ds_read_b64_tr_b16 v[94:95], v111 offset:40960
    v_mfma_f32_16x16x32_bf16 v[24:27], v[80:83], v[52:55], v[24:27]
    ds_read_b64_tr_b16 v[96:97], v112 offset:36864
    v_mfma_f32_16x16x32_bf16 v[40:43], v[80:83], v[56:59], v[40:43]
    ds_read_b64_tr_b16 v[98:99], v112 offset:40960
    s_waitcnt lgkmcnt(9)
    v_mfma_f32_16x16x32_bf16 v[12:15], v[84:87], v[48:51], v[12:15]
    ds_read_b64_tr_b16 v[100:101], v113 offset:36864
    v_mfma_f32_16x16x32_bf16 v[28:31], v[84:87], v[52:55], v[28:31]
    ds_read_b64_tr_b16 v[102:103], v113 offset:40960
    v_mfma_f32_16x16x32_bf16 v[44:47], v[84:87], v[56:59], v[44:47]
    s_waitcnt lgkmcnt(0)
    s_add_u32 s58, s58, 1
    s_cmp_lt_u32 s58, 8
    s_cbranch_scc1 K1W2_TC
    v_mfma_f32_16x16x32_bf16 v[0:3], v[88:91], v[60:63], v[0:3]
    v_mfma_f32_16x16x32_bf16 v[16:19], v[88:91], v[64:67], v[16:19]
    v_mfma_f32_16x16x32_bf16 v[32:35], v[88:91], v[68:71], v[32:35]
    v_mfma_f32_16x16x32_bf16 v[4:7], v[92:95], v[60:63], v[4:7]
    v_mfma_f32_16x16x32_bf16 v[20:23], v[92:95], v[64:67], v[20:23]
    v_mfma_f32_16x16x32_bf16 v[36:39], v[92:95], v[68:71], v[36:39]
    v_mfma_f32_16x16x32_bf16 v[8:11], v[96:99], v[60:63], v[8:11]
    v_mfma_f32_16x16x32_bf16 v[24:27], v[96:99], v[64:67], v[24:27]
    v_mfma_f32_16x16x32_bf16 v[40:43], v[96:99], v[68:71], v[40:43]
    v_mfma_f32_16x16x32_bf16 v[12:15], v[100:103], v[60:63], v[12:15]
    v_mfma_f32_16x16x32_bf16 v[28:31], v[100:103], v[64:67], v[28:31]
    v_mfma_f32_16x16x32_bf16 v[44:47], v[100:103], v[68:71], v[44:47]
    s_nop 7
    s_mul_i32 s30, s2, 49152
    s_add_u32 s30, s30, 0
    s_cmp_eq_u32 s51, 1
    s_cbranch_scc1 K1W2_TK
    buffer_store_dwordx4 v[0:3], v248, s[8:11], s30 offen offset:0 sc1
    buffer_store_dwordx4 v[4:7], v248, s[8:11], s30 offen offset:1024 sc1
    buffer_store_dwordx4 v[8:11], v248, s[8:11], s30 offen offset:2048 sc1
    buffer_store_dwordx4 v[12:15], v248, s[8:11], s30 offen offset:3072 sc1
    s_add_u32 s30, s30, 4096
    buffer_store_dwordx4 v[16:19], v248, s[8:11], s30 offen offset:0 sc1
    buffer_store_dwordx4 v[20:23], v248, s[8:11], s30 offen offset:1024 sc1
    buffer_store_dwordx4 v[24:27], v248, s[8:11], s30 offen offset:2048 sc1
    buffer_store_dwordx4 v[28:31], v248, s[8:11], s30 offen offset:3072 sc1
    s_add_u32 s30, s30, 4096
    buffer_store_dwordx4 v[32:35], v248, s[8:11], s30 offen offset:0 sc1
    buffer_store_dwordx4 v[36:39], v248, s[8:11], s30 offen offset:1024 sc1
    buffer_store_dwordx4 v[40:43], v248, s[8:11], s30 offen offset:2048 sc1
    buffer_store_dwordx4 v[44:47], v248, s[8:11], s30 offen offset:3072 sc1
K1W2_TK:
    s_waitcnt vmcnt(0)
    s_barrier
    s_barrier
    s_cmp_eq_u32 s51, 1
    s_cbranch_scc0 K1W2_TF
    s_xor_b32 s30, s2, 1
    s_mul_i32 s30, s30, 49152
    s_add_u32 s30, s30, 0
    buffer_load_dwordx4 v[120:123], v248, s[8:11], s30 offen offset:0 sc1
    buffer_load_dwordx4 v[124:127], v248, s[8:11], s30 offen offset:1024 sc1
    buffer_load_dwordx4 v[128:131], v248, s[8:11], s30 offen offset:2048 sc1
    buffer_load_dwordx4 v[132:135], v248, s[8:11], s30 offen offset:3072 sc1
    s_add_u32 s30, s30, 4096
    buffer_load_dwordx4 v[136:139], v248, s[8:11], s30 offen offset:0 sc1
    buffer_load_dwordx4 v[140:143], v248, s[8:11], s30 offen offset:1024 sc1
    buffer_load_dwordx4 v[144:147], v248, s[8:11], s30 offen offset:2048 sc1
    buffer_load_dwordx4 v[148:151], v248, s[8:11], s30 offen offset:3072 sc1
    s_add_u32 s30, s30, 4096
    buffer_load_dwordx4 v[152:155], v248, s[8:11], s30 offen offset:0 sc1
    buffer_load_dwordx4 v[156:159], v248, s[8:11], s30 offen offset:1024 sc1
    buffer_load_dwordx4 v[160:163], v248, s[8:11], s30 offen offset:2048 sc1
    buffer_load_dwordx4 v[164:167], v248, s[8:11], s30 offen offset:3072 sc1
    v_and_b32 v116, 15, v245
    v_mul_u32_u24 v116, 2560, v116
    v_lshrrev_b32 v117, 4, v245
    v_lshl_add_u32 v116, v117, 3, v116
    s_waitcnt vmcnt(11)
    v_add_f32 v0, v0, v120
    v_add_f32 v1, v1, v121
    v_add_f32 v2, v2, v122
    v_add_f32 v3, v3, v123
    v_cvt_pk_bf16_f32 v48, v0, v1
    v_cvt_pk_bf16_f32 v49, v2, v3
    buffer_store_dwordx2 v[48:49], v116, s[4:7], s41 offen offset:0
    s_waitcnt vmcnt(11)
    v_add_f32 v4, v4, v124
    v_add_f32 v5, v5, v125
    v_add_f32 v6, v6, v126
    v_add_f32 v7, v7, v127
    v_cvt_pk_bf16_f32 v50, v4, v5
    v_cvt_pk_bf16_f32 v51, v6, v7
    buffer_store_dwordx2 v[50:51], v116, s[4:7], s41 offen offset:32
    s_waitcnt vmcnt(11)
    v_add_f32 v8, v8, v128
    v_add_f32 v9, v9, v129
    v_add_f32 v10, v10, v130
    v_add_f32 v11, v11, v131
    v_cvt_pk_bf16_f32 v52, v8, v9
    v_cvt_pk_bf16_f32 v53, v10, v11
    buffer_store_dwordx2 v[52:53], v116, s[4:7], s41 offen offset:64
    s_waitcnt vmcnt(11)
    v_add_f32 v12, v12, v132
    v_add_f32 v13, v13, v133
    v_add_f32 v14, v14, v134
    v_add_f32 v15, v15, v135
    v_cvt_pk_bf16_f32 v54, v12, v13
    v_cvt_pk_bf16_f32 v55, v14, v15
    buffer_store_dwordx2 v[54:55], v116, s[4:7], s41 offen offset:96
    s_waitcnt vmcnt(11)
    v_add_f32 v16, v16, v136
    v_add_f32 v17, v17, v137
    v_add_f32 v18, v18, v138
    v_add_f32 v19, v19, v139
    v_cvt_pk_bf16_f32 v56, v16, v17
    v_cvt_pk_bf16_f32 v57, v18, v19
    buffer_store_dwordx2 v[56:57], v116, s[4:7], s42 offen offset:0
    s_waitcnt vmcnt(11)
    v_add_f32 v20, v20, v140
    v_add_f32 v21, v21, v141
    v_add_f32 v22, v22, v142
    v_add_f32 v23, v23, v143
    v_cvt_pk_bf16_f32 v58, v20, v21
    v_cvt_pk_bf16_f32 v59, v22, v23
    buffer_store_dwordx2 v[58:59], v116, s[4:7], s42 offen offset:32
    s_waitcnt vmcnt(11)
    v_add_f32 v24, v24, v144
    v_add_f32 v25, v25, v145
    v_add_f32 v26, v26, v146
    v_add_f32 v27, v27, v147
    v_cvt_pk_bf16_f32 v60, v24, v25
    v_cvt_pk_bf16_f32 v61, v26, v27
    buffer_store_dwordx2 v[60:61], v116, s[4:7], s42 offen offset:64
    s_waitcnt vmcnt(11)
    v_add_f32 v28, v28, v148
    v_add_f32 v29, v29, v149
    v_add_f32 v30, v30, v150
    v_add_f32 v31, v31, v151
    v_cvt_pk_bf16_f32 v62, v28, v29
    v_cvt_pk_bf16_f32 v63, v30, v31
    buffer_store_dwordx2 v[62:63], v116, s[4:7], s42 offen offset:96
    s_waitcnt vmcnt(11)
    v_add_f32 v32, v32, v152
    v_add_f32 v33, v33, v153
    v_add_f32 v34, v34, v154
    v_add_f32 v35, v35, v155
    v_cvt_pk_bf16_f32 v64, v32, v33
    v_cvt_pk_bf16_f32 v65, v34, v35
    buffer_store_dwordx2 v[64:65], v116, s[4:7], s43 offen offset:0
    s_waitcnt vmcnt(11)
    v_add_f32 v36, v36, v156
    v_add_f32 v37, v37, v157
    v_add_f32 v38, v38, v158
    v_add_f32 v39, v39, v159
    v_cvt_pk_bf16_f32 v66, v36, v37
    v_cvt_pk_bf16_f32 v67, v38, v39
    buffer_store_dwordx2 v[66:67], v116, s[4:7], s43 offen offset:32
    s_waitcnt vmcnt(11)
    v_add_f32 v40, v40, v160
    v_add_f32 v41, v41, v161
    v_add_f32 v42, v42, v162
    v_add_f32 v43, v43, v163
    v_cvt_pk_bf16_f32 v68, v40, v41
    v_cvt_pk_bf16_f32 v69, v42, v43
    buffer_store_dwordx2 v[68:69], v116, s[4:7], s43 offen offset:64
    s_waitcnt vmcnt(11)
    v_add_f32 v44, v44, v164
    v_add_f32 v45, v45, v165
    v_add_f32 v46, v46, v166
    v_add_f32 v47, v47, v167
    v_cvt_pk_bf16_f32 v70, v44, v45
    v_cvt_pk_bf16_f32 v71, v46, v47
    buffer_store_dwordx2 v[70:71], v116, s[4:7], s43 offen offset:96
K1W2_TF:
    s_endpgm
K1W2_FINAL1:
    s_nop 7
    v_add_u32 v246, 81920, v248
    v_and_b32 v247, 15, v245
    v_lshlrev_b32 v247, 2, v247
    v_add_u32 v247, 114688, v247
    ds_write_b128 v246, v[64:67] offset:0
    ds_write_b128 v246, v[68:71] offset:1024
    ds_write_b128 v246, v[72:75] offset:2048
    ds_write_b128 v246, v[76:79] offset:3072
    ds_write_b128 v246, v[80:83] offset:4096
    ds_write_b128 v246, v[84:87] offset:5120
    ds_write_b128 v246, v[88:91] offset:6144
    ds_write_b128 v246, v[92:95] offset:7168
    v_mov_b32 v244, v230
    s_nop 1
    v_permlane16_swap_b32 v244, v230
    v_add_f32 v230, v230, v244
    v_mov_b32 v244, v230
    s_nop 1
    v_permlane32_swap_b32 v244, v230
    v_add_f32 v230, v230, v244
    v_sub_f32 v244, 0, v192
    ds_write_b32 v247, v244 offset:0
    ds_write_b32 v247, v230 offset:64
    v_mov_b32 v244, v228
    s_nop 1
    v_permlane16_swap_b32 v244, v228
    v_add_f32 v228, v228, v244
    v_mov_b32 v244, v228
    s_nop 1
    v_permlane32_swap_b32 v244, v228
    v_add_f32 v228, v228, v244
    v_mov_b32 v244, v229
    s_nop 1
    v_permlane16_swap_b32 v244, v229
    v_add_f32 v229, v229, v244
    v_mov_b32 v244, v229
    s_nop 1
    v_permlane32_swap_b32 v244, v229
    v_add_f32 v229, v229, v244
    v_rcp_f32 v228, v228
    v_rcp_f32 v229, v229
    v_mul_f32 v0, v0, v228
    v_mul_f32 v1, v1, v228
    v_mul_f32 v2, v2, v228
    v_mul_f32 v3, v3, v228
    v_mul_f32 v4, v4, v228
    v_mul_f32 v5, v5, v228
    v_mul_f32 v6, v6, v228
    v_mul_f32 v7, v7, v228
    v_cvt_pk_bf16_f32 v96, v0, v1
    v_cvt_pk_bf16_f32 v97, v2, v3
    v_cvt_pk_bf16_f32 v98, v4, v5
    v_cvt_pk_bf16_f32 v99, v6, v7
    v_mul_f32 v8, v8, v228
    v_mul_f32 v9, v9, v228
    v_mul_f32 v10, v10, v228
    v_mul_f32 v11, v11, v228
    v_mul_f32 v12, v12, v228
    v_mul_f32 v13, v13, v228
    v_mul_f32 v14, v14, v228
    v_mul_f32 v15, v15, v228
    v_cvt_pk_bf16_f32 v100, v8, v9
    v_cvt_pk_bf16_f32 v101, v10, v11
    v_cvt_pk_bf16_f32 v102, v12, v13
    v_cvt_pk_bf16_f32 v103, v14, v15
    v_mul_f32 v16, v16, v228
    v_mul_f32 v17, v17, v228
    v_mul_f32 v18, v18, v228
    v_mul_f32 v19, v19, v228
    v_mul_f32 v20, v20, v228
    v_mul_f32 v21, v21, v228
    v_mul_f32 v22, v22, v228
    v_mul_f32 v23, v23, v228
    v_cvt_pk_bf16_f32 v104, v16, v17
    v_cvt_pk_bf16_f32 v105, v18, v19
    v_cvt_pk_bf16_f32 v106, v20, v21
    v_cvt_pk_bf16_f32 v107, v22, v23
    v_mul_f32 v24, v24, v228
    v_mul_f32 v25, v25, v228
    v_mul_f32 v26, v26, v228
    v_mul_f32 v27, v27, v228
    v_mul_f32 v28, v28, v228
    v_mul_f32 v29, v29, v228
    v_mul_f32 v30, v30, v228
    v_mul_f32 v31, v31, v228
    v_cvt_pk_bf16_f32 v108, v24, v25
    v_cvt_pk_bf16_f32 v109, v26, v27
    v_cvt_pk_bf16_f32 v110, v28, v29
    v_cvt_pk_bf16_f32 v111, v30, v31
    v_mul_f32 v32, v32, v229
    v_mul_f32 v33, v33, v229
    v_mul_f32 v34, v34, v229
    v_mul_f32 v35, v35, v229
    v_mul_f32 v36, v36, v229
    v_mul_f32 v37, v37, v229
    v_mul_f32 v38, v38, v229
    v_mul_f32 v39, v39, v229
    v_cvt_pk_bf16_f32 v112, v32, v33
    v_cvt_pk_bf16_f32 v113, v34, v35
    v_cvt_pk_bf16_f32 v114, v36, v37
    v_cvt_pk_bf16_f32 v115, v38, v39
    v_mul_f32 v40, v40, v229
    v_mul_f32 v41, v41, v229
    v_mul_f32 v42, v42, v229
    v_mul_f32 v43, v43, v229
    v_mul_f32 v44, v44, v229
    v_mul_f32 v45, v45, v229
    v_mul_f32 v46, v46, v229
    v_mul_f32 v47, v47, v229
    v_cvt_pk_bf16_f32 v116, v40, v41
    v_cvt_pk_bf16_f32 v117, v42, v43
    v_cvt_pk_bf16_f32 v118, v44, v45
    v_cvt_pk_bf16_f32 v119, v46, v47
    v_mul_f32 v48, v48, v229
    v_mul_f32 v49, v49, v229
    v_mul_f32 v50, v50, v229
    v_mul_f32 v51, v51, v229
    v_mul_f32 v52, v52, v229
    v_mul_f32 v53, v53, v229
    v_mul_f32 v54, v54, v229
    v_mul_f32 v55, v55, v229
    v_cvt_pk_bf16_f32 v120, v48, v49
    v_cvt_pk_bf16_f32 v121, v50, v51
    v_cvt_pk_bf16_f32 v122, v52, v53
    v_cvt_pk_bf16_f32 v123, v54, v55
    v_mul_f32 v56, v56, v229
    v_mul_f32 v57, v57, v229
    v_mul_f32 v58, v58, v229
    v_mul_f32 v59, v59, v229
    v_mul_f32 v60, v60, v229
    v_mul_f32 v61, v61, v229
    v_mul_f32 v62, v62, v229
    v_mul_f32 v63, v63, v229
    v_cvt_pk_bf16_f32 v124, v56, v57
    v_cvt_pk_bf16_f32 v125, v58, v59
    v_cvt_pk_bf16_f32 v126, v60, v61
    v_cvt_pk_bf16_f32 v127, v62, v63
    s_waitcnt lgkmcnt(0)
    s_barrier
    ds_read_b32 v144, v247 offset:0
    ds_read_b32 v148, v247 offset:64
    ds_read_b32 v145, v247 offset:128
    ds_read_b32 v149, v247 offset:192
    ds_read_b128 v[32:35], v246 offset:4096
    ds_read_b128 v[36:39], v246 offset:5120
    ds_read_b128 v[40:43], v246 offset:12288
    ds_read_b128 v[44:47], v246 offset:13312
    s_waitcnt lgkmcnt(5)
    v_max_f32 v244, v144, v145
    v_sub_f32 v152, v144, v244
    v_sub_f32 v153, v145, v244
    v_exp_f32 v152, v152
    v_exp_f32 v153, v153
    v_mul_f32 v244, v152, v148
    s_waitcnt lgkmcnt(4)
    v_fma_f32 v244, v153, v149, v244
    v_rcp_f32 v244, v244
    s_nop 0
    v_mul_f32 v152, v152, v244
    v_mul_f32 v153, v153, v244
    s_waitcnt lgkmcnt(3)
    v_mul_f32 v0, v32, v152
    s_waitcnt lgkmcnt(1)
    v_fma_f32 v0, v40, v153, v0
    v_mul_f32 v1, v33, v152
    v_fma_f32 v1, v41, v153, v1
    v_mul_f32 v2, v34, v152
    v_fma_f32 v2, v42, v153, v2
    v_mul_f32 v3, v35, v152
    v_fma_f32 v3, v43, v153, v3
    v_mul_f32 v4, v36, v152
    s_waitcnt lgkmcnt(0)
    v_fma_f32 v4, v44, v153, v4
    v_mul_f32 v5, v37, v152
    v_fma_f32 v5, v45, v153, v5
    v_mul_f32 v6, v38, v152
    v_fma_f32 v6, v46, v153, v6
    v_mul_f32 v7, v39, v152
    v_fma_f32 v7, v47, v153, v7
    v_cvt_pk_bf16_f32 v128, v0, v1
    v_cvt_pk_bf16_f32 v129, v2, v3
    v_cvt_pk_bf16_f32 v130, v4, v5
    v_cvt_pk_bf16_f32 v131, v6, v7
    s_mov_b32 s30, 16384
    buffer_store_dwordx4 v[96:99], v248, s[20:23], s30 offen offset:0 sc1
    buffer_store_dwordx4 v[100:103], v248, s[20:23], s30 offen offset:1024 sc1
    buffer_store_dwordx4 v[104:107], v248, s[20:23], s30 offen offset:2048 sc1
    buffer_store_dwordx4 v[108:111], v248, s[20:23], s30 offen offset:3072 sc1
    s_mov_b32 s30, 20480
    buffer_store_dwordx4 v[112:115], v248, s[20:23], s30 offen offset:0 sc1
    buffer_store_dwordx4 v[116:119], v248, s[20:23], s30 offen offset:1024 sc1
    buffer_store_dwordx4 v[120:123], v248, s[20:23], s30 offen offset:2048 sc1
    buffer_store_dwordx4 v[124:127], v248, s[20:23], s30 offen offset:3072 sc1
    s_mov_b32 s30, 34816
    buffer_store_dwordx4 v[128:131], v248, s[20:23], s30 offen sc1
    s_lshl_b32 s30, s85, 3
    s_add_u32 s30, s30, s84
    s_mul_i32 s44, s30, 52
    s_lshr_b32 s44, s44, 8
    s_mul_i32 s31, s44, 5
    s_sub_u32 s45, s30, s31
    s_and_b32 s51, s2, 1
    s_load_dwordx2 s[72:73], s[0:1], 32
    s_load_dwordx2 s[74:75], s[0:1], 72
    s_load_dwordx2 s[46:47], s[0:1], 80
    s_waitcnt lgkmcnt(0)
    s_cmp_eq_u32 s64, 0
    s_cselect_b64 s[72:73], s[72:73], s[74:75]
    s_lshl_b32 s30, s45, 8
    s_add_u32 s12, s72, s30
    s_addc_u32 s13, s73, 0
    s_sub_u32 s14, 5242880, s30
    s_mov_b32 s15, 131072
    s_mov_b32 s16, s48
    s_mov_b32 s17, s49
    s_mov_b32 s18, 18874368
    s_mov_b32 s19, 131072
    s_add_u32 s80, s48, 50331648
    s_addc_u32 s81, s49, 0
    s_mov_b32 s82, 131072
    s_mov_b32 s83, 131072
    s_mov_b32 s4, s46
    s_mov_b32 s5, s47
    s_mov_b32 s6, 2949120
    s_mov_b32 s7, 131072
    s_add_u32 s8, s48, 33554432
    s_addc_u32 s9, s49, 0
    s_mov_b32 s10, 12582912
    s_mov_b32 s11, 131072
    s_sub_u32 s69, s65, s85
    s_mul_i32 s30, s44, 6
    s_add_u32 s30, s30, 0
    s_mul_i32 s31, s30, 57
    s_lshr_b32 s31, s31, 9
    s_mul_i32 s72, s31, 9
    s_sub_u32 s72, s30, s72
    s_add_u32 s31, s31, s69
    s_lshl_b32 s73, s64, 3
    s_add_u32 s73, s73, s31
    s_lshl_b32 s73, s73, 5
    s_lshl_b32 s74, s51, 4
    s_add_u32 s73, s73, s74
    s_mul_i32 s73, s73, 36864
    s_lshl_b32 s74, s72, 12
    s_add_u32 s32, s73, s74
    s_mul_i32 s73, s31, 144
    s_lshl_b32 s74, s72, 4
    s_add_u32 s73, s73, s74
    s_mul_i32 s73, s73, 2560
    s_mul_i32 s74, s64, 1280
    s_add_u32 s73, s73, s74
    s_lshl_b32 s74, s45, 8
    s_add_u32 s38, s73, s74
    s_mul_i32 s30, s44, 6
    s_add_u32 s30, s30, 1
    s_mul_i32 s31, s30, 57
    s_lshr_b32 s31, s31, 9
    s_mul_i32 s72, s31, 9
    s_sub_u32 s72, s30, s72
    s_add_u32 s31, s31, s69
    s_lshl_b32 s73, s64, 3
    s_add_u32 s73, s73, s31
    s_lshl_b32 s73, s73, 5
    s_lshl_b32 s74, s51, 4
    s_add_u32 s73, s73, s74
    s_mul_i32 s73, s73, 36864
    s_lshl_b32 s74, s72, 12
    s_add_u32 s33, s73, s74
    s_mul_i32 s73, s31, 144
    s_lshl_b32 s74, s72, 4
    s_add_u32 s73, s73, s74
    s_mul_i32 s73, s73, 2560
    s_mul_i32 s74, s64, 1280
    s_add_u32 s73, s73, s74
    s_lshl_b32 s74, s45, 8
    s_add_u32 s39, s73, s74
    s_mul_i32 s30, s44, 6
    s_add_u32 s30, s30, 2
    s_mul_i32 s31, s30, 57
    s_lshr_b32 s31, s31, 9
    s_mul_i32 s72, s31, 9
    s_sub_u32 s72, s30, s72
    s_add_u32 s31, s31, s69
    s_lshl_b32 s73, s64, 3
    s_add_u32 s73, s73, s31
    s_lshl_b32 s73, s73, 5
    s_lshl_b32 s74, s51, 4
    s_add_u32 s73, s73, s74
    s_mul_i32 s73, s73, 36864
    s_lshl_b32 s74, s72, 12
    s_add_u32 s34, s73, s74
    s_mul_i32 s73, s31, 144
    s_lshl_b32 s74, s72, 4
    s_add_u32 s73, s73, s74
    s_mul_i32 s73, s73, 2560
    s_mul_i32 s74, s64, 1280
    s_add_u32 s73, s73, s74
    s_lshl_b32 s74, s45, 8
    s_add_u32 s40, s73, s74
    s_mul_i32 s30, s44, 6
    s_add_u32 s30, s30, 3
    s_mul_i32 s31, s30, 57
    s_lshr_b32 s31, s31, 9
    s_mul_i32 s72, s31, 9
    s_sub_u32 s72, s30, s72
    s_add_u32 s31, s31, s69
    s_lshl_b32 s73, s64, 3
    s_add_u32 s73, s73, s31
    s_lshl_b32 s73, s73, 5
    s_lshl_b32 s74, s51, 4
    s_add_u32 s73, s73, s74
    s_mul_i32 s73, s73, 36864
    s_lshl_b32 s74, s72, 12
    s_add_u32 s35, s73, s74
    s_mul_i32 s73, s31, 144
    s_lshl_b32 s74, s72, 4
    s_add_u32 s73, s73, s74
    s_mul_i32 s73, s73, 2560
    s_mul_i32 s74, s64, 1280
    s_add_u32 s73, s73, s74
    s_lshl_b32 s74, s45, 8
    s_add_u32 s41, s73, s74
    s_mul_i32 s30, s44, 6
    s_add_u32 s30, s30, 4
    s_mul_i32 s31, s30, 57
    s_lshr_b32 s31, s31, 9
    s_mul_i32 s72, s31, 9
    s_sub_u32 s72, s30, s72
    s_add_u32 s31, s31, s69
    s_lshl_b32 s73, s64, 3
    s_add_u32 s73, s73, s31
    s_lshl_b32 s73, s73, 5
    s_lshl_b32 s74, s51, 4
    s_add_u32 s73, s73, s74
    s_mul_i32 s73, s73, 36864
    s_lshl_b32 s74, s72, 12
    s_add_u32 s36, s73, s74
    s_mul_i32 s73, s31, 144
    s_lshl_b32 s74, s72, 4
    s_add_u32 s73, s73, s74
    s_mul_i32 s73, s73, 2560
    s_mul_i32 s74, s64, 1280
    s_add_u32 s73, s73, s74
    s_lshl_b32 s74, s45, 8
    s_add_u32 s42, s73, s74
    s_mul_i32 s30, s44, 6
    s_add_u32 s30, s30, 5
    s_mul_i32 s31, s30, 57
    s_lshr_b32 s31, s31, 9
    s_mul_i32 s72, s31, 9
    s_sub_u32 s72, s30, s72
    s_add_u32 s31, s31, s69
    s_lshl_b32 s73, s64, 3
    s_add_u32 s73, s73, s31
    s_lshl_b32 s73, s73, 5
    s_lshl_b32 s74, s51, 4
    s_add_u32 s73, s73, s74
    s_mul_i32 s73, s73, 36864
    s_lshl_b32 s74, s72, 12
    s_add_u32 s37, s73, s74
    s_mul_i32 s73, s31, 144
    s_lshl_b32 s74, s72, 4
    s_add_u32 s73, s73, s74
    s_mul_i32 s73, s73, 2560
    s_mul_i32 s74, s64, 1280
    s_add_u32 s73, s73, s74
    s_lshl_b32 s74, s45, 8
    s_add_u32 s43, s73, s74
    s_mul_i32 s53, s51, 2621440
    v_lshrrev_b32 v116, 4, v245
    v_and_b32 v117, 15, v245
    v_lshlrev_b32 v118, 1, v116
    v_xor_b32 v117, v117, v118
    v_lshlrev_b32 v117, 4, v117
    v_mul_u32_u24 v116, 1280, v116
    v_add_u32 v114, v116, v117
    v_xor_b32 v117, 128, v117
    v_add_u32 v115, v116, v117
    s_waitcnt vmcnt(0) lgkmcnt(0)
    s_barrier
    s_cmp_ge_u32 s44, 6
    s_cbranch_scc1 K1_END
    s_mov_b32 m0, 20480
    s_add_u32 s30, s53, 40960
    buffer_load_dwordx4 v114, s[12:15], s30 offen offset:0 lds
    s_add_u32 s30, s53, 45056
    buffer_load_dwordx4 v115, s[12:15], s30 offen offset:1024 lds
    s_add_u32 s30, s53, 49152
    buffer_load_dwordx4 v114, s[12:15], s30 offen offset:2048 lds
    s_add_u32 s30, s53, 53248
    buffer_load_dwordx4 v115, s[12:15], s30 offen offset:3072 lds
    s_mov_b32 m0, 49152
    s_add_u32 s30, s53, 122880
    buffer_load_dwordx4 v114, s[12:15], s30 offen offset:0 lds
    s_add_u32 s30, s53, 126976
    buffer_load_dwordx4 v115, s[12:15], s30 offen offset:1024 lds
    s_add_u32 s30, s53, 131072
    buffer_load_dwordx4 v114, s[12:15], s30 offen offset:2048 lds
    s_add_u32 s30, s53, 135168
    buffer_load_dwordx4 v115, s[12:15], s30 offen offset:3072 lds
    s_mov_b32 m0, 77824
    s_add_u32 s30, s53, 204800
    buffer_load_dwordx4 v114, s[12:15], s30 offen offset:0 lds
    s_add_u32 s30, s53, 208896
    buffer_load_dwordx4 v115, s[12:15], s30 offen offset:1024 lds
    s_add_u32 s30, s53, 212992
    buffer_load_dwordx4 v114, s[12:15], s30 offen offset:2048 lds
    s_add_u32 s30, s53, 217088
    buffer_load_dwordx4 v115, s[12:15], s30 offen offset:3072 lds
    s_barrier
    s_mov_b32 m0, 6144
    s_add_u32 s30, s35, 0
    buffer_load_dwordx4 v248, s[16:19], s30 offen lds
    s_mov_b32 m0, 7168
    s_add_u32 s30, s35, 1024
    buffer_load_dwordx4 v248, s[16:19], s30 offen lds
    s_mov_b32 m0, 8192
    s_add_u32 s30, s36, 0
    buffer_load_dwordx4 v248, s[16:19], s30 offen lds
    s_mov_b32 m0, 34816
    s_add_u32 s30, s35, 2048
    buffer_load_dwordx4 v248, s[16:19], s30 offen lds
    s_mov_b32 m0, 35840
    s_add_u32 s30, s35, 3072
    buffer_load_dwordx4 v248, s[16:19], s30 offen lds
    s_mov_b32 m0, 36864
    s_add_u32 s30, s36, 2048
    buffer_load_dwordx4 v248, s[16:19], s30 offen lds
    s_mov_b32 m0, 63488
    s_add_u32 s30, s35, 36864
    buffer_load_dwordx4 v248, s[16:19], s30 offen lds
    s_mov_b32 m0, 64512
    s_add_u32 s30, s35, 37888
    buffer_load_dwordx4 v248, s[16:19], s30 offen lds
    s_mov_b32 m0, 65536
    s_add_u32 s30, s36, 36864
    buffer_load_dwordx4 v248, s[16:19], s30 offen lds
    s_mov_b32 s58, 0
K1W2_TL:
    s_cmp_eq_u32 s58, 0
    s_cbranch_scc0 K1W2_TLw0
    s_waitcnt vmcnt(6)
    s_branch K1W2_TLx0
K1W2_TLw0:
    s_waitcnt vmcnt(14)
K1W2_TLx0:
    s_barrier
    s_mov_b32 m0, 92160
    s_add_u32 s30, s35, 38912
    buffer_load_dwordx4 v248, s[16:19], s30 offen lds
    s_mov_b32 m0, 93184
    s_add_u32 s30, s35, 39936
    buffer_load_dwordx4 v248, s[16:19], s30 offen lds
    s_mov_b32 m0, 94208
    s_add_u32 s30, s36, 38912
    buffer_load_dwordx4 v248, s[16:19], s30 offen lds
    s_mov_b32 m0, 106496
    s_add_u32 s30, s53, 286720
    buffer_load_dwordx4 v114, s[12:15], s30 offen offset:0 lds
    s_add_u32 s30, s53, 290816
    buffer_load_dwordx4 v115, s[12:15], s30 offen offset:1024 lds
    s_add_u32 s30, s53, 294912
    buffer_load_dwordx4 v114, s[12:15], s30 offen offset:2048 lds
    s_add_u32 s30, s53, 299008
    buffer_load_dwordx4 v115, s[12:15], s30 offen offset:3072 lds
    s_cmp_eq_u32 s58, 0
    s_cbranch_scc0 K1W2_TLw1
    s_waitcnt vmcnt(10)
    s_branch K1W2_TLx1
K1W2_TLw1:
    s_waitcnt vmcnt(14)
K1W2_TLx1:
    s_barrier
    s_cmp_eq_u32 s58, 7
    s_cbranch_scc1 K1W2_TLs1
    s_mov_b32 m0, 6144
    s_add_u32 s30, s35, 73728
    buffer_load_dwordx4 v248, s[16:19], s30 offen lds
    s_mov_b32 m0, 7168
    s_add_u32 s30, s35, 74752
    buffer_load_dwordx4 v248, s[16:19], s30 offen lds
    s_mov_b32 m0, 8192
    s_add_u32 s30, s36, 73728
    buffer_load_dwordx4 v248, s[16:19], s30 offen lds
    s_mov_b32 m0, 20480
    s_add_u32 s30, s53, 368640
    buffer_load_dwordx4 v114, s[12:15], s30 offen offset:0 lds
    s_add_u32 s30, s53, 372736
    buffer_load_dwordx4 v115, s[12:15], s30 offen offset:1024 lds
    s_add_u32 s30, s53, 376832
    buffer_load_dwordx4 v114, s[12:15], s30 offen offset:2048 lds
    s_add_u32 s30, s53, 380928
    buffer_load_dwordx4 v115, s[12:15], s30 offen offset:3072 lds
K1W2_TLs1:
    s_cmp_eq_u32 s58, 0
    s_cbranch_scc0 K1W2_TLw2
    s_waitcnt vmcnt(14)
    s_branch K1W2_TLx2
K1W2_TLw2:
    s_cmp_eq_u32 s58, 7
    s_cbranch_scc0 K1W2_TLu2
    s_waitcnt vmcnt(7)
    s_branch K1W2_TLx2
K1W2_TLu2:
    s_waitcnt vmcnt(14)
K1W2_TLx2:
    s_barrier
    s_cmp_eq_u32 s58, 7
    s_cbranch_scc1 K1W2_TLs2
    s_mov_b32 m0, 34816
    s_add_u32 s30, s35, 75776
    buffer_load_dwordx4 v248, s[16:19], s30 offen lds
    s_mov_b32 m0, 35840
    s_add_u32 s30, s35, 76800
    buffer_load_dwordx4 v248, s[16:19], s30 offen lds
    s_mov_b32 m0, 36864
    s_add_u32 s30, s36, 75776
    buffer_load_dwordx4 v248, s[16:19], s30 offen lds
    s_mov_b32 m0, 49152
    s_add_u32 s30, s53, 450560
    buffer_load_dwordx4 v114, s[12:15], s30 offen offset:0 lds
    s_add_u32 s30, s53, 454656
    buffer_load_dwordx4 v115, s[12:15], s30 offen offset:1024 lds
    s_add_u32 s30, s53, 458752
    buffer_load_dwordx4 v114, s[12:15], s30 offen offset:2048 lds
    s_add_u32 s30, s53, 462848
    buffer_load_dwordx4 v115, s[12:15], s30 offen offset:3072 lds
K1W2_TLs2:
    s_cmp_eq_u32 s58, 7
    s_cbranch_scc0 K1W2_TLu3
    s_waitcnt vmcnt(0)
    s_branch K1W2_TLx3
K1W2_TLu3:
    s_waitcnt vmcnt(14)
K1W2_TLx3:
    s_barrier
    s_cmp_eq_u32 s58, 7
    s_cbranch_scc1 K1W2_TLs3
    s_mov_b32 m0, 63488
    s_add_u32 s30, s35, 110592
    buffer_load_dwordx4 v248, s[16:19], s30 offen lds
    s_mov_b32 m0, 64512
    s_add_u32 s30, s35, 111616
    buffer_load_dwordx4 v248, s[16:19], s30 offen lds
    s_mov_b32 m0, 65536
    s_add_u32 s30, s36, 110592
    buffer_load_dwordx4 v248, s[16:19], s30 offen lds
    s_mov_b32 m0, 77824
    s_add_u32 s30, s53, 532480
    buffer_load_dwordx4 v114, s[12:15], s30 offen offset:0 lds
    s_add_u32 s30, s53, 536576
    buffer_load_dwordx4 v115, s[12:15], s30 offen offset:1024 lds
    s_add_u32 s30, s53, 540672
    buffer_load_dwordx4 v114, s[12:15], s30 offen offset:2048 lds
    s_add_u32 s30, s53, 544768
    buffer_load_dwordx4 v115, s[12:15], s30 offen offset:3072 lds
K1W2_TLs3:
    s_add_u32 s32, s32, 73728
    s_add_u32 s33, s33, 73728
    s_add_u32 s34, s34, 73728
    s_add_u32 s35, s35, 73728
    s_add_u32 s36, s36, 73728
    s_add_u32 s37, s37, 73728
    s_add_u32 s53, s53, 327680
    s_add_u32 s58, s58, 1
    s_cmp_lt_u32 s58, 8
    s_cbranch_scc1 K1W2_TL
    s_endpgm
K1W2_slow0:
    s_nop 7
    ds_read_b128 v[196:199], v234 offset:0
    ds_read_b128 v[200:203], v235 offset:0
    ds_read_b128 v[204:207], v236 offset:0
    ds_read_b128 v[208:211], v237 offset:0
    ds_read_b128 v[212:215], v234 offset:4096
    ds_read_b128 v[216:219], v235 offset:4096
    ds_read_b128 v[220:223], v236 offset:4096
    ds_read_b128 v[224:227], v237 offset:4096
    s_waitcnt lgkmcnt(7)
    v_mfma_f32_16x16x32_bf16 v[144:147], v[196:199], v[96:99], 0
    v_mfma_f32_16x16x32_bf16 v[160:163], v[196:199], v[112:115], 0
    v_mfma_f32_16x16x32_bf16 v[176:179], v[196:199], v[128:131], 0
    s_waitcnt lgkmcnt(6)
    v_mfma_f32_16x16x32_bf16 v[144:147], v[200:203], v[100:103], v[144:147]
    v_mfma_f32_16x16x32_bf16 v[160:163], v[200:203], v[116:119], v[160:163]
    v_mfma_f32_16x16x32_bf16 v[176:179], v[200:203], v[132:135], v[176:179]
    s_waitcnt lgkmcnt(5)
    v_mfma_f32_16x16x32_bf16 v[144:147], v[204:207], v[104:107], v[144:147]
    v_mfma_f32_16x16x32_bf16 v[160:163], v[204:207], v[120:123], v[160:163]
    v_mfma_f32_16x16x32_bf16 v[176:179], v[204:207], v[136:139], v[176:179]
    s_waitcnt lgkmcnt(4)
    v_mfma_f32_16x16x32_bf16 v[144:147], v[208:211], v[108:111], v[144:147]
    v_mfma_f32_16x16x32_bf16 v[160:163], v[208:211], v[124:127], v[160:163]
    v_mfma_f32_16x16x32_bf16 v[176:179], v[208:211], v[140:143], v[176:179]
    ds_read_b128 v[196:199], v234 offset:8192
    ds_read_b128 v[200:203], v235 offset:8192
    ds_read_b128 v[204:207], v236 offset:8192
    ds_read_b128 v[208:211], v237 offset:8192
    s_waitcnt lgkmcnt(7)
    v_mfma_f32_16x16x32_bf16 v[148:151], v[212:215], v[96:99], 0
    v_mfma_f32_16x16x32_bf16 v[164:167], v[212:215], v[112:115], 0
    v_mfma_f32_16x16x32_bf16 v[180:183], v[212:215], v[128:131], 0
    s_waitcnt lgkmcnt(6)
    v_mfma_f32_16x16x32_bf16 v[148:151], v[216:219], v[100:103], v[148:151]
    v_mfma_f32_16x16x32_bf16 v[164:167], v[216:219], v[116:119], v[164:167]
    v_mfma_f32_16x16x32_bf16 v[180:183], v[216:219], v[132:135], v[180:183]
    s_waitcnt lgkmcnt(5)
    v_mfma_f32_16x16x32_bf16 v[148:151], v[220:223], v[104:107], v[148:151]
    v_mfma_f32_16x16x32_bf16 v[164:167], v[220:223], v[120:123], v[164:167]
    v_mfma_f32_16x16x32_bf16 v[180:183], v[220:223], v[136:139], v[180:183]
    s_waitcnt lgkmcnt(4)
    v_mfma_f32_16x16x32_bf16 v[148:151], v[224:227], v[108:111], v[148:151]
    v_mfma_f32_16x16x32_bf16 v[164:167], v[224:227], v[124:127], v[164:167]
    v_mfma_f32_16x16x32_bf16 v[180:183], v[224:227], v[140:143], v[180:183]
    ds_read_b128 v[212:215], v234 offset:12288
    ds_read_b128 v[216:219], v235 offset:12288
    ds_read_b128 v[220:223], v236 offset:12288
    ds_read_b128 v[224:227], v237 offset:12288
    s_waitcnt lgkmcnt(7)
    v_mfma_f32_16x16x32_bf16 v[152:155], v[196:199], v[96:99], 0
    v_mfma_f32_16x16x32_bf16 v[168:171], v[196:199], v[112:115], 0
    s_waitcnt lgkmcnt(6)
    v_mfma_f32_16x16x32_bf16 v[152:155], v[200:203], v[100:103], v[152:155]
    v_mfma_f32_16x16x32_bf16 v[168:171], v[200:203], v[116:119], v[168:171]
    s_waitcnt lgkmcnt(5)
    v_mfma_f32_16x16x32_bf16 v[152:155], v[204:207], v[104:107], v[152:155]
    v_mfma_f32_16x16x32_bf16 v[168:171], v[204:207], v[120:123], v[168:171]
    s_waitcnt lgkmcnt(4)
    v_mfma_f32_16x16x32_bf16 v[152:155], v[208:211], v[108:111], v[152:155]
    v_mfma_f32_16x16x32_bf16 v[168:171], v[208:211], v[124:127], v[168:171]
    s_waitcnt lgkmcnt(3)
    v_mfma_f32_16x16x32_bf16 v[156:159], v[212:215], v[96:99], 0
    v_mfma_f32_16x16x32_bf16 v[172:175], v[212:215], v[112:115], 0
    s_waitcnt lgkmcnt(2)
    v_mfma_f32_16x16x32_bf16 v[156:159], v[216:219], v[100:103], v[156:159]
    v_mfma_f32_16x16x32_bf16 v[172:175], v[216:219], v[116:119], v[172:175]
    s_waitcnt lgkmcnt(1)
    v_mfma_f32_16x16x32_bf16 v[156:159], v[220:223], v[104:107], v[156:159]
    v_mfma_f32_16x16x32_bf16 v[172:175], v[220:223], v[120:123], v[172:175]
    s_waitcnt lgkmcnt(0)
    v_mfma_f32_16x16x32_bf16 v[156:159], v[224:227], v[108:111], v[156:159]
    v_mfma_f32_16x16x32_bf16 v[172:175], v[224:227], v[124:127], v[172:175]
    v_max3_f32 v243, v144, v145, v146
    v_max3_f32 v243, v243, v147, v148
    v_max3_f32 v243, v243, v149, v150
    v_max3_f32 v243, v243, v151, v152
    v_max3_f32 v243, v243, v153, v154
    s_nop 1
    v_max3_f32 v243, v243, v155, v156
    v_max3_f32 v243, v243, v157, v158
    v_max_f32 v243, v243, v159
    v_mov_b32 v244, v243
    s_nop 1
    v_permlane16_swap_b32 v244, v243
    v_max_f32 v243, v243, v244
    v_mov_b32 v244, v243
    s_nop 1
    v_permlane32_swap_b32 v244, v243
    v_max_f32 v243, v243, v244
    v_sub_f32 v244, 0, v184
    v_max_f32 v243, v243, v244
    v_sub_f32 v244, v244, v243
    v_exp_f32 v244, v244
    v_sub_f32 v184, 0, v243
    v_sub_f32 v185, 0, v243
    v_sub_f32 v186, 0, v243
    v_sub_f32 v187, 0, v243
    v_mul_f32 v0, v0, v244
    v_mul_f32 v1, v1, v244
    v_mul_f32 v2, v2, v244
    v_mul_f32 v3, v3, v244
    v_mul_f32 v4, v4, v244
    v_mul_f32 v5, v5, v244
    v_mul_f32 v6, v6, v244
    v_mul_f32 v7, v7, v244
    v_mul_f32 v8, v8, v244
    v_mul_f32 v9, v9, v244
    v_mul_f32 v10, v10, v244
    v_mul_f32 v11, v11, v244
    v_mul_f32 v12, v12, v244
    v_mul_f32 v13, v13, v244
    v_mul_f32 v14, v14, v244
    v_mul_f32 v15, v15, v244
    v_mul_f32 v16, v16, v244
    v_mul_f32 v17, v17, v244
    v_mul_f32 v18, v18, v244
    v_mul_f32 v19, v19, v244
    v_mul_f32 v20, v20, v244
    v_mul_f32 v21, v21, v244
    v_mul_f32 v22, v22, v244
    v_mul_f32 v23, v23, v244
    v_mul_f32 v24, v24, v244
    v_mul_f32 v25, v25, v244
    v_mul_f32 v26, v26, v244
    v_mul_f32 v27, v27, v244
    v_mul_f32 v28, v28, v244
    v_mul_f32 v29, v29, v244
    v_mul_f32 v30, v30, v244
    v_mul_f32 v31, v31, v244
    v_mul_f32 v228, v228, v244
    v_sub_f32 v144, v144, v243
    v_sub_f32 v145, v145, v243
    v_sub_f32 v146, v146, v243
    v_sub_f32 v147, v147, v243
    v_sub_f32 v148, v148, v243
    v_sub_f32 v149, v149, v243
    v_sub_f32 v150, v150, v243
    v_sub_f32 v151, v151, v243
    v_sub_f32 v152, v152, v243
    v_sub_f32 v153, v153, v243
    v_sub_f32 v154, v154, v243
    v_sub_f32 v155, v155, v243
    v_sub_f32 v156, v156, v243
    v_sub_f32 v157, v157, v243
    v_sub_f32 v158, v158, v243
    v_sub_f32 v159, v159, v243
    v_max3_f32 v243, v160, v161, v162
    v_max3_f32 v243, v243, v163, v164
    v_max3_f32 v243, v243, v165, v166
    v_max3_f32 v243, v243, v167, v168
    v_max3_f32 v243, v243, v169, v170
    v_max3_f32 v243, v243, v171, v172
    v_max3_f32 v243, v243, v173, v174
    v_max_f32 v243, v243, v175
    v_mov_b32 v244, v243
    s_nop 1
    v_permlane16_swap_b32 v244, v243
    v_max_f32 v243, v243, v244
    v_mov_b32 v244, v243
    s_nop 1
    v_permlane32_swap_b32 v244, v243
    v_max_f32 v243, v243, v244
    v_sub_f32 v244, 0, v188
    v_max_f32 v243, v243, v244
    v_sub_f32 v244, v244, v243
    v_exp_f32 v244, v244
    v_sub_f32 v188, 0, v243
    v_sub_f32 v189, 0, v243
    v_sub_f32 v190, 0, v243
    v_sub_f32 v191, 0, v243
    v_mul_f32 v32, v32, v244
    v_mul_f32 v33, v33, v244
    v_mul_f32 v34, v34, v244
    v_mul_f32 v35, v35, v244
    v_mul_f32 v36, v36, v244
    v_mul_f32 v37, v37, v244
    v_mul_f32 v38, v38, v244
    v_mul_f32 v39, v39, v244
    v_mul_f32 v40, v40, v244
    v_mul_f32 v41, v41, v244
    v_mul_f32 v42, v42, v244
    v_mul_f32 v43, v43, v244
    v_mul_f32 v44, v44, v244
    v_mul_f32 v45, v45, v244
    v_mul_f32 v46, v46, v244
    v_mul_f32 v47, v47, v244
    v_mul_f32 v48, v48, v244
    v_mul_f32 v49, v49, v244
    v_mul_f32 v50, v50, v244
    v_mul_f32 v51, v51, v244
    v_mul_f32 v52, v52, v244
    v_mul_f32 v53, v53, v244
    v_mul_f32 v54, v54, v244
    v_mul_f32 v55, v55, v244
    v_mul_f32 v56, v56, v244
    v_mul_f32 v57, v57, v244
    v_mul_f32 v58, v58, v244
    v_mul_f32 v59, v59, v244
    v_mul_f32 v60, v60, v244
    v_mul_f32 v61, v61, v244
    v_mul_f32 v62, v62, v244
    v_mul_f32 v63, v63, v244
    v_mul_f32 v229, v229, v244
    v_sub_f32 v160, v160, v243
    v_sub_f32 v161, v161, v243
    v_sub_f32 v162, v162, v243
    v_sub_f32 v163, v163, v243
    v_sub_f32 v164, v164, v243
    v_sub_f32 v165, v165, v243
    v_sub_f32 v166, v166, v243
    v_sub_f32 v167, v167, v243
    v_sub_f32 v168, v168, v243
    v_sub_f32 v169, v169, v243
    v_sub_f32 v170, v170, v243
    v_sub_f32 v171, v171, v243
    v_sub_f32 v172, v172, v243
    v_sub_f32 v173, v173, v243
    v_sub_f32 v174, v174, v243
    v_sub_f32 v175, v175, v243
    v_max3_f32 v243, v176, v177, v178
    v_max3_f32 v243, v243, v179, v180
    v_max3_f32 v243, v243, v181, v182
    v_max_f32 v243, v243, v183
    v_mov_b32 v244, v243
    s_nop 1
    v_permlane16_swap_b32 v244, v243
    v_max_f32 v243, v243, v244
    v_mov_b32 v244, v243
    s_nop 1
    v_permlane32_swap_b32 v244, v243
    v_max_f32 v243, v243, v244
    v_sub_f32 v244, 0, v192
    v_max_f32 v243, v243, v244
    v_sub_f32 v244, v244, v243
    v_exp_f32 v244, v244
    v_sub_f32 v192, 0, v243
    v_sub_f32 v193, 0, v243
    v_sub_f32 v194, 0, v243
    v_sub_f32 v195, 0, v243
    v_mul_f32 v64, v64, v244
    v_mul_f32 v65, v65, v244
    v_mul_f32 v66, v66, v244
    v_mul_f32 v67, v67, v244
    v_mul_f32 v68, v68, v244
    v_mul_f32 v69, v69, v244
    v_mul_f32 v70, v70, v244
    v_mul_f32 v71, v71, v244
    v_mul_f32 v72, v72, v244
    v_mul_f32 v73, v73, v244
    v_mul_f32 v74, v74, v244
    v_mul_f32 v75, v75, v244
    v_mul_f32 v76, v76, v244
    v_mul_f32 v77, v77, v244
    v_mul_f32 v78, v78, v244
    v_mul_f32 v79, v79, v244
    v_mul_f32 v80, v80, v244
    v_mul_f32 v81, v81, v244
    v_mul_f32 v82, v82, v244
    v_mul_f32 v83, v83, v244
    v_mul_f32 v84, v84, v244
    v_mul_f32 v85, v85, v244
    v_mul_f32 v86, v86, v244
    v_mul_f32 v87, v87, v244
    v_mul_f32 v88, v88, v244
    v_mul_f32 v89, v89, v244
    v_mul_f32 v90, v90, v244
    v_mul_f32 v91, v91, v244
    v_mul_f32 v92, v92, v244
    v_mul_f32 v93, v93, v244
    v_mul_f32 v94, v94, v244
    v_mul_f32 v95, v95, v244
    v_mul_f32 v230, v230, v244
    v_sub_f32 v176, v176, v243
    v_sub_f32 v177, v177, v243
    v_sub_f32 v178, v178, v243
    v_sub_f32 v179, v179, v243
    v_sub_f32 v180, v180, v243
    v_sub_f32 v181, v181, v243
    v_sub_f32 v182, v182, v243
    v_sub_f32 v183, v183, v243
    v_exp_f32 v144, v144
    v_exp_f32 v145, v145
    v_exp_f32 v146, v146
    v_exp_f32 v147, v147
    v_exp_f32 v160, v160
    v_exp_f32 v161, v161
    v_exp_f32 v162, v162
    v_exp_f32 v163, v163
    v_exp_f32 v176, v176
    v_exp_f32 v177, v177
    v_exp_f32 v178, v178
    v_exp_f32 v179, v179
    v_exp_f32 v148, v148
    v_exp_f32 v149, v149
    v_exp_f32 v150, v150
    v_exp_f32 v151, v151
    v_exp_f32 v164, v164
    v_exp_f32 v165, v165
    v_exp_f32 v166, v166
    v_exp_f32 v167, v167
    v_exp_f32 v180, v180
    v_exp_f32 v181, v181
    v_exp_f32 v182, v182
    v_exp_f32 v183, v183
    v_add_f32 v231, v144, v145
    v_add_f32 v231, v231, v146
    v_add_f32 v231, v231, v147
    v_add_f32 v232, v160, v161
    v_add_f32 v232, v232, v162
    v_add_f32 v232, v232, v163
    v_add_f32 v233, v176, v177
    v_add_f32 v233, v233, v178
    v_add_f32 v233, v233, v179
    v_add_f32 v231, v231, v148
    v_add_f32 v231, v231, v149
    v_add_f32 v231, v231, v150
    v_add_f32 v231, v231, v151
    v_add_f32 v232, v232, v164
    v_add_f32 v232, v232, v165
    v_add_f32 v232, v232, v166
    v_add_f32 v232, v232, v167
    v_add_f32 v233, v233, v180
    v_add_f32 v233, v233, v181
    v_add_f32 v233, v233, v182
    v_add_f32 v233, v233, v183
    v_cvt_pk_bf16_f32 v144, v144, v145
    v_cvt_pk_bf16_f32 v145, v146, v147
    v_cvt_pk_bf16_f32 v146, v148, v149
    v_cvt_pk_bf16_f32 v147, v150, v151
    v_cvt_pk_bf16_f32 v160, v160, v161
    v_cvt_pk_bf16_f32 v161, v162, v163
    v_cvt_pk_bf16_f32 v162, v164, v165
    v_cvt_pk_bf16_f32 v163, v166, v167
    v_cvt_pk_bf16_f32 v176, v176, v177
    v_cvt_pk_bf16_f32 v177, v178, v179
    v_cvt_pk_bf16_f32 v178, v180, v181
    v_cvt_pk_bf16_f32 v179, v182, v183
    s_nop 1
    s_branch K1W2_back0
K1W2_slow1:
    s_nop 7
    ds_read_b128 v[196:199], v234 offset:8192
    ds_read_b128 v[200:203], v235 offset:8192
    ds_read_b128 v[204:207], v236 offset:8192
    ds_read_b128 v[208:211], v237 offset:8192
    ds_read_b128 v[212:215], v234 offset:12288
    ds_read_b128 v[216:219], v235 offset:12288
    ds_read_b128 v[220:223], v236 offset:12288
    ds_read_b128 v[224:227], v237 offset:12288
    s_waitcnt lgkmcnt(7)
    v_mfma_f32_16x16x32_bf16 v[152:155], v[196:199], v[96:99], 0
    v_mfma_f32_16x16x32_bf16 v[168:171], v[196:199], v[112:115], 0
    s_waitcnt lgkmcnt(6)
    v_mfma_f32_16x16x32_bf16 v[152:155], v[200:203], v[100:103], v[152:155]
    v_mfma_f32_16x16x32_bf16 v[168:171], v[200:203], v[116:119], v[168:171]
    s_waitcnt lgkmcnt(5)
    v_mfma_f32_16x16x32_bf16 v[152:155], v[204:207], v[104:107], v[152:155]
    v_mfma_f32_16x16x32_bf16 v[168:171], v[204:207], v[120:123], v[168:171]
    s_waitcnt lgkmcnt(4)
    v_mfma_f32_16x16x32_bf16 v[152:155], v[208:211], v[108:111], v[152:155]
    v_mfma_f32_16x16x32_bf16 v[168:171], v[208:211], v[124:127], v[168:171]
    s_waitcnt lgkmcnt(3)
    v_mfma_f32_16x16x32_bf16 v[156:159], v[212:215], v[96:99], 0
    v_mfma_f32_16x16x32_bf16 v[172:175], v[212:215], v[112:115], 0
    s_waitcnt lgkmcnt(2)
    v_mfma_f32_16x16x32_bf16 v[156:159], v[216:219], v[100:103], v[156:159]
    v_mfma_f32_16x16x32_bf16 v[172:175], v[216:219], v[116:119], v[172:175]
    s_waitcnt lgkmcnt(1)
    v_mfma_f32_16x16x32_bf16 v[156:159], v[220:223], v[104:107], v[156:159]
    v_mfma_f32_16x16x32_bf16 v[172:175], v[220:223], v[120:123], v[172:175]
    s_waitcnt lgkmcnt(0)
    v_mfma_f32_16x16x32_bf16 v[156:159], v[224:227], v[108:111], v[156:159]
    v_mfma_f32_16x16x32_bf16 v[172:175], v[224:227], v[124:127], v[172:175]
    v_max3_f32 v243, v152, v153, v154
    s_nop 5
    v_max3_f32 v243, v243, v155, v156
    v_max3_f32 v243, v243, v157, v158
    v_max_f32 v243, v243, v159
    v_mov_b32 v244, v243
    s_nop 1
    v_permlane16_swap_b32 v244, v243
    v_max_f32 v243, v243, v244
    v_mov_b32 v244, v243
    s_nop 1
    v_permlane32_swap_b32 v244, v243
    v_max_f32 v243, v243, v244
    v_sub_f32 v244, 0, v184
    v_max_f32 v243, v243, v244
    v_sub_f32 v244, v244, v243
    v_exp_f32 v244, v244
    v_sub_f32 v184, 0, v243
    v_sub_f32 v185, 0, v243
    v_sub_f32 v186, 0, v243
    v_sub_f32 v187, 0, v243
    v_mul_f32 v0, v0, v244
    v_mul_f32 v1, v1, v244
    v_mul_f32 v2, v2, v244
    v_mul_f32 v3, v3, v244
    v_mul_f32 v4, v4, v244
    v_mul_f32 v5, v5, v244
    v_mul_f32 v6, v6, v244
    v_mul_f32 v7, v7, v244
    v_mul_f32 v8, v8, v244
    v_mul_f32 v9, v9, v244
    v_mul_f32 v10, v10, v244
    v_mul_f32 v11, v11, v244
    v_mul_f32 v12, v12, v244
    v_mul_f32 v13, v13, v244
    v_mul_f32 v14, v14, v244
    v_mul_f32 v15, v15, v244
    v_mul_f32 v16, v16, v244
    v_mul_f32 v17, v17, v244
    v_mul_f32 v18, v18, v244
    v_mul_f32 v19, v19, v244
    v_mul_f32 v20, v20, v244
    v_mul_f32 v21, v21, v244
    v_mul_f32 v22, v22, v244
    v_mul_f32 v23, v23, v244
    v_mul_f32 v24, v24, v244
    v_mul_f32 v25, v25, v244
    v_mul_f32 v26, v26, v244
    v_mul_f32 v27, v27, v244
    v_mul_f32 v28, v28, v244
    v_mul_f32 v29, v29, v244
    v_mul_f32 v30, v30, v244
    v_mul_f32 v31, v31, v244
    v_mul_f32 v228, v228, v244
    v_sub_f32 v152, v152, v243
    v_sub_f32 v153, v153, v243
    v_sub_f32 v154, v154, v243
    v_sub_f32 v155, v155, v243
    v_sub_f32 v156, v156, v243
    v_sub_f32 v157, v157, v243
    v_sub_f32 v158, v158, v243
    v_sub_f32 v159, v159, v243
    v_max3_f32 v243, v168, v169, v170
    v_max3_f32 v243, v243, v171, v172
    v_max3_f32 v243, v243, v173, v174
    v_max_f32 v243, v243, v175
    v_mov_b32 v244, v243
    s_nop 1
    v_permlane16_swap_b32 v244, v243
    v_max_f32 v243, v243, v244
    v_mov_b32 v244, v243
    s_nop 1
    v_permlane32_swap_b32 v244, v243
    v_max_f32 v243, v243, v244
    v_sub_f32 v244, 0, v188
    v_max_f32 v243, v243, v244
    v_sub_f32 v244, v244, v243
    v_exp_f32 v244, v244
    v_sub_f32 v188, 0, v243
    v_sub_f32 v189, 0, v243
    v_sub_f32 v190, 0, v243
    v_sub_f32 v191, 0, v243
    v_mul_f32 v32, v32, v244
    v_mul_f32 v33, v33, v244
    v_mul_f32 v34, v34, v244
    v_mul_f32 v35, v35, v244
    v_mul_f32 v36, v36, v244
    v_mul_f32 v37, v37, v244
    v_mul_f32 v38, v38, v244
    v_mul_f32 v39, v39, v244
    v_mul_f32 v40, v40, v244
    v_mul_f32 v41, v41, v244
    v_mul_f32 v42, v42, v244
    v_mul_f32 v43, v43, v244
    v_mul_f32 v44, v44, v244
    v_mul_f32 v45, v45, v244
    v_mul_f32 v46, v46, v244
    v_mul_f32 v47, v47, v244
    v_mul_f32 v48, v48, v244
    v_mul_f32 v49, v49, v244
    v_mul_f32 v50, v50, v244
    v_mul_f32 v51, v51, v244
    v_mul_f32 v52, v52, v244
    v_mul_f32 v53, v53, v244
    v_mul_f32 v54, v54, v244
    v_mul_f32 v55, v55, v244
    v_mul_f32 v56, v56, v244
    v_mul_f32 v57, v57, v244
    v_mul_f32 v58, v58, v244
    v_mul_f32 v59, v59, v244
    v_mul_f32 v60, v60, v244
    v_mul_f32 v61, v61, v244
    v_mul_f32 v62, v62, v244
    v_mul_f32 v63, v63, v244
    v_mul_f32 v229, v229, v244
    v_sub_f32 v168, v168, v243
    v_sub_f32 v169, v169, v243
    v_sub_f32 v170, v170, v243
    v_sub_f32 v171, v171, v243
    v_sub_f32 v172, v172, v243
    v_sub_f32 v173, v173, v243
    v_sub_f32 v174, v174, v243
    v_sub_f32 v175, v175, v243
    v_exp_f32 v152, v152
    v_exp_f32 v153, v153
    v_exp_f32 v154, v154
    v_exp_f32 v155, v155
    v_exp_f32 v168, v168
    v_exp_f32 v169, v169
    v_exp_f32 v170, v170
    v_exp_f32 v171, v171
    v_exp_f32 v156, v156
    v_exp_f32 v157, v157
    v_exp_f32 v158, v158
    v_exp_f32 v159, v159
    v_exp_f32 v172, v172
    v_exp_f32 v173, v173
    v_exp_f32 v174, v174
    v_exp_f32 v175, v175
    v_add_f32 v231, v152, v153
    v_add_f32 v231, v231, v154
    v_add_f32 v231, v231, v155
    v_add_f32 v232, v168, v169
    v_add_f32 v232, v232, v170
    v_add_f32 v232, v232, v171
    v_add_f32 v231, v231, v156
    v_add_f32 v231, v231, v157
    v_add_f32 v231, v231, v158
    v_add_f32 v231, v231, v159
    v_add_f32 v232, v232, v172
    v_add_f32 v232, v232, v173
    v_add_f32 v232, v232, v174
    v_add_f32 v232, v232, v175
    v_cvt_pk_bf16_f32 v148, v152, v153
    v_cvt_pk_bf16_f32 v149, v154, v155
    v_cvt_pk_bf16_f32 v150, v156, v157
    v_cvt_pk_bf16_f32 v151, v158, v159
    v_cvt_pk_bf16_f32 v164, v168, v169
    v_cvt_pk_bf16_f32 v165, v170, v171
    v_cvt_pk_bf16_f32 v166, v172, v173
    v_cvt_pk_bf16_f32 v167, v174, v175
    ds_read_b64_tr_b16 v[196:197], v238 offset:8192
    ds_read_b64_tr_b16 v[198:199], v238 offset:12288
    v_xor_b32 v240, 32, v238
    ds_read_b64_tr_b16 v[200:201], v240 offset:8192
    ds_read_b64_tr_b16 v[202:203], v240 offset:12288
    v_xor_b32 v239, 64, v238
    ds_read_b64_tr_b16 v[204:205], v239 offset:8192
    ds_read_b64_tr_b16 v[206:207], v239 offset:12288
    v_xor_b32 v240, 96, v238
    ds_read_b64_tr_b16 v[208:209], v240 offset:8192
    ds_read_b64_tr_b16 v[210:211], v240 offset:12288
    v_xor_b32 v239, 128, v238
    ds_read_b64_tr_b16 v[212:213], v239 offset:8192
    ds_read_b64_tr_b16 v[214:215], v239 offset:12288
    v_xor_b32 v240, 160, v238
    ds_read_b64_tr_b16 v[216:217], v240 offset:8192
    ds_read_b64_tr_b16 v[218:219], v240 offset:12288
    v_xor_b32 v239, 192, v238
    ds_read_b64_tr_b16 v[220:221], v239 offset:8192
    ds_read_b64_tr_b16 v[222:223], v239 offset:12288
    v_xor_b32 v240, 224, v238
    ds_read_b64_tr_b16 v[224:225], v240 offset:8192
    ds_read_b64_tr_b16 v[226:227], v240 offset:12288
    s_waitcnt lgkmcnt(0)
    s_nop 1
    s_branch K1W2_back1
K1W3_START:
    s_getpc_b64 s[72:73]
K1W3_PC:
    s_sub_u32 s72, s72, K1W3_PC-concat_heads__mha_block_cached__gqa_block_cached__near_ridge_kernel
    s_subb_u32 s73, s73, 0
    s_mov_b32 s74, 73000
    s_mov_b32 s75, 131072
    s_lshr_b32 s30, s2, 3
    s_lshl_b32 s30, s30, 1
    s_add_u32 s30, s30, s26
    s_lshl_b32 s30, s30, 11
    v_lshlrev_b32 v243, 7, v245
    v_mov_b32 v244, 2147418112
    v_cmp_gt_u32 vcc, 16, v245
    s_nop 1
    v_cndmask_b32 v243, v244, v243, vcc
    buffer_load_dword v253, v243, s[72:75], s30 offen
    s_lshl_b32 s58, s26, 14
    s_add_u32 s58, s58, 30720
    s_lshl_b32 s30, s26, 3
    s_add_u32 s30, s30, 6
    s_lshl_b32 s59, s30, 10
    s_mul_i32 s60, s30, 10240
    s_lshl_b32 s30, s26, 14
    s_add_u32 s30, s30, 53248
    v_add_u32 v196, s30, v196
    v_add_u32 v197, s30, v197
    v_add_u32 v198, s30, v198
    v_add_u32 v199, s30, v199
    v_add_u32 v200, s30, v200
    v_add_u32 v201, s30, v201
    v_add_u32 v202, s30, v202
    v_add_u32 v203, s30, v203
    v_add_u32 v204, 53248, v204
    v_add_u32 v205, 53248, v205
    s_mov_b32 s52, 0
    s_mov_b32 s53, 0
    s_mov_b32 s56, 102400
    s_add_u32 m0, s56, s58
    s_add_u32 s30, s52, 393216
    buffer_load_dwordx4 v206, s[12:15], s30 offen offset:0 lds
    s_add_u32 s30, s52, 424960
    buffer_load_dwordx4 v206, s[12:15], s30 offen offset:1024 lds
    s_add_u32 s30, s52, 456704
    buffer_load_dwordx4 v207, s[12:15], s30 offen offset:2048 lds
    s_add_u32 s30, s52, 488448
    buffer_load_dwordx4 v207, s[12:15], s30 offen offset:3072 lds
    s_add_u32 m0, s56, s59
    s_add_u32 s30, s53, s60
    buffer_load_dwordx4 v208, s[16:19], s30 offen lds
    s_add_u32 s30, s30, 9216
    buffer_load_dwordx4 v209, s[16:19], s30 offen offset:1024 lds
    s_add_u32 s52, s52, 524288
    s_add_u32 s53, s53, 128
    s_mov_b32 s56, 0
    s_add_u32 m0, s56, s58
    s_add_u32 s30, s52, 393216
    buffer_load_dwordx4 v206, s[12:15], s30 offen offset:0 lds
    s_add_u32 s30, s52, 424960
    buffer_load_dwordx4 v206, s[12:15], s30 offen offset:1024 lds
    s_add_u32 s30, s52, 456704
    buffer_load_dwordx4 v207, s[12:15], s30 offen offset:2048 lds
    s_add_u32 s30, s52, 488448
    buffer_load_dwordx4 v207, s[12:15], s30 offen offset:3072 lds
    s_add_u32 m0, s56, s59
    s_add_u32 s30, s53, s60
    buffer_load_dwordx4 v208, s[16:19], s30 offen lds
    s_add_u32 s30, s30, 9216
    buffer_load_dwordx4 v209, s[16:19], s30 offen offset:1024 lds
    s_add_u32 s52, s52, 524288
    s_add_u32 s53, s53, 128
    v_mov_b32 v0, 0
    v_mov_b32 v1, 0
    v_mov_b32 v2, 0
    v_mov_b32 v3, 0
    v_mov_b32 v4, 0
    v_mov_b32 v5, 0
    v_mov_b32 v6, 0
    v_mov_b32 v7, 0
    v_mov_b32 v8, 0
    v_mov_b32 v9, 0
    v_mov_b32 v10, 0
    v_mov_b32 v11, 0
    v_mov_b32 v12, 0
    v_mov_b32 v13, 0
    v_mov_b32 v14, 0
    v_mov_b32 v15, 0
    v_mov_b32 v16, 0
    v_mov_b32 v17, 0
    v_mov_b32 v18, 0
    v_mov_b32 v19, 0
    v_mov_b32 v20, 0
    v_mov_b32 v21, 0
    v_mov_b32 v22, 0
    v_mov_b32 v23, 0
    v_mov_b32 v24, 0
    v_mov_b32 v25, 0
    v_mov_b32 v26, 0
    v_mov_b32 v27, 0
    v_mov_b32 v28, 0
    v_mov_b32 v29, 0
    v_mov_b32 v30, 0
    v_mov_b32 v31, 0
    v_mov_b32 v32, 0
    v_mov_b32 v33, 0
    v_mov_b32 v34, 0
    v_mov_b32 v35, 0
    v_mov_b32 v36, 0
    v_mov_b32 v37, 0
    v_mov_b32 v38, 0
    v_mov_b32 v39, 0
    v_mov_b32 v40, 0
    v_mov_b32 v41, 0
    v_mov_b32 v42, 0
    v_mov_b32 v43, 0
    v_mov_b32 v44, 0
    v_mov_b32 v45, 0
    v_mov_b32 v46, 0
    v_mov_b32 v47, 0
    v_mov_b32 v48, 0
    v_mov_b32 v49, 0
    v_mov_b32 v50, 0
    v_mov_b32 v51, 0
    v_mov_b32 v52, 0
    v_mov_b32 v53, 0
    v_mov_b32 v54, 0
    v_mov_b32 v55, 0
    v_mov_b32 v56, 0
    v_mov_b32 v57, 0
    v_mov_b32 v58, 0
    v_mov_b32 v59, 0
    v_mov_b32 v60, 0
    v_mov_b32 v61, 0
    v_mov_b32 v62, 0
    v_mov_b32 v63, 0
    v_mov_b32 v64, 0
    v_mov_b32 v65, 0
    v_mov_b32 v66, 0
    v_mov_b32 v67, 0
    v_mov_b32 v68, 0
    v_mov_b32 v69, 0
    v_mov_b32 v70, 0
    v_mov_b32 v71, 0
    s_waitcnt vmcnt(6)
    s_barrier
    s_mov_b32 s56, 51200
    ds_read_b128 v[160:163], v204 offset:12288
    ds_read_b128 v[164:167], v204 offset:14336
    ds_read_b128 v[168:171], v204 offset:16384
    ds_read_b64_tr_b16 v[96:97], v196 offset:0
    ds_read_b64_tr_b16 v[98:99], v196 offset:1024
    ds_read_b64_tr_b16 v[100:101], v197 offset:0
    ds_read_b64_tr_b16 v[102:103], v197 offset:1024
    ds_read_b64_tr_b16 v[104:105], v198 offset:0
    ds_read_b64_tr_b16 v[106:107], v198 offset:1024
    ds_read_b64_tr_b16 v[108:109], v199 offset:0
    ds_read_b64_tr_b16 v[110:111], v199 offset:1024
    ds_read_b64_tr_b16 v[112:113], v200 offset:0
    ds_read_b64_tr_b16 v[114:115], v200 offset:1024
    ds_read_b64_tr_b16 v[116:117], v201 offset:0
    ds_read_b64_tr_b16 v[118:119], v201 offset:1024
    ds_read_b64_tr_b16 v[120:121], v202 offset:0
    ds_read_b64_tr_b16 v[122:123], v202 offset:1024
    ds_read_b64_tr_b16 v[124:125], v203 offset:0
    ds_read_b64_tr_b16 v[126:127], v203 offset:1024
    ds_read_b128 v[172:175], v205 offset:12288
    ds_read_b128 v[176:179], v205 offset:14336
    ds_read_b128 v[180:183], v205 offset:16384
    ds_read_b64_tr_b16 v[128:129], v196 offset:8192
    ds_read_b64_tr_b16 v[130:131], v196 offset:9216
    ds_read_b64_tr_b16 v[132:133], v197 offset:8192
    ds_read_b64_tr_b16 v[134:135], v197 offset:9216
    ds_read_b64_tr_b16 v[136:137], v198 offset:8192
    ds_read_b64_tr_b16 v[138:139], v198 offset:9216
    ds_read_b64_tr_b16 v[140:141], v199 offset:8192
    ds_read_b64_tr_b16 v[142:143], v199 offset:9216
    ds_read_b64_tr_b16 v[144:145], v200 offset:8192
    ds_read_b64_tr_b16 v[146:147], v200 offset:9216
    ds_read_b64_tr_b16 v[148:149], v201 offset:8192
    ds_read_b64_tr_b16 v[150:151], v201 offset:9216
    ds_read_b64_tr_b16 v[152:153], v202 offset:8192
    ds_read_b64_tr_b16 v[154:155], v202 offset:9216
    ds_read_b64_tr_b16 v[156:157], v203 offset:8192
    ds_read_b64_tr_b16 v[158:159], v203 offset:9216
    s_waitcnt lgkmcnt(15)
    v_mfma_f32_16x16x32_bf16 v[0:3], v[96:99], v[160:163], v[0:3]
    s_add_u32 m0, s56, s58
    v_mfma_f32_16x16x32_bf16 v[32:35], v[96:99], v[164:167], v[32:35]
    s_add_u32 s30, s52, 393216
    v_mfma_f32_16x16x32_bf16 v[4:7], v[100:103], v[160:163], v[4:7]
    buffer_load_dwordx4 v206, s[12:15], s30 offen offset:0 lds
    v_mfma_f32_16x16x32_bf16 v[36:39], v[100:103], v[164:167], v[36:39]
    s_add_u32 s30, s52, 424960
    v_mfma_f32_16x16x32_bf16 v[8:11], v[104:107], v[160:163], v[8:11]
    buffer_load_dwordx4 v206, s[12:15], s30 offen offset:1024 lds
    v_mfma_f32_16x16x32_bf16 v[40:43], v[104:107], v[164:167], v[40:43]
    s_add_u32 s30, s52, 456704
    v_mfma_f32_16x16x32_bf16 v[12:15], v[108:111], v[160:163], v[12:15]
    buffer_load_dwordx4 v207, s[12:15], s30 offen offset:2048 lds
    v_mfma_f32_16x16x32_bf16 v[44:47], v[108:111], v[164:167], v[44:47]
    s_add_u32 s30, s52, 488448
    v_mfma_f32_16x16x32_bf16 v[16:19], v[112:115], v[160:163], v[16:19]
    v_mfma_f32_16x16x32_bf16 v[48:51], v[112:115], v[164:167], v[48:51]
    buffer_load_dwordx4 v207, s[12:15], s30 offen offset:3072 lds
    v_mfma_f32_16x16x32_bf16 v[20:23], v[116:119], v[160:163], v[20:23]
    s_add_u32 m0, s56, s59
    v_mfma_f32_16x16x32_bf16 v[52:55], v[116:119], v[164:167], v[52:55]
    s_add_u32 s30, s53, s60
    v_mfma_f32_16x16x32_bf16 v[24:27], v[120:123], v[160:163], v[24:27]
    buffer_load_dwordx4 v208, s[16:19], s30 offen lds
    v_mfma_f32_16x16x32_bf16 v[56:59], v[120:123], v[164:167], v[56:59]
    s_add_u32 s30, s30, 9216
    v_mfma_f32_16x16x32_bf16 v[64:67], v[120:123], v[168:171], v[64:67]
    buffer_load_dwordx4 v209, s[16:19], s30 offen offset:1024 lds
    v_mfma_f32_16x16x32_bf16 v[28:31], v[124:127], v[160:163], v[28:31]
    s_add_u32 s52, s52, 524288
    v_mfma_f32_16x16x32_bf16 v[60:63], v[124:127], v[164:167], v[60:63]
    s_add_u32 s53, s53, 128
    v_mfma_f32_16x16x32_bf16 v[68:71], v[124:127], v[168:171], v[68:71]
    s_waitcnt lgkmcnt(0)
    s_mov_b32 s51, 1
    s_mov_b32 s57, 4294864896
    v_add_u32 v196, s57, v196
    v_add_u32 v197, s57, v197
    v_add_u32 v198, s57, v198
    v_add_u32 v199, s57, v199
    v_add_u32 v200, s57, v200
    v_add_u32 v201, s57, v201
    v_add_u32 v202, s57, v202
    v_add_u32 v203, s57, v203
    v_add_u32 v204, s57, v204
    v_add_u32 v205, s57, v205
    s_mov_b32 s56, 102400
K1W3_P1:
    s_cmp_eq_u32 s51, 9
    s_cbranch_scc1 K1W3_P1a
    s_waitcnt vmcnt(6)
    s_branch K1W3_P1b
K1W3_P1a:
    s_waitcnt vmcnt(4)
K1W3_P1b:
    s_barrier
    s_cmp_le_u32 s51, 7
    s_cbranch_scc1 K1W3_P1c
    v_mfma_f32_16x16x32_bf16 v[0:3], v[128:131], v[172:175], v[0:3]
    ds_read_b128 v[160:163], v204 offset:12288
    ds_read_b128 v[164:167], v204 offset:14336
    v_mfma_f32_16x16x32_bf16 v[32:35], v[128:131], v[176:179], v[32:35]
    ds_read_b128 v[168:171], v204 offset:16384
    v_mfma_f32_16x16x32_bf16 v[4:7], v[132:135], v[172:175], v[4:7]
    ds_read_b64_tr_b16 v[96:97], v196 offset:0
    v_mfma_f32_16x16x32_bf16 v[36:39], v[132:135], v[176:179], v[36:39]
    ds_read_b64_tr_b16 v[98:99], v196 offset:1024
    v_mfma_f32_16x16x32_bf16 v[8:11], v[136:139], v[172:175], v[8:11]
    ds_read_b64_tr_b16 v[100:101], v197 offset:0
    v_mfma_f32_16x16x32_bf16 v[40:43], v[136:139], v[176:179], v[40:43]
    ds_read_b64_tr_b16 v[102:103], v197 offset:1024
    v_mfma_f32_16x16x32_bf16 v[12:15], v[140:143], v[172:175], v[12:15]
    ds_read_b64_tr_b16 v[104:105], v198 offset:0
    v_mfma_f32_16x16x32_bf16 v[44:47], v[140:143], v[176:179], v[44:47]
    ds_read_b64_tr_b16 v[106:107], v198 offset:1024
    v_mfma_f32_16x16x32_bf16 v[16:19], v[144:147], v[172:175], v[16:19]
    ds_read_b64_tr_b16 v[108:109], v199 offset:0
    v_mfma_f32_16x16x32_bf16 v[48:51], v[144:147], v[176:179], v[48:51]
    ds_read_b64_tr_b16 v[110:111], v199 offset:1024
    v_mfma_f32_16x16x32_bf16 v[20:23], v[148:151], v[172:175], v[20:23]
    ds_read_b64_tr_b16 v[112:113], v200 offset:0
    v_mfma_f32_16x16x32_bf16 v[52:55], v[148:151], v[176:179], v[52:55]
    ds_read_b64_tr_b16 v[114:115], v200 offset:1024
    v_mfma_f32_16x16x32_bf16 v[24:27], v[152:155], v[172:175], v[24:27]
    ds_read_b64_tr_b16 v[116:117], v201 offset:0
    v_mfma_f32_16x16x32_bf16 v[56:59], v[152:155], v[176:179], v[56:59]
    ds_read_b64_tr_b16 v[118:119], v201 offset:1024
    v_mfma_f32_16x16x32_bf16 v[64:67], v[152:155], v[180:183], v[64:67]
    ds_read_b64_tr_b16 v[120:121], v202 offset:0
    v_mfma_f32_16x16x32_bf16 v[28:31], v[156:159], v[172:175], v[28:31]
    ds_read_b64_tr_b16 v[122:123], v202 offset:1024
    v_mfma_f32_16x16x32_bf16 v[60:63], v[156:159], v[176:179], v[60:63]
    ds_read_b64_tr_b16 v[124:125], v203 offset:0
    v_mfma_f32_16x16x32_bf16 v[68:71], v[156:159], v[180:183], v[68:71]
    ds_read_b64_tr_b16 v[126:127], v203 offset:1024
    s_cmp_eq_u32 s51, 8
    s_cbranch_scc0 K1W3_P1d
    s_lshl_b32 s31, s26, 13
    s_add_u32 s31, s31, 6144
    v_xor_b32 v243, 128, v241
    v_xor_b32 v244, 192, v241
    s_mov_b32 m0, s31
    s_nop 0
    buffer_load_dwordx4 v243, s[4:7], s31 offen nt lds
    buffer_load_dwordx4 v244, s[4:7], s31 offen offset:1024 nt lds
    s_add_u32 s30, s31, 32768
    s_mov_b32 m0, s30
    v_xor_b32 v243, 128, v242
    buffer_load_dwordx4 v242, s[8:11], s31 offen nt lds
    buffer_load_dwordx4 v243, s[8:11], s31 offen offset:1024 nt lds
K1W3_P1d:
    s_waitcnt lgkmcnt(0)
    s_cmp_eq_u32 s51, 9
    s_cbranch_scc0 K1W3_P1t
    s_and_b32 s47, s2, 1
    s_load_dwordx2 s[72:73], s[0:1], 32
    s_load_dwordx2 s[74:75], s[0:1], 72
    s_waitcnt lgkmcnt(0)
    s_cmp_eq_u32 s64, 0
    s_cselect_b64 s[76:77], s[72:73], s[74:75]
    s_mov_b32 s78, 5242880
    s_mov_b32 s79, 131072
    s_lshl_b32 s30, s47, 11
    s_lshl_b32 s31, s26, 10
    s_add_u32 s30, s30, s31
    s_lshl_b32 s31, s85, 3
    s_add_u32 s31, s31, s84
    s_lshl_b32 s31, s31, 5
    s_add_u32 s30, s30, s31
    s_mul_i32 s30, s30, 1280
    v_lshlrev_b32 v243, 7, v245
    s_add_u32 s30, s30, 30720
    buffer_load_dword v249, v243, s[76:79], s30 offen
    v_add_u32 v243, 8192, v243
    v_mov_b32 v244, 2147418112
    v_cmp_gt_u32 vcc, 16, v245
    s_nop 1
    v_cndmask_b32 v243, v244, v243, vcc
    buffer_load_dword v250, v243, s[76:79], s30 offen
K1W3_P1t:
    v_mfma_f32_16x16x32_bf16 v[0:3], v[96:99], v[160:163], v[0:3]
    ds_read_b128 v[172:175], v205 offset:12288
    ds_read_b128 v[176:179], v205 offset:14336
    v_mfma_f32_16x16x32_bf16 v[32:35], v[96:99], v[164:167], v[32:35]
    ds_read_b128 v[180:183], v205 offset:16384
    v_mfma_f32_16x16x32_bf16 v[4:7], v[100:103], v[160:163], v[4:7]
    ds_read_b64_tr_b16 v[128:129], v196 offset:8192
    v_mfma_f32_16x16x32_bf16 v[36:39], v[100:103], v[164:167], v[36:39]
    ds_read_b64_tr_b16 v[130:131], v196 offset:9216
    v_mfma_f32_16x16x32_bf16 v[8:11], v[104:107], v[160:163], v[8:11]
    ds_read_b64_tr_b16 v[132:133], v197 offset:8192
    v_mfma_f32_16x16x32_bf16 v[40:43], v[104:107], v[164:167], v[40:43]
    ds_read_b64_tr_b16 v[134:135], v197 offset:9216
    v_mfma_f32_16x16x32_bf16 v[12:15], v[108:111], v[160:163], v[12:15]
    ds_read_b64_tr_b16 v[136:137], v198 offset:8192
    v_mfma_f32_16x16x32_bf16 v[44:47], v[108:111], v[164:167], v[44:47]
    ds_read_b64_tr_b16 v[138:139], v198 offset:9216
    v_mfma_f32_16x16x32_bf16 v[16:19], v[112:115], v[160:163], v[16:19]
    ds_read_b64_tr_b16 v[140:141], v199 offset:8192
    v_mfma_f32_16x16x32_bf16 v[48:51], v[112:115], v[164:167], v[48:51]
    ds_read_b64_tr_b16 v[142:143], v199 offset:9216
    v_mfma_f32_16x16x32_bf16 v[20:23], v[116:119], v[160:163], v[20:23]
    ds_read_b64_tr_b16 v[144:145], v200 offset:8192
    v_mfma_f32_16x16x32_bf16 v[52:55], v[116:119], v[164:167], v[52:55]
    ds_read_b64_tr_b16 v[146:147], v200 offset:9216
    v_mfma_f32_16x16x32_bf16 v[24:27], v[120:123], v[160:163], v[24:27]
    ds_read_b64_tr_b16 v[148:149], v201 offset:8192
    v_mfma_f32_16x16x32_bf16 v[56:59], v[120:123], v[164:167], v[56:59]
    ds_read_b64_tr_b16 v[150:151], v201 offset:9216
    v_mfma_f32_16x16x32_bf16 v[64:67], v[120:123], v[168:171], v[64:67]
    ds_read_b64_tr_b16 v[152:153], v202 offset:8192
    v_mfma_f32_16x16x32_bf16 v[28:31], v[124:127], v[160:163], v[28:31]
    ds_read_b64_tr_b16 v[154:155], v202 offset:9216
    v_mfma_f32_16x16x32_bf16 v[60:63], v[124:127], v[164:167], v[60:63]
    ds_read_b64_tr_b16 v[156:157], v203 offset:8192
    v_mfma_f32_16x16x32_bf16 v[68:71], v[124:127], v[168:171], v[68:71]
    ds_read_b64_tr_b16 v[158:159], v203 offset:9216
    s_branch K1W3_P1e
K1W3_P1c:
    v_mfma_f32_16x16x32_bf16 v[0:3], v[128:131], v[172:175], v[0:3]
    ds_read_b128 v[160:163], v204 offset:12288
    ds_read_b128 v[164:167], v204 offset:14336
    v_mfma_f32_16x16x32_bf16 v[32:35], v[128:131], v[176:179], v[32:35]
    ds_read_b128 v[168:171], v204 offset:16384
    v_mfma_f32_16x16x32_bf16 v[4:7], v[132:135], v[172:175], v[4:7]
    ds_read_b64_tr_b16 v[96:97], v196 offset:0
    ds_read_b64_tr_b16 v[98:99], v196 offset:1024
    v_mfma_f32_16x16x32_bf16 v[36:39], v[132:135], v[176:179], v[36:39]
    ds_read_b64_tr_b16 v[100:101], v197 offset:0
    v_mfma_f32_16x16x32_bf16 v[8:11], v[136:139], v[172:175], v[8:11]
    ds_read_b64_tr_b16 v[102:103], v197 offset:1024
    ds_read_b64_tr_b16 v[104:105], v198 offset:0
    v_mfma_f32_16x16x32_bf16 v[40:43], v[136:139], v[176:179], v[40:43]
    ds_read_b64_tr_b16 v[106:107], v198 offset:1024
    v_mfma_f32_16x16x32_bf16 v[12:15], v[140:143], v[172:175], v[12:15]
    ds_read_b64_tr_b16 v[108:109], v199 offset:0
    ds_read_b64_tr_b16 v[110:111], v199 offset:1024
    v_mfma_f32_16x16x32_bf16 v[44:47], v[140:143], v[176:179], v[44:47]
    ds_read_b64_tr_b16 v[112:113], v200 offset:0
    v_mfma_f32_16x16x32_bf16 v[16:19], v[144:147], v[172:175], v[16:19]
    ds_read_b64_tr_b16 v[114:115], v200 offset:1024
    ds_read_b64_tr_b16 v[116:117], v201 offset:0
    v_mfma_f32_16x16x32_bf16 v[48:51], v[144:147], v[176:179], v[48:51]
    ds_read_b64_tr_b16 v[118:119], v201 offset:1024
    v_mfma_f32_16x16x32_bf16 v[20:23], v[148:151], v[172:175], v[20:23]
    ds_read_b64_tr_b16 v[120:121], v202 offset:0
    ds_read_b64_tr_b16 v[122:123], v202 offset:1024
    v_mfma_f32_16x16x32_bf16 v[52:55], v[148:151], v[176:179], v[52:55]
    ds_read_b64_tr_b16 v[124:125], v203 offset:0
    v_mfma_f32_16x16x32_bf16 v[24:27], v[152:155], v[172:175], v[24:27]
    ds_read_b64_tr_b16 v[126:127], v203 offset:1024
    s_add_u32 m0, s56, s58
    v_mfma_f32_16x16x32_bf16 v[56:59], v[152:155], v[176:179], v[56:59]
    s_add_u32 s30, s52, 393216
    v_mfma_f32_16x16x32_bf16 v[64:67], v[152:155], v[180:183], v[64:67]
    buffer_load_dwordx4 v206, s[12:15], s30 offen offset:0 lds
    s_add_u32 s30, s52, 424960
    v_mfma_f32_16x16x32_bf16 v[28:31], v[156:159], v[172:175], v[28:31]
    buffer_load_dwordx4 v206, s[12:15], s30 offen offset:1024 lds
    v_mfma_f32_16x16x32_bf16 v[60:63], v[156:159], v[176:179], v[60:63]
    s_add_u32 s30, s52, 456704
    buffer_load_dwordx4 v207, s[12:15], s30 offen offset:2048 lds
    v_mfma_f32_16x16x32_bf16 v[68:71], v[156:159], v[180:183], v[68:71]
    s_add_u32 s30, s52, 488448
    s_waitcnt lgkmcnt(14)
    v_mfma_f32_16x16x32_bf16 v[0:3], v[96:99], v[160:163], v[0:3]
    ds_read_b128 v[172:175], v205 offset:12288
    ds_read_b128 v[176:179], v205 offset:14336
    v_mfma_f32_16x16x32_bf16 v[32:35], v[96:99], v[164:167], v[32:35]
    ds_read_b128 v[180:183], v205 offset:16384
    s_waitcnt lgkmcnt(15)
    v_mfma_f32_16x16x32_bf16 v[4:7], v[100:103], v[160:163], v[4:7]
    ds_read_b64_tr_b16 v[128:129], v196 offset:8192
    ds_read_b64_tr_b16 v[130:131], v196 offset:9216
    v_mfma_f32_16x16x32_bf16 v[36:39], v[100:103], v[164:167], v[36:39]
    ds_read_b64_tr_b16 v[132:133], v197 offset:8192
    s_waitcnt lgkmcnt(15)
    v_mfma_f32_16x16x32_bf16 v[8:11], v[104:107], v[160:163], v[8:11]
    ds_read_b64_tr_b16 v[134:135], v197 offset:9216
    ds_read_b64_tr_b16 v[136:137], v198 offset:8192
    v_mfma_f32_16x16x32_bf16 v[40:43], v[104:107], v[164:167], v[40:43]
    ds_read_b64_tr_b16 v[138:139], v198 offset:9216
    s_waitcnt lgkmcnt(15)
    v_mfma_f32_16x16x32_bf16 v[12:15], v[108:111], v[160:163], v[12:15]
    ds_read_b64_tr_b16 v[140:141], v199 offset:8192
    ds_read_b64_tr_b16 v[142:143], v199 offset:9216
    v_mfma_f32_16x16x32_bf16 v[44:47], v[108:111], v[164:167], v[44:47]
    ds_read_b64_tr_b16 v[144:145], v200 offset:8192
    v_mfma_f32_16x16x32_bf16 v[16:19], v[112:115], v[160:163], v[16:19]
    ds_read_b64_tr_b16 v[146:147], v200 offset:9216
    ds_read_b64_tr_b16 v[148:149], v201 offset:8192
    v_mfma_f32_16x16x32_bf16 v[48:51], v[112:115], v[164:167], v[48:51]
    ds_read_b64_tr_b16 v[150:151], v201 offset:9216
    s_waitcnt lgkmcnt(15)
    v_mfma_f32_16x16x32_bf16 v[20:23], v[116:119], v[160:163], v[20:23]
    ds_read_b64_tr_b16 v[152:153], v202 offset:8192
    ds_read_b64_tr_b16 v[154:155], v202 offset:9216
    v_mfma_f32_16x16x32_bf16 v[52:55], v[116:119], v[164:167], v[52:55]
    ds_read_b64_tr_b16 v[156:157], v203 offset:8192
    v_mfma_f32_16x16x32_bf16 v[24:27], v[120:123], v[160:163], v[24:27]
    ds_read_b64_tr_b16 v[158:159], v203 offset:9216
    buffer_load_dwordx4 v207, s[12:15], s30 offen offset:3072 lds
    v_mfma_f32_16x16x32_bf16 v[56:59], v[120:123], v[164:167], v[56:59]
    s_add_u32 m0, s56, s59
    v_mfma_f32_16x16x32_bf16 v[64:67], v[120:123], v[168:171], v[64:67]
    s_add_u32 s30, s53, s60
    buffer_load_dwordx4 v208, s[16:19], s30 offen lds
    v_mfma_f32_16x16x32_bf16 v[28:31], v[124:127], v[160:163], v[28:31]
    s_add_u32 s30, s30, 9216
    v_mfma_f32_16x16x32_bf16 v[60:63], v[124:127], v[164:167], v[60:63]
    buffer_load_dwordx4 v209, s[16:19], s30 offen offset:1024 lds
    s_add_u32 s52, s52, 524288
    v_mfma_f32_16x16x32_bf16 v[68:71], v[124:127], v[168:171], v[68:71]
    s_add_u32 s53, s53, 128
K1W3_P1e:
    s_waitcnt lgkmcnt(0)
    s_mul_i32 s30, s51, 43691
    s_lshr_b32 s30, s30, 17
    s_mul_i32 s30, s30, 3
    s_cmp_eq_u32 s51, s30
    s_mov_b32 s57, 51200
    s_cselect_b32 s57, 4294864896, s57
    v_add_u32 v196, s57, v196
    v_add_u32 v197, s57, v197
    v_add_u32 v198, s57, v198
    v_add_u32 v199, s57, v199
    v_add_u32 v200, s57, v200
    v_add_u32 v201, s57, v201
    v_add_u32 v202, s57, v202
    v_add_u32 v203, s57, v203
    v_add_u32 v204, s57, v204
    v_add_u32 v205, s57, v205
    s_add_u32 s56, s56, 51200
    s_cmp_eq_u32 s56, 153600
    s_cselect_b32 s56, 0, s56
    s_add_u32 s51, s51, 1
    s_cmp_lt_u32 s51, 10
    s_cbranch_scc1 K1W3_P1
    v_mfma_f32_16x16x32_bf16 v[0:3], v[128:131], v[172:175], v[0:3]
    v_mfma_f32_16x16x32_bf16 v[32:35], v[128:131], v[176:179], v[32:35]
    v_mfma_f32_16x16x32_bf16 v[4:7], v[132:135], v[172:175], v[4:7]
    v_mfma_f32_16x16x32_bf16 v[36:39], v[132:135], v[176:179], v[36:39]
    v_mfma_f32_16x16x32_bf16 v[8:11], v[136:139], v[172:175], v[8:11]
    v_mfma_f32_16x16x32_bf16 v[40:43], v[136:139], v[176:179], v[40:43]
    v_mfma_f32_16x16x32_bf16 v[12:15], v[140:143], v[172:175], v[12:15]
    v_mfma_f32_16x16x32_bf16 v[44:47], v[140:143], v[176:179], v[44:47]
    v_mfma_f32_16x16x32_bf16 v[16:19], v[144:147], v[172:175], v[16:19]
    v_mfma_f32_16x16x32_bf16 v[48:51], v[144:147], v[176:179], v[48:51]
    v_mfma_f32_16x16x32_bf16 v[20:23], v[148:151], v[172:175], v[20:23]
    v_mfma_f32_16x16x32_bf16 v[52:55], v[148:151], v[176:179], v[52:55]
    v_mfma_f32_16x16x32_bf16 v[24:27], v[152:155], v[172:175], v[24:27]
    v_mfma_f32_16x16x32_bf16 v[56:59], v[152:155], v[176:179], v[56:59]
    v_mfma_f32_16x16x32_bf16 v[64:67], v[152:155], v[180:183], v[64:67]
    v_mfma_f32_16x16x32_bf16 v[28:31], v[156:159], v[172:175], v[28:31]
    v_mfma_f32_16x16x32_bf16 v[60:63], v[156:159], v[176:179], v[60:63]
    v_mfma_f32_16x16x32_bf16 v[68:71], v[156:159], v[180:183], v[68:71]
    s_mov_b32 s30, 1040356334
    s_nop 3
    v_mul_f32 v64, s30, v64
    v_mul_f32 v65, s30, v65
    v_mul_f32 v66, s30, v66
    v_mul_f32 v67, s30, v67
    v_mul_f32 v68, s30, v68
    v_mul_f32 v69, s30, v69
    v_mul_f32 v70, s30, v70
    v_mul_f32 v71, s30, v71
    v_cvt_pk_bf16_f32 v212, v64, v65
    v_cvt_pk_bf16_f32 v213, v66, v67
    v_cvt_pk_bf16_f32 v214, v68, v69
    v_cvt_pk_bf16_f32 v215, v70, v71
    v_cndmask_b32 v216, v212, v214, s[54:55]
    v_cndmask_b32 v217, v213, v215, s[54:55]
    v_cndmask_b32 v218, v214, v212, s[54:55]
    v_cndmask_b32 v219, v215, v213, s[54:55]
    s_lshl_b32 s31, s26, 12
    s_add_u32 s31, s31, 153600
    v_add_u32 v246, s31, v248
    ds_write_b128 v246, v[216:219] offset:3072
    v_mul_f32 v0, s30, v0
    v_mul_f32 v1, s30, v1
    v_mul_f32 v2, s30, v2
    v_mul_f32 v3, s30, v3
    v_mul_f32 v4, s30, v4
    v_mul_f32 v5, s30, v5
    v_mul_f32 v6, s30, v6
    v_mul_f32 v7, s30, v7
    v_cvt_pk_bf16_f32 v212, v0, v1
    v_cvt_pk_bf16_f32 v213, v2, v3
    v_cvt_pk_bf16_f32 v214, v4, v5
    v_cvt_pk_bf16_f32 v215, v6, v7
    v_cndmask_b32 v96, v212, v214, s[54:55]
    v_cndmask_b32 v97, v213, v215, s[54:55]
    v_cndmask_b32 v98, v214, v212, s[54:55]
    v_cndmask_b32 v99, v215, v213, s[54:55]
    v_mul_f32 v32, s30, v32
    v_mul_f32 v33, s30, v33
    v_mul_f32 v34, s30, v34
    v_mul_f32 v35, s30, v35
    v_mul_f32 v36, s30, v36
    v_mul_f32 v37, s30, v37
    v_mul_f32 v38, s30, v38
    v_mul_f32 v39, s30, v39
    v_cvt_pk_bf16_f32 v212, v32, v33
    v_cvt_pk_bf16_f32 v213, v34, v35
    v_cvt_pk_bf16_f32 v214, v36, v37
    v_cvt_pk_bf16_f32 v215, v38, v39
    v_cndmask_b32 v112, v212, v214, s[54:55]
    v_cndmask_b32 v113, v213, v215, s[54:55]
    v_cndmask_b32 v114, v214, v212, s[54:55]
    v_cndmask_b32 v115, v215, v213, s[54:55]
    v_mul_f32 v8, s30, v8
    v_mul_f32 v9, s30, v9
    v_mul_f32 v10, s30, v10
    v_mul_f32 v11, s30, v11
    v_mul_f32 v12, s30, v12
    v_mul_f32 v13, s30, v13
    v_mul_f32 v14, s30, v14
    v_mul_f32 v15, s30, v15
    v_cvt_pk_bf16_f32 v212, v8, v9
    v_cvt_pk_bf16_f32 v213, v10, v11
    v_cvt_pk_bf16_f32 v214, v12, v13
    v_cvt_pk_bf16_f32 v215, v14, v15
    v_cndmask_b32 v100, v212, v214, s[54:55]
    v_cndmask_b32 v101, v213, v215, s[54:55]
    v_cndmask_b32 v102, v214, v212, s[54:55]
    v_cndmask_b32 v103, v215, v213, s[54:55]
    v_mul_f32 v40, s30, v40
    v_mul_f32 v41, s30, v41
    v_mul_f32 v42, s30, v42
    v_mul_f32 v43, s30, v43
    v_mul_f32 v44, s30, v44
    v_mul_f32 v45, s30, v45
    v_mul_f32 v46, s30, v46
    v_mul_f32 v47, s30, v47
    v_cvt_pk_bf16_f32 v212, v40, v41
    v_cvt_pk_bf16_f32 v213, v42, v43
    v_cvt_pk_bf16_f32 v214, v44, v45
    v_cvt_pk_bf16_f32 v215, v46, v47
    v_cndmask_b32 v116, v212, v214, s[54:55]
    v_cndmask_b32 v117, v213, v215, s[54:55]
    v_cndmask_b32 v118, v214, v212, s[54:55]
    v_cndmask_b32 v119, v215, v213, s[54:55]
    v_mul_f32 v16, s30, v16
    v_mul_f32 v17, s30, v17
    v_mul_f32 v18, s30, v18
    v_mul_f32 v19, s30, v19
    v_mul_f32 v20, s30, v20
    v_mul_f32 v21, s30, v21
    v_mul_f32 v22, s30, v22
    v_mul_f32 v23, s30, v23
    v_cvt_pk_bf16_f32 v212, v16, v17
    v_cvt_pk_bf16_f32 v213, v18, v19
    v_cvt_pk_bf16_f32 v214, v20, v21
    v_cvt_pk_bf16_f32 v215, v22, v23
    v_cndmask_b32 v104, v212, v214, s[54:55]
    v_cndmask_b32 v105, v213, v215, s[54:55]
    v_cndmask_b32 v106, v214, v212, s[54:55]
    v_cndmask_b32 v107, v215, v213, s[54:55]
    v_mul_f32 v48, s30, v48
    v_mul_f32 v49, s30, v49
    v_mul_f32 v50, s30, v50
    v_mul_f32 v51, s30, v51
    v_mul_f32 v52, s30, v52
    v_mul_f32 v53, s30, v53
    v_mul_f32 v54, s30, v54
    v_mul_f32 v55, s30, v55
    v_cvt_pk_bf16_f32 v212, v48, v49
    v_cvt_pk_bf16_f32 v213, v50, v51
    v_cvt_pk_bf16_f32 v214, v52, v53
    v_cvt_pk_bf16_f32 v215, v54, v55
    v_cndmask_b32 v120, v212, v214, s[54:55]
    v_cndmask_b32 v121, v213, v215, s[54:55]
    v_cndmask_b32 v122, v214, v212, s[54:55]
    v_cndmask_b32 v123, v215, v213, s[54:55]
    v_mul_f32 v24, s30, v24
    v_mul_f32 v25, s30, v25
    v_mul_f32 v26, s30, v26
    v_mul_f32 v27, s30, v27
    v_mul_f32 v28, s30, v28
    v_mul_f32 v29, s30, v29
    v_mul_f32 v30, s30, v30
    v_mul_f32 v31, s30, v31
    v_cvt_pk_bf16_f32 v212, v24, v25
    v_cvt_pk_bf16_f32 v213, v26, v27
    v_cvt_pk_bf16_f32 v214, v28, v29
    v_cvt_pk_bf16_f32 v215, v30, v31
    v_cndmask_b32 v108, v212, v214, s[54:55]
    v_cndmask_b32 v109, v213, v215, s[54:55]
    v_cndmask_b32 v110, v214, v212, s[54:55]
    v_cndmask_b32 v111, v215, v213, s[54:55]
    v_mul_f32 v56, s30, v56
    v_mul_f32 v57, s30, v57
    v_mul_f32 v58, s30, v58
    v_mul_f32 v59, s30, v59
    v_mul_f32 v60, s30, v60
    v_mul_f32 v61, s30, v61
    v_mul_f32 v62, s30, v62
    v_mul_f32 v63, s30, v63
    v_cvt_pk_bf16_f32 v212, v56, v57
    v_cvt_pk_bf16_f32 v213, v58, v59
    v_cvt_pk_bf16_f32 v214, v60, v61
    v_cvt_pk_bf16_f32 v215, v62, v63
    v_cndmask_b32 v124, v212, v214, s[54:55]
    v_cndmask_b32 v125, v213, v215, s[54:55]
    v_cndmask_b32 v126, v214, v212, s[54:55]
    v_cndmask_b32 v127, v215, v213, s[54:55]
    s_waitcnt lgkmcnt(0)
    s_waitcnt vmcnt(2)
    s_barrier
    ds_read_b128 v[128:131], v246 offset:0
    ds_read_b128 v[132:135], v246 offset:1024
    ds_read_b128 v[136:139], v246 offset:2048
    ds_read_b128 v[140:143], v246 offset:3072
    v_mov_b32 v0, 0
    v_mov_b32 v1, 0
    v_mov_b32 v2, 0
    v_mov_b32 v3, 0
    v_mov_b32 v4, 0
    v_mov_b32 v5, 0
    v_mov_b32 v6, 0
    v_mov_b32 v7, 0
    v_mov_b32 v8, 0
    v_mov_b32 v9, 0
    v_mov_b32 v10, 0
    v_mov_b32 v11, 0
    v_mov_b32 v12, 0
    v_mov_b32 v13, 0
    v_mov_b32 v14, 0
    v_mov_b32 v15, 0
    v_mov_b32 v16, 0
    v_mov_b32 v17, 0
    v_mov_b32 v18, 0
    v_mov_b32 v19, 0
    v_mov_b32 v20, 0
    v_mov_b32 v21, 0
    v_mov_b32 v22, 0
    v_mov_b32 v23, 0
    v_mov_b32 v24, 0
    v_mov_b32 v25, 0
    v_mov_b32 v26, 0
    v_mov_b32 v27, 0
    v_mov_b32 v28, 0
    v_mov_b32 v29, 0
    v_mov_b32 v30, 0
    v_mov_b32 v31, 0
    v_mov_b32 v32, 0
    v_mov_b32 v33, 0
    v_mov_b32 v34, 0
    v_mov_b32 v35, 0
    v_mov_b32 v36, 0
    v_mov_b32 v37, 0
    v_mov_b32 v38, 0
    v_mov_b32 v39, 0
    v_mov_b32 v40, 0
    v_mov_b32 v41, 0
    v_mov_b32 v42, 0
    v_mov_b32 v43, 0
    v_mov_b32 v44, 0
    v_mov_b32 v45, 0
    v_mov_b32 v46, 0
    v_mov_b32 v47, 0
    v_mov_b32 v48, 0
    v_mov_b32 v49, 0
    v_mov_b32 v50, 0
    v_mov_b32 v51, 0
    v_mov_b32 v52, 0
    v_mov_b32 v53, 0
    v_mov_b32 v54, 0
    v_mov_b32 v55, 0
    v_mov_b32 v56, 0
    v_mov_b32 v57, 0
    v_mov_b32 v58, 0
    v_mov_b32 v59, 0
    v_mov_b32 v60, 0
    v_mov_b32 v61, 0
    v_mov_b32 v62, 0
    v_mov_b32 v63, 0
    v_mov_b32 v64, 0
    v_mov_b32 v65, 0
    v_mov_b32 v66, 0
    v_mov_b32 v67, 0
    v_mov_b32 v68, 0
    v_mov_b32 v69, 0
    v_mov_b32 v70, 0
    v_mov_b32 v71, 0
    v_mov_b32 v72, 0
    v_mov_b32 v73, 0
    v_mov_b32 v74, 0
    v_mov_b32 v75, 0
    v_mov_b32 v76, 0
    v_mov_b32 v77, 0
    v_mov_b32 v78, 0
    v_mov_b32 v79, 0
    v_mov_b32 v80, 0
    v_mov_b32 v81, 0
    v_mov_b32 v82, 0
    v_mov_b32 v83, 0
    v_mov_b32 v84, 0
    v_mov_b32 v85, 0
    v_mov_b32 v86, 0
    v_mov_b32 v87, 0
    v_mov_b32 v88, 0
    v_mov_b32 v89, 0
    v_mov_b32 v90, 0
    v_mov_b32 v91, 0
    v_mov_b32 v92, 0
    v_mov_b32 v93, 0
    v_mov_b32 v94, 0
    v_mov_b32 v95, 0
    v_mov_b32 v228, 0
    v_mov_b32 v229, 0
    v_mov_b32 v230, 0
    v_mov_b32 v180, 0
    v_mov_b32 v181, 0
    v_mov_b32 v182, 0
    v_mov_b32 v183, 0
    s_waitcnt lgkmcnt(0)
    s_cmp_eq_u32 s26, 0
    s_cselect_b32 s30, 2113536, 0
    s_add_u32 s31, s30, 28672
    v_add_u32 v241, s31, v241
    s_cmp_eq_u32 s26, 0
    s_cselect_b32 s30, 2097152, 0
    s_add_u32 s31, s30, 28672
    v_add_u32 v242, s31, v242
    s_mov_b32 s27, 0
    s_cmp_eq_u32 s26, 0
    s_cbranch_scc1 K1W3_RND
    s_mov_b32 s28, 28672
    s_mov_b32 m0, s28
    v_xor_b32 v243, 64, v241
    buffer_load_dwordx4 v241, s[4:7], 0 offen nt lds
    v_xor_b32 v244, 128, v241
    buffer_load_dwordx4 v243, s[4:7], 0 offen offset:1024 nt lds
    v_xor_b32 v243, 192, v241
    buffer_load_dwordx4 v244, s[4:7], 0 offen offset:2048 nt lds
    buffer_load_dwordx4 v243, s[4:7], 0 offen offset:3072 nt lds
    v_add_u32 v241, 16384, v241
K1W3_RND:
    v_add_u32 v238, 16384, v238
    s_mov_b32 s29, 77824
K1W3_ROUND:
    s_mov_b32 s25, 0
    s_cmp_eq_u32 s26, s27
    s_cbranch_scc0 K1W3_LDR
    s_mov_b32 s57, s27
    s_mul_i32 s30, s27, 16384
    v_add_u32 v234, s30, v234
    v_add_u32 v235, s30, v235
    v_add_u32 v236, s30, v236
    v_add_u32 v237, s30, v237
    s_nop 1
K1W3_LOOP:
    s_cmp_eq_u32 s25, 0
    s_cbranch_scc1 K1W3_A1a
    s_waitcnt vmcnt(0) lgkmcnt(0)
    s_barrier
    s_branch K1W3_A1b
K1W3_A1a:
    s_waitcnt vmcnt(8) lgkmcnt(0)
    s_barrier
    ds_read_b128 v[196:199], v234
    ds_read_b128 v[200:203], v235
    ds_read_b128 v[204:207], v236
    ds_read_b128 v[208:211], v237
    ds_read_b128 v[212:215], v234 offset:8192
    ds_read_b128 v[216:219], v235 offset:8192
    ds_read_b128 v[220:223], v236 offset:8192
    ds_read_b128 v[224:227], v237 offset:8192
    s_waitcnt lgkmcnt(7)
    v_mfma_f32_16x16x32_bf16 v[144:147], v[196:199], v[96:99], 0
    v_mfma_f32_16x16x32_bf16 v[160:163], v[196:199], v[112:115], 0
    s_waitcnt lgkmcnt(3)
    v_mfma_f32_16x16x32_bf16 v[176:179], v[212:215], v[128:131], 0
    v_mfma_f32_16x16x32_bf16 v[144:147], v[200:203], v[100:103], v[144:147]
    v_mfma_f32_16x16x32_bf16 v[160:163], v[200:203], v[116:119], v[160:163]
    s_waitcnt lgkmcnt(2)
    v_mfma_f32_16x16x32_bf16 v[176:179], v[216:219], v[132:135], v[176:179]
    v_mfma_f32_16x16x32_bf16 v[144:147], v[204:207], v[104:107], v[144:147]
    v_mfma_f32_16x16x32_bf16 v[160:163], v[204:207], v[120:123], v[160:163]
    s_waitcnt lgkmcnt(1)
    v_mfma_f32_16x16x32_bf16 v[176:179], v[220:223], v[136:139], v[176:179]
    v_mfma_f32_16x16x32_bf16 v[144:147], v[208:211], v[108:111], v[144:147]
    v_mfma_f32_16x16x32_bf16 v[160:163], v[208:211], v[124:127], v[160:163]
    s_waitcnt lgkmcnt(0)
    v_mfma_f32_16x16x32_bf16 v[176:179], v[224:227], v[140:143], v[176:179]
    s_nop 4
    v_max3_f32 v243, v144, v145, v146
    v_max_f32 v243, v243, v147
    v_mov_b32 v244, v243
    s_nop 1
    v_permlane16_swap_b32 v244, v243
    v_max_f32 v243, v243, v244
    v_mov_b32 v244, v243
    s_nop 1
    v_permlane32_swap_b32 v244, v243
    v_max_f32 v243, v243, v244
    v_sub_f32 v184, 0, v243
    v_sub_f32 v185, 0, v243
    v_sub_f32 v186, 0, v243
    v_sub_f32 v187, 0, v243
    v_max3_f32 v243, v160, v161, v162
    v_max_f32 v243, v243, v163
    v_mov_b32 v244, v243
    s_nop 1
    v_permlane16_swap_b32 v244, v243
    v_max_f32 v243, v243, v244
    v_mov_b32 v244, v243
    s_nop 1
    v_permlane32_swap_b32 v244, v243
    v_max_f32 v243, v243, v244
    v_sub_f32 v188, 0, v243
    v_sub_f32 v189, 0, v243
    v_sub_f32 v190, 0, v243
    v_sub_f32 v191, 0, v243
    v_max3_f32 v243, v176, v177, v178
    v_max_f32 v243, v243, v179
    v_mov_b32 v244, v243
    s_nop 1
    v_permlane16_swap_b32 v244, v243
    v_max_f32 v243, v243, v244
    v_mov_b32 v244, v243
    s_nop 1
    v_permlane32_swap_b32 v244, v243
    v_max_f32 v243, v243, v244
    v_sub_f32 v192, 0, v243
    v_sub_f32 v193, 0, v243
    v_sub_f32 v194, 0, v243
    v_sub_f32 v195, 0, v243
    s_nop 3
K1W3_A1b:
    ds_read_b128 v[196:199], v234 offset:0
    ds_read_b128 v[200:203], v235 offset:0
    ds_read_b128 v[204:207], v236 offset:0
    ds_read_b128 v[208:211], v237 offset:0
    ds_read_b128 v[212:215], v234 offset:4096
    ds_read_b128 v[216:219], v235 offset:4096
    ds_read_b128 v[220:223], v236 offset:4096
    ds_read_b128 v[224:227], v237 offset:4096
    s_waitcnt lgkmcnt(7)
    v_mfma_f32_16x16x32_bf16 v[144:147], v[196:199], v[96:99], v[184:187]
    v_mfma_f32_16x16x32_bf16 v[160:163], v[196:199], v[112:115], v[188:191]
    s_waitcnt lgkmcnt(6)
    v_mfma_f32_16x16x32_bf16 v[144:147], v[200:203], v[100:103], v[144:147]
    v_mfma_f32_16x16x32_bf16 v[160:163], v[200:203], v[116:119], v[160:163]
    s_waitcnt lgkmcnt(5)
    v_mfma_f32_16x16x32_bf16 v[144:147], v[204:207], v[104:107], v[144:147]
    v_mfma_f32_16x16x32_bf16 v[160:163], v[204:207], v[120:123], v[160:163]
    s_waitcnt lgkmcnt(4)
    v_mfma_f32_16x16x32_bf16 v[144:147], v[208:211], v[108:111], v[144:147]
    v_mfma_f32_16x16x32_bf16 v[160:163], v[208:211], v[124:127], v[160:163]
    s_waitcnt lgkmcnt(3)
    v_mfma_f32_16x16x32_bf16 v[148:151], v[212:215], v[96:99], v[184:187]
    v_mfma_f32_16x16x32_bf16 v[164:167], v[212:215], v[112:115], v[188:191]
    ds_read_b128 v[196:199], v234 offset:8192
    ds_read_b128 v[200:203], v235 offset:8192
    s_waitcnt lgkmcnt(4)
    v_mfma_f32_16x16x32_bf16 v[148:151], v[216:219], v[100:103], v[148:151]
    ds_read_b128 v[204:207], v236 offset:8192
    ds_read_b128 v[208:211], v237 offset:8192
    v_mfma_f32_16x16x32_bf16 v[164:167], v[216:219], v[116:119], v[164:167]
    v_exp_f32 v144, v144
    v_exp_f32 v145, v145
    s_waitcnt lgkmcnt(5)
    v_mfma_f32_16x16x32_bf16 v[148:151], v[220:223], v[104:107], v[148:151]
    v_exp_f32 v146, v146
    v_mfma_f32_16x16x32_bf16 v[164:167], v[220:223], v[120:123], v[164:167]
    v_exp_f32 v147, v147
    v_exp_f32 v160, v160
    s_waitcnt lgkmcnt(4)
    v_mfma_f32_16x16x32_bf16 v[148:151], v[224:227], v[108:111], v[148:151]
    v_exp_f32 v161, v161
    v_exp_f32 v162, v162
    v_mfma_f32_16x16x32_bf16 v[164:167], v[224:227], v[124:127], v[164:167]
    v_exp_f32 v163, v163
    s_waitcnt lgkmcnt(3)
    v_mfma_f32_16x16x32_bf16 v[152:155], v[196:199], v[96:99], v[184:187]
    v_mfma_f32_16x16x32_bf16 v[168:171], v[196:199], v[112:115], v[188:191]
    ds_read_b128 v[212:215], v234 offset:12288
    ds_read_b128 v[216:219], v235 offset:12288
    v_mfma_f32_16x16x32_bf16 v[176:179], v[196:199], v[128:131], v[192:195]
    ds_read_b128 v[220:223], v236 offset:12288
    ds_read_b128 v[224:227], v237 offset:12288
    s_waitcnt lgkmcnt(6)
    v_mfma_f32_16x16x32_bf16 v[152:155], v[200:203], v[100:103], v[152:155]
    v_exp_f32 v148, v148
    v_mfma_f32_16x16x32_bf16 v[168:171], v[200:203], v[116:119], v[168:171]
    v_exp_f32 v149, v149
    v_exp_f32 v150, v150
    v_mfma_f32_16x16x32_bf16 v[176:179], v[200:203], v[132:135], v[176:179]
    v_exp_f32 v151, v151
    v_exp_f32 v164, v164
    s_waitcnt lgkmcnt(5)
    v_mfma_f32_16x16x32_bf16 v[152:155], v[204:207], v[104:107], v[152:155]
    v_exp_f32 v165, v165
    v_mfma_f32_16x16x32_bf16 v[168:171], v[204:207], v[120:123], v[168:171]
    v_exp_f32 v166, v166
    v_exp_f32 v167, v167
    v_mfma_f32_16x16x32_bf16 v[176:179], v[204:207], v[136:139], v[176:179]
    v_add_f32 v231, v144, v145
    v_add_f32 v231, v231, v146
    s_waitcnt lgkmcnt(4)
    v_mfma_f32_16x16x32_bf16 v[152:155], v[208:211], v[108:111], v[152:155]
    v_add_f32 v231, v231, v147
    v_mfma_f32_16x16x32_bf16 v[168:171], v[208:211], v[124:127], v[168:171]
    v_add_f32 v232, v160, v161
    v_add_f32 v232, v232, v162
    v_mfma_f32_16x16x32_bf16 v[176:179], v[208:211], v[140:143], v[176:179]
    v_add_f32 v232, v232, v163
    s_waitcnt lgkmcnt(3)
    v_mfma_f32_16x16x32_bf16 v[156:159], v[212:215], v[96:99], v[184:187]
    v_add_f32 v231, v231, v148
    v_add_f32 v231, v231, v149
    v_mfma_f32_16x16x32_bf16 v[172:175], v[212:215], v[112:115], v[188:191]
    v_add_f32 v231, v231, v150
    v_mfma_f32_16x16x32_bf16 v[180:183], v[212:215], v[128:131], v[192:195]
    v_add_f32 v231, v231, v151
    s_waitcnt lgkmcnt(2)
    v_mfma_f32_16x16x32_bf16 v[156:159], v[216:219], v[100:103], v[156:159]
    v_add_f32 v232, v232, v164
    v_add_f32 v232, v232, v165
    v_mfma_f32_16x16x32_bf16 v[172:175], v[216:219], v[116:119], v[172:175]
    v_add_f32 v232, v232, v166
    v_mfma_f32_16x16x32_bf16 v[180:183], v[216:219], v[132:135], v[180:183]
    v_add_f32 v232, v232, v167
    s_waitcnt lgkmcnt(1)
    v_mfma_f32_16x16x32_bf16 v[156:159], v[220:223], v[104:107], v[156:159]
    v_cvt_pk_bf16_f32 v144, v144, v145
    v_cvt_pk_bf16_f32 v145, v146, v147
    v_mfma_f32_16x16x32_bf16 v[172:175], v[220:223], v[120:123], v[172:175]
    v_cvt_pk_bf16_f32 v146, v148, v149
    v_mfma_f32_16x16x32_bf16 v[180:183], v[220:223], v[136:139], v[180:183]
    v_cvt_pk_bf16_f32 v147, v150, v151
    s_waitcnt lgkmcnt(0)
    v_mfma_f32_16x16x32_bf16 v[156:159], v[224:227], v[108:111], v[156:159]
    v_cvt_pk_bf16_f32 v160, v160, v161
    v_cvt_pk_bf16_f32 v161, v162, v163
    v_mfma_f32_16x16x32_bf16 v[172:175], v[224:227], v[124:127], v[172:175]
    v_cvt_pk_bf16_f32 v162, v164, v165
    v_mfma_f32_16x16x32_bf16 v[180:183], v[224:227], v[140:143], v[180:183]
    v_cvt_pk_bf16_f32 v163, v166, v167
    v_add_f32 v243, v231, v232
    v_cmp_ngt_f32 vcc, s50, v243
    s_cbranch_vccnz K1W3_slow0
K1W3_back0:
    v_add_f32 v228, v228, v231
    v_add_f32 v229, v229, v232
    v_exp_f32 v152, v152
    v_exp_f32 v153, v153
    v_exp_f32 v154, v154
    v_exp_f32 v155, v155
    v_exp_f32 v168, v168
    v_exp_f32 v169, v169
    v_exp_f32 v170, v170
    v_exp_f32 v171, v171
    v_exp_f32 v176, v176
    v_exp_f32 v177, v177
    v_exp_f32 v178, v178
    v_exp_f32 v179, v179
    v_add_f32 v231, v152, v153
    v_add_f32 v231, v231, v154
    v_add_f32 v231, v231, v155
    v_add_f32 v232, v168, v169
    v_add_f32 v232, v232, v170
    v_add_f32 v232, v232, v171
    v_add_f32 v233, v176, v177
    v_add_f32 v233, v233, v178
    v_add_f32 v233, v233, v179
    s_cmp_eq_u32 s25, 0
    s_cbranch_scc1 K1W3_A2a
    s_waitcnt vmcnt(0) lgkmcnt(0)
    s_branch K1W3_A2b
K1W3_A2a:
    s_waitcnt vmcnt(4) lgkmcnt(0)
K1W3_A2b:
    s_barrier
    ds_read_b64_tr_b16 v[196:197], v238 offset:0
    ds_read_b64_tr_b16 v[198:199], v238 offset:4096
    v_xor_b32 v240, 32, v238
    ds_read_b64_tr_b16 v[200:201], v240 offset:0
    ds_read_b64_tr_b16 v[202:203], v240 offset:4096
    v_xor_b32 v239, 64, v238
    ds_read_b64_tr_b16 v[204:205], v239 offset:0
    ds_read_b64_tr_b16 v[206:207], v239 offset:4096
    v_xor_b32 v240, 96, v238
    ds_read_b64_tr_b16 v[208:209], v240 offset:0
    ds_read_b64_tr_b16 v[210:211], v240 offset:4096
    v_xor_b32 v239, 128, v238
    ds_read_b64_tr_b16 v[212:213], v239 offset:0
    ds_read_b64_tr_b16 v[214:215], v239 offset:4096
    v_xor_b32 v240, 160, v238
    ds_read_b64_tr_b16 v[216:217], v240 offset:0
    ds_read_b64_tr_b16 v[218:219], v240 offset:4096
    v_xor_b32 v239, 192, v238
    ds_read_b64_tr_b16 v[220:221], v239 offset:0
    ds_read_b64_tr_b16 v[222:223], v239 offset:4096
    v_xor_b32 v240, 224, v238
    ds_read_b64_tr_b16 v[224:225], v240 offset:0
    ds_read_b64_tr_b16 v[226:227], v240 offset:4096
    s_waitcnt lgkmcnt(14)
    v_mfma_f32_16x16x32_bf16 v[0:3], v[196:199], v[144:147], v[0:3]
    v_exp_f32 v156, v156
    v_exp_f32 v157, v157
    v_mfma_f32_16x16x32_bf16 v[32:35], v[196:199], v[160:163], v[32:35]
    v_exp_f32 v158, v158
    v_exp_f32 v159, v159
    ds_read_b64_tr_b16 v[196:197], v238 offset:8192
    ds_read_b64_tr_b16 v[198:199], v238 offset:12288
    s_waitcnt lgkmcnt(14)
    v_mfma_f32_16x16x32_bf16 v[4:7], v[200:203], v[144:147], v[4:7]
    v_exp_f32 v172, v172
    v_exp_f32 v173, v173
    v_exp_f32 v174, v174
    v_mfma_f32_16x16x32_bf16 v[36:39], v[200:203], v[160:163], v[36:39]
    v_exp_f32 v175, v175
    v_exp_f32 v180, v180
    v_xor_b32 v240, 32, v238
    ds_read_b64_tr_b16 v[200:201], v240 offset:8192
    ds_read_b64_tr_b16 v[202:203], v240 offset:12288
    s_waitcnt lgkmcnt(14)
    v_mfma_f32_16x16x32_bf16 v[8:11], v[204:207], v[144:147], v[8:11]
    v_exp_f32 v181, v181
    v_exp_f32 v182, v182
    v_mfma_f32_16x16x32_bf16 v[40:43], v[204:207], v[160:163], v[40:43]
    v_exp_f32 v183, v183
    v_add_f32 v231, v231, v156
    v_xor_b32 v239, 64, v238
    ds_read_b64_tr_b16 v[204:205], v239 offset:8192
    ds_read_b64_tr_b16 v[206:207], v239 offset:12288
    s_waitcnt lgkmcnt(14)
    v_mfma_f32_16x16x32_bf16 v[12:15], v[208:211], v[144:147], v[12:15]
    v_add_f32 v231, v231, v157
    v_add_f32 v231, v231, v158
    v_add_f32 v231, v231, v159
    v_mfma_f32_16x16x32_bf16 v[44:47], v[208:211], v[160:163], v[44:47]
    v_add_f32 v232, v232, v172
    v_add_f32 v232, v232, v173
    v_xor_b32 v240, 96, v238
    ds_read_b64_tr_b16 v[208:209], v240 offset:8192
    ds_read_b64_tr_b16 v[210:211], v240 offset:12288
    s_waitcnt lgkmcnt(14)
    v_mfma_f32_16x16x32_bf16 v[16:19], v[212:215], v[144:147], v[16:19]
    v_add_f32 v232, v232, v174
    v_add_f32 v232, v232, v175
    v_mfma_f32_16x16x32_bf16 v[48:51], v[212:215], v[160:163], v[48:51]
    v_add_f32 v233, v233, v180
    v_add_f32 v233, v233, v181
    v_xor_b32 v239, 128, v238
    ds_read_b64_tr_b16 v[212:213], v239 offset:8192
    ds_read_b64_tr_b16 v[214:215], v239 offset:12288
    s_waitcnt lgkmcnt(14)
    v_mfma_f32_16x16x32_bf16 v[20:23], v[216:219], v[144:147], v[20:23]
    v_add_f32 v233, v233, v182
    v_add_f32 v233, v233, v183
    v_cvt_pk_bf16_f32 v148, v152, v153
    v_mfma_f32_16x16x32_bf16 v[52:55], v[216:219], v[160:163], v[52:55]
    v_cvt_pk_bf16_f32 v149, v154, v155
    v_cvt_pk_bf16_f32 v150, v156, v157
    v_xor_b32 v240, 160, v238
    ds_read_b64_tr_b16 v[216:217], v240 offset:8192
    ds_read_b64_tr_b16 v[218:219], v240 offset:12288
    s_waitcnt lgkmcnt(14)
    v_mfma_f32_16x16x32_bf16 v[24:27], v[220:223], v[144:147], v[24:27]
    v_cvt_pk_bf16_f32 v151, v158, v159
    v_cvt_pk_bf16_f32 v164, v168, v169
    v_mfma_f32_16x16x32_bf16 v[56:59], v[220:223], v[160:163], v[56:59]
    v_cvt_pk_bf16_f32 v165, v170, v171
    v_cvt_pk_bf16_f32 v166, v172, v173
    v_xor_b32 v239, 192, v238
    ds_read_b64_tr_b16 v[220:221], v239 offset:8192
    ds_read_b64_tr_b16 v[222:223], v239 offset:12288
    s_waitcnt lgkmcnt(14)
    v_mfma_f32_16x16x32_bf16 v[28:31], v[224:227], v[144:147], v[28:31]
    v_cvt_pk_bf16_f32 v167, v174, v175
    v_cvt_pk_bf16_f32 v176, v176, v177
    v_cvt_pk_bf16_f32 v177, v178, v179
    v_mfma_f32_16x16x32_bf16 v[60:63], v[224:227], v[160:163], v[60:63]
    v_cvt_pk_bf16_f32 v178, v180, v181
    v_cvt_pk_bf16_f32 v179, v182, v183
    v_xor_b32 v240, 224, v238
    ds_read_b64_tr_b16 v[224:225], v240 offset:8192
    ds_read_b64_tr_b16 v[226:227], v240 offset:12288
    v_add_f32 v243, v231, v232
    v_add_f32 v243, v243, v233
    v_cmp_ngt_f32 vcc, s50, v243
    s_cbranch_vccnz K1W3_slow1
K1W3_back1:
    v_add_f32 v228, v228, v231
    v_add_f32 v229, v229, v232
    v_add_f32 v230, v230, v233
    s_waitcnt lgkmcnt(14)
    v_mfma_f32_16x16x32_bf16 v[0:3], v[196:199], v[148:151], v[0:3]
    v_mfma_f32_16x16x32_bf16 v[32:35], v[196:199], v[164:167], v[32:35]
    v_mfma_f32_16x16x32_bf16 v[64:67], v[196:199], v[176:179], v[64:67]
    s_waitcnt lgkmcnt(12)
    v_mfma_f32_16x16x32_bf16 v[4:7], v[200:203], v[148:151], v[4:7]
    v_mfma_f32_16x16x32_bf16 v[36:39], v[200:203], v[164:167], v[36:39]
    v_mfma_f32_16x16x32_bf16 v[68:71], v[200:203], v[176:179], v[68:71]
    s_waitcnt lgkmcnt(10)
    v_mfma_f32_16x16x32_bf16 v[8:11], v[204:207], v[148:151], v[8:11]
    v_mfma_f32_16x16x32_bf16 v[40:43], v[204:207], v[164:167], v[40:43]
    v_mfma_f32_16x16x32_bf16 v[72:75], v[204:207], v[176:179], v[72:75]
    s_waitcnt lgkmcnt(8)
    v_mfma_f32_16x16x32_bf16 v[12:15], v[208:211], v[148:151], v[12:15]
    v_mfma_f32_16x16x32_bf16 v[44:47], v[208:211], v[164:167], v[44:47]
    v_mfma_f32_16x16x32_bf16 v[76:79], v[208:211], v[176:179], v[76:79]
    s_waitcnt lgkmcnt(6)
    v_mfma_f32_16x16x32_bf16 v[16:19], v[212:215], v[148:151], v[16:19]
    v_mfma_f32_16x16x32_bf16 v[48:51], v[212:215], v[164:167], v[48:51]
    v_mfma_f32_16x16x32_bf16 v[80:83], v[212:215], v[176:179], v[80:83]
    s_waitcnt lgkmcnt(4)
    v_mfma_f32_16x16x32_bf16 v[20:23], v[216:219], v[148:151], v[20:23]
    v_mfma_f32_16x16x32_bf16 v[52:55], v[216:219], v[164:167], v[52:55]
    v_mfma_f32_16x16x32_bf16 v[84:87], v[216:219], v[176:179], v[84:87]
    s_waitcnt lgkmcnt(2)
    v_mfma_f32_16x16x32_bf16 v[24:27], v[220:223], v[148:151], v[24:27]
    v_mfma_f32_16x16x32_bf16 v[56:59], v[220:223], v[164:167], v[56:59]
    v_mfma_f32_16x16x32_bf16 v[88:91], v[220:223], v[176:179], v[88:91]
    s_waitcnt lgkmcnt(0)
    v_mfma_f32_16x16x32_bf16 v[28:31], v[224:227], v[148:151], v[28:31]
    v_mfma_f32_16x16x32_bf16 v[60:63], v[224:227], v[164:167], v[60:63]
    v_mfma_f32_16x16x32_bf16 v[92:95], v[224:227], v[176:179], v[92:95]
    s_cmp_eq_u32 s57, 0
    s_cselect_b32 s60, 16384, 0
    s_cmp_eq_u32 s57, 1
    s_cselect_b32 s60, 32768, s60
    s_cmp_eq_u32 s57, 2
    s_cselect_b32 s60, 4294918144, s60
    s_cselect_b32 s57, -1, s57
    s_add_u32 s57, s57, 1
    v_add_u32 v234, s60, v234
    v_add_u32 v235, s60, v235
    v_add_u32 v236, s60, v236
    v_add_u32 v237, s60, v237
    v_xor_b32 v238, 98304, v238
    s_add_u32 s25, s25, 1
    s_cmp_lt_u32 s25, 16
    s_cbranch_scc1 K1W3_LOOP
    s_cmp_eq_u32 s27, 1
    s_cbranch_scc1 K1W3_FINAL1
    s_mov_b32 s27, 1
    s_branch K1W3_ROUND
K1W3_LDR:
    s_nop 1
    s_and_b32 s51, s2, 1
    s_cmp_eq_u32 s27, 0
    s_cbranch_scc1 K1W3_LR0
K1W3_LR0:
    s_cmp_eq_u32 s27, 0
    s_cselect_b32 s57, 2, 0
    s_mov_b32 s28, 12288
    s_cselect_b32 s28, 61440, s28
    s_mov_b32 s45, 0
K1W3_LLOOP:
    s_mov_b32 s46, s45
    s_mov_b32 s45, 0
    s_cmp_eq_u32 s46, 0
    s_cbranch_scc0 K1W3_XW1_1
    s_waitcnt vmcnt(8) lgkmcnt(0)
    s_branch K1W3_XW1_z
K1W3_XW1_1:
    s_cmp_eq_u32 s46, 1
    s_cbranch_scc0 K1W3_XW1_2
    s_waitcnt vmcnt(9) lgkmcnt(0)
    s_branch K1W3_XW1_z
K1W3_XW1_2:
    s_cmp_eq_u32 s46, 2
    s_cbranch_scc0 K1W3_XW1_3
    s_waitcnt vmcnt(10) lgkmcnt(0)
    s_branch K1W3_XW1_z
K1W3_XW1_3:
    s_waitcnt vmcnt(11) lgkmcnt(0)
K1W3_XW1_z:
    s_barrier
    s_cmp_eq_u32 s27, 0
    s_cbranch_scc0 K1W3_L0
    s_cmp_eq_u32 s25, 15
    s_cbranch_scc0 K1W3_L0
    v_add_u32 v242, 1835008, v242
K1W3_L0:
    s_mov_b32 m0, s29
    v_xor_b32 v243, 128, v242
    buffer_load_dwordx4 v242, s[8:11], 0 offen nt lds
    buffer_load_dwordx4 v243, s[8:11], 0 offen offset:1024 nt lds
    buffer_load_dwordx4 v242, s[8:11], 0 offen offset:2048 nt lds
    buffer_load_dwordx4 v243, s[8:11], 0 offen offset:3072 nt lds
    v_add_u32 v242, 16384, v242
    s_xor_b32 s29, s29, 98304
    s_cmp_eq_u32 s27, 1
    s_cbranch_scc0 K1W3_L1
    s_cmp_eq_u32 s25, 0
    s_cbranch_scc0 K1W3_E0
    s_nop 7
    v_add_u32 v246, 81920, v248
    v_and_b32 v247, 15, v245
    v_lshlrev_b32 v247, 2, v247
    v_add_u32 v247, 114688, v247
    ds_write_b128 v246, v[64:67] offset:8192
    ds_write_b128 v246, v[68:71] offset:9216
    ds_write_b128 v246, v[72:75] offset:10240
    ds_write_b128 v246, v[76:79] offset:11264
    ds_write_b128 v246, v[80:83] offset:12288
    ds_write_b128 v246, v[84:87] offset:13312
    ds_write_b128 v246, v[88:91] offset:14336
    ds_write_b128 v246, v[92:95] offset:15360
    v_mov_b32 v244, v230
    s_nop 1
    v_permlane16_swap_b32 v244, v230
    v_add_f32 v230, v230, v244
    v_mov_b32 v244, v230
    s_nop 1
    v_permlane32_swap_b32 v244, v230
    v_add_f32 v230, v230, v244
    v_sub_f32 v244, 0, v192
    ds_write_b32 v247, v244 offset:128
    ds_write_b32 v247, v230 offset:192
    v_mov_b32 v244, v228
    s_nop 1
    v_permlane16_swap_b32 v244, v228
    v_add_f32 v228, v228, v244
    v_mov_b32 v244, v228
    s_nop 1
    v_permlane32_swap_b32 v244, v228
    v_add_f32 v228, v228, v244
    v_mov_b32 v244, v229
    s_nop 1
    v_permlane16_swap_b32 v244, v229
    v_add_f32 v229, v229, v244
    v_mov_b32 v244, v229
    s_nop 1
    v_permlane32_swap_b32 v244, v229
    v_add_f32 v229, v229, v244
    v_rcp_f32 v228, v228
    v_rcp_f32 v229, v229
    s_waitcnt lgkmcnt(0)
    s_branch K1W3_L1
K1W3_E0:
    s_cmp_eq_u32 s25, 1
    s_cbranch_scc0 K1W3_E1
    s_nop 1
    v_mul_f32 v0, v0, v228
    v_mul_f32 v1, v1, v228
    v_mul_f32 v2, v2, v228
    v_mul_f32 v3, v3, v228
    v_mul_f32 v4, v4, v228
    v_mul_f32 v5, v5, v228
    v_mul_f32 v6, v6, v228
    v_mul_f32 v7, v7, v228
    v_cvt_pk_bf16_f32 v96, v0, v1
    v_cvt_pk_bf16_f32 v97, v2, v3
    v_cvt_pk_bf16_f32 v98, v4, v5
    v_cvt_pk_bf16_f32 v99, v6, v7
    v_mul_f32 v8, v8, v228
    v_mul_f32 v9, v9, v228
    v_mul_f32 v10, v10, v228
    v_mul_f32 v11, v11, v228
    v_mul_f32 v12, v12, v228
    v_mul_f32 v13, v13, v228
    v_mul_f32 v14, v14, v228
    v_mul_f32 v15, v15, v228
    v_cvt_pk_bf16_f32 v100, v8, v9
    v_cvt_pk_bf16_f32 v101, v10, v11
    v_cvt_pk_bf16_f32 v102, v12, v13
    v_cvt_pk_bf16_f32 v103, v14, v15
    v_mul_f32 v16, v16, v228
    v_mul_f32 v17, v17, v228
    v_mul_f32 v18, v18, v228
    v_mul_f32 v19, v19, v228
    v_mul_f32 v20, v20, v228
    v_mul_f32 v21, v21, v228
    v_mul_f32 v22, v22, v228
    v_mul_f32 v23, v23, v228
    v_cvt_pk_bf16_f32 v104, v16, v17
    v_cvt_pk_bf16_f32 v105, v18, v19
    v_cvt_pk_bf16_f32 v106, v20, v21
    v_cvt_pk_bf16_f32 v107, v22, v23
    v_mul_f32 v24, v24, v228
    v_mul_f32 v25, v25, v228
    v_mul_f32 v26, v26, v228
    v_mul_f32 v27, v27, v228
    v_mul_f32 v28, v28, v228
    v_mul_f32 v29, v29, v228
    v_mul_f32 v30, v30, v228
    v_mul_f32 v31, v31, v228
    v_cvt_pk_bf16_f32 v108, v24, v25
    v_cvt_pk_bf16_f32 v109, v26, v27
    v_cvt_pk_bf16_f32 v110, v28, v29
    v_cvt_pk_bf16_f32 v111, v30, v31
    s_branch K1W3_L1
K1W3_E1:
    s_cmp_eq_u32 s25, 2
    s_cbranch_scc0 K1W3_E2
    s_nop 1
    v_mul_f32 v32, v32, v229
    v_mul_f32 v33, v33, v229
    v_mul_f32 v34, v34, v229
    v_mul_f32 v35, v35, v229
    v_mul_f32 v36, v36, v229
    v_mul_f32 v37, v37, v229
    v_mul_f32 v38, v38, v229
    v_mul_f32 v39, v39, v229
    v_cvt_pk_bf16_f32 v112, v32, v33
    v_cvt_pk_bf16_f32 v113, v34, v35
    v_cvt_pk_bf16_f32 v114, v36, v37
    v_cvt_pk_bf16_f32 v115, v38, v39
    v_mul_f32 v40, v40, v229
    v_mul_f32 v41, v41, v229
    v_mul_f32 v42, v42, v229
    v_mul_f32 v43, v43, v229
    v_mul_f32 v44, v44, v229
    v_mul_f32 v45, v45, v229
    v_mul_f32 v46, v46, v229
    v_mul_f32 v47, v47, v229
    v_cvt_pk_bf16_f32 v116, v40, v41
    v_cvt_pk_bf16_f32 v117, v42, v43
    v_cvt_pk_bf16_f32 v118, v44, v45
    v_cvt_pk_bf16_f32 v119, v46, v47
    v_mul_f32 v48, v48, v229
    v_mul_f32 v49, v49, v229
    v_mul_f32 v50, v50, v229
    v_mul_f32 v51, v51, v229
    v_mul_f32 v52, v52, v229
    v_mul_f32 v53, v53, v229
    v_mul_f32 v54, v54, v229
    v_mul_f32 v55, v55, v229
    v_cvt_pk_bf16_f32 v120, v48, v49
    v_cvt_pk_bf16_f32 v121, v50, v51
    v_cvt_pk_bf16_f32 v122, v52, v53
    v_cvt_pk_bf16_f32 v123, v54, v55
    v_mul_f32 v56, v56, v229
    v_mul_f32 v57, v57, v229
    v_mul_f32 v58, v58, v229
    v_mul_f32 v59, v59, v229
    v_mul_f32 v60, v60, v229
    v_mul_f32 v61, v61, v229
    v_mul_f32 v62, v62, v229
    v_mul_f32 v63, v63, v229
    v_cvt_pk_bf16_f32 v124, v56, v57
    v_cvt_pk_bf16_f32 v125, v58, v59
    v_cvt_pk_bf16_f32 v126, v60, v61
    v_cvt_pk_bf16_f32 v127, v62, v63
    s_branch K1W3_L1
K1W3_E2:
    s_cmp_eq_u32 s25, 3
    s_cbranch_scc0 K1W3_E3
    s_nop 1
    ds_read_b32 v144, v247 offset:0
    ds_read_b32 v148, v247 offset:64
    ds_read_b32 v145, v247 offset:128
    ds_read_b32 v149, v247 offset:192
    ds_read_b128 v[196:199], v246 offset:6144
    ds_read_b128 v[200:203], v246 offset:7168
    ds_read_b128 v[204:207], v246 offset:14336
    ds_read_b128 v[208:211], v246 offset:15360
    s_waitcnt lgkmcnt(5)
    v_max_f32 v244, v144, v145
    v_sub_f32 v152, v144, v244
    v_sub_f32 v153, v145, v244
    v_exp_f32 v152, v152
    v_exp_f32 v153, v153
    v_mul_f32 v244, v152, v148
    s_waitcnt lgkmcnt(4)
    v_fma_f32 v244, v153, v149, v244
    v_rcp_f32 v244, v244
    s_nop 0
    v_mul_f32 v152, v152, v244
    v_mul_f32 v153, v153, v244
    s_waitcnt lgkmcnt(3)
    v_mul_f32 v160, v196, v152
    s_waitcnt lgkmcnt(1)
    v_fma_f32 v160, v204, v153, v160
    v_mul_f32 v161, v197, v152
    v_fma_f32 v161, v205, v153, v161
    v_mul_f32 v162, v198, v152
    v_fma_f32 v162, v206, v153, v162
    v_mul_f32 v163, v199, v152
    v_fma_f32 v163, v207, v153, v163
    v_mul_f32 v164, v200, v152
    s_waitcnt lgkmcnt(0)
    v_fma_f32 v164, v208, v153, v164
    v_mul_f32 v165, v201, v152
    v_fma_f32 v165, v209, v153, v165
    v_mul_f32 v166, v202, v152
    v_fma_f32 v166, v210, v153, v166
    v_mul_f32 v167, v203, v152
    v_fma_f32 v167, v211, v153, v167
    v_cvt_pk_bf16_f32 v128, v160, v161
    v_cvt_pk_bf16_f32 v129, v162, v163
    v_cvt_pk_bf16_f32 v130, v164, v165
    v_cvt_pk_bf16_f32 v131, v166, v167
    s_branch K1W3_L1
K1W3_E3:
K1W3_L1c:
K1W3_L1:
    s_add_u32 s47, s46, s45
    s_cmp_eq_u32 s47, 0
    s_cbranch_scc0 K1W3_XW2_1
    s_waitcnt vmcnt(8) lgkmcnt(0)
    s_branch K1W3_XW2_z
K1W3_XW2_1:
    s_cmp_eq_u32 s47, 1
    s_cbranch_scc0 K1W3_XW2_2
    s_waitcnt vmcnt(9) lgkmcnt(0)
    s_branch K1W3_XW2_z
K1W3_XW2_2:
    s_cmp_eq_u32 s47, 2
    s_cbranch_scc0 K1W3_XW2_3
    s_waitcnt vmcnt(10) lgkmcnt(0)
    s_branch K1W3_XW2_z
K1W3_XW2_3:
    s_waitcnt vmcnt(11) lgkmcnt(0)
K1W3_XW2_z:
    s_barrier
    s_cmp_eq_u32 s27, 0
    s_cbranch_scc0 K1W3_L2
    s_cmp_eq_u32 s25, 14
    s_cbranch_scc0 K1W3_L2
    v_add_u32 v241, 1835008, v241
K1W3_L2:
    s_mov_b32 m0, s28
    v_xor_b32 v243, 64, v241
    buffer_load_dwordx4 v241, s[4:7], 0 offen nt lds
    v_xor_b32 v244, 128, v241
    buffer_load_dwordx4 v243, s[4:7], 0 offen offset:1024 nt lds
    v_xor_b32 v243, 192, v241
    buffer_load_dwordx4 v244, s[4:7], 0 offen offset:2048 nt lds
    buffer_load_dwordx4 v243, s[4:7], 0 offen offset:3072 nt lds
    v_add_u32 v241, 16384, v241
    s_add_u32 s57, s57, 1
    s_cmp_eq_u32 s57, 3
    s_cselect_b32 s57, 0, s57
    s_cmp_eq_u32 s57, 0
    s_cselect_b32 s28, 12288, 0
    s_cmp_eq_u32 s57, 1
    s_cselect_b32 s28, 28672, s28
    s_cmp_eq_u32 s57, 2
    s_cselect_b32 s28, 61440, s28
    s_add_u32 s25, s25, 1
    s_cmp_lt_u32 s25, 16
    s_cbranch_scc1 K1W3_LLOOP
    s_cmp_eq_u32 s27, 1
    s_cbranch_scc1 K1W3_FIN0
    s_mov_b32 s27, 1
    s_branch K1W3_ROUND
K1W3_FIN0:
    s_nop 1
    s_mov_b32 s30, 24576
    buffer_store_dwordx4 v[96:99], v248, s[20:23], s30 offen offset:0 sc1
    buffer_store_dwordx4 v[100:103], v248, s[20:23], s30 offen offset:1024 sc1
    buffer_store_dwordx4 v[104:107], v248, s[20:23], s30 offen offset:2048 sc1
    buffer_store_dwordx4 v[108:111], v248, s[20:23], s30 offen offset:3072 sc1
    s_mov_b32 s30, 28672
    buffer_store_dwordx4 v[112:115], v248, s[20:23], s30 offen offset:0 sc1
    buffer_store_dwordx4 v[116:119], v248, s[20:23], s30 offen offset:1024 sc1
    buffer_store_dwordx4 v[120:123], v248, s[20:23], s30 offen offset:2048 sc1
    buffer_store_dwordx4 v[124:127], v248, s[20:23], s30 offen offset:3072 sc1
    s_mov_b32 s30, 35840
    buffer_store_dwordx4 v[128:131], v248, s[20:23], s30 offen sc1
    s_barrier
    s_waitcnt vmcnt(0)
    s_lshl_b32 s30, s85, 3
    s_add_u32 s30, s30, s84
    s_mul_i32 s44, s30, 52
    s_lshr_b32 s44, s44, 8
    s_mul_i32 s31, s44, 5
    s_sub_u32 s45, s30, s31
    s_and_b32 s51, s2, 1
    s_load_dwordx2 s[72:73], s[0:1], 32
    s_load_dwordx2 s[74:75], s[0:1], 72
    s_load_dwordx2 s[46:47], s[0:1], 80
    s_waitcnt lgkmcnt(0)
    s_cmp_eq_u32 s64, 0
    s_cselect_b64 s[72:73], s[72:73], s[74:75]
    s_lshl_b32 s30, s45, 8
    s_add_u32 s12, s72, s30
    s_addc_u32 s13, s73, 0
    s_sub_u32 s14, 5242880, s30
    s_mov_b32 s15, 131072
    s_mov_b32 s16, s48
    s_mov_b32 s17, s49
    s_mov_b32 s18, 18874368
    s_mov_b32 s19, 131072
    s_add_u32 s80, s48, 50331648
    s_addc_u32 s81, s49, 0
    s_mov_b32 s82, 131072
    s_mov_b32 s83, 131072
    s_mov_b32 s4, s46
    s_mov_b32 s5, s47
    s_mov_b32 s6, 2949120
    s_mov_b32 s7, 131072
    s_add_u32 s8, s48, 33554432
    s_addc_u32 s9, s49, 0
    s_mov_b32 s10, 12582912
    s_mov_b32 s11, 131072
    s_sub_u32 s69, s65, s85
    s_mul_i32 s30, s44, 6
    s_add_u32 s30, s30, 0
    s_mul_i32 s31, s30, 57
    s_lshr_b32 s31, s31, 9
    s_mul_i32 s72, s31, 9
    s_sub_u32 s72, s30, s72
    s_add_u32 s31, s31, s69
    s_lshl_b32 s73, s64, 3
    s_add_u32 s73, s73, s31
    s_lshl_b32 s73, s73, 5
    s_lshl_b32 s74, s51, 4
    s_add_u32 s73, s73, s74
    s_mul_i32 s73, s73, 36864
    s_lshl_b32 s74, s72, 12
    s_add_u32 s32, s73, s74
    s_mul_i32 s73, s31, 144
    s_lshl_b32 s74, s72, 4
    s_add_u32 s73, s73, s74
    s_mul_i32 s73, s73, 2560
    s_mul_i32 s74, s64, 1280
    s_add_u32 s73, s73, s74
    s_lshl_b32 s74, s45, 8
    s_add_u32 s38, s73, s74
    s_mul_i32 s30, s44, 6
    s_add_u32 s30, s30, 1
    s_mul_i32 s31, s30, 57
    s_lshr_b32 s31, s31, 9
    s_mul_i32 s72, s31, 9
    s_sub_u32 s72, s30, s72
    s_add_u32 s31, s31, s69
    s_lshl_b32 s73, s64, 3
    s_add_u32 s73, s73, s31
    s_lshl_b32 s73, s73, 5
    s_lshl_b32 s74, s51, 4
    s_add_u32 s73, s73, s74
    s_mul_i32 s73, s73, 36864
    s_lshl_b32 s74, s72, 12
    s_add_u32 s33, s73, s74
    s_mul_i32 s73, s31, 144
    s_lshl_b32 s74, s72, 4
    s_add_u32 s73, s73, s74
    s_mul_i32 s73, s73, 2560
    s_mul_i32 s74, s64, 1280
    s_add_u32 s73, s73, s74
    s_lshl_b32 s74, s45, 8
    s_add_u32 s39, s73, s74
    s_mul_i32 s30, s44, 6
    s_add_u32 s30, s30, 2
    s_mul_i32 s31, s30, 57
    s_lshr_b32 s31, s31, 9
    s_mul_i32 s72, s31, 9
    s_sub_u32 s72, s30, s72
    s_add_u32 s31, s31, s69
    s_lshl_b32 s73, s64, 3
    s_add_u32 s73, s73, s31
    s_lshl_b32 s73, s73, 5
    s_lshl_b32 s74, s51, 4
    s_add_u32 s73, s73, s74
    s_mul_i32 s73, s73, 36864
    s_lshl_b32 s74, s72, 12
    s_add_u32 s34, s73, s74
    s_mul_i32 s73, s31, 144
    s_lshl_b32 s74, s72, 4
    s_add_u32 s73, s73, s74
    s_mul_i32 s73, s73, 2560
    s_mul_i32 s74, s64, 1280
    s_add_u32 s73, s73, s74
    s_lshl_b32 s74, s45, 8
    s_add_u32 s40, s73, s74
    s_mul_i32 s30, s44, 6
    s_add_u32 s30, s30, 3
    s_mul_i32 s31, s30, 57
    s_lshr_b32 s31, s31, 9
    s_mul_i32 s72, s31, 9
    s_sub_u32 s72, s30, s72
    s_add_u32 s31, s31, s69
    s_lshl_b32 s73, s64, 3
    s_add_u32 s73, s73, s31
    s_lshl_b32 s73, s73, 5
    s_lshl_b32 s74, s51, 4
    s_add_u32 s73, s73, s74
    s_mul_i32 s73, s73, 36864
    s_lshl_b32 s74, s72, 12
    s_add_u32 s35, s73, s74
    s_mul_i32 s73, s31, 144
    s_lshl_b32 s74, s72, 4
    s_add_u32 s73, s73, s74
    s_mul_i32 s73, s73, 2560
    s_mul_i32 s74, s64, 1280
    s_add_u32 s73, s73, s74
    s_lshl_b32 s74, s45, 8
    s_add_u32 s41, s73, s74
    s_mul_i32 s30, s44, 6
    s_add_u32 s30, s30, 4
    s_mul_i32 s31, s30, 57
    s_lshr_b32 s31, s31, 9
    s_mul_i32 s72, s31, 9
    s_sub_u32 s72, s30, s72
    s_add_u32 s31, s31, s69
    s_lshl_b32 s73, s64, 3
    s_add_u32 s73, s73, s31
    s_lshl_b32 s73, s73, 5
    s_lshl_b32 s74, s51, 4
    s_add_u32 s73, s73, s74
    s_mul_i32 s73, s73, 36864
    s_lshl_b32 s74, s72, 12
    s_add_u32 s36, s73, s74
    s_mul_i32 s73, s31, 144
    s_lshl_b32 s74, s72, 4
    s_add_u32 s73, s73, s74
    s_mul_i32 s73, s73, 2560
    s_mul_i32 s74, s64, 1280
    s_add_u32 s73, s73, s74
    s_lshl_b32 s74, s45, 8
    s_add_u32 s42, s73, s74
    s_mul_i32 s30, s44, 6
    s_add_u32 s30, s30, 5
    s_mul_i32 s31, s30, 57
    s_lshr_b32 s31, s31, 9
    s_mul_i32 s72, s31, 9
    s_sub_u32 s72, s30, s72
    s_add_u32 s31, s31, s69
    s_lshl_b32 s73, s64, 3
    s_add_u32 s73, s73, s31
    s_lshl_b32 s73, s73, 5
    s_lshl_b32 s74, s51, 4
    s_add_u32 s73, s73, s74
    s_mul_i32 s73, s73, 36864
    s_lshl_b32 s74, s72, 12
    s_add_u32 s37, s73, s74
    s_mul_i32 s73, s31, 144
    s_lshl_b32 s74, s72, 4
    s_add_u32 s73, s73, s74
    s_mul_i32 s73, s73, 2560
    s_mul_i32 s74, s64, 1280
    s_add_u32 s73, s73, s74
    s_lshl_b32 s74, s45, 8
    s_add_u32 s43, s73, s74
    s_mul_i32 s53, s51, 2621440
    v_mov_b32 v104, v248
    v_add_u32 v105, 57344, v248
    v_lshrrev_b32 v116, 4, v245
    v_bfe_u32 v117, v245, 2, 2
    v_lshl_add_u32 v116, v116, 2, v117
    v_and_b32 v117, 7, v116
    v_lshlrev_b32 v117, 1, v117
    v_bfe_u32 v118, v245, 1, 1
    v_xor_b32 v117, v117, v118
    v_lshlrev_b32 v117, 4, v117
    v_lshl_or_b32 v116, v116, 8, v117
    v_and_b32 v117, 1, v245
    v_lshl_or_b32 v116, v117, 3, v116
    v_xor_b32 v117, 128, v116
    v_add_u32 v106, 12288, v117
    v_add_u32 v110, 69632, v117
    v_xor_b32 v117, 160, v116
    v_add_u32 v107, 12288, v117
    v_add_u32 v111, 69632, v117
    v_xor_b32 v117, 192, v116
    v_add_u32 v108, 12288, v117
    v_add_u32 v112, 69632, v117
    v_xor_b32 v117, 224, v116
    v_add_u32 v109, 12288, v117
    v_add_u32 v113, 69632, v117
    v_mov_b32 v0, 0
    v_mov_b32 v1, 0
    v_mov_b32 v2, 0
    v_mov_b32 v3, 0
    v_mov_b32 v4, 0
    v_mov_b32 v5, 0
    v_mov_b32 v6, 0
    v_mov_b32 v7, 0
    v_mov_b32 v8, 0
    v_mov_b32 v9, 0
    v_mov_b32 v10, 0
    v_mov_b32 v11, 0
    v_mov_b32 v12, 0
    v_mov_b32 v13, 0
    v_mov_b32 v14, 0
    v_mov_b32 v15, 0
    v_mov_b32 v16, 0
    v_mov_b32 v17, 0
    v_mov_b32 v18, 0
    v_mov_b32 v19, 0
    v_mov_b32 v20, 0
    v_mov_b32 v21, 0
    v_mov_b32 v22, 0
    v_mov_b32 v23, 0
    v_mov_b32 v24, 0
    v_mov_b32 v25, 0
    v_mov_b32 v26, 0
    v_mov_b32 v27, 0
    v_mov_b32 v28, 0
    v_mov_b32 v29, 0
    v_mov_b32 v30, 0
    v_mov_b32 v31, 0
    v_mov_b32 v32, 0
    v_mov_b32 v33, 0
    v_mov_b32 v34, 0
    v_mov_b32 v35, 0
    v_mov_b32 v36, 0
    v_mov_b32 v37, 0
    v_mov_b32 v38, 0
    v_mov_b32 v39, 0
    v_mov_b32 v40, 0
    v_mov_b32 v41, 0
    v_mov_b32 v42, 0
    v_mov_b32 v43, 0
    v_mov_b32 v44, 0
    v_mov_b32 v45, 0
    v_mov_b32 v46, 0
    v_mov_b32 v47, 0
    s_barrier
    s_cmp_ge_u32 s44, 6
    s_cbranch_scc1 K1_END
    s_barrier
    s_mov_b32 s58, 0
    s_nop 1
K1W3_TC:
    s_barrier
    s_cmp_eq_u32 s58, 0
    s_cbranch_scc1 K1W3_TCf
    v_mfma_f32_16x16x32_bf16 v[0:3], v[88:91], v[60:63], v[0:3]
    ds_read_b128 v[48:51], v104 offset:6144
    v_mfma_f32_16x16x32_bf16 v[16:19], v[88:91], v[64:67], v[16:19]
    ds_read_b128 v[52:55], v104 offset:8192
    v_mfma_f32_16x16x32_bf16 v[32:35], v[88:91], v[68:71], v[32:35]
    ds_read_b128 v[56:59], v104 offset:10240
    v_mfma_f32_16x16x32_bf16 v[4:7], v[92:95], v[60:63], v[4:7]
    ds_read_b64_tr_b16 v[72:73], v106 offset:0
    v_mfma_f32_16x16x32_bf16 v[20:23], v[92:95], v[64:67], v[20:23]
    ds_read_b64_tr_b16 v[74:75], v106 offset:4096
    v_mfma_f32_16x16x32_bf16 v[36:39], v[92:95], v[68:71], v[36:39]
    ds_read_b64_tr_b16 v[76:77], v107 offset:0
    v_mfma_f32_16x16x32_bf16 v[8:11], v[96:99], v[60:63], v[8:11]
    ds_read_b64_tr_b16 v[78:79], v107 offset:4096
    v_mfma_f32_16x16x32_bf16 v[24:27], v[96:99], v[64:67], v[24:27]
    ds_read_b64_tr_b16 v[80:81], v108 offset:0
    v_mfma_f32_16x16x32_bf16 v[40:43], v[96:99], v[68:71], v[40:43]
    ds_read_b64_tr_b16 v[82:83], v108 offset:4096
    v_mfma_f32_16x16x32_bf16 v[12:15], v[100:103], v[60:63], v[12:15]
    ds_read_b64_tr_b16 v[84:85], v109 offset:0
    v_mfma_f32_16x16x32_bf16 v[28:31], v[100:103], v[64:67], v[28:31]
    ds_read_b64_tr_b16 v[86:87], v109 offset:4096
    v_mfma_f32_16x16x32_bf16 v[44:47], v[100:103], v[68:71], v[44:47]
    s_branch K1W3_TCg
K1W3_TCf:
    ds_read_b128 v[48:51], v104 offset:6144
    ds_read_b128 v[52:55], v104 offset:8192
    ds_read_b128 v[56:59], v104 offset:10240
    ds_read_b64_tr_b16 v[72:73], v106 offset:0
    ds_read_b64_tr_b16 v[74:75], v106 offset:4096
    ds_read_b64_tr_b16 v[76:77], v107 offset:0
    ds_read_b64_tr_b16 v[78:79], v107 offset:4096
    ds_read_b64_tr_b16 v[80:81], v108 offset:0
    ds_read_b64_tr_b16 v[82:83], v108 offset:4096
    ds_read_b64_tr_b16 v[84:85], v109 offset:0
    ds_read_b64_tr_b16 v[86:87], v109 offset:4096
K1W3_TCg:
    s_waitcnt lgkmcnt(0)
    v_mfma_f32_16x16x32_bf16 v[0:3], v[72:75], v[48:51], v[0:3]
    ds_read_b128 v[60:63], v104 offset:7168
    v_mfma_f32_16x16x32_bf16 v[16:19], v[72:75], v[52:55], v[16:19]
    ds_read_b128 v[64:67], v104 offset:9216
    v_mfma_f32_16x16x32_bf16 v[32:35], v[72:75], v[56:59], v[32:35]
    ds_read_b128 v[68:71], v104 offset:11264
    v_mfma_f32_16x16x32_bf16 v[4:7], v[76:79], v[48:51], v[4:7]
    ds_read_b64_tr_b16 v[88:89], v106 offset:8192
    v_mfma_f32_16x16x32_bf16 v[20:23], v[76:79], v[52:55], v[20:23]
    ds_read_b64_tr_b16 v[90:91], v106 offset:12288
    v_mfma_f32_16x16x32_bf16 v[36:39], v[76:79], v[56:59], v[36:39]
    ds_read_b64_tr_b16 v[92:93], v107 offset:8192
    v_mfma_f32_16x16x32_bf16 v[8:11], v[80:83], v[48:51], v[8:11]
    ds_read_b64_tr_b16 v[94:95], v107 offset:12288
    v_mfma_f32_16x16x32_bf16 v[24:27], v[80:83], v[52:55], v[24:27]
    ds_read_b64_tr_b16 v[96:97], v108 offset:8192
    v_mfma_f32_16x16x32_bf16 v[40:43], v[80:83], v[56:59], v[40:43]
    ds_read_b64_tr_b16 v[98:99], v108 offset:12288
    v_mfma_f32_16x16x32_bf16 v[12:15], v[84:87], v[48:51], v[12:15]
    ds_read_b64_tr_b16 v[100:101], v109 offset:8192
    v_mfma_f32_16x16x32_bf16 v[28:31], v[84:87], v[52:55], v[28:31]
    ds_read_b64_tr_b16 v[102:103], v109 offset:12288
    v_mfma_f32_16x16x32_bf16 v[44:47], v[84:87], v[56:59], v[44:47]
    s_waitcnt lgkmcnt(0)
    s_barrier
    v_mfma_f32_16x16x32_bf16 v[0:3], v[88:91], v[60:63], v[0:3]
    ds_read_b128 v[48:51], v104 offset:34816
    v_mfma_f32_16x16x32_bf16 v[16:19], v[88:91], v[64:67], v[16:19]
    ds_read_b128 v[52:55], v104 offset:36864
    v_mfma_f32_16x16x32_bf16 v[32:35], v[88:91], v[68:71], v[32:35]
    ds_read_b128 v[56:59], v104 offset:38912
    v_mfma_f32_16x16x32_bf16 v[4:7], v[92:95], v[60:63], v[4:7]
    ds_read_b64_tr_b16 v[72:73], v106 offset:28672
    v_mfma_f32_16x16x32_bf16 v[20:23], v[92:95], v[64:67], v[20:23]
    ds_read_b64_tr_b16 v[74:75], v106 offset:32768
    v_mfma_f32_16x16x32_bf16 v[36:39], v[92:95], v[68:71], v[36:39]
    ds_read_b64_tr_b16 v[76:77], v107 offset:28672
    v_mfma_f32_16x16x32_bf16 v[8:11], v[96:99], v[60:63], v[8:11]
    ds_read_b64_tr_b16 v[78:79], v107 offset:32768
    v_mfma_f32_16x16x32_bf16 v[24:27], v[96:99], v[64:67], v[24:27]
    ds_read_b64_tr_b16 v[80:81], v108 offset:28672
    v_mfma_f32_16x16x32_bf16 v[40:43], v[96:99], v[68:71], v[40:43]
    ds_read_b64_tr_b16 v[82:83], v108 offset:32768
    v_mfma_f32_16x16x32_bf16 v[12:15], v[100:103], v[60:63], v[12:15]
    ds_read_b64_tr_b16 v[84:85], v109 offset:28672
    v_mfma_f32_16x16x32_bf16 v[28:31], v[100:103], v[64:67], v[28:31]
    ds_read_b64_tr_b16 v[86:87], v109 offset:32768
    v_mfma_f32_16x16x32_bf16 v[44:47], v[100:103], v[68:71], v[44:47]
    s_waitcnt lgkmcnt(6)
    v_mfma_f32_16x16x32_bf16 v[0:3], v[72:75], v[48:51], v[0:3]
    ds_read_b128 v[60:63], v104 offset:35840
    v_mfma_f32_16x16x32_bf16 v[16:19], v[72:75], v[52:55], v[16:19]
    ds_read_b128 v[64:67], v104 offset:37888
    v_mfma_f32_16x16x32_bf16 v[32:35], v[72:75], v[56:59], v[32:35]
    ds_read_b128 v[68:71], v104 offset:39936
    s_waitcnt lgkmcnt(7)
    v_mfma_f32_16x16x32_bf16 v[4:7], v[76:79], v[48:51], v[4:7]
    ds_read_b64_tr_b16 v[88:89], v106 offset:36864
    v_mfma_f32_16x16x32_bf16 v[20:23], v[76:79], v[52:55], v[20:23]
    ds_read_b64_tr_b16 v[90:91], v106 offset:40960
    v_mfma_f32_16x16x32_bf16 v[36:39], v[76:79], v[56:59], v[36:39]
    ds_read_b64_tr_b16 v[92:93], v107 offset:36864
    s_waitcnt lgkmcnt(8)
    v_mfma_f32_16x16x32_bf16 v[8:11], v[80:83], v[48:51], v[8:11]
    ds_read_b64_tr_b16 v[94:95], v107 offset:40960
    v_mfma_f32_16x16x32_bf16 v[24:27], v[80:83], v[52:55], v[24:27]
    ds_read_b64_tr_b16 v[96:97], v108 offset:36864
    v_mfma_f32_16x16x32_bf16 v[40:43], v[80:83], v[56:59], v[40:43]
    ds_read_b64_tr_b16 v[98:99], v108 offset:40960
    s_waitcnt lgkmcnt(9)
    v_mfma_f32_16x16x32_bf16 v[12:15], v[84:87], v[48:51], v[12:15]
    ds_read_b64_tr_b16 v[100:101], v109 offset:36864
    v_mfma_f32_16x16x32_bf16 v[28:31], v[84:87], v[52:55], v[28:31]
    ds_read_b64_tr_b16 v[102:103], v109 offset:40960
    v_mfma_f32_16x16x32_bf16 v[44:47], v[84:87], v[56:59], v[44:47]
    s_waitcnt lgkmcnt(0)
    s_barrier
    v_mfma_f32_16x16x32_bf16 v[0:3], v[88:91], v[60:63], v[0:3]
    ds_read_b128 v[48:51], v105 offset:6144
    v_mfma_f32_16x16x32_bf16 v[16:19], v[88:91], v[64:67], v[16:19]
    ds_read_b128 v[52:55], v105 offset:8192
    v_mfma_f32_16x16x32_bf16 v[32:35], v[88:91], v[68:71], v[32:35]
    ds_read_b128 v[56:59], v105 offset:10240
    v_mfma_f32_16x16x32_bf16 v[4:7], v[92:95], v[60:63], v[4:7]
    ds_read_b64_tr_b16 v[72:73], v110 offset:0
    v_mfma_f32_16x16x32_bf16 v[20:23], v[92:95], v[64:67], v[20:23]
    ds_read_b64_tr_b16 v[74:75], v110 offset:4096
    v_mfma_f32_16x16x32_bf16 v[36:39], v[92:95], v[68:71], v[36:39]
    ds_read_b64_tr_b16 v[76:77], v111 offset:0
    v_mfma_f32_16x16x32_bf16 v[8:11], v[96:99], v[60:63], v[8:11]
    ds_read_b64_tr_b16 v[78:79], v111 offset:4096
    v_mfma_f32_16x16x32_bf16 v[24:27], v[96:99], v[64:67], v[24:27]
    ds_read_b64_tr_b16 v[80:81], v112 offset:0
    v_mfma_f32_16x16x32_bf16 v[40:43], v[96:99], v[68:71], v[40:43]
    ds_read_b64_tr_b16 v[82:83], v112 offset:4096
    v_mfma_f32_16x16x32_bf16 v[12:15], v[100:103], v[60:63], v[12:15]
    ds_read_b64_tr_b16 v[84:85], v113 offset:0
    v_mfma_f32_16x16x32_bf16 v[28:31], v[100:103], v[64:67], v[28:31]
    ds_read_b64_tr_b16 v[86:87], v113 offset:4096
    v_mfma_f32_16x16x32_bf16 v[44:47], v[100:103], v[68:71], v[44:47]
    s_waitcnt lgkmcnt(6)
    v_mfma_f32_16x16x32_bf16 v[0:3], v[72:75], v[48:51], v[0:3]
    ds_read_b128 v[60:63], v105 offset:7168
    v_mfma_f32_16x16x32_bf16 v[16:19], v[72:75], v[52:55], v[16:19]
    ds_read_b128 v[64:67], v105 offset:9216
    v_mfma_f32_16x16x32_bf16 v[32:35], v[72:75], v[56:59], v[32:35]
    ds_read_b128 v[68:71], v105 offset:11264
    s_waitcnt lgkmcnt(7)
    v_mfma_f32_16x16x32_bf16 v[4:7], v[76:79], v[48:51], v[4:7]
    ds_read_b64_tr_b16 v[88:89], v110 offset:8192
    v_mfma_f32_16x16x32_bf16 v[20:23], v[76:79], v[52:55], v[20:23]
    ds_read_b64_tr_b16 v[90:91], v110 offset:12288
    v_mfma_f32_16x16x32_bf16 v[36:39], v[76:79], v[56:59], v[36:39]
    ds_read_b64_tr_b16 v[92:93], v111 offset:8192
    s_waitcnt lgkmcnt(8)
    v_mfma_f32_16x16x32_bf16 v[8:11], v[80:83], v[48:51], v[8:11]
    ds_read_b64_tr_b16 v[94:95], v111 offset:12288
    v_mfma_f32_16x16x32_bf16 v[24:27], v[80:83], v[52:55], v[24:27]
    ds_read_b64_tr_b16 v[96:97], v112 offset:8192
    v_mfma_f32_16x16x32_bf16 v[40:43], v[80:83], v[56:59], v[40:43]
    ds_read_b64_tr_b16 v[98:99], v112 offset:12288
    s_waitcnt lgkmcnt(9)
    v_mfma_f32_16x16x32_bf16 v[12:15], v[84:87], v[48:51], v[12:15]
    ds_read_b64_tr_b16 v[100:101], v113 offset:8192
    v_mfma_f32_16x16x32_bf16 v[28:31], v[84:87], v[52:55], v[28:31]
    ds_read_b64_tr_b16 v[102:103], v113 offset:12288
    v_mfma_f32_16x16x32_bf16 v[44:47], v[84:87], v[56:59], v[44:47]
    s_waitcnt lgkmcnt(0)
    s_barrier
    v_mfma_f32_16x16x32_bf16 v[0:3], v[88:91], v[60:63], v[0:3]
    ds_read_b128 v[48:51], v105 offset:34816
    v_mfma_f32_16x16x32_bf16 v[16:19], v[88:91], v[64:67], v[16:19]
    ds_read_b128 v[52:55], v105 offset:36864
    v_mfma_f32_16x16x32_bf16 v[32:35], v[88:91], v[68:71], v[32:35]
    ds_read_b128 v[56:59], v105 offset:38912
    v_mfma_f32_16x16x32_bf16 v[4:7], v[92:95], v[60:63], v[4:7]
    ds_read_b64_tr_b16 v[72:73], v110 offset:28672
    v_mfma_f32_16x16x32_bf16 v[20:23], v[92:95], v[64:67], v[20:23]
    ds_read_b64_tr_b16 v[74:75], v110 offset:32768
    v_mfma_f32_16x16x32_bf16 v[36:39], v[92:95], v[68:71], v[36:39]
    ds_read_b64_tr_b16 v[76:77], v111 offset:28672
    v_mfma_f32_16x16x32_bf16 v[8:11], v[96:99], v[60:63], v[8:11]
    ds_read_b64_tr_b16 v[78:79], v111 offset:32768
    v_mfma_f32_16x16x32_bf16 v[24:27], v[96:99], v[64:67], v[24:27]
    ds_read_b64_tr_b16 v[80:81], v112 offset:28672
    v_mfma_f32_16x16x32_bf16 v[40:43], v[96:99], v[68:71], v[40:43]
    ds_read_b64_tr_b16 v[82:83], v112 offset:32768
    v_mfma_f32_16x16x32_bf16 v[12:15], v[100:103], v[60:63], v[12:15]
    ds_read_b64_tr_b16 v[84:85], v113 offset:28672
    v_mfma_f32_16x16x32_bf16 v[28:31], v[100:103], v[64:67], v[28:31]
    ds_read_b64_tr_b16 v[86:87], v113 offset:32768
    v_mfma_f32_16x16x32_bf16 v[44:47], v[100:103], v[68:71], v[44:47]
    s_waitcnt lgkmcnt(6)
    v_mfma_f32_16x16x32_bf16 v[0:3], v[72:75], v[48:51], v[0:3]
    ds_read_b128 v[60:63], v105 offset:35840
    v_mfma_f32_16x16x32_bf16 v[16:19], v[72:75], v[52:55], v[16:19]
    ds_read_b128 v[64:67], v105 offset:37888
    v_mfma_f32_16x16x32_bf16 v[32:35], v[72:75], v[56:59], v[32:35]
    ds_read_b128 v[68:71], v105 offset:39936
    s_waitcnt lgkmcnt(7)
    v_mfma_f32_16x16x32_bf16 v[4:7], v[76:79], v[48:51], v[4:7]
    ds_read_b64_tr_b16 v[88:89], v110 offset:36864
    v_mfma_f32_16x16x32_bf16 v[20:23], v[76:79], v[52:55], v[20:23]
    ds_read_b64_tr_b16 v[90:91], v110 offset:40960
    v_mfma_f32_16x16x32_bf16 v[36:39], v[76:79], v[56:59], v[36:39]
    ds_read_b64_tr_b16 v[92:93], v111 offset:36864
    s_waitcnt lgkmcnt(8)
    v_mfma_f32_16x16x32_bf16 v[8:11], v[80:83], v[48:51], v[8:11]
    ds_read_b64_tr_b16 v[94:95], v111 offset:40960
    v_mfma_f32_16x16x32_bf16 v[24:27], v[80:83], v[52:55], v[24:27]
    ds_read_b64_tr_b16 v[96:97], v112 offset:36864
    v_mfma_f32_16x16x32_bf16 v[40:43], v[80:83], v[56:59], v[40:43]
    ds_read_b64_tr_b16 v[98:99], v112 offset:40960
    s_waitcnt lgkmcnt(9)
    v_mfma_f32_16x16x32_bf16 v[12:15], v[84:87], v[48:51], v[12:15]
    ds_read_b64_tr_b16 v[100:101], v113 offset:36864
    v_mfma_f32_16x16x32_bf16 v[28:31], v[84:87], v[52:55], v[28:31]
    ds_read_b64_tr_b16 v[102:103], v113 offset:40960
    v_mfma_f32_16x16x32_bf16 v[44:47], v[84:87], v[56:59], v[44:47]
    s_waitcnt lgkmcnt(0)
    s_add_u32 s58, s58, 1
    s_cmp_lt_u32 s58, 8
    s_cbranch_scc1 K1W3_TC
    v_mfma_f32_16x16x32_bf16 v[0:3], v[88:91], v[60:63], v[0:3]
    v_mfma_f32_16x16x32_bf16 v[16:19], v[88:91], v[64:67], v[16:19]
    v_mfma_f32_16x16x32_bf16 v[32:35], v[88:91], v[68:71], v[32:35]
    v_mfma_f32_16x16x32_bf16 v[4:7], v[92:95], v[60:63], v[4:7]
    v_mfma_f32_16x16x32_bf16 v[20:23], v[92:95], v[64:67], v[20:23]
    v_mfma_f32_16x16x32_bf16 v[36:39], v[92:95], v[68:71], v[36:39]
    v_mfma_f32_16x16x32_bf16 v[8:11], v[96:99], v[60:63], v[8:11]
    v_mfma_f32_16x16x32_bf16 v[24:27], v[96:99], v[64:67], v[24:27]
    v_mfma_f32_16x16x32_bf16 v[40:43], v[96:99], v[68:71], v[40:43]
    v_mfma_f32_16x16x32_bf16 v[12:15], v[100:103], v[60:63], v[12:15]
    v_mfma_f32_16x16x32_bf16 v[28:31], v[100:103], v[64:67], v[28:31]
    v_mfma_f32_16x16x32_bf16 v[44:47], v[100:103], v[68:71], v[44:47]
    s_nop 7
    s_mul_i32 s30, s2, 49152
    s_add_u32 s30, s30, 12288
    s_cmp_eq_u32 s51, 1
    s_cbranch_scc1 K1W3_TK
    buffer_store_dwordx4 v[0:3], v248, s[8:11], s30 offen offset:0 sc1
    buffer_store_dwordx4 v[4:7], v248, s[8:11], s30 offen offset:1024 sc1
    buffer_store_dwordx4 v[8:11], v248, s[8:11], s30 offen offset:2048 sc1
    buffer_store_dwordx4 v[12:15], v248, s[8:11], s30 offen offset:3072 sc1
    s_add_u32 s30, s30, 4096
    buffer_store_dwordx4 v[16:19], v248, s[8:11], s30 offen offset:0 sc1
    buffer_store_dwordx4 v[20:23], v248, s[8:11], s30 offen offset:1024 sc1
    buffer_store_dwordx4 v[24:27], v248, s[8:11], s30 offen offset:2048 sc1
    buffer_store_dwordx4 v[28:31], v248, s[8:11], s30 offen offset:3072 sc1
    s_add_u32 s30, s30, 4096
    buffer_store_dwordx4 v[32:35], v248, s[8:11], s30 offen offset:0 sc1
    buffer_store_dwordx4 v[36:39], v248, s[8:11], s30 offen offset:1024 sc1
    buffer_store_dwordx4 v[40:43], v248, s[8:11], s30 offen offset:2048 sc1
    buffer_store_dwordx4 v[44:47], v248, s[8:11], s30 offen offset:3072 sc1
K1W3_TK:
    s_waitcnt vmcnt(0)
    s_barrier
    s_barrier
    s_cmp_eq_u32 s51, 1
    s_cbranch_scc0 K1W3_TF
    s_xor_b32 s30, s2, 1
    s_mul_i32 s30, s30, 49152
    s_add_u32 s30, s30, 12288
    buffer_load_dwordx4 v[120:123], v248, s[8:11], s30 offen offset:0 sc1
    buffer_load_dwordx4 v[124:127], v248, s[8:11], s30 offen offset:1024 sc1
    buffer_load_dwordx4 v[128:131], v248, s[8:11], s30 offen offset:2048 sc1
    buffer_load_dwordx4 v[132:135], v248, s[8:11], s30 offen offset:3072 sc1
    s_add_u32 s30, s30, 4096
    buffer_load_dwordx4 v[136:139], v248, s[8:11], s30 offen offset:0 sc1
    buffer_load_dwordx4 v[140:143], v248, s[8:11], s30 offen offset:1024 sc1
    buffer_load_dwordx4 v[144:147], v248, s[8:11], s30 offen offset:2048 sc1
    buffer_load_dwordx4 v[148:151], v248, s[8:11], s30 offen offset:3072 sc1
    s_add_u32 s30, s30, 4096
    buffer_load_dwordx4 v[152:155], v248, s[8:11], s30 offen offset:0 sc1
    buffer_load_dwordx4 v[156:159], v248, s[8:11], s30 offen offset:1024 sc1
    buffer_load_dwordx4 v[160:163], v248, s[8:11], s30 offen offset:2048 sc1
    buffer_load_dwordx4 v[164:167], v248, s[8:11], s30 offen offset:3072 sc1
    v_and_b32 v116, 15, v245
    v_mul_u32_u24 v116, 2560, v116
    v_lshrrev_b32 v117, 4, v245
    v_lshl_add_u32 v116, v117, 3, v116
    s_waitcnt vmcnt(11)
    v_add_f32 v0, v0, v120
    v_add_f32 v1, v1, v121
    v_add_f32 v2, v2, v122
    v_add_f32 v3, v3, v123
    v_cvt_pk_bf16_f32 v48, v0, v1
    v_cvt_pk_bf16_f32 v49, v2, v3
    buffer_store_dwordx2 v[48:49], v116, s[4:7], s41 offen offset:128
    s_waitcnt vmcnt(11)
    v_add_f32 v4, v4, v124
    v_add_f32 v5, v5, v125
    v_add_f32 v6, v6, v126
    v_add_f32 v7, v7, v127
    v_cvt_pk_bf16_f32 v50, v4, v5
    v_cvt_pk_bf16_f32 v51, v6, v7
    buffer_store_dwordx2 v[50:51], v116, s[4:7], s41 offen offset:160
    s_waitcnt vmcnt(11)
    v_add_f32 v8, v8, v128
    v_add_f32 v9, v9, v129
    v_add_f32 v10, v10, v130
    v_add_f32 v11, v11, v131
    v_cvt_pk_bf16_f32 v52, v8, v9
    v_cvt_pk_bf16_f32 v53, v10, v11
    buffer_store_dwordx2 v[52:53], v116, s[4:7], s41 offen offset:192
    s_waitcnt vmcnt(11)
    v_add_f32 v12, v12, v132
    v_add_f32 v13, v13, v133
    v_add_f32 v14, v14, v134
    v_add_f32 v15, v15, v135
    v_cvt_pk_bf16_f32 v54, v12, v13
    v_cvt_pk_bf16_f32 v55, v14, v15
    buffer_store_dwordx2 v[54:55], v116, s[4:7], s41 offen offset:224
    s_waitcnt vmcnt(11)
    v_add_f32 v16, v16, v136
    v_add_f32 v17, v17, v137
    v_add_f32 v18, v18, v138
    v_add_f32 v19, v19, v139
    v_cvt_pk_bf16_f32 v56, v16, v17
    v_cvt_pk_bf16_f32 v57, v18, v19
    buffer_store_dwordx2 v[56:57], v116, s[4:7], s42 offen offset:128
    s_waitcnt vmcnt(11)
    v_add_f32 v20, v20, v140
    v_add_f32 v21, v21, v141
    v_add_f32 v22, v22, v142
    v_add_f32 v23, v23, v143
    v_cvt_pk_bf16_f32 v58, v20, v21
    v_cvt_pk_bf16_f32 v59, v22, v23
    buffer_store_dwordx2 v[58:59], v116, s[4:7], s42 offen offset:160
    s_waitcnt vmcnt(11)
    v_add_f32 v24, v24, v144
    v_add_f32 v25, v25, v145
    v_add_f32 v26, v26, v146
    v_add_f32 v27, v27, v147
    v_cvt_pk_bf16_f32 v60, v24, v25
    v_cvt_pk_bf16_f32 v61, v26, v27
    buffer_store_dwordx2 v[60:61], v116, s[4:7], s42 offen offset:192
    s_waitcnt vmcnt(11)
    v_add_f32 v28, v28, v148
    v_add_f32 v29, v29, v149
    v_add_f32 v30, v30, v150
    v_add_f32 v31, v31, v151
    v_cvt_pk_bf16_f32 v62, v28, v29
    v_cvt_pk_bf16_f32 v63, v30, v31
    buffer_store_dwordx2 v[62:63], v116, s[4:7], s42 offen offset:224
    s_waitcnt vmcnt(11)
    v_add_f32 v32, v32, v152
    v_add_f32 v33, v33, v153
    v_add_f32 v34, v34, v154
    v_add_f32 v35, v35, v155
    v_cvt_pk_bf16_f32 v64, v32, v33
    v_cvt_pk_bf16_f32 v65, v34, v35
    buffer_store_dwordx2 v[64:65], v116, s[4:7], s43 offen offset:128
    s_waitcnt vmcnt(11)
    v_add_f32 v36, v36, v156
    v_add_f32 v37, v37, v157
    v_add_f32 v38, v38, v158
    v_add_f32 v39, v39, v159
    v_cvt_pk_bf16_f32 v66, v36, v37
    v_cvt_pk_bf16_f32 v67, v38, v39
    buffer_store_dwordx2 v[66:67], v116, s[4:7], s43 offen offset:160
    s_waitcnt vmcnt(11)
    v_add_f32 v40, v40, v160
    v_add_f32 v41, v41, v161
    v_add_f32 v42, v42, v162
    v_add_f32 v43, v43, v163
    v_cvt_pk_bf16_f32 v68, v40, v41
    v_cvt_pk_bf16_f32 v69, v42, v43
    buffer_store_dwordx2 v[68:69], v116, s[4:7], s43 offen offset:192
    s_waitcnt vmcnt(11)
    v_add_f32 v44, v44, v164
    v_add_f32 v45, v45, v165
    v_add_f32 v46, v46, v166
    v_add_f32 v47, v47, v167
    v_cvt_pk_bf16_f32 v70, v44, v45
    v_cvt_pk_bf16_f32 v71, v46, v47
    buffer_store_dwordx2 v[70:71], v116, s[4:7], s43 offen offset:224
K1W3_TF:
    s_endpgm
K1W3_FINAL1:
    s_nop 7
    v_add_u32 v246, 81920, v248
    v_and_b32 v247, 15, v245
    v_lshlrev_b32 v247, 2, v247
    v_add_u32 v247, 114688, v247
    ds_write_b128 v246, v[64:67] offset:8192
    ds_write_b128 v246, v[68:71] offset:9216
    ds_write_b128 v246, v[72:75] offset:10240
    ds_write_b128 v246, v[76:79] offset:11264
    ds_write_b128 v246, v[80:83] offset:12288
    ds_write_b128 v246, v[84:87] offset:13312
    ds_write_b128 v246, v[88:91] offset:14336
    ds_write_b128 v246, v[92:95] offset:15360
    v_mov_b32 v244, v230
    s_nop 1
    v_permlane16_swap_b32 v244, v230
    v_add_f32 v230, v230, v244
    v_mov_b32 v244, v230
    s_nop 1
    v_permlane32_swap_b32 v244, v230
    v_add_f32 v230, v230, v244
    v_sub_f32 v244, 0, v192
    ds_write_b32 v247, v244 offset:128
    ds_write_b32 v247, v230 offset:192
    v_mov_b32 v244, v228
    s_nop 1
    v_permlane16_swap_b32 v244, v228
    v_add_f32 v228, v228, v244
    v_mov_b32 v244, v228
    s_nop 1
    v_permlane32_swap_b32 v244, v228
    v_add_f32 v228, v228, v244
    v_mov_b32 v244, v229
    s_nop 1
    v_permlane16_swap_b32 v244, v229
    v_add_f32 v229, v229, v244
    v_mov_b32 v244, v229
    s_nop 1
    v_permlane32_swap_b32 v244, v229
    v_add_f32 v229, v229, v244
    v_rcp_f32 v228, v228
    v_rcp_f32 v229, v229
    v_mul_f32 v0, v0, v228
    v_mul_f32 v1, v1, v228
    v_mul_f32 v2, v2, v228
    v_mul_f32 v3, v3, v228
    v_mul_f32 v4, v4, v228
    v_mul_f32 v5, v5, v228
    v_mul_f32 v6, v6, v228
    v_mul_f32 v7, v7, v228
    v_cvt_pk_bf16_f32 v96, v0, v1
    v_cvt_pk_bf16_f32 v97, v2, v3
    v_cvt_pk_bf16_f32 v98, v4, v5
    v_cvt_pk_bf16_f32 v99, v6, v7
    v_mul_f32 v8, v8, v228
    v_mul_f32 v9, v9, v228
    v_mul_f32 v10, v10, v228
    v_mul_f32 v11, v11, v228
    v_mul_f32 v12, v12, v228
    v_mul_f32 v13, v13, v228
    v_mul_f32 v14, v14, v228
    v_mul_f32 v15, v15, v228
    v_cvt_pk_bf16_f32 v100, v8, v9
    v_cvt_pk_bf16_f32 v101, v10, v11
    v_cvt_pk_bf16_f32 v102, v12, v13
    v_cvt_pk_bf16_f32 v103, v14, v15
    v_mul_f32 v16, v16, v228
    v_mul_f32 v17, v17, v228
    v_mul_f32 v18, v18, v228
    v_mul_f32 v19, v19, v228
    v_mul_f32 v20, v20, v228
    v_mul_f32 v21, v21, v228
    v_mul_f32 v22, v22, v228
    v_mul_f32 v23, v23, v228
    v_cvt_pk_bf16_f32 v104, v16, v17
    v_cvt_pk_bf16_f32 v105, v18, v19
    v_cvt_pk_bf16_f32 v106, v20, v21
    v_cvt_pk_bf16_f32 v107, v22, v23
    v_mul_f32 v24, v24, v228
    v_mul_f32 v25, v25, v228
    v_mul_f32 v26, v26, v228
    v_mul_f32 v27, v27, v228
    v_mul_f32 v28, v28, v228
    v_mul_f32 v29, v29, v228
    v_mul_f32 v30, v30, v228
    v_mul_f32 v31, v31, v228
    v_cvt_pk_bf16_f32 v108, v24, v25
    v_cvt_pk_bf16_f32 v109, v26, v27
    v_cvt_pk_bf16_f32 v110, v28, v29
    v_cvt_pk_bf16_f32 v111, v30, v31
    v_mul_f32 v32, v32, v229
    v_mul_f32 v33, v33, v229
    v_mul_f32 v34, v34, v229
    v_mul_f32 v35, v35, v229
    v_mul_f32 v36, v36, v229
    v_mul_f32 v37, v37, v229
    v_mul_f32 v38, v38, v229
    v_mul_f32 v39, v39, v229
    v_cvt_pk_bf16_f32 v112, v32, v33
    v_cvt_pk_bf16_f32 v113, v34, v35
    v_cvt_pk_bf16_f32 v114, v36, v37
    v_cvt_pk_bf16_f32 v115, v38, v39
    v_mul_f32 v40, v40, v229
    v_mul_f32 v41, v41, v229
    v_mul_f32 v42, v42, v229
    v_mul_f32 v43, v43, v229
    v_mul_f32 v44, v44, v229
    v_mul_f32 v45, v45, v229
    v_mul_f32 v46, v46, v229
    v_mul_f32 v47, v47, v229
    v_cvt_pk_bf16_f32 v116, v40, v41
    v_cvt_pk_bf16_f32 v117, v42, v43
    v_cvt_pk_bf16_f32 v118, v44, v45
    v_cvt_pk_bf16_f32 v119, v46, v47
    v_mul_f32 v48, v48, v229
    v_mul_f32 v49, v49, v229
    v_mul_f32 v50, v50, v229
    v_mul_f32 v51, v51, v229
    v_mul_f32 v52, v52, v229
    v_mul_f32 v53, v53, v229
    v_mul_f32 v54, v54, v229
    v_mul_f32 v55, v55, v229
    v_cvt_pk_bf16_f32 v120, v48, v49
    v_cvt_pk_bf16_f32 v121, v50, v51
    v_cvt_pk_bf16_f32 v122, v52, v53
    v_cvt_pk_bf16_f32 v123, v54, v55
    v_mul_f32 v56, v56, v229
    v_mul_f32 v57, v57, v229
    v_mul_f32 v58, v58, v229
    v_mul_f32 v59, v59, v229
    v_mul_f32 v60, v60, v229
    v_mul_f32 v61, v61, v229
    v_mul_f32 v62, v62, v229
    v_mul_f32 v63, v63, v229
    v_cvt_pk_bf16_f32 v124, v56, v57
    v_cvt_pk_bf16_f32 v125, v58, v59
    v_cvt_pk_bf16_f32 v126, v60, v61
    v_cvt_pk_bf16_f32 v127, v62, v63
    s_waitcnt lgkmcnt(0)
    s_barrier
    ds_read_b32 v144, v247 offset:0
    ds_read_b32 v148, v247 offset:64
    ds_read_b32 v145, v247 offset:128
    ds_read_b32 v149, v247 offset:192
    ds_read_b128 v[32:35], v246 offset:6144
    ds_read_b128 v[36:39], v246 offset:7168
    ds_read_b128 v[40:43], v246 offset:14336
    ds_read_b128 v[44:47], v246 offset:15360
    s_waitcnt lgkmcnt(5)
    v_max_f32 v244, v144, v145
    v_sub_f32 v152, v144, v244
    v_sub_f32 v153, v145, v244
    v_exp_f32 v152, v152
    v_exp_f32 v153, v153
    v_mul_f32 v244, v152, v148
    s_waitcnt lgkmcnt(4)
    v_fma_f32 v244, v153, v149, v244
    v_rcp_f32 v244, v244
    s_nop 0
    v_mul_f32 v152, v152, v244
    v_mul_f32 v153, v153, v244
    s_waitcnt lgkmcnt(3)
    v_mul_f32 v0, v32, v152
    s_waitcnt lgkmcnt(1)
    v_fma_f32 v0, v40, v153, v0
    v_mul_f32 v1, v33, v152
    v_fma_f32 v1, v41, v153, v1
    v_mul_f32 v2, v34, v152
    v_fma_f32 v2, v42, v153, v2
    v_mul_f32 v3, v35, v152
    v_fma_f32 v3, v43, v153, v3
    v_mul_f32 v4, v36, v152
    s_waitcnt lgkmcnt(0)
    v_fma_f32 v4, v44, v153, v4
    v_mul_f32 v5, v37, v152
    v_fma_f32 v5, v45, v153, v5
    v_mul_f32 v6, v38, v152
    v_fma_f32 v6, v46, v153, v6
    v_mul_f32 v7, v39, v152
    v_fma_f32 v7, v47, v153, v7
    v_cvt_pk_bf16_f32 v128, v0, v1
    v_cvt_pk_bf16_f32 v129, v2, v3
    v_cvt_pk_bf16_f32 v130, v4, v5
    v_cvt_pk_bf16_f32 v131, v6, v7
    s_mov_b32 s30, 24576
    buffer_store_dwordx4 v[96:99], v248, s[20:23], s30 offen offset:0 sc1
    buffer_store_dwordx4 v[100:103], v248, s[20:23], s30 offen offset:1024 sc1
    buffer_store_dwordx4 v[104:107], v248, s[20:23], s30 offen offset:2048 sc1
    buffer_store_dwordx4 v[108:111], v248, s[20:23], s30 offen offset:3072 sc1
    s_mov_b32 s30, 28672
    buffer_store_dwordx4 v[112:115], v248, s[20:23], s30 offen offset:0 sc1
    buffer_store_dwordx4 v[116:119], v248, s[20:23], s30 offen offset:1024 sc1
    buffer_store_dwordx4 v[120:123], v248, s[20:23], s30 offen offset:2048 sc1
    buffer_store_dwordx4 v[124:127], v248, s[20:23], s30 offen offset:3072 sc1
    s_mov_b32 s30, 35840
    buffer_store_dwordx4 v[128:131], v248, s[20:23], s30 offen sc1
    s_lshl_b32 s30, s85, 3
    s_add_u32 s30, s30, s84
    s_mul_i32 s44, s30, 52
    s_lshr_b32 s44, s44, 8
    s_mul_i32 s31, s44, 5
    s_sub_u32 s45, s30, s31
    s_and_b32 s51, s2, 1
    s_load_dwordx2 s[72:73], s[0:1], 32
    s_load_dwordx2 s[74:75], s[0:1], 72
    s_load_dwordx2 s[46:47], s[0:1], 80
    s_waitcnt lgkmcnt(0)
    s_cmp_eq_u32 s64, 0
    s_cselect_b64 s[72:73], s[72:73], s[74:75]
    s_lshl_b32 s30, s45, 8
    s_add_u32 s12, s72, s30
    s_addc_u32 s13, s73, 0
    s_sub_u32 s14, 5242880, s30
    s_mov_b32 s15, 131072
    s_mov_b32 s16, s48
    s_mov_b32 s17, s49
    s_mov_b32 s18, 18874368
    s_mov_b32 s19, 131072
    s_add_u32 s80, s48, 50331648
    s_addc_u32 s81, s49, 0
    s_mov_b32 s82, 131072
    s_mov_b32 s83, 131072
    s_mov_b32 s4, s46
    s_mov_b32 s5, s47
    s_mov_b32 s6, 2949120
    s_mov_b32 s7, 131072
    s_add_u32 s8, s48, 33554432
    s_addc_u32 s9, s49, 0
    s_mov_b32 s10, 12582912
    s_mov_b32 s11, 131072
    s_sub_u32 s69, s65, s85
    s_mul_i32 s30, s44, 6
    s_add_u32 s30, s30, 0
    s_mul_i32 s31, s30, 57
    s_lshr_b32 s31, s31, 9
    s_mul_i32 s72, s31, 9
    s_sub_u32 s72, s30, s72
    s_add_u32 s31, s31, s69
    s_lshl_b32 s73, s64, 3
    s_add_u32 s73, s73, s31
    s_lshl_b32 s73, s73, 5
    s_lshl_b32 s74, s51, 4
    s_add_u32 s73, s73, s74
    s_mul_i32 s73, s73, 36864
    s_lshl_b32 s74, s72, 12
    s_add_u32 s32, s73, s74
    s_mul_i32 s73, s31, 144
    s_lshl_b32 s74, s72, 4
    s_add_u32 s73, s73, s74
    s_mul_i32 s73, s73, 2560
    s_mul_i32 s74, s64, 1280
    s_add_u32 s73, s73, s74
    s_lshl_b32 s74, s45, 8
    s_add_u32 s38, s73, s74
    s_mul_i32 s30, s44, 6
    s_add_u32 s30, s30, 1
    s_mul_i32 s31, s30, 57
    s_lshr_b32 s31, s31, 9
    s_mul_i32 s72, s31, 9
    s_sub_u32 s72, s30, s72
    s_add_u32 s31, s31, s69
    s_lshl_b32 s73, s64, 3
    s_add_u32 s73, s73, s31
    s_lshl_b32 s73, s73, 5
    s_lshl_b32 s74, s51, 4
    s_add_u32 s73, s73, s74
    s_mul_i32 s73, s73, 36864
    s_lshl_b32 s74, s72, 12
    s_add_u32 s33, s73, s74
    s_mul_i32 s73, s31, 144
    s_lshl_b32 s74, s72, 4
    s_add_u32 s73, s73, s74
    s_mul_i32 s73, s73, 2560
    s_mul_i32 s74, s64, 1280
    s_add_u32 s73, s73, s74
    s_lshl_b32 s74, s45, 8
    s_add_u32 s39, s73, s74
    s_mul_i32 s30, s44, 6
    s_add_u32 s30, s30, 2
    s_mul_i32 s31, s30, 57
    s_lshr_b32 s31, s31, 9
    s_mul_i32 s72, s31, 9
    s_sub_u32 s72, s30, s72
    s_add_u32 s31, s31, s69
    s_lshl_b32 s73, s64, 3
    s_add_u32 s73, s73, s31
    s_lshl_b32 s73, s73, 5
    s_lshl_b32 s74, s51, 4
    s_add_u32 s73, s73, s74
    s_mul_i32 s73, s73, 36864
    s_lshl_b32 s74, s72, 12
    s_add_u32 s34, s73, s74
    s_mul_i32 s73, s31, 144
    s_lshl_b32 s74, s72, 4
    s_add_u32 s73, s73, s74
    s_mul_i32 s73, s73, 2560
    s_mul_i32 s74, s64, 1280
    s_add_u32 s73, s73, s74
    s_lshl_b32 s74, s45, 8
    s_add_u32 s40, s73, s74
    s_mul_i32 s30, s44, 6
    s_add_u32 s30, s30, 3
    s_mul_i32 s31, s30, 57
    s_lshr_b32 s31, s31, 9
    s_mul_i32 s72, s31, 9
    s_sub_u32 s72, s30, s72
    s_add_u32 s31, s31, s69
    s_lshl_b32 s73, s64, 3
    s_add_u32 s73, s73, s31
    s_lshl_b32 s73, s73, 5
    s_lshl_b32 s74, s51, 4
    s_add_u32 s73, s73, s74
    s_mul_i32 s73, s73, 36864
    s_lshl_b32 s74, s72, 12
    s_add_u32 s35, s73, s74
    s_mul_i32 s73, s31, 144
    s_lshl_b32 s74, s72, 4
    s_add_u32 s73, s73, s74
    s_mul_i32 s73, s73, 2560
    s_mul_i32 s74, s64, 1280
    s_add_u32 s73, s73, s74
    s_lshl_b32 s74, s45, 8
    s_add_u32 s41, s73, s74
    s_mul_i32 s30, s44, 6
    s_add_u32 s30, s30, 4
    s_mul_i32 s31, s30, 57
    s_lshr_b32 s31, s31, 9
    s_mul_i32 s72, s31, 9
    s_sub_u32 s72, s30, s72
    s_add_u32 s31, s31, s69
    s_lshl_b32 s73, s64, 3
    s_add_u32 s73, s73, s31
    s_lshl_b32 s73, s73, 5
    s_lshl_b32 s74, s51, 4
    s_add_u32 s73, s73, s74
    s_mul_i32 s73, s73, 36864
    s_lshl_b32 s74, s72, 12
    s_add_u32 s36, s73, s74
    s_mul_i32 s73, s31, 144
    s_lshl_b32 s74, s72, 4
    s_add_u32 s73, s73, s74
    s_mul_i32 s73, s73, 2560
    s_mul_i32 s74, s64, 1280
    s_add_u32 s73, s73, s74
    s_lshl_b32 s74, s45, 8
    s_add_u32 s42, s73, s74
    s_mul_i32 s30, s44, 6
    s_add_u32 s30, s30, 5
    s_mul_i32 s31, s30, 57
    s_lshr_b32 s31, s31, 9
    s_mul_i32 s72, s31, 9
    s_sub_u32 s72, s30, s72
    s_add_u32 s31, s31, s69
    s_lshl_b32 s73, s64, 3
    s_add_u32 s73, s73, s31
    s_lshl_b32 s73, s73, 5
    s_lshl_b32 s74, s51, 4
    s_add_u32 s73, s73, s74
    s_mul_i32 s73, s73, 36864
    s_lshl_b32 s74, s72, 12
    s_add_u32 s37, s73, s74
    s_mul_i32 s73, s31, 144
    s_lshl_b32 s74, s72, 4
    s_add_u32 s73, s73, s74
    s_mul_i32 s73, s73, 2560
    s_mul_i32 s74, s64, 1280
    s_add_u32 s73, s73, s74
    s_lshl_b32 s74, s45, 8
    s_add_u32 s43, s73, s74
    s_mul_i32 s53, s51, 2621440
    v_lshrrev_b32 v116, 4, v245
    v_and_b32 v117, 15, v245
    v_lshlrev_b32 v118, 1, v116
    v_xor_b32 v117, v117, v118
    v_lshlrev_b32 v117, 4, v117
    v_mul_u32_u24 v116, 1280, v116
    v_add_u32 v114, v116, v117
    v_xor_b32 v117, 128, v117
    v_add_u32 v115, v116, v117
    s_waitcnt vmcnt(0) lgkmcnt(0)
    s_barrier
    s_cmp_ge_u32 s44, 6
    s_cbranch_scc1 K1_END
    s_mov_b32 m0, 24576
    s_add_u32 s30, s53, 61440
    buffer_load_dwordx4 v114, s[12:15], s30 offen offset:0 lds
    s_add_u32 s30, s53, 65536
    buffer_load_dwordx4 v115, s[12:15], s30 offen offset:1024 lds
    s_add_u32 s30, s53, 69632
    buffer_load_dwordx4 v114, s[12:15], s30 offen offset:2048 lds
    s_add_u32 s30, s53, 73728
    buffer_load_dwordx4 v115, s[12:15], s30 offen offset:3072 lds
    s_mov_b32 m0, 53248
    s_add_u32 s30, s53, 143360
    buffer_load_dwordx4 v114, s[12:15], s30 offen offset:0 lds
    s_add_u32 s30, s53, 147456
    buffer_load_dwordx4 v115, s[12:15], s30 offen offset:1024 lds
    s_add_u32 s30, s53, 151552
    buffer_load_dwordx4 v114, s[12:15], s30 offen offset:2048 lds
    s_add_u32 s30, s53, 155648
    buffer_load_dwordx4 v115, s[12:15], s30 offen offset:3072 lds
    s_mov_b32 m0, 81920
    s_add_u32 s30, s53, 225280
    buffer_load_dwordx4 v114, s[12:15], s30 offen offset:0 lds
    s_add_u32 s30, s53, 229376
    buffer_load_dwordx4 v115, s[12:15], s30 offen offset:1024 lds
    s_add_u32 s30, s53, 233472
    buffer_load_dwordx4 v114, s[12:15], s30 offen offset:2048 lds
    s_add_u32 s30, s53, 237568
    buffer_load_dwordx4 v115, s[12:15], s30 offen offset:3072 lds
    s_barrier
    s_mov_b32 m0, 9216
    s_add_u32 s30, s36, 1024
    buffer_load_dwordx4 v248, s[16:19], s30 offen lds
    s_mov_b32 m0, 10240
    s_add_u32 s30, s37, 0
    buffer_load_dwordx4 v248, s[16:19], s30 offen lds
    s_mov_b32 m0, 11264
    s_add_u32 s30, s37, 1024
    buffer_load_dwordx4 v248, s[16:19], s30 offen lds
    s_mov_b32 m0, 37888
    s_add_u32 s30, s36, 3072
    buffer_load_dwordx4 v248, s[16:19], s30 offen lds
    s_mov_b32 m0, 38912
    s_add_u32 s30, s37, 2048
    buffer_load_dwordx4 v248, s[16:19], s30 offen lds
    s_mov_b32 m0, 39936
    s_add_u32 s30, s37, 3072
    buffer_load_dwordx4 v248, s[16:19], s30 offen lds
    s_mov_b32 m0, 66560
    s_add_u32 s30, s36, 37888
    buffer_load_dwordx4 v248, s[16:19], s30 offen lds
    s_mov_b32 m0, 67584
    s_add_u32 s30, s37, 36864
    buffer_load_dwordx4 v248, s[16:19], s30 offen lds
    s_mov_b32 m0, 68608
    s_add_u32 s30, s37, 37888
    buffer_load_dwordx4 v248, s[16:19], s30 offen lds
    s_mov_b32 s58, 0
K1W3_TL:
    s_cmp_eq_u32 s58, 0
    s_cbranch_scc0 K1W3_TLw0
    s_waitcnt vmcnt(6)
    s_branch K1W3_TLx0
K1W3_TLw0:
    s_waitcnt vmcnt(14)
K1W3_TLx0:
    s_barrier
    s_mov_b32 m0, 95232
    s_add_u32 s30, s36, 39936
    buffer_load_dwordx4 v248, s[16:19], s30 offen lds
    s_mov_b32 m0, 96256
    s_add_u32 s30, s37, 38912
    buffer_load_dwordx4 v248, s[16:19], s30 offen lds
    s_mov_b32 m0, 97280
    s_add_u32 s30, s37, 39936
    buffer_load_dwordx4 v248, s[16:19], s30 offen lds
    s_mov_b32 m0, 110592
    s_add_u32 s30, s53, 307200
    buffer_load_dwordx4 v114, s[12:15], s30 offen offset:0 lds
    s_add_u32 s30, s53, 311296
    buffer_load_dwordx4 v115, s[12:15], s30 offen offset:1024 lds
    s_add_u32 s30, s53, 315392
    buffer_load_dwordx4 v114, s[12:15], s30 offen offset:2048 lds
    s_add_u32 s30, s53, 319488
    buffer_load_dwordx4 v115, s[12:15], s30 offen offset:3072 lds
    s_cmp_eq_u32 s58, 0
    s_cbranch_scc0 K1W3_TLw1
    s_waitcnt vmcnt(10)
    s_branch K1W3_TLx1
K1W3_TLw1:
    s_waitcnt vmcnt(14)
K1W3_TLx1:
    s_barrier
    s_cmp_eq_u32 s58, 7
    s_cbranch_scc1 K1W3_TLs1
    s_mov_b32 m0, 9216
    s_add_u32 s30, s36, 74752
    buffer_load_dwordx4 v248, s[16:19], s30 offen lds
    s_mov_b32 m0, 10240
    s_add_u32 s30, s37, 73728
    buffer_load_dwordx4 v248, s[16:19], s30 offen lds
    s_mov_b32 m0, 11264
    s_add_u32 s30, s37, 74752
    buffer_load_dwordx4 v248, s[16:19], s30 offen lds
    s_mov_b32 m0, 24576
    s_add_u32 s30, s53, 389120
    buffer_load_dwordx4 v114, s[12:15], s30 offen offset:0 lds
    s_add_u32 s30, s53, 393216
    buffer_load_dwordx4 v115, s[12:15], s30 offen offset:1024 lds
    s_add_u32 s30, s53, 397312
    buffer_load_dwordx4 v114, s[12:15], s30 offen offset:2048 lds
    s_add_u32 s30, s53, 401408
    buffer_load_dwordx4 v115, s[12:15], s30 offen offset:3072 lds
K1W3_TLs1:
    s_cmp_eq_u32 s58, 0
    s_cbranch_scc0 K1W3_TLw2
    s_waitcnt vmcnt(14)
    s_branch K1W3_TLx2
K1W3_TLw2:
    s_cmp_eq_u32 s58, 7
    s_cbranch_scc0 K1W3_TLu2
    s_waitcnt vmcnt(7)
    s_branch K1W3_TLx2
K1W3_TLu2:
    s_waitcnt vmcnt(14)
K1W3_TLx2:
    s_barrier
    s_cmp_eq_u32 s58, 7
    s_cbranch_scc1 K1W3_TLs2
    s_mov_b32 m0, 37888
    s_add_u32 s30, s36, 76800
    buffer_load_dwordx4 v248, s[16:19], s30 offen lds
    s_mov_b32 m0, 38912
    s_add_u32 s30, s37, 75776
    buffer_load_dwordx4 v248, s[16:19], s30 offen lds
    s_mov_b32 m0, 39936
    s_add_u32 s30, s37, 76800
    buffer_load_dwordx4 v248, s[16:19], s30 offen lds
    s_mov_b32 m0, 53248
    s_add_u32 s30, s53, 471040
    buffer_load_dwordx4 v114, s[12:15], s30 offen offset:0 lds
    s_add_u32 s30, s53, 475136
    buffer_load_dwordx4 v115, s[12:15], s30 offen offset:1024 lds
    s_add_u32 s30, s53, 479232
    buffer_load_dwordx4 v114, s[12:15], s30 offen offset:2048 lds
    s_add_u32 s30, s53, 483328
    buffer_load_dwordx4 v115, s[12:15], s30 offen offset:3072 lds
K1W3_TLs2:
    s_cmp_eq_u32 s58, 7
    s_cbranch_scc0 K1W3_TLu3
    s_waitcnt vmcnt(0)
    s_branch K1W3_TLx3
K1W3_TLu3:
    s_waitcnt vmcnt(14)
K1W3_TLx3:
    s_barrier
    s_cmp_eq_u32 s58, 7
    s_cbranch_scc1 K1W3_TLs3
    s_mov_b32 m0, 66560
    s_add_u32 s30, s36, 111616
    buffer_load_dwordx4 v248, s[16:19], s30 offen lds
    s_mov_b32 m0, 67584
    s_add_u32 s30, s37, 110592
    buffer_load_dwordx4 v248, s[16:19], s30 offen lds
    s_mov_b32 m0, 68608
    s_add_u32 s30, s37, 111616
    buffer_load_dwordx4 v248, s[16:19], s30 offen lds
    s_mov_b32 m0, 81920
    s_add_u32 s30, s53, 552960
    buffer_load_dwordx4 v114, s[12:15], s30 offen offset:0 lds
    s_add_u32 s30, s53, 557056
    buffer_load_dwordx4 v115, s[12:15], s30 offen offset:1024 lds
    s_add_u32 s30, s53, 561152
    buffer_load_dwordx4 v114, s[12:15], s30 offen offset:2048 lds
    s_add_u32 s30, s53, 565248
    buffer_load_dwordx4 v115, s[12:15], s30 offen offset:3072 lds
K1W3_TLs3:
    s_add_u32 s32, s32, 73728
    s_add_u32 s33, s33, 73728
    s_add_u32 s34, s34, 73728
    s_add_u32 s35, s35, 73728
    s_add_u32 s36, s36, 73728
    s_add_u32 s37, s37, 73728
    s_add_u32 s53, s53, 327680
    s_add_u32 s58, s58, 1
    s_cmp_lt_u32 s58, 8
    s_cbranch_scc1 K1W3_TL
    s_endpgm
K1W3_slow0:
    s_nop 7
    ds_read_b128 v[196:199], v234 offset:0
    ds_read_b128 v[200:203], v235 offset:0
    ds_read_b128 v[204:207], v236 offset:0
    ds_read_b128 v[208:211], v237 offset:0
    ds_read_b128 v[212:215], v234 offset:4096
    ds_read_b128 v[216:219], v235 offset:4096
    ds_read_b128 v[220:223], v236 offset:4096
    ds_read_b128 v[224:227], v237 offset:4096
    s_waitcnt lgkmcnt(7)
    v_mfma_f32_16x16x32_bf16 v[144:147], v[196:199], v[96:99], 0
    v_mfma_f32_16x16x32_bf16 v[160:163], v[196:199], v[112:115], 0
    s_waitcnt lgkmcnt(6)
    v_mfma_f32_16x16x32_bf16 v[144:147], v[200:203], v[100:103], v[144:147]
    v_mfma_f32_16x16x32_bf16 v[160:163], v[200:203], v[116:119], v[160:163]
    s_waitcnt lgkmcnt(5)
    v_mfma_f32_16x16x32_bf16 v[144:147], v[204:207], v[104:107], v[144:147]
    v_mfma_f32_16x16x32_bf16 v[160:163], v[204:207], v[120:123], v[160:163]
    s_waitcnt lgkmcnt(4)
    v_mfma_f32_16x16x32_bf16 v[144:147], v[208:211], v[108:111], v[144:147]
    v_mfma_f32_16x16x32_bf16 v[160:163], v[208:211], v[124:127], v[160:163]
    ds_read_b128 v[196:199], v234 offset:8192
    ds_read_b128 v[200:203], v235 offset:8192
    ds_read_b128 v[204:207], v236 offset:8192
    ds_read_b128 v[208:211], v237 offset:8192
    s_waitcnt lgkmcnt(7)
    v_mfma_f32_16x16x32_bf16 v[148:151], v[212:215], v[96:99], 0
    v_mfma_f32_16x16x32_bf16 v[164:167], v[212:215], v[112:115], 0
    s_waitcnt lgkmcnt(6)
    v_mfma_f32_16x16x32_bf16 v[148:151], v[216:219], v[100:103], v[148:151]
    v_mfma_f32_16x16x32_bf16 v[164:167], v[216:219], v[116:119], v[164:167]
    s_waitcnt lgkmcnt(5)
    v_mfma_f32_16x16x32_bf16 v[148:151], v[220:223], v[104:107], v[148:151]
    v_mfma_f32_16x16x32_bf16 v[164:167], v[220:223], v[120:123], v[164:167]
    s_waitcnt lgkmcnt(4)
    v_mfma_f32_16x16x32_bf16 v[148:151], v[224:227], v[108:111], v[148:151]
    v_mfma_f32_16x16x32_bf16 v[164:167], v[224:227], v[124:127], v[164:167]
    ds_read_b128 v[212:215], v234 offset:12288
    ds_read_b128 v[216:219], v235 offset:12288
    ds_read_b128 v[220:223], v236 offset:12288
    ds_read_b128 v[224:227], v237 offset:12288
    s_waitcnt lgkmcnt(7)
    v_mfma_f32_16x16x32_bf16 v[152:155], v[196:199], v[96:99], 0
    v_mfma_f32_16x16x32_bf16 v[168:171], v[196:199], v[112:115], 0
    s_waitcnt lgkmcnt(6)
    v_mfma_f32_16x16x32_bf16 v[152:155], v[200:203], v[100:103], v[152:155]
    v_mfma_f32_16x16x32_bf16 v[168:171], v[200:203], v[116:119], v[168:171]
    s_waitcnt lgkmcnt(5)
    v_mfma_f32_16x16x32_bf16 v[152:155], v[204:207], v[104:107], v[152:155]
    v_mfma_f32_16x16x32_bf16 v[168:171], v[204:207], v[120:123], v[168:171]
    s_waitcnt lgkmcnt(4)
    v_mfma_f32_16x16x32_bf16 v[152:155], v[208:211], v[108:111], v[152:155]
    v_mfma_f32_16x16x32_bf16 v[168:171], v[208:211], v[124:127], v[168:171]
    s_waitcnt lgkmcnt(3)
    v_mfma_f32_16x16x32_bf16 v[156:159], v[212:215], v[96:99], 0
    v_mfma_f32_16x16x32_bf16 v[172:175], v[212:215], v[112:115], 0
    s_waitcnt lgkmcnt(2)
    v_mfma_f32_16x16x32_bf16 v[156:159], v[216:219], v[100:103], v[156:159]
    v_mfma_f32_16x16x32_bf16 v[172:175], v[216:219], v[116:119], v[172:175]
    s_waitcnt lgkmcnt(1)
    v_mfma_f32_16x16x32_bf16 v[156:159], v[220:223], v[104:107], v[156:159]
    v_mfma_f32_16x16x32_bf16 v[172:175], v[220:223], v[120:123], v[172:175]
    s_waitcnt lgkmcnt(0)
    v_mfma_f32_16x16x32_bf16 v[156:159], v[224:227], v[108:111], v[156:159]
    v_mfma_f32_16x16x32_bf16 v[172:175], v[224:227], v[124:127], v[172:175]
    v_max3_f32 v243, v144, v145, v146
    v_max3_f32 v243, v243, v147, v148
    v_max3_f32 v243, v243, v149, v150
    v_max3_f32 v243, v243, v151, v152
    v_max3_f32 v243, v243, v153, v154
    s_nop 1
    v_max3_f32 v243, v243, v155, v156
    v_max3_f32 v243, v243, v157, v158
    v_max_f32 v243, v243, v159
    v_mov_b32 v244, v243
    s_nop 1
    v_permlane16_swap_b32 v244, v243
    v_max_f32 v243, v243, v244
    v_mov_b32 v244, v243
    s_nop 1
    v_permlane32_swap_b32 v244, v243
    v_max_f32 v243, v243, v244
    v_sub_f32 v244, 0, v184
    v_max_f32 v243, v243, v244
    v_sub_f32 v244, v244, v243
    v_exp_f32 v244, v244
    v_sub_f32 v184, 0, v243
    v_sub_f32 v185, 0, v243
    v_sub_f32 v186, 0, v243
    v_sub_f32 v187, 0, v243
    v_mul_f32 v0, v0, v244
    v_mul_f32 v1, v1, v244
    v_mul_f32 v2, v2, v244
    v_mul_f32 v3, v3, v244
    v_mul_f32 v4, v4, v244
    v_mul_f32 v5, v5, v244
    v_mul_f32 v6, v6, v244
    v_mul_f32 v7, v7, v244
    v_mul_f32 v8, v8, v244
    v_mul_f32 v9, v9, v244
    v_mul_f32 v10, v10, v244
    v_mul_f32 v11, v11, v244
    v_mul_f32 v12, v12, v244
    v_mul_f32 v13, v13, v244
    v_mul_f32 v14, v14, v244
    v_mul_f32 v15, v15, v244
    v_mul_f32 v16, v16, v244
    v_mul_f32 v17, v17, v244
    v_mul_f32 v18, v18, v244
    v_mul_f32 v19, v19, v244
    v_mul_f32 v20, v20, v244
    v_mul_f32 v21, v21, v244
    v_mul_f32 v22, v22, v244
    v_mul_f32 v23, v23, v244
    v_mul_f32 v24, v24, v244
    v_mul_f32 v25, v25, v244
    v_mul_f32 v26, v26, v244
    v_mul_f32 v27, v27, v244
    v_mul_f32 v28, v28, v244
    v_mul_f32 v29, v29, v244
    v_mul_f32 v30, v30, v244
    v_mul_f32 v31, v31, v244
    v_mul_f32 v228, v228, v244
    v_sub_f32 v144, v144, v243
    v_sub_f32 v145, v145, v243
    v_sub_f32 v146, v146, v243
    v_sub_f32 v147, v147, v243
    v_sub_f32 v148, v148, v243
    v_sub_f32 v149, v149, v243
    v_sub_f32 v150, v150, v243
    v_sub_f32 v151, v151, v243
    v_sub_f32 v152, v152, v243
    v_sub_f32 v153, v153, v243
    v_sub_f32 v154, v154, v243
    v_sub_f32 v155, v155, v243
    v_sub_f32 v156, v156, v243
    v_sub_f32 v157, v157, v243
    v_sub_f32 v158, v158, v243
    v_sub_f32 v159, v159, v243
    v_max3_f32 v243, v160, v161, v162
    v_max3_f32 v243, v243, v163, v164
    v_max3_f32 v243, v243, v165, v166
    v_max3_f32 v243, v243, v167, v168
    v_max3_f32 v243, v243, v169, v170
    v_max3_f32 v243, v243, v171, v172
    v_max3_f32 v243, v243, v173, v174
    v_max_f32 v243, v243, v175
    v_mov_b32 v244, v243
    s_nop 1
    v_permlane16_swap_b32 v244, v243
    v_max_f32 v243, v243, v244
    v_mov_b32 v244, v243
    s_nop 1
    v_permlane32_swap_b32 v244, v243
    v_max_f32 v243, v243, v244
    v_sub_f32 v244, 0, v188
    v_max_f32 v243, v243, v244
    v_sub_f32 v244, v244, v243
    v_exp_f32 v244, v244
    v_sub_f32 v188, 0, v243
    v_sub_f32 v189, 0, v243
    v_sub_f32 v190, 0, v243
    v_sub_f32 v191, 0, v243
    v_mul_f32 v32, v32, v244
    v_mul_f32 v33, v33, v244
    v_mul_f32 v34, v34, v244
    v_mul_f32 v35, v35, v244
    v_mul_f32 v36, v36, v244
    v_mul_f32 v37, v37, v244
    v_mul_f32 v38, v38, v244
    v_mul_f32 v39, v39, v244
    v_mul_f32 v40, v40, v244
    v_mul_f32 v41, v41, v244
    v_mul_f32 v42, v42, v244
    v_mul_f32 v43, v43, v244
    v_mul_f32 v44, v44, v244
    v_mul_f32 v45, v45, v244
    v_mul_f32 v46, v46, v244
    v_mul_f32 v47, v47, v244
    v_mul_f32 v48, v48, v244
    v_mul_f32 v49, v49, v244
    v_mul_f32 v50, v50, v244
    v_mul_f32 v51, v51, v244
    v_mul_f32 v52, v52, v244
    v_mul_f32 v53, v53, v244
    v_mul_f32 v54, v54, v244
    v_mul_f32 v55, v55, v244
    v_mul_f32 v56, v56, v244
    v_mul_f32 v57, v57, v244
    v_mul_f32 v58, v58, v244
    v_mul_f32 v59, v59, v244
    v_mul_f32 v60, v60, v244
    v_mul_f32 v61, v61, v244
    v_mul_f32 v62, v62, v244
    v_mul_f32 v63, v63, v244
    v_mul_f32 v229, v229, v244
    v_sub_f32 v160, v160, v243
    v_sub_f32 v161, v161, v243
    v_sub_f32 v162, v162, v243
    v_sub_f32 v163, v163, v243
    v_sub_f32 v164, v164, v243
    v_sub_f32 v165, v165, v243
    v_sub_f32 v166, v166, v243
    v_sub_f32 v167, v167, v243
    v_sub_f32 v168, v168, v243
    v_sub_f32 v169, v169, v243
    v_sub_f32 v170, v170, v243
    v_sub_f32 v171, v171, v243
    v_sub_f32 v172, v172, v243
    v_sub_f32 v173, v173, v243
    v_sub_f32 v174, v174, v243
    v_sub_f32 v175, v175, v243
    v_exp_f32 v144, v144
    v_exp_f32 v145, v145
    v_exp_f32 v146, v146
    v_exp_f32 v147, v147
    v_exp_f32 v160, v160
    v_exp_f32 v161, v161
    v_exp_f32 v162, v162
    v_exp_f32 v163, v163
    v_exp_f32 v148, v148
    v_exp_f32 v149, v149
    v_exp_f32 v150, v150
    v_exp_f32 v151, v151
    v_exp_f32 v164, v164
    v_exp_f32 v165, v165
    v_exp_f32 v166, v166
    v_exp_f32 v167, v167
    v_add_f32 v231, v144, v145
    v_add_f32 v231, v231, v146
    v_add_f32 v231, v231, v147
    v_add_f32 v232, v160, v161
    v_add_f32 v232, v232, v162
    v_add_f32 v232, v232, v163
    v_add_f32 v231, v231, v148
    v_add_f32 v231, v231, v149
    v_add_f32 v231, v231, v150
    v_add_f32 v231, v231, v151
    v_add_f32 v232, v232, v164
    v_add_f32 v232, v232, v165
    v_add_f32 v232, v232, v166
    v_add_f32 v232, v232, v167
    v_cvt_pk_bf16_f32 v144, v144, v145
    v_cvt_pk_bf16_f32 v145, v146, v147
    v_cvt_pk_bf16_f32 v146, v148, v149
    v_cvt_pk_bf16_f32 v147, v150, v151
    v_cvt_pk_bf16_f32 v160, v160, v161
    v_cvt_pk_bf16_f32 v161, v162, v163
    v_cvt_pk_bf16_f32 v162, v164, v165
    v_cvt_pk_bf16_f32 v163, v166, v167
    s_nop 1
    s_branch K1W3_back0
K1W3_slow1:
    s_nop 7
    ds_read_b128 v[196:199], v234 offset:8192
    ds_read_b128 v[200:203], v235 offset:8192
    ds_read_b128 v[204:207], v236 offset:8192
    ds_read_b128 v[208:211], v237 offset:8192
    ds_read_b128 v[212:215], v234 offset:12288
    ds_read_b128 v[216:219], v235 offset:12288
    ds_read_b128 v[220:223], v236 offset:12288
    ds_read_b128 v[224:227], v237 offset:12288
    s_waitcnt lgkmcnt(7)
    v_mfma_f32_16x16x32_bf16 v[152:155], v[196:199], v[96:99], 0
    v_mfma_f32_16x16x32_bf16 v[168:171], v[196:199], v[112:115], 0
    v_mfma_f32_16x16x32_bf16 v[176:179], v[196:199], v[128:131], 0
    s_waitcnt lgkmcnt(6)
    v_mfma_f32_16x16x32_bf16 v[152:155], v[200:203], v[100:103], v[152:155]
    v_mfma_f32_16x16x32_bf16 v[168:171], v[200:203], v[116:119], v[168:171]
    v_mfma_f32_16x16x32_bf16 v[176:179], v[200:203], v[132:135], v[176:179]
    s_waitcnt lgkmcnt(5)
    v_mfma_f32_16x16x32_bf16 v[152:155], v[204:207], v[104:107], v[152:155]
    v_mfma_f32_16x16x32_bf16 v[168:171], v[204:207], v[120:123], v[168:171]
    v_mfma_f32_16x16x32_bf16 v[176:179], v[204:207], v[136:139], v[176:179]
    s_waitcnt lgkmcnt(4)
    v_mfma_f32_16x16x32_bf16 v[152:155], v[208:211], v[108:111], v[152:155]
    v_mfma_f32_16x16x32_bf16 v[168:171], v[208:211], v[124:127], v[168:171]
    v_mfma_f32_16x16x32_bf16 v[176:179], v[208:211], v[140:143], v[176:179]
    s_waitcnt lgkmcnt(3)
    v_mfma_f32_16x16x32_bf16 v[156:159], v[212:215], v[96:99], 0
    v_mfma_f32_16x16x32_bf16 v[172:175], v[212:215], v[112:115], 0
    v_mfma_f32_16x16x32_bf16 v[180:183], v[212:215], v[128:131], 0
    s_waitcnt lgkmcnt(2)
    v_mfma_f32_16x16x32_bf16 v[156:159], v[216:219], v[100:103], v[156:159]
    v_mfma_f32_16x16x32_bf16 v[172:175], v[216:219], v[116:119], v[172:175]
    v_mfma_f32_16x16x32_bf16 v[180:183], v[216:219], v[132:135], v[180:183]
    s_waitcnt lgkmcnt(1)
    v_mfma_f32_16x16x32_bf16 v[156:159], v[220:223], v[104:107], v[156:159]
    v_mfma_f32_16x16x32_bf16 v[172:175], v[220:223], v[120:123], v[172:175]
    v_mfma_f32_16x16x32_bf16 v[180:183], v[220:223], v[136:139], v[180:183]
    s_waitcnt lgkmcnt(0)
    v_mfma_f32_16x16x32_bf16 v[156:159], v[224:227], v[108:111], v[156:159]
    v_mfma_f32_16x16x32_bf16 v[172:175], v[224:227], v[124:127], v[172:175]
    v_mfma_f32_16x16x32_bf16 v[180:183], v[224:227], v[140:143], v[180:183]
    v_max3_f32 v243, v152, v153, v154
    s_nop 4
    v_max3_f32 v243, v243, v155, v156
    v_max3_f32 v243, v243, v157, v158
    v_max_f32 v243, v243, v159
    v_mov_b32 v244, v243
    s_nop 1
    v_permlane16_swap_b32 v244, v243
    v_max_f32 v243, v243, v244
    v_mov_b32 v244, v243
    s_nop 1
    v_permlane32_swap_b32 v244, v243
    v_max_f32 v243, v243, v244
    v_sub_f32 v244, 0, v184
    v_max_f32 v243, v243, v244
    v_sub_f32 v244, v244, v243
    v_exp_f32 v244, v244
    v_sub_f32 v184, 0, v243
    v_sub_f32 v185, 0, v243
    v_sub_f32 v186, 0, v243
    v_sub_f32 v187, 0, v243
    v_mul_f32 v0, v0, v244
    v_mul_f32 v1, v1, v244
    v_mul_f32 v2, v2, v244
    v_mul_f32 v3, v3, v244
    v_mul_f32 v4, v4, v244
    v_mul_f32 v5, v5, v244
    v_mul_f32 v6, v6, v244
    v_mul_f32 v7, v7, v244
    v_mul_f32 v8, v8, v244
    v_mul_f32 v9, v9, v244
    v_mul_f32 v10, v10, v244
    v_mul_f32 v11, v11, v244
    v_mul_f32 v12, v12, v244
    v_mul_f32 v13, v13, v244
    v_mul_f32 v14, v14, v244
    v_mul_f32 v15, v15, v244
    v_mul_f32 v16, v16, v244
    v_mul_f32 v17, v17, v244
    v_mul_f32 v18, v18, v244
    v_mul_f32 v19, v19, v244
    v_mul_f32 v20, v20, v244
    v_mul_f32 v21, v21, v244
    v_mul_f32 v22, v22, v244
    v_mul_f32 v23, v23, v244
    v_mul_f32 v24, v24, v244
    v_mul_f32 v25, v25, v244
    v_mul_f32 v26, v26, v244
    v_mul_f32 v27, v27, v244
    v_mul_f32 v28, v28, v244
    v_mul_f32 v29, v29, v244
    v_mul_f32 v30, v30, v244
    v_mul_f32 v31, v31, v244
    v_mul_f32 v228, v228, v244
    v_sub_f32 v152, v152, v243
    v_sub_f32 v153, v153, v243
    v_sub_f32 v154, v154, v243
    v_sub_f32 v155, v155, v243
    v_sub_f32 v156, v156, v243
    v_sub_f32 v157, v157, v243
    v_sub_f32 v158, v158, v243
    v_sub_f32 v159, v159, v243
    v_max3_f32 v243, v168, v169, v170
    v_max3_f32 v243, v243, v171, v172
    v_max3_f32 v243, v243, v173, v174
    v_max_f32 v243, v243, v175
    v_mov_b32 v244, v243
    s_nop 1
    v_permlane16_swap_b32 v244, v243
    v_max_f32 v243, v243, v244
    v_mov_b32 v244, v243
    s_nop 1
    v_permlane32_swap_b32 v244, v243
    v_max_f32 v243, v243, v244
    v_sub_f32 v244, 0, v188
    v_max_f32 v243, v243, v244
    v_sub_f32 v244, v244, v243
    v_exp_f32 v244, v244
    v_sub_f32 v188, 0, v243
    v_sub_f32 v189, 0, v243
    v_sub_f32 v190, 0, v243
    v_sub_f32 v191, 0, v243
    v_mul_f32 v32, v32, v244
    v_mul_f32 v33, v33, v244
    v_mul_f32 v34, v34, v244
    v_mul_f32 v35, v35, v244
    v_mul_f32 v36, v36, v244
    v_mul_f32 v37, v37, v244
    v_mul_f32 v38, v38, v244
    v_mul_f32 v39, v39, v244
    v_mul_f32 v40, v40, v244
    v_mul_f32 v41, v41, v244
    v_mul_f32 v42, v42, v244
    v_mul_f32 v43, v43, v244
    v_mul_f32 v44, v44, v244
    v_mul_f32 v45, v45, v244
    v_mul_f32 v46, v46, v244
    v_mul_f32 v47, v47, v244
    v_mul_f32 v48, v48, v244
    v_mul_f32 v49, v49, v244
    v_mul_f32 v50, v50, v244
    v_mul_f32 v51, v51, v244
    v_mul_f32 v52, v52, v244
    v_mul_f32 v53, v53, v244
    v_mul_f32 v54, v54, v244
    v_mul_f32 v55, v55, v244
    v_mul_f32 v56, v56, v244
    v_mul_f32 v57, v57, v244
    v_mul_f32 v58, v58, v244
    v_mul_f32 v59, v59, v244
    v_mul_f32 v60, v60, v244
    v_mul_f32 v61, v61, v244
    v_mul_f32 v62, v62, v244
    v_mul_f32 v63, v63, v244
    v_mul_f32 v229, v229, v244
    v_sub_f32 v168, v168, v243
    v_sub_f32 v169, v169, v243
    v_sub_f32 v170, v170, v243
    v_sub_f32 v171, v171, v243
    v_sub_f32 v172, v172, v243
    v_sub_f32 v173, v173, v243
    v_sub_f32 v174, v174, v243
    v_sub_f32 v175, v175, v243
    v_max3_f32 v243, v176, v177, v178
    v_max3_f32 v243, v243, v179, v180
    v_max3_f32 v243, v243, v181, v182
    v_max_f32 v243, v243, v183
    v_mov_b32 v244, v243
    s_nop 1
    v_permlane16_swap_b32 v244, v243
    v_max_f32 v243, v243, v244
    v_mov_b32 v244, v243
    s_nop 1
    v_permlane32_swap_b32 v244, v243
    v_max_f32 v243, v243, v244
    v_sub_f32 v244, 0, v192
    v_max_f32 v243, v243, v244
    v_sub_f32 v244, v244, v243
    v_exp_f32 v244, v244
    v_sub_f32 v192, 0, v243
    v_sub_f32 v193, 0, v243
    v_sub_f32 v194, 0, v243
    v_sub_f32 v195, 0, v243
    v_mul_f32 v64, v64, v244
    v_mul_f32 v65, v65, v244
    v_mul_f32 v66, v66, v244
    v_mul_f32 v67, v67, v244
    v_mul_f32 v68, v68, v244
    v_mul_f32 v69, v69, v244
    v_mul_f32 v70, v70, v244
    v_mul_f32 v71, v71, v244
    v_mul_f32 v72, v72, v244
    v_mul_f32 v73, v73, v244
    v_mul_f32 v74, v74, v244
    v_mul_f32 v75, v75, v244
    v_mul_f32 v76, v76, v244
    v_mul_f32 v77, v77, v244
    v_mul_f32 v78, v78, v244
    v_mul_f32 v79, v79, v244
    v_mul_f32 v80, v80, v244
    v_mul_f32 v81, v81, v244
    v_mul_f32 v82, v82, v244
    v_mul_f32 v83, v83, v244
    v_mul_f32 v84, v84, v244
    v_mul_f32 v85, v85, v244
    v_mul_f32 v86, v86, v244
    v_mul_f32 v87, v87, v244
    v_mul_f32 v88, v88, v244
    v_mul_f32 v89, v89, v244
    v_mul_f32 v90, v90, v244
    v_mul_f32 v91, v91, v244
    v_mul_f32 v92, v92, v244
    v_mul_f32 v93, v93, v244
    v_mul_f32 v94, v94, v244
    v_mul_f32 v95, v95, v244
    v_mul_f32 v230, v230, v244
    v_sub_f32 v176, v176, v243
    v_sub_f32 v177, v177, v243
    v_sub_f32 v178, v178, v243
    v_sub_f32 v179, v179, v243
    v_sub_f32 v180, v180, v243
    v_sub_f32 v181, v181, v243
    v_sub_f32 v182, v182, v243
    v_sub_f32 v183, v183, v243
    v_exp_f32 v152, v152
    v_exp_f32 v153, v153
    v_exp_f32 v154, v154
    v_exp_f32 v155, v155
    v_exp_f32 v168, v168
    v_exp_f32 v169, v169
    v_exp_f32 v170, v170
    v_exp_f32 v171, v171
    v_exp_f32 v176, v176
    v_exp_f32 v177, v177
    v_exp_f32 v178, v178
    v_exp_f32 v179, v179
    v_exp_f32 v156, v156
    v_exp_f32 v157, v157
    v_exp_f32 v158, v158
    v_exp_f32 v159, v159
    v_exp_f32 v172, v172
    v_exp_f32 v173, v173
    v_exp_f32 v174, v174
    v_exp_f32 v175, v175
    v_exp_f32 v180, v180
    v_exp_f32 v181, v181
    v_exp_f32 v182, v182
    v_exp_f32 v183, v183
    v_add_f32 v231, v152, v153
    v_add_f32 v231, v231, v154
    v_add_f32 v231, v231, v155
    v_add_f32 v232, v168, v169
    v_add_f32 v232, v232, v170
    v_add_f32 v232, v232, v171
    v_add_f32 v233, v176, v177
    v_add_f32 v233, v233, v178
    v_add_f32 v233, v233, v179
    v_add_f32 v231, v231, v156
    v_add_f32 v231, v231, v157
    v_add_f32 v231, v231, v158
    v_add_f32 v231, v231, v159
    v_add_f32 v232, v232, v172
    v_add_f32 v232, v232, v173
    v_add_f32 v232, v232, v174
    v_add_f32 v232, v232, v175
    v_add_f32 v233, v233, v180
    v_add_f32 v233, v233, v181
    v_add_f32 v233, v233, v182
    v_add_f32 v233, v233, v183
    v_cvt_pk_bf16_f32 v148, v152, v153
    v_cvt_pk_bf16_f32 v149, v154, v155
    v_cvt_pk_bf16_f32 v150, v156, v157
    v_cvt_pk_bf16_f32 v151, v158, v159
    v_cvt_pk_bf16_f32 v164, v168, v169
    v_cvt_pk_bf16_f32 v165, v170, v171
    v_cvt_pk_bf16_f32 v166, v172, v173
    v_cvt_pk_bf16_f32 v167, v174, v175
    v_cvt_pk_bf16_f32 v176, v176, v177
    v_cvt_pk_bf16_f32 v177, v178, v179
    v_cvt_pk_bf16_f32 v178, v180, v181
    v_cvt_pk_bf16_f32 v179, v182, v183
    ds_read_b64_tr_b16 v[196:197], v238 offset:8192
    ds_read_b64_tr_b16 v[198:199], v238 offset:12288
    v_xor_b32 v240, 32, v238
    ds_read_b64_tr_b16 v[200:201], v240 offset:8192
    ds_read_b64_tr_b16 v[202:203], v240 offset:12288
    v_xor_b32 v239, 64, v238
    ds_read_b64_tr_b16 v[204:205], v239 offset:8192
    ds_read_b64_tr_b16 v[206:207], v239 offset:12288
    v_xor_b32 v240, 96, v238
    ds_read_b64_tr_b16 v[208:209], v240 offset:8192
    ds_read_b64_tr_b16 v[210:211], v240 offset:12288
    v_xor_b32 v239, 128, v238
    ds_read_b64_tr_b16 v[212:213], v239 offset:8192
    ds_read_b64_tr_b16 v[214:215], v239 offset:12288
    v_xor_b32 v240, 160, v238
    ds_read_b64_tr_b16 v[216:217], v240 offset:8192
    ds_read_b64_tr_b16 v[218:219], v240 offset:12288
    v_xor_b32 v239, 192, v238
    ds_read_b64_tr_b16 v[220:221], v239 offset:8192
    ds_read_b64_tr_b16 v[222:223], v239 offset:12288
    v_xor_b32 v240, 224, v238
    ds_read_b64_tr_b16 v[224:225], v240 offset:8192
    ds_read_b64_tr_b16 v[226:227], v240 offset:12288
    s_waitcnt lgkmcnt(0)
    s_nop 1
    s_branch K1W3_back1
K1_END:
    s_endpgm

.section .rodata,"a"
.p2align 6
.amdhsa_kernel concat_heads__mha_block_cached__gqa_block_cached__near_ridge_kernel
  .amdhsa_next_free_vgpr 256
  .amdhsa_next_free_sgpr 100
  .amdhsa_accum_offset 256
  .amdhsa_group_segment_fixed_size 0
  .amdhsa_kernarg_size 104
  .amdhsa_user_sgpr_count 2
  .amdhsa_user_sgpr_kernarg_segment_ptr 1
  .amdhsa_system_sgpr_workgroup_id_x 1
.end_amdhsa_kernel
```
